```python
import torch

def _softmax(x, axis=-1):
    return torch.softmax(x, dim=axis)

def _gelu(x):
    return torch.nn.functional.gelu(x, approximate='tanh')

def _silu(x):
    return torch.nn.functional.silu(x)

def _sigmoid(x):
    return torch.sigmoid(x)

def _layernorm(x, axis=-1, eps=1e-05):
    m = x.mean(dim=axis, keepdim=True)
    v = x.var(dim=axis, keepdim=True, unbiased=False)
    return (x - m) / torch.sqrt(v + eps)

def _scatter_add(tgt, idx, src, axis=0):
    return tgt.clone().index_add_(axis, idx, src)

def _segment_sum(src, seg, n):
    out = torch.zeros((n,) + src.shape[1:], dtype=src.dtype)
    return out.index_add_(0, seg, src)

def _pad(x, pw):
    flat = tuple((v for pair in reversed(pw) for v in pair))
    return torch.nn.functional.pad(x, flat)
kernel_name = 'interleave_layers__memory_aug_recurrent_mem_tr__mixer_channel_mlp__prompt'

def setup_inputs():

    _w = lambda a: (lambda t: t.to(torch.bfloat16) if t.is_floating_point() else t)(torch.as_tensor(a))

    def _A_setup():
        B, S, Dm = (1, 2048, 448)
        H, Dh = (16, 256)
        M, seg = (8, 32)
        seg = min(seg, S)
        S = S // seg * seg
        return {'x': _w((lambda *s: torch.randn(*s, dtype=torch.bfloat16) * 0.05)(B, S, Dm)), 'mem0': _w((lambda *s: torch.randn(*s, dtype=torch.bfloat16) * 0.8)(B, M, Dm)), 'Wq': _w((lambda *s: torch.randn(*s, dtype=torch.bfloat16) * 1.6)(Dm, H, Dh) * Dm ** (-0.5)), 'Wk': _w((lambda *s: torch.randn(*s, dtype=torch.bfloat16) * 1.6)(Dm, H, Dh) * Dm ** (-0.5)), 'Wv': _w((lambda *s: torch.randn(*s, dtype=torch.bfloat16) * 0.8)(Dm, H, Dh) * Dm ** (-0.5)), 'Wo': _w((lambda *s: torch.randn(*s, dtype=torch.bfloat16) * 0.8)(H, Dh, Dm) * (H * Dh) ** (-0.5)), 'seg_len': seg}
    _A_in = _A_setup()

    def _B_setup():
        B, S, D, F = (1, 2048, 448, 1792)
        return {'x': _w((lambda *s: torch.randn(*s, dtype=torch.bfloat16) * 0.05)(B, S, D)), 'w1': _w((lambda *s: torch.randn(*s, dtype=torch.bfloat16) * 3.2)(D, F) * D ** (-0.5)), 'b1': _w((lambda *s: torch.randn(*s, dtype=torch.bfloat16) * 1.6)(F)), 'w2': _w((lambda *s: torch.randn(*s, dtype=torch.bfloat16) * 0.1)(F, D) * F ** (-0.5)), 'b2': _w((lambda *s: torch.randn(*s, dtype=torch.bfloat16) * 0.1)(D))}
    _B_in = _B_setup()
    return {'A_x': _A_in['x'], 'A_mem0': _A_in['mem0'], 'A_Wq': _A_in['Wq'], 'A_Wk': _A_in['Wk'], 'A_Wv': _A_in['Wv'], 'A_Wo': _A_in['Wo'], 'A_seg_len': _A_in['seg_len'], 'B_x': _B_in['x'], 'B_w1': _B_in['w1'], 'B_b1': _B_in['b1'], 'B_w2': _B_in['w2'], 'B_b2': _B_in['b2']}

def reference(A_x, A_mem0, A_Wq, A_Wk, A_Wv, A_Wo, A_seg_len, B_x, B_w1, B_b1, B_w2, B_b2):

    def _A_ref(x, mem0, Wq, Wk, Wv, Wo, seg_len):
        B, S, Dm = x.shape
        H, Dh = (Wq.shape[1], Wq.shape[2])
        M = mem0.shape[1]
        scale = Dh ** (-0.5)
        n_seg = S // seg_len
        L = M + seg_len
        idx = torch.arange(L)
        mask = (idx[:, None] < M) | (idx[:, None] >= idx[None, :])
        mem = mem0
        outs = []
        for s in range(n_seg):
            xs = x[:, s * seg_len:(s + 1) * seg_len, :].clone()
            h = torch.concatenate([mem, xs], axis=1)
            q = torch.einsum('btd,dhe->bhte', h, Wq)
            k = torch.einsum('btd,dhe->bhte', h, Wk)
            v = torch.einsum('btd,dhe->bhte', h, Wv)
            scores = torch.einsum('bhqe,bhke->bhqk', q, k) * scale
            scores = torch.where(mask[None, None], scores, -1000000000.0)
            p = _softmax(scores, axis=-1)
            o = torch.einsum('bhqk,bhke->bhqe', p, v)
            o = torch.einsum('bhte,hed->btd', o, Wo)
            mem = o[:, :M, :].clone()
            outs.append(o[:, M:, :])
        return torch.concatenate(outs, axis=1)

    def _B_ref(x, w1, b1, w2, b2):
        y = _layernorm(x, axis=-1)
        h = _gelu(torch.einsum('bsd,df->bsf', y, w1) + b1)
        return torch.einsum('bsf,fd->bsd', h, w2) + b2
    x = A_x
    x = x + _A_ref(_layernorm(x, axis=-1), A_mem0, A_Wq, A_Wk, A_Wv, A_Wo, A_seg_len)
    x = x + _B_ref(_layernorm(x, axis=-1), B_w1, B_b1, B_w2, B_b2)
    x = x + _A_ref(_layernorm(x, axis=-1), A_mem0, A_Wq, A_Wk, A_Wv, A_Wo, A_seg_len)
    x = x + _B_ref(_layernorm(x, axis=-1), B_w1, B_b1, B_w2, B_b2)
    return x
```

```asm
; @launch grid=(256,1,1) block=(256,1,1) lds=163840
.amdgcn_target "amdgcn-amd-amdhsa--gfx950"
.text
.globl interleave_layers__memory_aug_recurrent_mem_tr__mixer_channel_mlp__prompt_kernel
.p2align 8
.type interleave_layers__memory_aug_recurrent_mem_tr__mixer_channel_mlp__prompt_kernel,@function
interleave_layers__memory_aug_recurrent_mem_tr__mixer_channel_mlp__prompt_kernel:
Lstart:
    s_cmp_ge_u32 s2, 256
    s_cbranch_scc1 Lend
    s_load_dwordx2 s[4:5], s[0:1], 0
    s_load_dwordx2 s[6:7], s[0:1], 112
    s_load_dwordx8 s[36:43], s[0:1], 64
    s_load_dwordx4 s[44:47], s[0:1], 96
    s_load_dwordx8 s[92:99], s[0:1], 16
    s_load_dwordx2 s[100:101], s[0:1], 8
    s_getreg_b32 s21, hwreg(HW_REG_XCC_ID)
    s_and_b32 s21, s21, 7
    v_lshrrev_b32 v2, 6, v0
    v_and_b32 v0, 63, v0
    v_readfirstlane_b32 s20, v2
    v_mov_b32 v3, 0
    s_getpc_b64 s[12:13]
    s_and_b32 s12, s12, 0xffffff00
    s_mov_b32 s14, Lend-Lstart
    s_mov_b32 s15, 0x20000
    s_lshr_b32 s16, s2, 3
    s_and_b32 s16, s16, 3
    s_lshl_b32 s16, s16, 2
    s_add_u32 s16, s16, s20
    s_lshl_b32 s16, s16, 13
    v_lshlrev_b32 v8, 7, v0
    buffer_load_dword v119, v8, s[12:15], s16 offen
    s_waitcnt lgkmcnt(0)
    s_cmp_lg_u32 s20, 0
    s_cbranch_scc1 Lnorank
    s_lshl_b32 s22, s21, 5
    v_mov_b32 v4, s22
    v_mov_b32 v5, 1
    s_mov_b64 exec, 1
    global_atomic_add v6, v4, v5, s[46:47] sc0
    s_waitcnt vmcnt(0)
    ds_write_b32 v3, v6
    s_waitcnt lgkmcnt(0)
    s_mov_b64 exec, -1
Lnorank:
    s_barrier
    ds_read_b32 v6, v3
    s_mov_b32 s8, s6
    s_mov_b32 s9, s7
    s_mov_b32 s10, 38690816
    s_mov_b32 s11, 0x20000
    s_lshr_b32 s23, s21, 2
    s_and_b32 s24, s21, 3
    v_lshlrev_b32 v1, 4, v0
    s_mul_i32 s30, s21, 393216
    s_add_u32 s30, s30, 1064960
    s_mul_i32 s31, s21, 1835008
    s_add_u32 s31, s31, 19808256
    s_waitcnt lgkmcnt(0)
    v_readfirstlane_b32 s22, v6
    s_barrier
    s_cmp_ge_u32 s22, 32
    s_cbranch_scc1 Lend
    s_lshl_b32 s48, s22, 12
    s_lshl_b32 s49, s20, 10
    s_add_u32 s48, s48, s49
    s_add_u32 s48, s48, s30
    s_lshl_b32 s35, s21, 9
    s_add_u32 s35, s35, 34492416
    v_mov_b32 v8, -1
    v_mov_b32 v9, -1
    v_mov_b32 v10, -1
    v_mov_b32 v11, -1
    buffer_store_dwordx4 v[8:11], v1, s[8:11], s48 offen
    s_add_u32 s48, s48, 131072
    buffer_store_dwordx4 v[8:11], v1, s[8:11], s48 offen
    s_add_u32 s48, s48, 131072
    buffer_store_dwordx4 v[8:11], v1, s[8:11], s48 offen
    s_cmp_lt_u32 s21, 3
    s_cbranch_scc1 Lattn
    s_cmp_eq_u32 s21, 3
    s_cbranch_scc1 Lln
    s_cmp_ge_u32 s22, 28
    s_cbranch_scc1 Lnobt
    s_mov_b32 s12, s96
    s_mov_b32 s13, s97
    s_mov_b32 s14, 3670016
    s_mov_b32 s15, 0x20000
    s_mov_b32 s16, s98
    s_mov_b32 s17, s99
    s_mov_b32 s18, 3670016
    s_mov_b32 s19, 0x20000
    s_mul_i32 s48, s22, 37
    s_lshr_b32 s48, s48, 8
    s_mul_i32 s49, s48, 7
    s_sub_u32 s49, s22, s49
    s_and_b32 s50, s21, 3
    s_lshl_b32 s50, s50, 2
    s_add_u32 s50, s50, s48
    v_lshrrev_b32 v2, 3, v0
    v_mul_u32_u24 v2, 896, v2
    v_and_b32 v4, 7, v0
    v_bfe_u32 v5, v0, 4, 1
    v_lshlrev_b32 v5, 1, v5
    v_xor_b32 v4, v4, v5
    v_xor_b32 v5, 4, v4
    v_lshl_add_u32 v4, v4, 4, v2
    v_lshl_add_u32 v5, v5, 4, v2
    s_mul_i32 s51, s50, 229376
    s_mul_i32 s52, s20, 57344
    s_add_u32 s51, s51, s52
    s_lshl_b32 s52, s49, 7
    s_add_u32 s51, s51, s52
    s_lshl_b32 s52, s20, 13
    s_mov_b32 m0, s52
    s_nop 0
    buffer_load_dwordx4 v4, s[16:19], s51 offen nt lds
    s_add_u32 s51, s51, 7168
    s_add_u32 m0, m0, 1024
    s_nop 0
    buffer_load_dwordx4 v5, s[16:19], s51 offen nt lds
    s_add_u32 s51, s51, 7168
    s_add_u32 m0, m0, 1024
    s_nop 0
    buffer_load_dwordx4 v4, s[16:19], s51 offen nt lds
    s_add_u32 s51, s51, 7168
    s_add_u32 m0, m0, 1024
    s_nop 0
    buffer_load_dwordx4 v5, s[16:19], s51 offen nt lds
    s_add_u32 s51, s51, 7168
    s_add_u32 m0, m0, 1024
    s_nop 0
    buffer_load_dwordx4 v4, s[16:19], s51 offen nt lds
    s_add_u32 s51, s51, 7168
    s_add_u32 m0, m0, 1024
    s_nop 0
    buffer_load_dwordx4 v5, s[16:19], s51 offen nt lds
    s_add_u32 s51, s51, 7168
    s_add_u32 m0, m0, 1024
    s_nop 0
    buffer_load_dwordx4 v4, s[16:19], s51 offen nt lds
    s_add_u32 s51, s51, 7168
    s_add_u32 m0, m0, 1024
    s_nop 0
    buffer_load_dwordx4 v5, s[16:19], s51 offen nt lds
    v_lshrrev_b32 v112, 5, v0
    v_and_b32 v3, 31, v0
    v_xor_b32 v3, v3, v112
    v_lshlrev_b32 v3, 4, v3
    v_lshl_add_u32 v3, v112, 13, v3
    s_lshl_b32 s53, s49, 6
    s_add_u32 s53, s53, s50
    s_mul_i32 s53, s53, 14336
    s_add_u32 s53, s53, 13385728
    s_lshl_b32 s57, s50, 9
    s_lshl_b32 s60, s49, 1
    s_add_u32 s60, s60, s20
    s_add_u32 s61, s60, 4
    s_add_u32 s62, s60, 8
    s_add_u32 s63, s60, 12
    s_lshl_b32 s55, s20, 15
    s_add_u32 s55, s55, 32768
    s_sub_u32 s52, s60, 14
    s_cselect_b32 s60, s60, s52
    s_sub_u32 s52, s61, 14
    s_cselect_b32 s61, s61, s52
    s_sub_u32 s52, s62, 14
    s_cselect_b32 s62, s62, s52
    s_sub_u32 s52, s63, 14
    s_cselect_b32 s63, s63, s52
    s_cmp_ge_u32 s20, 2
    s_cselect_b32 s63, 14, s63
    s_add_u32 m0, s55, 0
    s_lshl_b32 s51, s60, 18
    s_add_u32 s51, s51, s57
    v_xor_b32 v6, 0, v3
    buffer_load_dwordx4 v6, s[12:15], s51 offen nt lds
    s_add_u32 s51, s51, 16384
    s_add_u32 m0, m0, 1024
    v_xor_b32 v6, 32, v3
    buffer_load_dwordx4 v6, s[12:15], s51 offen nt lds
    s_add_u32 s51, s51, 16384
    s_add_u32 m0, m0, 1024
    v_xor_b32 v6, 0, v3
    buffer_load_dwordx4 v6, s[12:15], s51 offen nt lds
    s_add_u32 s51, s51, 16384
    s_add_u32 m0, m0, 1024
    v_xor_b32 v6, 32, v3
    buffer_load_dwordx4 v6, s[12:15], s51 offen nt lds
    s_add_u32 s51, s51, 16384
    s_add_u32 m0, m0, 1024
    v_xor_b32 v6, 64, v3
    buffer_load_dwordx4 v6, s[12:15], s51 offen nt lds
    s_add_u32 s51, s51, 16384
    s_add_u32 m0, m0, 1024
    v_xor_b32 v6, 96, v3
    buffer_load_dwordx4 v6, s[12:15], s51 offen nt lds
    s_add_u32 s51, s51, 16384
    s_add_u32 m0, m0, 1024
    v_xor_b32 v6, 64, v3
    buffer_load_dwordx4 v6, s[12:15], s51 offen nt lds
    s_add_u32 s51, s51, 16384
    s_add_u32 m0, m0, 1024
    v_xor_b32 v6, 96, v3
    buffer_load_dwordx4 v6, s[12:15], s51 offen nt lds
    s_add_u32 s51, s51, 16384
    s_add_u32 m0, m0, 1024
    v_xor_b32 v6, 128, v3
    buffer_load_dwordx4 v6, s[12:15], s51 offen nt lds
    s_add_u32 s51, s51, 16384
    s_add_u32 m0, m0, 1024
    v_xor_b32 v6, 160, v3
    buffer_load_dwordx4 v6, s[12:15], s51 offen nt lds
    s_add_u32 s51, s51, 16384
    s_add_u32 m0, m0, 1024
    v_xor_b32 v6, 128, v3
    buffer_load_dwordx4 v6, s[12:15], s51 offen nt lds
    s_add_u32 s51, s51, 16384
    s_add_u32 m0, m0, 1024
    v_xor_b32 v6, 160, v3
    buffer_load_dwordx4 v6, s[12:15], s51 offen nt lds
    s_add_u32 s51, s51, 16384
    s_add_u32 m0, m0, 1024
    v_xor_b32 v6, 192, v3
    buffer_load_dwordx4 v6, s[12:15], s51 offen nt lds
    s_add_u32 s51, s51, 16384
    s_add_u32 m0, m0, 1024
    v_xor_b32 v6, 224, v3
    buffer_load_dwordx4 v6, s[12:15], s51 offen nt lds
    s_add_u32 s51, s51, 16384
    s_add_u32 m0, m0, 1024
    v_xor_b32 v6, 192, v3
    buffer_load_dwordx4 v6, s[12:15], s51 offen nt lds
    s_add_u32 s51, s51, 16384
    s_add_u32 m0, m0, 1024
    v_xor_b32 v6, 224, v3
    buffer_load_dwordx4 v6, s[12:15], s51 offen nt lds
    v_and_b32 v112, 15, v0
    v_lshrrev_b32 v113, 4, v0
    v_xor_b32 v113, v112, v113
    v_lshlrev_b32 v113, 4, v113
    v_lshrrev_b32 v114, 2, v112
    v_lshlrev_b32 v114, 3, v114
    v_and_b32 v112, 3, v112
    v_add_u32 v114, v114, v112
    v_lshl_add_u32 v12, v114, 9, v113
    v_xor_b32 v13, 64, v12
    v_xor_b32 v14, 128, v12
    v_xor_b32 v15, 192, v12
    v_add_u32 v12, s55, v12
    v_add_u32 v13, s55, v13
    v_add_u32 v14, s55, v14
    v_add_u32 v15, s55, v15
    v_lshrrev_b32 v4, 4, v0
    v_bfe_u32 v5, v0, 2, 2
    v_lshl_add_u32 v7, v4, 3, v5
    v_lshlrev_b32 v7, 7, v7
    v_and_b32 v2, 3, v0
    v_lshl_add_u32 v7, v2, 3, v7
    v_and_b32 v4, 1, v4
    v_lshrrev_b32 v5, 1, v5
    v_lshl_add_u32 v4, v4, 1, v5
    v_lshl_add_u32 v16, v4, 5, v7
    v_xor_b32 v17, 32, v16
    v_xor_b32 v18, 64, v16
    v_xor_b32 v19, 96, v16
    s_waitcnt vmcnt(16)
    s_barrier
    ds_read_b64_tr_b16 v[64:65], v16 offset:0
    ds_read_b64_tr_b16 v[66:67], v16 offset:512
    s_add_u32 m0, s55, 16384
    s_lshl_b32 s51, s61, 18
    s_add_u32 s51, s51, s57
    ds_read_b64_tr_b16 v[96:97], v17 offset:0
    ds_read_b64_tr_b16 v[98:99], v17 offset:512
    v_xor_b32 v6, 0, v3
    buffer_load_dwordx4 v6, s[12:15], s51 offen nt lds
    ds_read_b64_tr_b16 v[128:129], v18 offset:0
    ds_read_b64_tr_b16 v[130:131], v18 offset:512
    s_add_u32 s51, s51, 16384
    s_add_u32 m0, m0, 1024
    ds_read_b64_tr_b16 v[160:161], v19 offset:0
    ds_read_b64_tr_b16 v[162:163], v19 offset:512
    v_xor_b32 v6, 32, v3
    buffer_load_dwordx4 v6, s[12:15], s51 offen nt lds
    ds_read_b64_tr_b16 v[68:69], v16 offset:4096
    ds_read_b64_tr_b16 v[70:71], v16 offset:4608
    s_add_u32 s51, s51, 16384
    s_add_u32 m0, m0, 1024
    ds_read_b64_tr_b16 v[100:101], v17 offset:4096
    ds_read_b64_tr_b16 v[102:103], v17 offset:4608
    v_xor_b32 v6, 0, v3
    buffer_load_dwordx4 v6, s[12:15], s51 offen nt lds
    ds_read_b64_tr_b16 v[132:133], v18 offset:4096
    ds_read_b64_tr_b16 v[134:135], v18 offset:4608
    s_add_u32 s51, s51, 16384
    s_add_u32 m0, m0, 1024
    ds_read_b64_tr_b16 v[164:165], v19 offset:4096
    ds_read_b64_tr_b16 v[166:167], v19 offset:4608
    v_xor_b32 v6, 32, v3
    buffer_load_dwordx4 v6, s[12:15], s51 offen nt lds
    ds_read_b64_tr_b16 v[72:73], v16 offset:8192
    ds_read_b64_tr_b16 v[74:75], v16 offset:8704
    s_add_u32 s51, s51, 16384
    s_add_u32 m0, m0, 1024
    ds_read_b64_tr_b16 v[104:105], v17 offset:8192
    ds_read_b64_tr_b16 v[106:107], v17 offset:8704
    v_xor_b32 v6, 64, v3
    buffer_load_dwordx4 v6, s[12:15], s51 offen nt lds
    ds_read_b64_tr_b16 v[136:137], v18 offset:8192
    ds_read_b64_tr_b16 v[138:139], v18 offset:8704
    s_add_u32 s51, s51, 16384
    s_add_u32 m0, m0, 1024
    ds_read_b64_tr_b16 v[168:169], v19 offset:8192
    ds_read_b64_tr_b16 v[170:171], v19 offset:8704
    v_xor_b32 v6, 96, v3
    buffer_load_dwordx4 v6, s[12:15], s51 offen nt lds
    ds_read_b64_tr_b16 v[76:77], v16 offset:12288
    ds_read_b64_tr_b16 v[78:79], v16 offset:12800
    s_add_u32 s51, s51, 16384
    s_add_u32 m0, m0, 1024
    ds_read_b64_tr_b16 v[108:109], v17 offset:12288
    ds_read_b64_tr_b16 v[110:111], v17 offset:12800
    v_xor_b32 v6, 64, v3
    buffer_load_dwordx4 v6, s[12:15], s51 offen nt lds
    ds_read_b64_tr_b16 v[140:141], v18 offset:12288
    ds_read_b64_tr_b16 v[142:143], v18 offset:12800
    s_add_u32 s51, s51, 16384
    s_add_u32 m0, m0, 1024
    ds_read_b64_tr_b16 v[172:173], v19 offset:12288
    ds_read_b64_tr_b16 v[174:175], v19 offset:12800
    v_xor_b32 v6, 96, v3
    buffer_load_dwordx4 v6, s[12:15], s51 offen nt lds
    ds_read_b64_tr_b16 v[80:81], v16 offset:16384
    ds_read_b64_tr_b16 v[82:83], v16 offset:16896
    s_add_u32 s51, s51, 16384
    s_add_u32 m0, m0, 1024
    ds_read_b64_tr_b16 v[112:113], v17 offset:16384
    ds_read_b64_tr_b16 v[114:115], v17 offset:16896
    v_xor_b32 v6, 128, v3
    buffer_load_dwordx4 v6, s[12:15], s51 offen nt lds
    ds_read_b64_tr_b16 v[144:145], v18 offset:16384
    ds_read_b64_tr_b16 v[146:147], v18 offset:16896
    s_add_u32 s51, s51, 16384
    s_add_u32 m0, m0, 1024
    ds_read_b64_tr_b16 v[176:177], v19 offset:16384
    ds_read_b64_tr_b16 v[178:179], v19 offset:16896
    v_xor_b32 v6, 160, v3
    buffer_load_dwordx4 v6, s[12:15], s51 offen nt lds
    ds_read_b64_tr_b16 v[84:85], v16 offset:20480
    ds_read_b64_tr_b16 v[86:87], v16 offset:20992
    s_add_u32 s51, s51, 16384
    s_add_u32 m0, m0, 1024
    ds_read_b64_tr_b16 v[116:117], v17 offset:20480
    ds_read_b64_tr_b16 v[118:119], v17 offset:20992
    v_xor_b32 v6, 128, v3
    buffer_load_dwordx4 v6, s[12:15], s51 offen nt lds
    ds_read_b64_tr_b16 v[148:149], v18 offset:20480
    ds_read_b64_tr_b16 v[150:151], v18 offset:20992
    s_add_u32 s51, s51, 16384
    s_add_u32 m0, m0, 1024
    ds_read_b64_tr_b16 v[180:181], v19 offset:20480
    ds_read_b64_tr_b16 v[182:183], v19 offset:20992
    v_xor_b32 v6, 160, v3
    buffer_load_dwordx4 v6, s[12:15], s51 offen nt lds
    ds_read_b64_tr_b16 v[88:89], v16 offset:24576
    ds_read_b64_tr_b16 v[90:91], v16 offset:25088
    s_add_u32 s51, s51, 16384
    s_add_u32 m0, m0, 1024
    ds_read_b64_tr_b16 v[120:121], v17 offset:24576
    ds_read_b64_tr_b16 v[122:123], v17 offset:25088
    v_xor_b32 v6, 192, v3
    buffer_load_dwordx4 v6, s[12:15], s51 offen nt lds
    ds_read_b64_tr_b16 v[152:153], v18 offset:24576
    ds_read_b64_tr_b16 v[154:155], v18 offset:25088
    s_add_u32 s51, s51, 16384
    s_add_u32 m0, m0, 1024
    ds_read_b64_tr_b16 v[184:185], v19 offset:24576
    ds_read_b64_tr_b16 v[186:187], v19 offset:25088
    v_xor_b32 v6, 224, v3
    buffer_load_dwordx4 v6, s[12:15], s51 offen nt lds
    ds_read_b64_tr_b16 v[92:93], v16 offset:28672
    ds_read_b64_tr_b16 v[94:95], v16 offset:29184
    s_add_u32 s51, s51, 16384
    s_add_u32 m0, m0, 1024
    ds_read_b64_tr_b16 v[124:125], v17 offset:28672
    ds_read_b64_tr_b16 v[126:127], v17 offset:29184
    v_xor_b32 v6, 192, v3
    buffer_load_dwordx4 v6, s[12:15], s51 offen nt lds
    ds_read_b64_tr_b16 v[156:157], v18 offset:28672
    ds_read_b64_tr_b16 v[158:159], v18 offset:29184
    s_add_u32 s51, s51, 16384
    s_add_u32 m0, m0, 1024
    ds_read_b64_tr_b16 v[188:189], v19 offset:28672
    ds_read_b64_tr_b16 v[190:191], v19 offset:29184
    v_xor_b32 v6, 224, v3
    buffer_load_dwordx4 v6, s[12:15], s51 offen nt lds
    s_waitcnt vmcnt(16)
    ds_read_b128 v[192:195], v12 offset:0
    ds_read_b128 v[196:199], v12 offset:2048
    ds_read_b128 v[200:203], v13 offset:0
    ds_read_b128 v[204:207], v13 offset:2048
    ds_read_b128 v[208:211], v14 offset:0
    ds_read_b128 v[212:215], v14 offset:2048
    ds_read_b128 v[216:219], v15 offset:0
    ds_read_b128 v[220:223], v15 offset:2048
    ds_read_b128 v[224:227], v12 offset:256
    ds_read_b128 v[228:231], v12 offset:2304
    ds_read_b128 v[232:235], v13 offset:256
    ds_read_b128 v[236:239], v13 offset:2304
    ds_read_b128 v[240:243], v14 offset:256
    ds_read_b128 v[244:247], v14 offset:2304
    ds_read_b128 v[248:251], v15 offset:256
    ds_read_b128 v[252:255], v15 offset:2304
    s_waitcnt lgkmcnt(15)
    v_mfma_f32_16x16x32_bf16 v[32:35], v[192:195], v[64:67], 0
    v_mfma_f32_16x16x32_bf16 v[36:39], v[192:195], v[96:99], 0
    v_mfma_f32_16x16x32_bf16 v[40:43], v[192:195], v[128:131], 0
    v_mfma_f32_16x16x32_bf16 v[44:47], v[192:195], v[160:163], 0
    s_waitcnt lgkmcnt(14)
    v_mfma_f32_16x16x32_bf16 v[48:51], v[196:199], v[64:67], 0
    v_mfma_f32_16x16x32_bf16 v[52:55], v[196:199], v[96:99], 0
    v_mfma_f32_16x16x32_bf16 v[56:59], v[196:199], v[128:131], 0
    v_mfma_f32_16x16x32_bf16 v[60:63], v[196:199], v[160:163], 0
    s_waitcnt lgkmcnt(13)
    v_mfma_f32_16x16x32_bf16 v[32:35], v[200:203], v[68:71], v[32:35]
    v_mfma_f32_16x16x32_bf16 v[36:39], v[200:203], v[100:103], v[36:39]
    v_mfma_f32_16x16x32_bf16 v[40:43], v[200:203], v[132:135], v[40:43]
    v_mfma_f32_16x16x32_bf16 v[44:47], v[200:203], v[164:167], v[44:47]
    s_waitcnt lgkmcnt(12)
    v_mfma_f32_16x16x32_bf16 v[48:51], v[204:207], v[68:71], v[48:51]
    v_mfma_f32_16x16x32_bf16 v[52:55], v[204:207], v[100:103], v[52:55]
    v_mfma_f32_16x16x32_bf16 v[56:59], v[204:207], v[132:135], v[56:59]
    v_mfma_f32_16x16x32_bf16 v[60:63], v[204:207], v[164:167], v[60:63]
    s_waitcnt lgkmcnt(0)
    v_mfma_f32_16x16x32_bf16 v[32:35], v[208:211], v[72:75], v[32:35]
    v_mfma_f32_16x16x32_bf16 v[36:39], v[208:211], v[104:107], v[36:39]
    s_add_u32 m0, s55, 0
    s_lshl_b32 s51, s62, 18
    s_add_u32 s51, s51, s57
    v_mfma_f32_16x16x32_bf16 v[40:43], v[208:211], v[136:139], v[40:43]
    v_xor_b32 v6, 0, v3
    buffer_load_dwordx4 v6, s[12:15], s51 offen nt lds
    v_mfma_f32_16x16x32_bf16 v[44:47], v[208:211], v[168:171], v[44:47]
    v_mfma_f32_16x16x32_bf16 v[48:51], v[212:215], v[72:75], v[48:51]
    s_add_u32 s51, s51, 16384
    s_add_u32 m0, m0, 1024
    v_mfma_f32_16x16x32_bf16 v[52:55], v[212:215], v[104:107], v[52:55]
    v_xor_b32 v6, 32, v3
    buffer_load_dwordx4 v6, s[12:15], s51 offen nt lds
    v_mfma_f32_16x16x32_bf16 v[56:59], v[212:215], v[136:139], v[56:59]
    v_mfma_f32_16x16x32_bf16 v[60:63], v[212:215], v[168:171], v[60:63]
    s_add_u32 s51, s51, 16384
    s_add_u32 m0, m0, 1024
    v_mfma_f32_16x16x32_bf16 v[32:35], v[216:219], v[76:79], v[32:35]
    v_xor_b32 v6, 0, v3
    buffer_load_dwordx4 v6, s[12:15], s51 offen nt lds
    v_mfma_f32_16x16x32_bf16 v[36:39], v[216:219], v[108:111], v[36:39]
    v_mfma_f32_16x16x32_bf16 v[40:43], v[216:219], v[140:143], v[40:43]
    s_add_u32 s51, s51, 16384
    s_add_u32 m0, m0, 1024
    v_mfma_f32_16x16x32_bf16 v[44:47], v[216:219], v[172:175], v[44:47]
    v_xor_b32 v6, 32, v3
    buffer_load_dwordx4 v6, s[12:15], s51 offen nt lds
    v_mfma_f32_16x16x32_bf16 v[48:51], v[220:223], v[76:79], v[48:51]
    v_mfma_f32_16x16x32_bf16 v[52:55], v[220:223], v[108:111], v[52:55]
    s_add_u32 s51, s51, 16384
    s_add_u32 m0, m0, 1024
    v_mfma_f32_16x16x32_bf16 v[56:59], v[220:223], v[140:143], v[56:59]
    v_xor_b32 v6, 64, v3
    buffer_load_dwordx4 v6, s[12:15], s51 offen nt lds
    v_mfma_f32_16x16x32_bf16 v[60:63], v[220:223], v[172:175], v[60:63]
    v_mfma_f32_16x16x32_bf16 v[32:35], v[224:227], v[80:83], v[32:35]
    s_add_u32 s51, s51, 16384
    s_add_u32 m0, m0, 1024
    v_mfma_f32_16x16x32_bf16 v[36:39], v[224:227], v[112:115], v[36:39]
    v_xor_b32 v6, 96, v3
    buffer_load_dwordx4 v6, s[12:15], s51 offen nt lds
    v_mfma_f32_16x16x32_bf16 v[40:43], v[224:227], v[144:147], v[40:43]
    v_mfma_f32_16x16x32_bf16 v[44:47], v[224:227], v[176:179], v[44:47]
    s_add_u32 s51, s51, 16384
    s_add_u32 m0, m0, 1024
    v_mfma_f32_16x16x32_bf16 v[48:51], v[228:231], v[80:83], v[48:51]
    v_xor_b32 v6, 64, v3
    buffer_load_dwordx4 v6, s[12:15], s51 offen nt lds
    v_mfma_f32_16x16x32_bf16 v[52:55], v[228:231], v[112:115], v[52:55]
    v_mfma_f32_16x16x32_bf16 v[56:59], v[228:231], v[144:147], v[56:59]
    s_add_u32 s51, s51, 16384
    s_add_u32 m0, m0, 1024
    v_mfma_f32_16x16x32_bf16 v[60:63], v[228:231], v[176:179], v[60:63]
    v_xor_b32 v6, 96, v3
    buffer_load_dwordx4 v6, s[12:15], s51 offen nt lds
    v_mfma_f32_16x16x32_bf16 v[32:35], v[232:235], v[84:87], v[32:35]
    v_mfma_f32_16x16x32_bf16 v[36:39], v[232:235], v[116:119], v[36:39]
    s_add_u32 s51, s51, 16384
    s_add_u32 m0, m0, 1024
    v_mfma_f32_16x16x32_bf16 v[40:43], v[232:235], v[148:151], v[40:43]
    v_xor_b32 v6, 128, v3
    buffer_load_dwordx4 v6, s[12:15], s51 offen nt lds
    v_mfma_f32_16x16x32_bf16 v[44:47], v[232:235], v[180:183], v[44:47]
    v_mfma_f32_16x16x32_bf16 v[48:51], v[236:239], v[84:87], v[48:51]
    s_add_u32 s51, s51, 16384
    s_add_u32 m0, m0, 1024
    v_mfma_f32_16x16x32_bf16 v[52:55], v[236:239], v[116:119], v[52:55]
    v_xor_b32 v6, 160, v3
    buffer_load_dwordx4 v6, s[12:15], s51 offen nt lds
    v_mfma_f32_16x16x32_bf16 v[56:59], v[236:239], v[148:151], v[56:59]
    v_mfma_f32_16x16x32_bf16 v[60:63], v[236:239], v[180:183], v[60:63]
    s_add_u32 s51, s51, 16384
    s_add_u32 m0, m0, 1024
    v_mfma_f32_16x16x32_bf16 v[32:35], v[240:243], v[88:91], v[32:35]
    v_xor_b32 v6, 128, v3
    buffer_load_dwordx4 v6, s[12:15], s51 offen nt lds
    v_mfma_f32_16x16x32_bf16 v[36:39], v[240:243], v[120:123], v[36:39]
    v_mfma_f32_16x16x32_bf16 v[40:43], v[240:243], v[152:155], v[40:43]
    s_add_u32 s51, s51, 16384
    s_add_u32 m0, m0, 1024
    v_mfma_f32_16x16x32_bf16 v[44:47], v[240:243], v[184:187], v[44:47]
    v_xor_b32 v6, 160, v3
    buffer_load_dwordx4 v6, s[12:15], s51 offen nt lds
    v_mfma_f32_16x16x32_bf16 v[48:51], v[244:247], v[88:91], v[48:51]
    v_mfma_f32_16x16x32_bf16 v[52:55], v[244:247], v[120:123], v[52:55]
    s_add_u32 s51, s51, 16384
    s_add_u32 m0, m0, 1024
    v_mfma_f32_16x16x32_bf16 v[56:59], v[244:247], v[152:155], v[56:59]
    v_xor_b32 v6, 192, v3
    buffer_load_dwordx4 v6, s[12:15], s51 offen nt lds
    v_mfma_f32_16x16x32_bf16 v[60:63], v[244:247], v[184:187], v[60:63]
    v_mfma_f32_16x16x32_bf16 v[32:35], v[248:251], v[92:95], v[32:35]
    s_add_u32 s51, s51, 16384
    s_add_u32 m0, m0, 1024
    v_mfma_f32_16x16x32_bf16 v[36:39], v[248:251], v[124:127], v[36:39]
    v_xor_b32 v6, 224, v3
    buffer_load_dwordx4 v6, s[12:15], s51 offen nt lds
    v_mfma_f32_16x16x32_bf16 v[40:43], v[248:251], v[156:159], v[40:43]
    v_mfma_f32_16x16x32_bf16 v[44:47], v[248:251], v[188:191], v[44:47]
    s_add_u32 s51, s51, 16384
    s_add_u32 m0, m0, 1024
    v_mfma_f32_16x16x32_bf16 v[48:51], v[252:255], v[92:95], v[48:51]
    v_xor_b32 v6, 192, v3
    buffer_load_dwordx4 v6, s[12:15], s51 offen nt lds
    v_mfma_f32_16x16x32_bf16 v[52:55], v[252:255], v[124:127], v[52:55]
    v_mfma_f32_16x16x32_bf16 v[56:59], v[252:255], v[156:159], v[56:59]
    s_add_u32 s51, s51, 16384
    s_add_u32 m0, m0, 1024
    v_mfma_f32_16x16x32_bf16 v[60:63], v[252:255], v[188:191], v[60:63]
    v_xor_b32 v6, 224, v3
    buffer_load_dwordx4 v6, s[12:15], s51 offen nt lds
    s_lshl_b32 s56, s60, 10
    s_add_u32 s56, s56, s53
    v_cvt_pk_bf16_f32 v20, v32, v33
    v_cvt_pk_bf16_f32 v21, v34, v35
    v_cvt_pk_bf16_f32 v22, v48, v49
    v_cvt_pk_bf16_f32 v23, v50, v51
    buffer_store_dwordx4 v[20:23], v1, s[8:11], s56 offen sc1
    s_add_u32 s56, s56, 229376
    v_cvt_pk_bf16_f32 v24, v36, v37
    v_cvt_pk_bf16_f32 v25, v38, v39
    v_cvt_pk_bf16_f32 v26, v52, v53
    v_cvt_pk_bf16_f32 v27, v54, v55
    buffer_store_dwordx4 v[24:27], v1, s[8:11], s56 offen sc1
    s_add_u32 s56, s56, 229376
    v_cvt_pk_bf16_f32 v20, v40, v41
    v_cvt_pk_bf16_f32 v21, v42, v43
    v_cvt_pk_bf16_f32 v22, v56, v57
    v_cvt_pk_bf16_f32 v23, v58, v59
    buffer_store_dwordx4 v[20:23], v1, s[8:11], s56 offen sc1
    s_add_u32 s56, s56, 229376
    v_cvt_pk_bf16_f32 v24, v44, v45
    v_cvt_pk_bf16_f32 v25, v46, v47
    v_cvt_pk_bf16_f32 v26, v60, v61
    v_cvt_pk_bf16_f32 v27, v62, v63
    buffer_store_dwordx4 v[24:27], v1, s[8:11], s56 offen sc1
    s_waitcnt vmcnt(20)
    v_mov_b32 v28, 132
    global_load_dword v28, v28, s[46:47] sc1
    ds_read_b128 v[192:195], v12 offset:16384
    ds_read_b128 v[196:199], v12 offset:18432
    ds_read_b128 v[200:203], v13 offset:16384
    ds_read_b128 v[204:207], v13 offset:18432
    ds_read_b128 v[208:211], v14 offset:16384
    ds_read_b128 v[212:215], v14 offset:18432
    ds_read_b128 v[216:219], v15 offset:16384
    ds_read_b128 v[220:223], v15 offset:18432
    ds_read_b128 v[224:227], v12 offset:16640
    ds_read_b128 v[228:231], v12 offset:18688
    ds_read_b128 v[232:235], v13 offset:16640
    ds_read_b128 v[236:239], v13 offset:18688
    ds_read_b128 v[240:243], v14 offset:16640
    ds_read_b128 v[244:247], v14 offset:18688
    ds_read_b128 v[248:251], v15 offset:16640
    ds_read_b128 v[252:255], v15 offset:18688
    s_waitcnt lgkmcnt(15)
    v_mfma_f32_16x16x32_bf16 v[32:35], v[192:195], v[64:67], 0
    v_mfma_f32_16x16x32_bf16 v[36:39], v[192:195], v[96:99], 0
    v_mfma_f32_16x16x32_bf16 v[40:43], v[192:195], v[128:131], 0
    v_mfma_f32_16x16x32_bf16 v[44:47], v[192:195], v[160:163], 0
    s_waitcnt lgkmcnt(14)
    v_mfma_f32_16x16x32_bf16 v[48:51], v[196:199], v[64:67], 0
    v_mfma_f32_16x16x32_bf16 v[52:55], v[196:199], v[96:99], 0
    v_mfma_f32_16x16x32_bf16 v[56:59], v[196:199], v[128:131], 0
    v_mfma_f32_16x16x32_bf16 v[60:63], v[196:199], v[160:163], 0
    s_waitcnt lgkmcnt(13)
    v_mfma_f32_16x16x32_bf16 v[32:35], v[200:203], v[68:71], v[32:35]
    v_mfma_f32_16x16x32_bf16 v[36:39], v[200:203], v[100:103], v[36:39]
    v_mfma_f32_16x16x32_bf16 v[40:43], v[200:203], v[132:135], v[40:43]
    v_mfma_f32_16x16x32_bf16 v[44:47], v[200:203], v[164:167], v[44:47]
    s_waitcnt lgkmcnt(12)
    v_mfma_f32_16x16x32_bf16 v[48:51], v[204:207], v[68:71], v[48:51]
    v_mfma_f32_16x16x32_bf16 v[52:55], v[204:207], v[100:103], v[52:55]
    v_mfma_f32_16x16x32_bf16 v[56:59], v[204:207], v[132:135], v[56:59]
    v_mfma_f32_16x16x32_bf16 v[60:63], v[204:207], v[164:167], v[60:63]
    s_waitcnt lgkmcnt(0)
    v_mfma_f32_16x16x32_bf16 v[32:35], v[208:211], v[72:75], v[32:35]
    v_mfma_f32_16x16x32_bf16 v[36:39], v[208:211], v[104:107], v[36:39]
    s_add_u32 m0, s55, 16384
    s_lshl_b32 s51, s63, 18
    s_add_u32 s51, s51, s57
    v_mfma_f32_16x16x32_bf16 v[40:43], v[208:211], v[136:139], v[40:43]
    v_xor_b32 v6, 0, v3
    buffer_load_dwordx4 v6, s[12:15], s51 offen nt lds
    v_mfma_f32_16x16x32_bf16 v[44:47], v[208:211], v[168:171], v[44:47]
    v_mfma_f32_16x16x32_bf16 v[48:51], v[212:215], v[72:75], v[48:51]
    s_add_u32 s51, s51, 16384
    s_add_u32 m0, m0, 1024
    v_mfma_f32_16x16x32_bf16 v[52:55], v[212:215], v[104:107], v[52:55]
    v_xor_b32 v6, 32, v3
    buffer_load_dwordx4 v6, s[12:15], s51 offen nt lds
    v_mfma_f32_16x16x32_bf16 v[56:59], v[212:215], v[136:139], v[56:59]
    v_mfma_f32_16x16x32_bf16 v[60:63], v[212:215], v[168:171], v[60:63]
    s_add_u32 s51, s51, 16384
    s_add_u32 m0, m0, 1024
    v_mfma_f32_16x16x32_bf16 v[32:35], v[216:219], v[76:79], v[32:35]
    v_xor_b32 v6, 0, v3
    buffer_load_dwordx4 v6, s[12:15], s51 offen nt lds
    v_mfma_f32_16x16x32_bf16 v[36:39], v[216:219], v[108:111], v[36:39]
    v_mfma_f32_16x16x32_bf16 v[40:43], v[216:219], v[140:143], v[40:43]
    s_add_u32 s51, s51, 16384
    s_add_u32 m0, m0, 1024
    v_mfma_f32_16x16x32_bf16 v[44:47], v[216:219], v[172:175], v[44:47]
    v_xor_b32 v6, 32, v3
    buffer_load_dwordx4 v6, s[12:15], s51 offen nt lds
    v_mfma_f32_16x16x32_bf16 v[48:51], v[220:223], v[76:79], v[48:51]
    v_mfma_f32_16x16x32_bf16 v[52:55], v[220:223], v[108:111], v[52:55]
    s_add_u32 s51, s51, 16384
    s_add_u32 m0, m0, 1024
    v_mfma_f32_16x16x32_bf16 v[56:59], v[220:223], v[140:143], v[56:59]
    v_xor_b32 v6, 64, v3
    buffer_load_dwordx4 v6, s[12:15], s51 offen nt lds
    v_mfma_f32_16x16x32_bf16 v[60:63], v[220:223], v[172:175], v[60:63]
    v_mfma_f32_16x16x32_bf16 v[32:35], v[224:227], v[80:83], v[32:35]
    s_add_u32 s51, s51, 16384
    s_add_u32 m0, m0, 1024
    v_mfma_f32_16x16x32_bf16 v[36:39], v[224:227], v[112:115], v[36:39]
    v_xor_b32 v6, 96, v3
    buffer_load_dwordx4 v6, s[12:15], s51 offen nt lds
    v_mfma_f32_16x16x32_bf16 v[40:43], v[224:227], v[144:147], v[40:43]
    v_mfma_f32_16x16x32_bf16 v[44:47], v[224:227], v[176:179], v[44:47]
    s_add_u32 s51, s51, 16384
    s_add_u32 m0, m0, 1024
    v_mfma_f32_16x16x32_bf16 v[48:51], v[228:231], v[80:83], v[48:51]
    v_xor_b32 v6, 64, v3
    buffer_load_dwordx4 v6, s[12:15], s51 offen nt lds
    v_mfma_f32_16x16x32_bf16 v[52:55], v[228:231], v[112:115], v[52:55]
    v_mfma_f32_16x16x32_bf16 v[56:59], v[228:231], v[144:147], v[56:59]
    s_add_u32 s51, s51, 16384
    s_add_u32 m0, m0, 1024
    v_mfma_f32_16x16x32_bf16 v[60:63], v[228:231], v[176:179], v[60:63]
    v_xor_b32 v6, 96, v3
    buffer_load_dwordx4 v6, s[12:15], s51 offen nt lds
    v_mfma_f32_16x16x32_bf16 v[32:35], v[232:235], v[84:87], v[32:35]
    v_mfma_f32_16x16x32_bf16 v[36:39], v[232:235], v[116:119], v[36:39]
    s_add_u32 s51, s51, 16384
    s_add_u32 m0, m0, 1024
    v_mfma_f32_16x16x32_bf16 v[40:43], v[232:235], v[148:151], v[40:43]
    v_xor_b32 v6, 128, v3
    buffer_load_dwordx4 v6, s[12:15], s51 offen nt lds
    v_mfma_f32_16x16x32_bf16 v[44:47], v[232:235], v[180:183], v[44:47]
    v_mfma_f32_16x16x32_bf16 v[48:51], v[236:239], v[84:87], v[48:51]
    s_add_u32 s51, s51, 16384
    s_add_u32 m0, m0, 1024
    v_mfma_f32_16x16x32_bf16 v[52:55], v[236:239], v[116:119], v[52:55]
    v_xor_b32 v6, 160, v3
    buffer_load_dwordx4 v6, s[12:15], s51 offen nt lds
    v_mfma_f32_16x16x32_bf16 v[56:59], v[236:239], v[148:151], v[56:59]
    v_mfma_f32_16x16x32_bf16 v[60:63], v[236:239], v[180:183], v[60:63]
    s_add_u32 s51, s51, 16384
    s_add_u32 m0, m0, 1024
    v_mfma_f32_16x16x32_bf16 v[32:35], v[240:243], v[88:91], v[32:35]
    v_xor_b32 v6, 128, v3
    buffer_load_dwordx4 v6, s[12:15], s51 offen nt lds
    v_mfma_f32_16x16x32_bf16 v[36:39], v[240:243], v[120:123], v[36:39]
    v_mfma_f32_16x16x32_bf16 v[40:43], v[240:243], v[152:155], v[40:43]
    s_add_u32 s51, s51, 16384
    s_add_u32 m0, m0, 1024
    v_mfma_f32_16x16x32_bf16 v[44:47], v[240:243], v[184:187], v[44:47]
    v_xor_b32 v6, 160, v3
    buffer_load_dwordx4 v6, s[12:15], s51 offen nt lds
    v_mfma_f32_16x16x32_bf16 v[48:51], v[244:247], v[88:91], v[48:51]
    v_mfma_f32_16x16x32_bf16 v[52:55], v[244:247], v[120:123], v[52:55]
    s_add_u32 s51, s51, 16384
    s_add_u32 m0, m0, 1024
    v_mfma_f32_16x16x32_bf16 v[56:59], v[244:247], v[152:155], v[56:59]
    v_xor_b32 v6, 192, v3
    buffer_load_dwordx4 v6, s[12:15], s51 offen nt lds
    v_mfma_f32_16x16x32_bf16 v[60:63], v[244:247], v[184:187], v[60:63]
    v_mfma_f32_16x16x32_bf16 v[32:35], v[248:251], v[92:95], v[32:35]
    s_add_u32 s51, s51, 16384
    s_add_u32 m0, m0, 1024
    v_mfma_f32_16x16x32_bf16 v[36:39], v[248:251], v[124:127], v[36:39]
    v_xor_b32 v6, 224, v3
    buffer_load_dwordx4 v6, s[12:15], s51 offen nt lds
    v_mfma_f32_16x16x32_bf16 v[40:43], v[248:251], v[156:159], v[40:43]
    v_mfma_f32_16x16x32_bf16 v[44:47], v[248:251], v[188:191], v[44:47]
    s_add_u32 s51, s51, 16384
    s_add_u32 m0, m0, 1024
    v_mfma_f32_16x16x32_bf16 v[48:51], v[252:255], v[92:95], v[48:51]
    v_xor_b32 v6, 192, v3
    buffer_load_dwordx4 v6, s[12:15], s51 offen nt lds
    v_mfma_f32_16x16x32_bf16 v[52:55], v[252:255], v[124:127], v[52:55]
    v_mfma_f32_16x16x32_bf16 v[56:59], v[252:255], v[156:159], v[56:59]
    s_add_u32 s51, s51, 16384
    s_add_u32 m0, m0, 1024
    v_mfma_f32_16x16x32_bf16 v[60:63], v[252:255], v[188:191], v[60:63]
    v_xor_b32 v6, 224, v3
    buffer_load_dwordx4 v6, s[12:15], s51 offen nt lds
    s_lshl_b32 s56, s61, 10
    s_add_u32 s56, s56, s53
    v_cvt_pk_bf16_f32 v20, v32, v33
    v_cvt_pk_bf16_f32 v21, v34, v35
    v_cvt_pk_bf16_f32 v22, v48, v49
    v_cvt_pk_bf16_f32 v23, v50, v51
    buffer_store_dwordx4 v[20:23], v1, s[8:11], s56 offen sc1
    s_add_u32 s56, s56, 229376
    v_cvt_pk_bf16_f32 v24, v36, v37
    v_cvt_pk_bf16_f32 v25, v38, v39
    v_cvt_pk_bf16_f32 v26, v52, v53
    v_cvt_pk_bf16_f32 v27, v54, v55
    buffer_store_dwordx4 v[24:27], v1, s[8:11], s56 offen sc1
    s_add_u32 s56, s56, 229376
    v_cvt_pk_bf16_f32 v20, v40, v41
    v_cvt_pk_bf16_f32 v21, v42, v43
    v_cvt_pk_bf16_f32 v22, v56, v57
    v_cvt_pk_bf16_f32 v23, v58, v59
    buffer_store_dwordx4 v[20:23], v1, s[8:11], s56 offen sc1
    s_add_u32 s56, s56, 229376
    v_cvt_pk_bf16_f32 v24, v44, v45
    v_cvt_pk_bf16_f32 v25, v46, v47
    v_cvt_pk_bf16_f32 v26, v60, v61
    v_cvt_pk_bf16_f32 v27, v62, v63
    buffer_store_dwordx4 v[24:27], v1, s[8:11], s56 offen sc1
    s_waitcnt vmcnt(25)
    s_waitcnt vmcnt(20)
    v_cmp_eq_u32 vcc, 0, v28
    s_cbranch_vccnz Lvwait_2
Lvok_1:
    ds_read_b128 v[192:195], v12 offset:0
    ds_read_b128 v[196:199], v12 offset:2048
    ds_read_b128 v[200:203], v13 offset:0
    ds_read_b128 v[204:207], v13 offset:2048
    ds_read_b128 v[208:211], v14 offset:0
    ds_read_b128 v[212:215], v14 offset:2048
    ds_read_b128 v[216:219], v15 offset:0
    ds_read_b128 v[220:223], v15 offset:2048
    ds_read_b128 v[224:227], v12 offset:256
    ds_read_b128 v[228:231], v12 offset:2304
    ds_read_b128 v[232:235], v13 offset:256
    ds_read_b128 v[236:239], v13 offset:2304
    ds_read_b128 v[240:243], v14 offset:256
    ds_read_b128 v[244:247], v14 offset:2304
    ds_read_b128 v[248:251], v15 offset:256
    ds_read_b128 v[252:255], v15 offset:2304
    s_waitcnt lgkmcnt(15)
    v_mfma_f32_16x16x32_bf16 v[32:35], v[192:195], v[64:67], 0
    v_mfma_f32_16x16x32_bf16 v[36:39], v[192:195], v[96:99], 0
    v_mfma_f32_16x16x32_bf16 v[40:43], v[192:195], v[128:131], 0
    v_mfma_f32_16x16x32_bf16 v[44:47], v[192:195], v[160:163], 0
    s_waitcnt lgkmcnt(14)
    v_mfma_f32_16x16x32_bf16 v[48:51], v[196:199], v[64:67], 0
    v_mfma_f32_16x16x32_bf16 v[52:55], v[196:199], v[96:99], 0
    v_mfma_f32_16x16x32_bf16 v[56:59], v[196:199], v[128:131], 0
    v_mfma_f32_16x16x32_bf16 v[60:63], v[196:199], v[160:163], 0
    s_waitcnt lgkmcnt(13)
    v_mfma_f32_16x16x32_bf16 v[32:35], v[200:203], v[68:71], v[32:35]
    v_mfma_f32_16x16x32_bf16 v[36:39], v[200:203], v[100:103], v[36:39]
    v_mfma_f32_16x16x32_bf16 v[40:43], v[200:203], v[132:135], v[40:43]
    v_mfma_f32_16x16x32_bf16 v[44:47], v[200:203], v[164:167], v[44:47]
    s_waitcnt lgkmcnt(12)
    v_mfma_f32_16x16x32_bf16 v[48:51], v[204:207], v[68:71], v[48:51]
    v_mfma_f32_16x16x32_bf16 v[52:55], v[204:207], v[100:103], v[52:55]
    v_mfma_f32_16x16x32_bf16 v[56:59], v[204:207], v[132:135], v[56:59]
    v_mfma_f32_16x16x32_bf16 v[60:63], v[204:207], v[164:167], v[60:63]
    s_waitcnt lgkmcnt(11)
    v_mfma_f32_16x16x32_bf16 v[32:35], v[208:211], v[72:75], v[32:35]
    v_mfma_f32_16x16x32_bf16 v[36:39], v[208:211], v[104:107], v[36:39]
    v_mfma_f32_16x16x32_bf16 v[40:43], v[208:211], v[136:139], v[40:43]
    v_mfma_f32_16x16x32_bf16 v[44:47], v[208:211], v[168:171], v[44:47]
    s_waitcnt lgkmcnt(10)
    v_mfma_f32_16x16x32_bf16 v[48:51], v[212:215], v[72:75], v[48:51]
    v_mfma_f32_16x16x32_bf16 v[52:55], v[212:215], v[104:107], v[52:55]
    v_mfma_f32_16x16x32_bf16 v[56:59], v[212:215], v[136:139], v[56:59]
    v_mfma_f32_16x16x32_bf16 v[60:63], v[212:215], v[168:171], v[60:63]
    s_waitcnt lgkmcnt(9)
    v_mfma_f32_16x16x32_bf16 v[32:35], v[216:219], v[76:79], v[32:35]
    v_mfma_f32_16x16x32_bf16 v[36:39], v[216:219], v[108:111], v[36:39]
    v_mfma_f32_16x16x32_bf16 v[40:43], v[216:219], v[140:143], v[40:43]
    v_mfma_f32_16x16x32_bf16 v[44:47], v[216:219], v[172:175], v[44:47]
    s_waitcnt lgkmcnt(8)
    v_mfma_f32_16x16x32_bf16 v[48:51], v[220:223], v[76:79], v[48:51]
    v_mfma_f32_16x16x32_bf16 v[52:55], v[220:223], v[108:111], v[52:55]
    v_mfma_f32_16x16x32_bf16 v[56:59], v[220:223], v[140:143], v[56:59]
    v_mfma_f32_16x16x32_bf16 v[60:63], v[220:223], v[172:175], v[60:63]
    s_waitcnt lgkmcnt(7)
    v_mfma_f32_16x16x32_bf16 v[32:35], v[224:227], v[80:83], v[32:35]
    v_mfma_f32_16x16x32_bf16 v[36:39], v[224:227], v[112:115], v[36:39]
    v_mfma_f32_16x16x32_bf16 v[40:43], v[224:227], v[144:147], v[40:43]
    v_mfma_f32_16x16x32_bf16 v[44:47], v[224:227], v[176:179], v[44:47]
    s_waitcnt lgkmcnt(6)
    v_mfma_f32_16x16x32_bf16 v[48:51], v[228:231], v[80:83], v[48:51]
    v_mfma_f32_16x16x32_bf16 v[52:55], v[228:231], v[112:115], v[52:55]
    v_mfma_f32_16x16x32_bf16 v[56:59], v[228:231], v[144:147], v[56:59]
    v_mfma_f32_16x16x32_bf16 v[60:63], v[228:231], v[176:179], v[60:63]
    s_waitcnt lgkmcnt(5)
    v_mfma_f32_16x16x32_bf16 v[32:35], v[232:235], v[84:87], v[32:35]
    v_mfma_f32_16x16x32_bf16 v[36:39], v[232:235], v[116:119], v[36:39]
    v_mfma_f32_16x16x32_bf16 v[40:43], v[232:235], v[148:151], v[40:43]
    v_mfma_f32_16x16x32_bf16 v[44:47], v[232:235], v[180:183], v[44:47]
    s_waitcnt lgkmcnt(4)
    v_mfma_f32_16x16x32_bf16 v[48:51], v[236:239], v[84:87], v[48:51]
    v_mfma_f32_16x16x32_bf16 v[52:55], v[236:239], v[116:119], v[52:55]
    v_mfma_f32_16x16x32_bf16 v[56:59], v[236:239], v[148:151], v[56:59]
    v_mfma_f32_16x16x32_bf16 v[60:63], v[236:239], v[180:183], v[60:63]
    s_waitcnt lgkmcnt(3)
    v_mfma_f32_16x16x32_bf16 v[32:35], v[240:243], v[88:91], v[32:35]
    v_mfma_f32_16x16x32_bf16 v[36:39], v[240:243], v[120:123], v[36:39]
    v_mfma_f32_16x16x32_bf16 v[40:43], v[240:243], v[152:155], v[40:43]
    v_mfma_f32_16x16x32_bf16 v[44:47], v[240:243], v[184:187], v[44:47]
    s_waitcnt lgkmcnt(2)
    v_mfma_f32_16x16x32_bf16 v[48:51], v[244:247], v[88:91], v[48:51]
    v_mfma_f32_16x16x32_bf16 v[52:55], v[244:247], v[120:123], v[52:55]
    v_mfma_f32_16x16x32_bf16 v[56:59], v[244:247], v[152:155], v[56:59]
    v_mfma_f32_16x16x32_bf16 v[60:63], v[244:247], v[184:187], v[60:63]
    s_waitcnt lgkmcnt(1)
    v_mfma_f32_16x16x32_bf16 v[32:35], v[248:251], v[92:95], v[32:35]
    v_mfma_f32_16x16x32_bf16 v[36:39], v[248:251], v[124:127], v[36:39]
    v_mfma_f32_16x16x32_bf16 v[40:43], v[248:251], v[156:159], v[40:43]
    v_mfma_f32_16x16x32_bf16 v[44:47], v[248:251], v[188:191], v[44:47]
    s_waitcnt lgkmcnt(0)
    v_mfma_f32_16x16x32_bf16 v[48:51], v[252:255], v[92:95], v[48:51]
    v_mfma_f32_16x16x32_bf16 v[52:55], v[252:255], v[124:127], v[52:55]
    v_mfma_f32_16x16x32_bf16 v[56:59], v[252:255], v[156:159], v[56:59]
    v_mfma_f32_16x16x32_bf16 v[60:63], v[252:255], v[188:191], v[60:63]
    s_lshl_b32 s56, s62, 10
    s_add_u32 s56, s56, s53
    v_cvt_pk_bf16_f32 v20, v32, v33
    v_cvt_pk_bf16_f32 v21, v34, v35
    v_cvt_pk_bf16_f32 v22, v48, v49
    v_cvt_pk_bf16_f32 v23, v50, v51
    buffer_store_dwordx4 v[20:23], v1, s[8:11], s56 offen sc1
    s_add_u32 s56, s56, 229376
    v_cvt_pk_bf16_f32 v24, v36, v37
    v_cvt_pk_bf16_f32 v25, v38, v39
    v_cvt_pk_bf16_f32 v26, v52, v53
    v_cvt_pk_bf16_f32 v27, v54, v55
    buffer_store_dwordx4 v[24:27], v1, s[8:11], s56 offen sc1
    s_add_u32 s56, s56, 229376
    v_cvt_pk_bf16_f32 v20, v40, v41
    v_cvt_pk_bf16_f32 v21, v42, v43
    v_cvt_pk_bf16_f32 v22, v56, v57
    v_cvt_pk_bf16_f32 v23, v58, v59
    buffer_store_dwordx4 v[20:23], v1, s[8:11], s56 offen sc1
    s_add_u32 s56, s56, 229376
    v_cvt_pk_bf16_f32 v24, v44, v45
    v_cvt_pk_bf16_f32 v25, v46, v47
    v_cvt_pk_bf16_f32 v26, v60, v61
    v_cvt_pk_bf16_f32 v27, v62, v63
    buffer_store_dwordx4 v[24:27], v1, s[8:11], s56 offen sc1
    s_cmp_ge_u32 s20, 2
    s_cbranch_scc1 Lbt_end
    s_waitcnt vmcnt(8)
    ds_read_b128 v[192:195], v12 offset:16384
    ds_read_b128 v[196:199], v12 offset:18432
    ds_read_b128 v[200:203], v13 offset:16384
    ds_read_b128 v[204:207], v13 offset:18432
    ds_read_b128 v[208:211], v14 offset:16384
    ds_read_b128 v[212:215], v14 offset:18432
    ds_read_b128 v[216:219], v15 offset:16384
    ds_read_b128 v[220:223], v15 offset:18432
    ds_read_b128 v[224:227], v12 offset:16640
    ds_read_b128 v[228:231], v12 offset:18688
    ds_read_b128 v[232:235], v13 offset:16640
    ds_read_b128 v[236:239], v13 offset:18688
    ds_read_b128 v[240:243], v14 offset:16640
    ds_read_b128 v[244:247], v14 offset:18688
    ds_read_b128 v[248:251], v15 offset:16640
    ds_read_b128 v[252:255], v15 offset:18688
    s_waitcnt lgkmcnt(15)
    v_mfma_f32_16x16x32_bf16 v[32:35], v[192:195], v[64:67], 0
    v_mfma_f32_16x16x32_bf16 v[36:39], v[192:195], v[96:99], 0
    v_mfma_f32_16x16x32_bf16 v[40:43], v[192:195], v[128:131], 0
    v_mfma_f32_16x16x32_bf16 v[44:47], v[192:195], v[160:163], 0
    s_waitcnt lgkmcnt(14)
    v_mfma_f32_16x16x32_bf16 v[48:51], v[196:199], v[64:67], 0
    v_mfma_f32_16x16x32_bf16 v[52:55], v[196:199], v[96:99], 0
    v_mfma_f32_16x16x32_bf16 v[56:59], v[196:199], v[128:131], 0
    v_mfma_f32_16x16x32_bf16 v[60:63], v[196:199], v[160:163], 0
    s_waitcnt lgkmcnt(13)
    v_mfma_f32_16x16x32_bf16 v[32:35], v[200:203], v[68:71], v[32:35]
    v_mfma_f32_16x16x32_bf16 v[36:39], v[200:203], v[100:103], v[36:39]
    v_mfma_f32_16x16x32_bf16 v[40:43], v[200:203], v[132:135], v[40:43]
    v_mfma_f32_16x16x32_bf16 v[44:47], v[200:203], v[164:167], v[44:47]
    s_waitcnt lgkmcnt(12)
    v_mfma_f32_16x16x32_bf16 v[48:51], v[204:207], v[68:71], v[48:51]
    v_mfma_f32_16x16x32_bf16 v[52:55], v[204:207], v[100:103], v[52:55]
    v_mfma_f32_16x16x32_bf16 v[56:59], v[204:207], v[132:135], v[56:59]
    v_mfma_f32_16x16x32_bf16 v[60:63], v[204:207], v[164:167], v[60:63]
    s_waitcnt lgkmcnt(11)
    v_mfma_f32_16x16x32_bf16 v[32:35], v[208:211], v[72:75], v[32:35]
    v_mfma_f32_16x16x32_bf16 v[36:39], v[208:211], v[104:107], v[36:39]
    v_mfma_f32_16x16x32_bf16 v[40:43], v[208:211], v[136:139], v[40:43]
    v_mfma_f32_16x16x32_bf16 v[44:47], v[208:211], v[168:171], v[44:47]
    s_waitcnt lgkmcnt(10)
    v_mfma_f32_16x16x32_bf16 v[48:51], v[212:215], v[72:75], v[48:51]
    v_mfma_f32_16x16x32_bf16 v[52:55], v[212:215], v[104:107], v[52:55]
    v_mfma_f32_16x16x32_bf16 v[56:59], v[212:215], v[136:139], v[56:59]
    v_mfma_f32_16x16x32_bf16 v[60:63], v[212:215], v[168:171], v[60:63]
    s_waitcnt lgkmcnt(9)
    v_mfma_f32_16x16x32_bf16 v[32:35], v[216:219], v[76:79], v[32:35]
    v_mfma_f32_16x16x32_bf16 v[36:39], v[216:219], v[108:111], v[36:39]
    v_mfma_f32_16x16x32_bf16 v[40:43], v[216:219], v[140:143], v[40:43]
    v_mfma_f32_16x16x32_bf16 v[44:47], v[216:219], v[172:175], v[44:47]
    s_waitcnt lgkmcnt(8)
    v_mfma_f32_16x16x32_bf16 v[48:51], v[220:223], v[76:79], v[48:51]
    v_mfma_f32_16x16x32_bf16 v[52:55], v[220:223], v[108:111], v[52:55]
    v_mfma_f32_16x16x32_bf16 v[56:59], v[220:223], v[140:143], v[56:59]
    v_mfma_f32_16x16x32_bf16 v[60:63], v[220:223], v[172:175], v[60:63]
    s_waitcnt lgkmcnt(7)
    v_mfma_f32_16x16x32_bf16 v[32:35], v[224:227], v[80:83], v[32:35]
    v_mfma_f32_16x16x32_bf16 v[36:39], v[224:227], v[112:115], v[36:39]
    v_mfma_f32_16x16x32_bf16 v[40:43], v[224:227], v[144:147], v[40:43]
    v_mfma_f32_16x16x32_bf16 v[44:47], v[224:227], v[176:179], v[44:47]
    s_waitcnt lgkmcnt(6)
    v_mfma_f32_16x16x32_bf16 v[48:51], v[228:231], v[80:83], v[48:51]
    v_mfma_f32_16x16x32_bf16 v[52:55], v[228:231], v[112:115], v[52:55]
    v_mfma_f32_16x16x32_bf16 v[56:59], v[228:231], v[144:147], v[56:59]
    v_mfma_f32_16x16x32_bf16 v[60:63], v[228:231], v[176:179], v[60:63]
    s_waitcnt lgkmcnt(5)
    v_mfma_f32_16x16x32_bf16 v[32:35], v[232:235], v[84:87], v[32:35]
    v_mfma_f32_16x16x32_bf16 v[36:39], v[232:235], v[116:119], v[36:39]
    v_mfma_f32_16x16x32_bf16 v[40:43], v[232:235], v[148:151], v[40:43]
    v_mfma_f32_16x16x32_bf16 v[44:47], v[232:235], v[180:183], v[44:47]
    s_waitcnt lgkmcnt(4)
    v_mfma_f32_16x16x32_bf16 v[48:51], v[236:239], v[84:87], v[48:51]
    v_mfma_f32_16x16x32_bf16 v[52:55], v[236:239], v[116:119], v[52:55]
    v_mfma_f32_16x16x32_bf16 v[56:59], v[236:239], v[148:151], v[56:59]
    v_mfma_f32_16x16x32_bf16 v[60:63], v[236:239], v[180:183], v[60:63]
    s_waitcnt lgkmcnt(3)
    v_mfma_f32_16x16x32_bf16 v[32:35], v[240:243], v[88:91], v[32:35]
    v_mfma_f32_16x16x32_bf16 v[36:39], v[240:243], v[120:123], v[36:39]
    v_mfma_f32_16x16x32_bf16 v[40:43], v[240:243], v[152:155], v[40:43]
    v_mfma_f32_16x16x32_bf16 v[44:47], v[240:243], v[184:187], v[44:47]
    s_waitcnt lgkmcnt(2)
    v_mfma_f32_16x16x32_bf16 v[48:51], v[244:247], v[88:91], v[48:51]
    v_mfma_f32_16x16x32_bf16 v[52:55], v[244:247], v[120:123], v[52:55]
    v_mfma_f32_16x16x32_bf16 v[56:59], v[244:247], v[152:155], v[56:59]
    v_mfma_f32_16x16x32_bf16 v[60:63], v[244:247], v[184:187], v[60:63]
    s_waitcnt lgkmcnt(1)
    v_mfma_f32_16x16x32_bf16 v[32:35], v[248:251], v[92:95], v[32:35]
    v_mfma_f32_16x16x32_bf16 v[36:39], v[248:251], v[124:127], v[36:39]
    v_mfma_f32_16x16x32_bf16 v[40:43], v[248:251], v[156:159], v[40:43]
    v_mfma_f32_16x16x32_bf16 v[44:47], v[248:251], v[188:191], v[44:47]
    s_waitcnt lgkmcnt(0)
    v_mfma_f32_16x16x32_bf16 v[48:51], v[252:255], v[92:95], v[48:51]
    v_mfma_f32_16x16x32_bf16 v[52:55], v[252:255], v[124:127], v[52:55]
    v_mfma_f32_16x16x32_bf16 v[56:59], v[252:255], v[156:159], v[56:59]
    v_mfma_f32_16x16x32_bf16 v[60:63], v[252:255], v[188:191], v[60:63]
    s_lshl_b32 s56, s63, 10
    s_add_u32 s56, s56, s53
    v_cvt_pk_bf16_f32 v20, v32, v33
    v_cvt_pk_bf16_f32 v21, v34, v35
    v_cvt_pk_bf16_f32 v22, v48, v49
    v_cvt_pk_bf16_f32 v23, v50, v51
    buffer_store_dwordx4 v[20:23], v1, s[8:11], s56 offen sc1
    s_add_u32 s56, s56, 229376
    v_cvt_pk_bf16_f32 v24, v36, v37
    v_cvt_pk_bf16_f32 v25, v38, v39
    v_cvt_pk_bf16_f32 v26, v52, v53
    v_cvt_pk_bf16_f32 v27, v54, v55
    buffer_store_dwordx4 v[24:27], v1, s[8:11], s56 offen sc1
    s_add_u32 s56, s56, 229376
    v_cvt_pk_bf16_f32 v20, v40, v41
    v_cvt_pk_bf16_f32 v21, v42, v43
    v_cvt_pk_bf16_f32 v22, v56, v57
    v_cvt_pk_bf16_f32 v23, v58, v59
    buffer_store_dwordx4 v[20:23], v1, s[8:11], s56 offen sc1
    s_add_u32 s56, s56, 229376
    v_cvt_pk_bf16_f32 v24, v44, v45
    v_cvt_pk_bf16_f32 v25, v46, v47
    v_cvt_pk_bf16_f32 v26, v60, v61
    v_cvt_pk_bf16_f32 v27, v62, v63
    buffer_store_dwordx4 v[24:27], v1, s[8:11], s56 offen sc1
Lbt_end:
    s_and_b32 s51, s21, 3
    s_mul_i32 s51, s51, 7
    s_add_u32 s51, s51, s49
    s_lshl_b32 s51, s51, 7
    s_lshl_b32 s48, s48, 2
    s_add_u32 s48, s48, s20
    s_lshl_b32 s48, s48, 2
    s_add_u32 s51, s51, s48
    s_add_u32 s51, s51, 34488320
    s_waitcnt vmcnt(0)
    v_mov_b32 v28, 0
    s_mov_b64 exec, 1
    buffer_store_dword v28, off, s[8:11], s51 sc1
    s_mov_b64 exec, -1
    s_barrier
Lnobt:
    s_cmp_lg_u32 s21, 7
    s_cbranch_scc1 Lattn
    s_branch Lmlp
Lln:
    s_mov_b32 s12, s4
    s_mov_b32 s13, s5
    s_mov_b32 s14, 1835008
    s_mov_b32 s15, 0x20000
    s_mov_b32 s16, s100
    s_mov_b32 s17, s101
    s_mov_b32 s18, 7168
    s_mov_b32 s19, 0x20000
    s_cmp_lg_u32 s22, 0
    s_cbranch_scc1 Lln_go
    s_lshl_b32 s51, s20, 11
    s_add_u32 s51, s51, 34488320
    buffer_store_dwordx4 v[8:11], v1, s[8:11], s51 offen sc1
    buffer_store_dwordx4 v[8:11], v1, s[8:11], s51 offen offset:1024 sc1
    v_mov_b32 v2, 132
    v_mov_b32 v3, 1
    s_waitcnt vmcnt(0)
    s_barrier
    s_mov_b64 exec, 1
    global_store_dword v2, v3, s[46:47] sc1
    s_mov_b64 exec, -1
Lln_go:
    s_lshl_b32 s51, s22, 2
    s_add_u32 s51, s51, s20
    s_mul_i32 s51, s51, 14336
    v_lshrrev_b32 v2, 3, v0
    v_mul_u32_u24 v2, 896, v2
    v_and_b32 v3, 7, v0
    v_lshl_add_u32 v3, v3, 4, v2
    s_add_u32 s52, s51, 7168
    buffer_load_dwordx4 v[16:19], v3, s[12:15], s51 offen offset:0 nt
    buffer_load_dwordx4 v[20:23], v3, s[12:15], s51 offen offset:128 nt
    buffer_load_dwordx4 v[24:27], v3, s[12:15], s51 offen offset:256 nt
    buffer_load_dwordx4 v[28:31], v3, s[12:15], s51 offen offset:384 nt
    buffer_load_dwordx4 v[32:35], v3, s[12:15], s51 offen offset:512 nt
    buffer_load_dwordx4 v[36:39], v3, s[12:15], s51 offen offset:640 nt
    buffer_load_dwordx4 v[40:43], v3, s[12:15], s51 offen offset:768 nt
    buffer_load_dwordx4 v[44:47], v3, s[12:15], s52 offen offset:0 nt
    buffer_load_dwordx4 v[48:51], v3, s[12:15], s52 offen offset:128 nt
    buffer_load_dwordx4 v[52:55], v3, s[12:15], s52 offen offset:256 nt
    buffer_load_dwordx4 v[56:59], v3, s[12:15], s52 offen offset:384 nt
    buffer_load_dwordx4 v[60:63], v3, s[12:15], s52 offen offset:512 nt
    buffer_load_dwordx4 v[64:67], v3, s[12:15], s52 offen offset:640 nt
    buffer_load_dwordx4 v[68:71], v3, s[12:15], s52 offen offset:768 nt
    s_mov_b32 s53, 0xffff0000
    s_mov_b32 s54, 0x3b124925
    s_mov_b32 s55, 0x3727c5ac
    s_waitcnt vmcnt(13)
    v_lshlrev_b32 v80, 16, v16
    v_and_b32 v81, s53, v16
    v_lshlrev_b32 v82, 16, v17
    v_and_b32 v83, s53, v17
    v_lshlrev_b32 v84, 16, v18
    v_and_b32 v85, s53, v18
    v_lshlrev_b32 v86, 16, v19
    v_and_b32 v87, s53, v19
    s_waitcnt vmcnt(12)
    v_lshlrev_b32 v88, 16, v20
    v_and_b32 v89, s53, v20
    v_lshlrev_b32 v90, 16, v21
    v_and_b32 v91, s53, v21
    v_lshlrev_b32 v92, 16, v22
    v_and_b32 v93, s53, v22
    v_lshlrev_b32 v94, 16, v23
    v_and_b32 v95, s53, v23
    s_waitcnt vmcnt(11)
    v_lshlrev_b32 v96, 16, v24
    v_and_b32 v97, s53, v24
    v_lshlrev_b32 v98, 16, v25
    v_and_b32 v99, s53, v25
    v_lshlrev_b32 v100, 16, v26
    v_and_b32 v101, s53, v26
    v_lshlrev_b32 v102, 16, v27
    v_and_b32 v103, s53, v27
    s_waitcnt vmcnt(10)
    v_lshlrev_b32 v104, 16, v28
    v_and_b32 v105, s53, v28
    v_lshlrev_b32 v106, 16, v29
    v_and_b32 v107, s53, v29
    v_lshlrev_b32 v108, 16, v30
    v_and_b32 v109, s53, v30
    v_lshlrev_b32 v110, 16, v31
    v_and_b32 v111, s53, v31
    s_waitcnt vmcnt(9)
    v_lshlrev_b32 v112, 16, v32
    v_and_b32 v113, s53, v32
    v_lshlrev_b32 v114, 16, v33
    v_and_b32 v115, s53, v33
    v_lshlrev_b32 v116, 16, v34
    v_and_b32 v117, s53, v34
    v_lshlrev_b32 v118, 16, v35
    v_and_b32 v119, s53, v35
    s_waitcnt vmcnt(8)
    v_lshlrev_b32 v120, 16, v36
    v_and_b32 v121, s53, v36
    v_lshlrev_b32 v122, 16, v37
    v_and_b32 v123, s53, v37
    v_lshlrev_b32 v124, 16, v38
    v_and_b32 v125, s53, v38
    v_lshlrev_b32 v126, 16, v39
    v_and_b32 v127, s53, v39
    s_waitcnt vmcnt(7)
    v_lshlrev_b32 v128, 16, v40
    v_and_b32 v129, s53, v40
    v_lshlrev_b32 v130, 16, v41
    v_and_b32 v131, s53, v41
    v_lshlrev_b32 v132, 16, v42
    v_and_b32 v133, s53, v42
    v_lshlrev_b32 v134, 16, v43
    v_and_b32 v135, s53, v43
    v_pk_add_f32 v[4:5], v[80:81], v[82:83]
    v_pk_add_f32 v[4:5], v[4:5], v[84:85]
    v_pk_add_f32 v[4:5], v[4:5], v[86:87]
    v_pk_add_f32 v[4:5], v[4:5], v[88:89]
    v_pk_add_f32 v[4:5], v[4:5], v[90:91]
    v_pk_add_f32 v[4:5], v[4:5], v[92:93]
    v_pk_add_f32 v[4:5], v[4:5], v[94:95]
    v_pk_add_f32 v[4:5], v[4:5], v[96:97]
    v_pk_add_f32 v[4:5], v[4:5], v[98:99]
    v_pk_add_f32 v[4:5], v[4:5], v[100:101]
    v_pk_add_f32 v[4:5], v[4:5], v[102:103]
    v_pk_add_f32 v[4:5], v[4:5], v[104:105]
    v_pk_add_f32 v[4:5], v[4:5], v[106:107]
    v_pk_add_f32 v[4:5], v[4:5], v[108:109]
    v_pk_add_f32 v[4:5], v[4:5], v[110:111]
    v_pk_add_f32 v[4:5], v[4:5], v[112:113]
    v_pk_add_f32 v[4:5], v[4:5], v[114:115]
    v_pk_add_f32 v[4:5], v[4:5], v[116:117]
    v_pk_add_f32 v[4:5], v[4:5], v[118:119]
    v_pk_add_f32 v[4:5], v[4:5], v[120:121]
    v_pk_add_f32 v[4:5], v[4:5], v[122:123]
    v_pk_add_f32 v[4:5], v[4:5], v[124:125]
    v_pk_add_f32 v[4:5], v[4:5], v[126:127]
    v_pk_add_f32 v[4:5], v[4:5], v[128:129]
    v_pk_add_f32 v[4:5], v[4:5], v[130:131]
    v_pk_add_f32 v[4:5], v[4:5], v[132:133]
    v_pk_add_f32 v[4:5], v[4:5], v[134:135]
    v_add_f32 v4, v4, v5
    s_nop 1
    v_add_f32_dpp v4, v4, v4 quad_perm:[1,0,3,2] row_mask:0xf bank_mask:0xf
    s_nop 1
    v_add_f32_dpp v4, v4, v4 quad_perm:[2,3,0,1] row_mask:0xf bank_mask:0xf
    s_nop 1
    v_add_f32_dpp v4, v4, v4 row_half_mirror row_mask:0xf bank_mask:0xf
    v_mul_f32 v4, s54, v4
    v_pk_add_f32 v[80:81], v[80:81], v[4:5] op_sel_hi:[1,0] neg_lo:[0,1] neg_hi:[0,1]
    v_pk_add_f32 v[82:83], v[82:83], v[4:5] op_sel_hi:[1,0] neg_lo:[0,1] neg_hi:[0,1]
    v_pk_add_f32 v[84:85], v[84:85], v[4:5] op_sel_hi:[1,0] neg_lo:[0,1] neg_hi:[0,1]
    v_pk_add_f32 v[86:87], v[86:87], v[4:5] op_sel_hi:[1,0] neg_lo:[0,1] neg_hi:[0,1]
    v_pk_add_f32 v[88:89], v[88:89], v[4:5] op_sel_hi:[1,0] neg_lo:[0,1] neg_hi:[0,1]
    v_pk_add_f32 v[90:91], v[90:91], v[4:5] op_sel_hi:[1,0] neg_lo:[0,1] neg_hi:[0,1]
    v_pk_add_f32 v[92:93], v[92:93], v[4:5] op_sel_hi:[1,0] neg_lo:[0,1] neg_hi:[0,1]
    v_pk_add_f32 v[94:95], v[94:95], v[4:5] op_sel_hi:[1,0] neg_lo:[0,1] neg_hi:[0,1]
    v_pk_add_f32 v[96:97], v[96:97], v[4:5] op_sel_hi:[1,0] neg_lo:[0,1] neg_hi:[0,1]
    v_pk_add_f32 v[98:99], v[98:99], v[4:5] op_sel_hi:[1,0] neg_lo:[0,1] neg_hi:[0,1]
    v_pk_add_f32 v[100:101], v[100:101], v[4:5] op_sel_hi:[1,0] neg_lo:[0,1] neg_hi:[0,1]
    v_pk_add_f32 v[102:103], v[102:103], v[4:5] op_sel_hi:[1,0] neg_lo:[0,1] neg_hi:[0,1]
    v_pk_add_f32 v[104:105], v[104:105], v[4:5] op_sel_hi:[1,0] neg_lo:[0,1] neg_hi:[0,1]
    v_pk_add_f32 v[106:107], v[106:107], v[4:5] op_sel_hi:[1,0] neg_lo:[0,1] neg_hi:[0,1]
    v_pk_add_f32 v[108:109], v[108:109], v[4:5] op_sel_hi:[1,0] neg_lo:[0,1] neg_hi:[0,1]
    v_pk_add_f32 v[110:111], v[110:111], v[4:5] op_sel_hi:[1,0] neg_lo:[0,1] neg_hi:[0,1]
    v_pk_add_f32 v[112:113], v[112:113], v[4:5] op_sel_hi:[1,0] neg_lo:[0,1] neg_hi:[0,1]
    v_pk_add_f32 v[114:115], v[114:115], v[4:5] op_sel_hi:[1,0] neg_lo:[0,1] neg_hi:[0,1]
    v_pk_add_f32 v[116:117], v[116:117], v[4:5] op_sel_hi:[1,0] neg_lo:[0,1] neg_hi:[0,1]
    v_pk_add_f32 v[118:119], v[118:119], v[4:5] op_sel_hi:[1,0] neg_lo:[0,1] neg_hi:[0,1]
    v_pk_add_f32 v[120:121], v[120:121], v[4:5] op_sel_hi:[1,0] neg_lo:[0,1] neg_hi:[0,1]
    v_pk_add_f32 v[122:123], v[122:123], v[4:5] op_sel_hi:[1,0] neg_lo:[0,1] neg_hi:[0,1]
    v_pk_add_f32 v[124:125], v[124:125], v[4:5] op_sel_hi:[1,0] neg_lo:[0,1] neg_hi:[0,1]
    v_pk_add_f32 v[126:127], v[126:127], v[4:5] op_sel_hi:[1,0] neg_lo:[0,1] neg_hi:[0,1]
    v_pk_add_f32 v[128:129], v[128:129], v[4:5] op_sel_hi:[1,0] neg_lo:[0,1] neg_hi:[0,1]
    v_pk_add_f32 v[130:131], v[130:131], v[4:5] op_sel_hi:[1,0] neg_lo:[0,1] neg_hi:[0,1]
    v_pk_add_f32 v[132:133], v[132:133], v[4:5] op_sel_hi:[1,0] neg_lo:[0,1] neg_hi:[0,1]
    v_pk_add_f32 v[134:135], v[134:135], v[4:5] op_sel_hi:[1,0] neg_lo:[0,1] neg_hi:[0,1]
    v_pk_mul_f32 v[12:13], v[80:81], v[80:81]
    v_pk_fma_f32 v[12:13], v[82:83], v[82:83], v[12:13]
    v_pk_fma_f32 v[12:13], v[84:85], v[84:85], v[12:13]
    v_pk_fma_f32 v[12:13], v[86:87], v[86:87], v[12:13]
    v_pk_fma_f32 v[12:13], v[88:89], v[88:89], v[12:13]
    v_pk_fma_f32 v[12:13], v[90:91], v[90:91], v[12:13]
    v_pk_fma_f32 v[12:13], v[92:93], v[92:93], v[12:13]
    v_pk_fma_f32 v[12:13], v[94:95], v[94:95], v[12:13]
    v_pk_fma_f32 v[12:13], v[96:97], v[96:97], v[12:13]
    v_pk_fma_f32 v[12:13], v[98:99], v[98:99], v[12:13]
    v_pk_fma_f32 v[12:13], v[100:101], v[100:101], v[12:13]
    v_pk_fma_f32 v[12:13], v[102:103], v[102:103], v[12:13]
    v_pk_fma_f32 v[12:13], v[104:105], v[104:105], v[12:13]
    v_pk_fma_f32 v[12:13], v[106:107], v[106:107], v[12:13]
    v_pk_fma_f32 v[12:13], v[108:109], v[108:109], v[12:13]
    v_pk_fma_f32 v[12:13], v[110:111], v[110:111], v[12:13]
    v_pk_fma_f32 v[12:13], v[112:113], v[112:113], v[12:13]
    v_pk_fma_f32 v[12:13], v[114:115], v[114:115], v[12:13]
    v_pk_fma_f32 v[12:13], v[116:117], v[116:117], v[12:13]
    v_pk_fma_f32 v[12:13], v[118:119], v[118:119], v[12:13]
    v_pk_fma_f32 v[12:13], v[120:121], v[120:121], v[12:13]
    v_pk_fma_f32 v[12:13], v[122:123], v[122:123], v[12:13]
    v_pk_fma_f32 v[12:13], v[124:125], v[124:125], v[12:13]
    v_pk_fma_f32 v[12:13], v[126:127], v[126:127], v[12:13]
    v_pk_fma_f32 v[12:13], v[128:129], v[128:129], v[12:13]
    v_pk_fma_f32 v[12:13], v[130:131], v[130:131], v[12:13]
    v_pk_fma_f32 v[12:13], v[132:133], v[132:133], v[12:13]
    v_pk_fma_f32 v[12:13], v[134:135], v[134:135], v[12:13]
    v_add_f32 v12, v12, v13
    s_nop 1
    v_add_f32_dpp v12, v12, v12 quad_perm:[1,0,3,2] row_mask:0xf bank_mask:0xf
    s_nop 1
    v_add_f32_dpp v12, v12, v12 quad_perm:[2,3,0,1] row_mask:0xf bank_mask:0xf
    s_nop 1
    v_add_f32_dpp v12, v12, v12 row_half_mirror row_mask:0xf bank_mask:0xf
    v_mov_b32 v13, s55
    v_fmac_f32 v13, s54, v12
    v_rsq_f32 v12, v13
    s_nop 0
    v_pk_mul_f32 v[80:81], v[80:81], v[12:13] op_sel_hi:[1,0]
    v_cvt_pk_bf16_f32 v16, v80, v81
    v_pk_mul_f32 v[82:83], v[82:83], v[12:13] op_sel_hi:[1,0]
    v_cvt_pk_bf16_f32 v17, v82, v83
    v_pk_mul_f32 v[84:85], v[84:85], v[12:13] op_sel_hi:[1,0]
    v_cvt_pk_bf16_f32 v18, v84, v85
    v_pk_mul_f32 v[86:87], v[86:87], v[12:13] op_sel_hi:[1,0]
    v_cvt_pk_bf16_f32 v19, v86, v87
    v_pk_mul_f32 v[88:89], v[88:89], v[12:13] op_sel_hi:[1,0]
    v_cvt_pk_bf16_f32 v20, v88, v89
    v_pk_mul_f32 v[90:91], v[90:91], v[12:13] op_sel_hi:[1,0]
    v_cvt_pk_bf16_f32 v21, v90, v91
    v_pk_mul_f32 v[92:93], v[92:93], v[12:13] op_sel_hi:[1,0]
    v_cvt_pk_bf16_f32 v22, v92, v93
    v_pk_mul_f32 v[94:95], v[94:95], v[12:13] op_sel_hi:[1,0]
    v_cvt_pk_bf16_f32 v23, v94, v95
    v_pk_mul_f32 v[96:97], v[96:97], v[12:13] op_sel_hi:[1,0]
    v_cvt_pk_bf16_f32 v24, v96, v97
    v_pk_mul_f32 v[98:99], v[98:99], v[12:13] op_sel_hi:[1,0]
    v_cvt_pk_bf16_f32 v25, v98, v99
    v_pk_mul_f32 v[100:101], v[100:101], v[12:13] op_sel_hi:[1,0]
    v_cvt_pk_bf16_f32 v26, v100, v101
    v_pk_mul_f32 v[102:103], v[102:103], v[12:13] op_sel_hi:[1,0]
    v_cvt_pk_bf16_f32 v27, v102, v103
    v_pk_mul_f32 v[104:105], v[104:105], v[12:13] op_sel_hi:[1,0]
    v_cvt_pk_bf16_f32 v28, v104, v105
    v_pk_mul_f32 v[106:107], v[106:107], v[12:13] op_sel_hi:[1,0]
    v_cvt_pk_bf16_f32 v29, v106, v107
    v_pk_mul_f32 v[108:109], v[108:109], v[12:13] op_sel_hi:[1,0]
    v_cvt_pk_bf16_f32 v30, v108, v109
    v_pk_mul_f32 v[110:111], v[110:111], v[12:13] op_sel_hi:[1,0]
    v_cvt_pk_bf16_f32 v31, v110, v111
    v_pk_mul_f32 v[112:113], v[112:113], v[12:13] op_sel_hi:[1,0]
    v_cvt_pk_bf16_f32 v32, v112, v113
    v_pk_mul_f32 v[114:115], v[114:115], v[12:13] op_sel_hi:[1,0]
    v_cvt_pk_bf16_f32 v33, v114, v115
    v_pk_mul_f32 v[116:117], v[116:117], v[12:13] op_sel_hi:[1,0]
    v_cvt_pk_bf16_f32 v34, v116, v117
    v_pk_mul_f32 v[118:119], v[118:119], v[12:13] op_sel_hi:[1,0]
    v_cvt_pk_bf16_f32 v35, v118, v119
    v_pk_mul_f32 v[120:121], v[120:121], v[12:13] op_sel_hi:[1,0]
    v_cvt_pk_bf16_f32 v36, v120, v121
    v_pk_mul_f32 v[122:123], v[122:123], v[12:13] op_sel_hi:[1,0]
    v_cvt_pk_bf16_f32 v37, v122, v123
    v_pk_mul_f32 v[124:125], v[124:125], v[12:13] op_sel_hi:[1,0]
    v_cvt_pk_bf16_f32 v38, v124, v125
    v_pk_mul_f32 v[126:127], v[126:127], v[12:13] op_sel_hi:[1,0]
    v_cvt_pk_bf16_f32 v39, v126, v127
    v_pk_mul_f32 v[128:129], v[128:129], v[12:13] op_sel_hi:[1,0]
    v_cvt_pk_bf16_f32 v40, v128, v129
    v_pk_mul_f32 v[130:131], v[130:131], v[12:13] op_sel_hi:[1,0]
    v_cvt_pk_bf16_f32 v41, v130, v131
    v_pk_mul_f32 v[132:133], v[132:133], v[12:13] op_sel_hi:[1,0]
    v_cvt_pk_bf16_f32 v42, v132, v133
    v_pk_mul_f32 v[134:135], v[134:135], v[12:13] op_sel_hi:[1,0]
    v_cvt_pk_bf16_f32 v43, v134, v135
    s_add_u32 s56, s51, 11550720
    buffer_store_dwordx4 v[16:19], v3, s[8:11], s56 offen offset:0 sc1
    buffer_store_dwordx4 v[20:23], v3, s[8:11], s56 offen offset:128 sc1
    buffer_store_dwordx4 v[24:27], v3, s[8:11], s56 offen offset:256 sc1
    buffer_store_dwordx4 v[28:31], v3, s[8:11], s56 offen offset:384 sc1
    buffer_store_dwordx4 v[32:35], v3, s[8:11], s56 offen offset:512 sc1
    buffer_store_dwordx4 v[36:39], v3, s[8:11], s56 offen offset:640 sc1
    buffer_store_dwordx4 v[40:43], v3, s[8:11], s56 offen offset:768 sc1
    s_waitcnt vmcnt(13)
    v_lshlrev_b32 v80, 16, v44
    v_and_b32 v81, s53, v44
    v_lshlrev_b32 v82, 16, v45
    v_and_b32 v83, s53, v45
    v_lshlrev_b32 v84, 16, v46
    v_and_b32 v85, s53, v46
    v_lshlrev_b32 v86, 16, v47
    v_and_b32 v87, s53, v47
    s_waitcnt vmcnt(12)
    v_lshlrev_b32 v88, 16, v48
    v_and_b32 v89, s53, v48
    v_lshlrev_b32 v90, 16, v49
    v_and_b32 v91, s53, v49
    v_lshlrev_b32 v92, 16, v50
    v_and_b32 v93, s53, v50
    v_lshlrev_b32 v94, 16, v51
    v_and_b32 v95, s53, v51
    s_waitcnt vmcnt(11)
    v_lshlrev_b32 v96, 16, v52
    v_and_b32 v97, s53, v52
    v_lshlrev_b32 v98, 16, v53
    v_and_b32 v99, s53, v53
    v_lshlrev_b32 v100, 16, v54
    v_and_b32 v101, s53, v54
    v_lshlrev_b32 v102, 16, v55
    v_and_b32 v103, s53, v55
    s_waitcnt vmcnt(10)
    v_lshlrev_b32 v104, 16, v56
    v_and_b32 v105, s53, v56
    v_lshlrev_b32 v106, 16, v57
    v_and_b32 v107, s53, v57
    v_lshlrev_b32 v108, 16, v58
    v_and_b32 v109, s53, v58
    v_lshlrev_b32 v110, 16, v59
    v_and_b32 v111, s53, v59
    s_waitcnt vmcnt(9)
    v_lshlrev_b32 v112, 16, v60
    v_and_b32 v113, s53, v60
    v_lshlrev_b32 v114, 16, v61
    v_and_b32 v115, s53, v61
    v_lshlrev_b32 v116, 16, v62
    v_and_b32 v117, s53, v62
    v_lshlrev_b32 v118, 16, v63
    v_and_b32 v119, s53, v63
    s_waitcnt vmcnt(8)
    v_lshlrev_b32 v120, 16, v64
    v_and_b32 v121, s53, v64
    v_lshlrev_b32 v122, 16, v65
    v_and_b32 v123, s53, v65
    v_lshlrev_b32 v124, 16, v66
    v_and_b32 v125, s53, v66
    v_lshlrev_b32 v126, 16, v67
    v_and_b32 v127, s53, v67
    s_waitcnt vmcnt(7)
    v_lshlrev_b32 v128, 16, v68
    v_and_b32 v129, s53, v68
    v_lshlrev_b32 v130, 16, v69
    v_and_b32 v131, s53, v69
    v_lshlrev_b32 v132, 16, v70
    v_and_b32 v133, s53, v70
    v_lshlrev_b32 v134, 16, v71
    v_and_b32 v135, s53, v71
    v_pk_add_f32 v[4:5], v[80:81], v[82:83]
    v_pk_add_f32 v[4:5], v[4:5], v[84:85]
    v_pk_add_f32 v[4:5], v[4:5], v[86:87]
    v_pk_add_f32 v[4:5], v[4:5], v[88:89]
    v_pk_add_f32 v[4:5], v[4:5], v[90:91]
    v_pk_add_f32 v[4:5], v[4:5], v[92:93]
    v_pk_add_f32 v[4:5], v[4:5], v[94:95]
    v_pk_add_f32 v[4:5], v[4:5], v[96:97]
    v_pk_add_f32 v[4:5], v[4:5], v[98:99]
    v_pk_add_f32 v[4:5], v[4:5], v[100:101]
    v_pk_add_f32 v[4:5], v[4:5], v[102:103]
    v_pk_add_f32 v[4:5], v[4:5], v[104:105]
    v_pk_add_f32 v[4:5], v[4:5], v[106:107]
    v_pk_add_f32 v[4:5], v[4:5], v[108:109]
    v_pk_add_f32 v[4:5], v[4:5], v[110:111]
    v_pk_add_f32 v[4:5], v[4:5], v[112:113]
    v_pk_add_f32 v[4:5], v[4:5], v[114:115]
    v_pk_add_f32 v[4:5], v[4:5], v[116:117]
    v_pk_add_f32 v[4:5], v[4:5], v[118:119]
    v_pk_add_f32 v[4:5], v[4:5], v[120:121]
    v_pk_add_f32 v[4:5], v[4:5], v[122:123]
    v_pk_add_f32 v[4:5], v[4:5], v[124:125]
    v_pk_add_f32 v[4:5], v[4:5], v[126:127]
    v_pk_add_f32 v[4:5], v[4:5], v[128:129]
    v_pk_add_f32 v[4:5], v[4:5], v[130:131]
    v_pk_add_f32 v[4:5], v[4:5], v[132:133]
    v_pk_add_f32 v[4:5], v[4:5], v[134:135]
    v_add_f32 v4, v4, v5
    s_nop 1
    v_add_f32_dpp v4, v4, v4 quad_perm:[1,0,3,2] row_mask:0xf bank_mask:0xf
    s_nop 1
    v_add_f32_dpp v4, v4, v4 quad_perm:[2,3,0,1] row_mask:0xf bank_mask:0xf
    s_nop 1
    v_add_f32_dpp v4, v4, v4 row_half_mirror row_mask:0xf bank_mask:0xf
    v_mul_f32 v4, s54, v4
    v_pk_add_f32 v[80:81], v[80:81], v[4:5] op_sel_hi:[1,0] neg_lo:[0,1] neg_hi:[0,1]
    v_pk_add_f32 v[82:83], v[82:83], v[4:5] op_sel_hi:[1,0] neg_lo:[0,1] neg_hi:[0,1]
    v_pk_add_f32 v[84:85], v[84:85], v[4:5] op_sel_hi:[1,0] neg_lo:[0,1] neg_hi:[0,1]
    v_pk_add_f32 v[86:87], v[86:87], v[4:5] op_sel_hi:[1,0] neg_lo:[0,1] neg_hi:[0,1]
    v_pk_add_f32 v[88:89], v[88:89], v[4:5] op_sel_hi:[1,0] neg_lo:[0,1] neg_hi:[0,1]
    v_pk_add_f32 v[90:91], v[90:91], v[4:5] op_sel_hi:[1,0] neg_lo:[0,1] neg_hi:[0,1]
    v_pk_add_f32 v[92:93], v[92:93], v[4:5] op_sel_hi:[1,0] neg_lo:[0,1] neg_hi:[0,1]
    v_pk_add_f32 v[94:95], v[94:95], v[4:5] op_sel_hi:[1,0] neg_lo:[0,1] neg_hi:[0,1]
    v_pk_add_f32 v[96:97], v[96:97], v[4:5] op_sel_hi:[1,0] neg_lo:[0,1] neg_hi:[0,1]
    v_pk_add_f32 v[98:99], v[98:99], v[4:5] op_sel_hi:[1,0] neg_lo:[0,1] neg_hi:[0,1]
    v_pk_add_f32 v[100:101], v[100:101], v[4:5] op_sel_hi:[1,0] neg_lo:[0,1] neg_hi:[0,1]
    v_pk_add_f32 v[102:103], v[102:103], v[4:5] op_sel_hi:[1,0] neg_lo:[0,1] neg_hi:[0,1]
    v_pk_add_f32 v[104:105], v[104:105], v[4:5] op_sel_hi:[1,0] neg_lo:[0,1] neg_hi:[0,1]
    v_pk_add_f32 v[106:107], v[106:107], v[4:5] op_sel_hi:[1,0] neg_lo:[0,1] neg_hi:[0,1]
    v_pk_add_f32 v[108:109], v[108:109], v[4:5] op_sel_hi:[1,0] neg_lo:[0,1] neg_hi:[0,1]
    v_pk_add_f32 v[110:111], v[110:111], v[4:5] op_sel_hi:[1,0] neg_lo:[0,1] neg_hi:[0,1]
    v_pk_add_f32 v[112:113], v[112:113], v[4:5] op_sel_hi:[1,0] neg_lo:[0,1] neg_hi:[0,1]
    v_pk_add_f32 v[114:115], v[114:115], v[4:5] op_sel_hi:[1,0] neg_lo:[0,1] neg_hi:[0,1]
    v_pk_add_f32 v[116:117], v[116:117], v[4:5] op_sel_hi:[1,0] neg_lo:[0,1] neg_hi:[0,1]
    v_pk_add_f32 v[118:119], v[118:119], v[4:5] op_sel_hi:[1,0] neg_lo:[0,1] neg_hi:[0,1]
    v_pk_add_f32 v[120:121], v[120:121], v[4:5] op_sel_hi:[1,0] neg_lo:[0,1] neg_hi:[0,1]
    v_pk_add_f32 v[122:123], v[122:123], v[4:5] op_sel_hi:[1,0] neg_lo:[0,1] neg_hi:[0,1]
    v_pk_add_f32 v[124:125], v[124:125], v[4:5] op_sel_hi:[1,0] neg_lo:[0,1] neg_hi:[0,1]
    v_pk_add_f32 v[126:127], v[126:127], v[4:5] op_sel_hi:[1,0] neg_lo:[0,1] neg_hi:[0,1]
    v_pk_add_f32 v[128:129], v[128:129], v[4:5] op_sel_hi:[1,0] neg_lo:[0,1] neg_hi:[0,1]
    v_pk_add_f32 v[130:131], v[130:131], v[4:5] op_sel_hi:[1,0] neg_lo:[0,1] neg_hi:[0,1]
    v_pk_add_f32 v[132:133], v[132:133], v[4:5] op_sel_hi:[1,0] neg_lo:[0,1] neg_hi:[0,1]
    v_pk_add_f32 v[134:135], v[134:135], v[4:5] op_sel_hi:[1,0] neg_lo:[0,1] neg_hi:[0,1]
    v_pk_mul_f32 v[12:13], v[80:81], v[80:81]
    v_pk_fma_f32 v[12:13], v[82:83], v[82:83], v[12:13]
    v_pk_fma_f32 v[12:13], v[84:85], v[84:85], v[12:13]
    v_pk_fma_f32 v[12:13], v[86:87], v[86:87], v[12:13]
    v_pk_fma_f32 v[12:13], v[88:89], v[88:89], v[12:13]
    v_pk_fma_f32 v[12:13], v[90:91], v[90:91], v[12:13]
    v_pk_fma_f32 v[12:13], v[92:93], v[92:93], v[12:13]
    v_pk_fma_f32 v[12:13], v[94:95], v[94:95], v[12:13]
    v_pk_fma_f32 v[12:13], v[96:97], v[96:97], v[12:13]
    v_pk_fma_f32 v[12:13], v[98:99], v[98:99], v[12:13]
    v_pk_fma_f32 v[12:13], v[100:101], v[100:101], v[12:13]
    v_pk_fma_f32 v[12:13], v[102:103], v[102:103], v[12:13]
    v_pk_fma_f32 v[12:13], v[104:105], v[104:105], v[12:13]
    v_pk_fma_f32 v[12:13], v[106:107], v[106:107], v[12:13]
    v_pk_fma_f32 v[12:13], v[108:109], v[108:109], v[12:13]
    v_pk_fma_f32 v[12:13], v[110:111], v[110:111], v[12:13]
    v_pk_fma_f32 v[12:13], v[112:113], v[112:113], v[12:13]
    v_pk_fma_f32 v[12:13], v[114:115], v[114:115], v[12:13]
    v_pk_fma_f32 v[12:13], v[116:117], v[116:117], v[12:13]
    v_pk_fma_f32 v[12:13], v[118:119], v[118:119], v[12:13]
    v_pk_fma_f32 v[12:13], v[120:121], v[120:121], v[12:13]
    v_pk_fma_f32 v[12:13], v[122:123], v[122:123], v[12:13]
    v_pk_fma_f32 v[12:13], v[124:125], v[124:125], v[12:13]
    v_pk_fma_f32 v[12:13], v[126:127], v[126:127], v[12:13]
    v_pk_fma_f32 v[12:13], v[128:129], v[128:129], v[12:13]
    v_pk_fma_f32 v[12:13], v[130:131], v[130:131], v[12:13]
    v_pk_fma_f32 v[12:13], v[132:133], v[132:133], v[12:13]
    v_pk_fma_f32 v[12:13], v[134:135], v[134:135], v[12:13]
    v_add_f32 v12, v12, v13
    s_nop 1
    v_add_f32_dpp v12, v12, v12 quad_perm:[1,0,3,2] row_mask:0xf bank_mask:0xf
    s_nop 1
    v_add_f32_dpp v12, v12, v12 quad_perm:[2,3,0,1] row_mask:0xf bank_mask:0xf
    s_nop 1
    v_add_f32_dpp v12, v12, v12 row_half_mirror row_mask:0xf bank_mask:0xf
    v_mov_b32 v13, s55
    v_fmac_f32 v13, s54, v12
    v_rsq_f32 v12, v13
    s_nop 0
    v_pk_mul_f32 v[80:81], v[80:81], v[12:13] op_sel_hi:[1,0]
    v_cvt_pk_bf16_f32 v44, v80, v81
    v_pk_mul_f32 v[82:83], v[82:83], v[12:13] op_sel_hi:[1,0]
    v_cvt_pk_bf16_f32 v45, v82, v83
    v_pk_mul_f32 v[84:85], v[84:85], v[12:13] op_sel_hi:[1,0]
    v_cvt_pk_bf16_f32 v46, v84, v85
    v_pk_mul_f32 v[86:87], v[86:87], v[12:13] op_sel_hi:[1,0]
    v_cvt_pk_bf16_f32 v47, v86, v87
    v_pk_mul_f32 v[88:89], v[88:89], v[12:13] op_sel_hi:[1,0]
    v_cvt_pk_bf16_f32 v48, v88, v89
    v_pk_mul_f32 v[90:91], v[90:91], v[12:13] op_sel_hi:[1,0]
    v_cvt_pk_bf16_f32 v49, v90, v91
    v_pk_mul_f32 v[92:93], v[92:93], v[12:13] op_sel_hi:[1,0]
    v_cvt_pk_bf16_f32 v50, v92, v93
    v_pk_mul_f32 v[94:95], v[94:95], v[12:13] op_sel_hi:[1,0]
    v_cvt_pk_bf16_f32 v51, v94, v95
    v_pk_mul_f32 v[96:97], v[96:97], v[12:13] op_sel_hi:[1,0]
    v_cvt_pk_bf16_f32 v52, v96, v97
    v_pk_mul_f32 v[98:99], v[98:99], v[12:13] op_sel_hi:[1,0]
    v_cvt_pk_bf16_f32 v53, v98, v99
    v_pk_mul_f32 v[100:101], v[100:101], v[12:13] op_sel_hi:[1,0]
    v_cvt_pk_bf16_f32 v54, v100, v101
    v_pk_mul_f32 v[102:103], v[102:103], v[12:13] op_sel_hi:[1,0]
    v_cvt_pk_bf16_f32 v55, v102, v103
    v_pk_mul_f32 v[104:105], v[104:105], v[12:13] op_sel_hi:[1,0]
    v_cvt_pk_bf16_f32 v56, v104, v105
    v_pk_mul_f32 v[106:107], v[106:107], v[12:13] op_sel_hi:[1,0]
    v_cvt_pk_bf16_f32 v57, v106, v107
    v_pk_mul_f32 v[108:109], v[108:109], v[12:13] op_sel_hi:[1,0]
    v_cvt_pk_bf16_f32 v58, v108, v109
    v_pk_mul_f32 v[110:111], v[110:111], v[12:13] op_sel_hi:[1,0]
    v_cvt_pk_bf16_f32 v59, v110, v111
    v_pk_mul_f32 v[112:113], v[112:113], v[12:13] op_sel_hi:[1,0]
    v_cvt_pk_bf16_f32 v60, v112, v113
    v_pk_mul_f32 v[114:115], v[114:115], v[12:13] op_sel_hi:[1,0]
    v_cvt_pk_bf16_f32 v61, v114, v115
    v_pk_mul_f32 v[116:117], v[116:117], v[12:13] op_sel_hi:[1,0]
    v_cvt_pk_bf16_f32 v62, v116, v117
    v_pk_mul_f32 v[118:119], v[118:119], v[12:13] op_sel_hi:[1,0]
    v_cvt_pk_bf16_f32 v63, v118, v119
    v_pk_mul_f32 v[120:121], v[120:121], v[12:13] op_sel_hi:[1,0]
    v_cvt_pk_bf16_f32 v64, v120, v121
    v_pk_mul_f32 v[122:123], v[122:123], v[12:13] op_sel_hi:[1,0]
    v_cvt_pk_bf16_f32 v65, v122, v123
    v_pk_mul_f32 v[124:125], v[124:125], v[12:13] op_sel_hi:[1,0]
    v_cvt_pk_bf16_f32 v66, v124, v125
    v_pk_mul_f32 v[126:127], v[126:127], v[12:13] op_sel_hi:[1,0]
    v_cvt_pk_bf16_f32 v67, v126, v127
    v_pk_mul_f32 v[128:129], v[128:129], v[12:13] op_sel_hi:[1,0]
    v_cvt_pk_bf16_f32 v68, v128, v129
    v_pk_mul_f32 v[130:131], v[130:131], v[12:13] op_sel_hi:[1,0]
    v_cvt_pk_bf16_f32 v69, v130, v131
    v_pk_mul_f32 v[132:133], v[132:133], v[12:13] op_sel_hi:[1,0]
    v_cvt_pk_bf16_f32 v70, v132, v133
    v_pk_mul_f32 v[134:135], v[134:135], v[12:13] op_sel_hi:[1,0]
    v_cvt_pk_bf16_f32 v71, v134, v135
    s_add_u32 s56, s52, 11550720
    buffer_store_dwordx4 v[44:47], v3, s[8:11], s56 offen offset:0 sc1
    buffer_store_dwordx4 v[48:51], v3, s[8:11], s56 offen offset:128 sc1
    buffer_store_dwordx4 v[52:55], v3, s[8:11], s56 offen offset:256 sc1
    buffer_store_dwordx4 v[56:59], v3, s[8:11], s56 offen offset:384 sc1
    buffer_store_dwordx4 v[60:63], v3, s[8:11], s56 offen offset:512 sc1
    buffer_store_dwordx4 v[64:67], v3, s[8:11], s56 offen offset:640 sc1
    buffer_store_dwordx4 v[68:71], v3, s[8:11], s56 offen offset:768 sc1
    s_cmp_lg_u32 s22, 0
    s_cbranch_scc1 Lln_home
    v_bfe_u32 v2, v0, 2, 3
    v_mul_u32_u24 v2, 224, v2
    v_and_b32 v4, 3, v0
    v_lshl_add_u32 v2, v4, 1, v2
    v_lshrrev_b32 v4, 5, v0
    v_add_u32 v2, v2, v4
    v_lshlrev_b32 v2, 2, v2
    s_lshl_b32 s51, s20, 5
    s_lshl_b32 s52, s20, 8
    v_lshl_add_u32 v4, v0, 2, s52
    s_mov_b32 s52, 4096
    s_mov_b32 s53, 8192
    s_mov_b32 s54, 12288
    buffer_load_dword v80, v2, s[16:19], s51 offen offset:0
    buffer_load_dword v81, v2, s[16:19], s51 offen offset:128
    buffer_load_dword v82, v2, s[16:19], s51 offen offset:256
    buffer_load_dword v83, v2, s[16:19], s51 offen offset:384
    buffer_load_dword v84, v2, s[16:19], s51 offen offset:512
    buffer_load_dword v85, v2, s[16:19], s51 offen offset:640
    buffer_load_dword v86, v2, s[16:19], s51 offen offset:768
    s_waitcnt vmcnt(6)
    buffer_store_dword v80, v4, s[8:11], 0 offen offset:0 sc1
    buffer_store_dword v80, v4, s[8:11], s53 offen offset:0 sc1
    s_waitcnt vmcnt(7)
    buffer_store_dword v81, v4, s[8:11], 0 offen offset:1024 sc1
    buffer_store_dword v81, v4, s[8:11], s53 offen offset:1024 sc1
    s_waitcnt vmcnt(8)
    buffer_store_dword v82, v4, s[8:11], 0 offen offset:2048 sc1
    buffer_store_dword v82, v4, s[8:11], s53 offen offset:2048 sc1
    s_waitcnt vmcnt(9)
    buffer_store_dword v83, v4, s[8:11], 0 offen offset:3072 sc1
    buffer_store_dword v83, v4, s[8:11], s53 offen offset:3072 sc1
    s_waitcnt vmcnt(10)
    buffer_store_dword v84, v4, s[8:11], s52 offen offset:0 sc1
    buffer_store_dword v84, v4, s[8:11], s54 offen offset:0 sc1
    s_waitcnt vmcnt(11)
    buffer_store_dword v85, v4, s[8:11], s52 offen offset:1024 sc1
    buffer_store_dword v85, v4, s[8:11], s54 offen offset:1024 sc1
    s_waitcnt vmcnt(12)
    buffer_store_dword v86, v4, s[8:11], s52 offen offset:2048 sc1
    buffer_store_dword v86, v4, s[8:11], s54 offen offset:2048 sc1
    v_mov_b32 v4, 0
    buffer_store_dword v4, off, s[8:11], s52 offset:3072 sc1
    buffer_store_dword v4, off, s[8:11], s54 offset:3072 sc1
Lln_home:
    v_mov_b32 v12, 0
    s_and_b32 s51, s22, 14
    s_cmp_lg_u32 s51, 14
    s_cbranch_scc1 Lln_novote
    s_and_b32 s51, s20, 1
    s_lshl_b32 s51, s51, 13
    s_lshr_b32 s52, s20, 1
    s_lshl_b32 s52, s52, 9
    s_add_u32 s51, s51, s52
    s_add_u32 s51, s51, 7168
    s_lshl_b32 s52, s22, 14
    s_add_u32 s51, s51, s52
    s_mov_b32 s52, -1
    v_lshlrev_b32 v2, 2, v0
    s_waitcnt vmcnt(0)
    s_barrier
    s_bitcmp0_b32 s20, 0
    s_cbranch_scc0 Lhv_3
    s_memtime s[54:55]
    s_waitcnt lgkmcnt(0)
    buffer_store_dword v2, v2, s[8:11], s51 offen sc1
    s_waitcnt vmcnt(0)
    s_memtime s[56:57]
    s_waitcnt lgkmcnt(0)
    s_sub_u32 s53, s56, s54
    s_min_u32 s52, s52, s53
Lhv_3:
    s_waitcnt vmcnt(0)
    s_barrier
    s_bitcmp1_b32 s20, 0
    s_cbranch_scc0 Lhv_4
    s_memtime s[54:55]
    s_waitcnt lgkmcnt(0)
    buffer_store_dword v2, v2, s[8:11], s51 offen sc1
    s_waitcnt vmcnt(0)
    s_memtime s[56:57]
    s_waitcnt lgkmcnt(0)
    s_sub_u32 s53, s56, s54
    s_min_u32 s52, s52, s53
Lhv_4:
    s_waitcnt vmcnt(0)
    s_barrier
    s_bitcmp0_b32 s20, 0
    s_cbranch_scc0 Lhv_5
    s_memtime s[54:55]
    s_waitcnt lgkmcnt(0)
    buffer_store_dword v2, v2, s[8:11], s51 offen sc1
    s_waitcnt vmcnt(0)
    s_memtime s[56:57]
    s_waitcnt lgkmcnt(0)
    s_sub_u32 s53, s56, s54
    s_min_u32 s52, s52, s53
Lhv_5:
    s_waitcnt vmcnt(0)
    s_barrier
    s_bitcmp1_b32 s20, 0
    s_cbranch_scc0 Lhv_6
    s_memtime s[54:55]
    s_waitcnt lgkmcnt(0)
    buffer_store_dword v2, v2, s[8:11], s51 offen sc1
    s_waitcnt vmcnt(0)
    s_memtime s[56:57]
    s_waitcnt lgkmcnt(0)
    s_sub_u32 s53, s56, s54
    s_min_u32 s52, s52, s53
Lhv_6:
    s_waitcnt vmcnt(0)
    s_barrier
    s_bitcmp0_b32 s20, 0
    s_cbranch_scc0 Lhv_7
    s_memtime s[54:55]
    s_waitcnt lgkmcnt(0)
    buffer_store_dword v2, v2, s[8:11], s51 offen sc1
    s_waitcnt vmcnt(0)
    s_memtime s[56:57]
    s_waitcnt lgkmcnt(0)
    s_sub_u32 s53, s56, s54
    s_min_u32 s52, s52, s53
Lhv_7:
    s_waitcnt vmcnt(0)
    s_barrier
    s_bitcmp1_b32 s20, 0
    s_cbranch_scc0 Lhv_8
    s_memtime s[54:55]
    s_waitcnt lgkmcnt(0)
    buffer_store_dword v2, v2, s[8:11], s51 offen sc1
    s_waitcnt vmcnt(0)
    s_memtime s[56:57]
    s_waitcnt lgkmcnt(0)
    s_sub_u32 s53, s56, s54
    s_min_u32 s52, s52, s53
Lhv_8:
    s_lshl_b32 s53, s20, 2
    v_mov_b32 v4, s53
    v_mov_b32 v5, s52
    ds_write_b32 v4, v5
    v_mov_b32 v4, 0
    s_waitcnt lgkmcnt(0)
    s_barrier
    ds_read_b128 v[8:11], v4
    s_waitcnt lgkmcnt(0)
    v_min_u32 v8, v8, v10
    v_min_u32 v9, v9, v11
    v_cmp_lt_u32 vcc, v9, v8
    s_nop 1
    v_cndmask_b32 v12, 0, 1, vcc
Lln_novote:
    v_mov_b32 v8, -1
    v_mov_b32 v9, -1
    v_mov_b32 v10, -1
    v_mov_b32 v11, -1
    s_lshl_b32 s48, s22, 12
    s_lshl_b32 s49, s20, 10
    s_add_u32 s48, s48, s49
    s_add_u32 s49, s48, 16384
    s_cmp_lt_u32 s22, 12
    s_cselect_b32 s49, s49, 0x40000000
    buffer_store_dwordx4 v[8:11], v1, s[8:11], s49 offen sc1
    s_add_u32 s48, s48, 4210688
    s_cmp_lt_u32 s22, 28
    s_cselect_b32 s48, s48, 0x40000000
    buffer_store_dwordx4 v[8:11], v1, s[8:11], s48 offen sc1
    s_add_u32 s48, s48, 1835008
    buffer_store_dwordx4 v[8:11], v1, s[8:11], s48 offen sc1
    s_add_u32 s48, s48, 1835008
    buffer_store_dwordx4 v[8:11], v1, s[8:11], s48 offen sc1
    s_add_u32 s48, s48, 1835008
    buffer_store_dwordx4 v[8:11], v1, s[8:11], s48 offen sc1
    v_mov_b32 v13, 132
    global_load_dword v13, v13, s[46:47] sc1
    s_lshl_b32 s51, s22, 2
    s_add_u32 s51, s51, s20
    s_lshl_b32 s51, s51, 2
    s_add_u32 s51, s51, 34491904
    s_waitcnt vmcnt(0)
    v_cmp_eq_u32 vcc, 0, v13
    s_cbranch_vccnz Lvwait_10
Lvok_9:
    s_mov_b64 exec, 1
    buffer_store_dword v12, off, s[8:11], s51 sc1
    s_mov_b64 exec, -1
    s_barrier
    s_branch Lmlp
Lattn:
    s_lshr_b32 s25, s22, 1
    s_and_b32 s26, s22, 1
    s_add_u32 s58, s25, 16
    s_cmp_eq_u32 s26, 1
    s_cselect_b32 s27, s25, s58
    s_lshl_b32 s71, s26, 2
    s_add_u32 s71, s71, s20
    s_lshl_b32 s41, s27, 2
    s_add_u32 s41, s41, s20
    s_mul_i32 s41, s41, 57344
    s_add_u32 s41, s41, 13385728
    s_cmp_ge_u32 s27, 28
    s_cselect_b32 s41, 1073741824, s41
    s_lshl_b32 s42, s20, 14
    s_add_u32 s42, s42, 98304
    s_lshr_b32 s43, s27, 2
    s_min_u32 s43, s43, 6
    s_mul_i32 s58, s20, 7
    s_add_u32 s43, s43, s58
    s_lshl_b32 s43, s43, 7
    s_add_u32 s43, s43, 34488320
    s_mov_b32 s39, 34491904
    s_mul_i32 s38, s24, 28672
    s_add_u32 s38, s38, 11550720
    s_cmp_eq_u32 s23, 0
    s_cselect_b32 s38, s38, 1073741824
    s_lshl_b32 s37, s20, 10
    s_add_u32 s37, s37, 32768
    s_cmp_eq_u32 s71, 7
    s_cbranch_scc1 LX_pro
    s_mov_b32 s12, s94
    s_mov_b32 s13, s95
    s_mov_b32 s14, 3670016
    s_mov_b32 s15, 0x20000
    s_mov_b32 s16, s92
    s_mov_b32 s17, s93
    s_mov_b32 s18, 3670016
    s_mov_b32 s19, 0x20000
    v_lshrrev_b32 v112, 5, v0
    v_and_b32 v117, 31, v0
    v_xor_b32 v117, v117, v112
    v_lshlrev_b32 v117, 4, v117
    v_lshl_add_u32 v117, v112, 13, v117
    s_lshl_b32 s48, s20, 6
    v_xor_b32 v2, s48, v117
    v_xor_b32 v3, 32, v2
    s_lshl_b32 s49, s25, 9
    s_lshl_b32 s50, s20, 16
    s_add_u32 s50, s50, s49
    s_lshl_b32 s51, s20, 12
    s_lshl_b32 s52, s71, 19
    s_add_u32 s52, s52, s49
    s_add_u32 s53, s20, 6
    s_lshl_b32 s53, s53, 14
    s_mov_b32 s54, 0x3db8aa3b
    s_add_u32 s55, s52, 0
    s_mov_b32 m0, s53
    v_xor_b32 v112, 0, v117
    buffer_load_dwordx4 v112, s[16:19], s55 offen nt lds
    s_add_u32 s55, s55, 16384
    s_add_u32 m0, m0, 1024
    v_xor_b32 v112, 32, v117
    buffer_load_dwordx4 v112, s[16:19], s55 offen nt lds
    s_add_u32 s55, s55, 16384
    s_add_u32 m0, m0, 1024
    v_xor_b32 v112, 0, v117
    buffer_load_dwordx4 v112, s[16:19], s55 offen nt lds
    s_add_u32 s55, s55, 16384
    s_add_u32 m0, m0, 1024
    v_xor_b32 v112, 32, v117
    buffer_load_dwordx4 v112, s[16:19], s55 offen nt lds
    s_add_u32 s55, s55, 16384
    s_add_u32 m0, m0, 1024
    v_xor_b32 v112, 64, v117
    buffer_load_dwordx4 v112, s[16:19], s55 offen nt lds
    s_add_u32 s55, s55, 16384
    s_add_u32 m0, m0, 1024
    v_xor_b32 v112, 96, v117
    buffer_load_dwordx4 v112, s[16:19], s55 offen nt lds
    s_add_u32 s55, s55, 16384
    s_add_u32 m0, m0, 1024
    v_xor_b32 v112, 64, v117
    buffer_load_dwordx4 v112, s[16:19], s55 offen nt lds
    s_add_u32 s55, s55, 16384
    s_add_u32 m0, m0, 1024
    v_xor_b32 v112, 96, v117
    buffer_load_dwordx4 v112, s[16:19], s55 offen nt lds
    s_add_u32 s55, s55, 16384
    s_add_u32 m0, m0, 1024
    v_xor_b32 v112, 128, v117
    buffer_load_dwordx4 v112, s[16:19], s55 offen nt lds
    s_add_u32 s55, s55, 16384
    s_add_u32 m0, m0, 1024
    v_xor_b32 v112, 160, v117
    buffer_load_dwordx4 v112, s[16:19], s55 offen nt lds
    s_add_u32 s55, s55, 16384
    s_add_u32 m0, m0, 1024
    v_xor_b32 v112, 128, v117
    buffer_load_dwordx4 v112, s[16:19], s55 offen nt lds
    s_add_u32 s55, s55, 16384
    s_add_u32 m0, m0, 1024
    v_xor_b32 v112, 160, v117
    buffer_load_dwordx4 v112, s[16:19], s55 offen nt lds
    s_add_u32 s55, s55, 16384
    s_add_u32 m0, m0, 1024
    v_xor_b32 v112, 192, v117
    buffer_load_dwordx4 v112, s[16:19], s55 offen nt lds
    s_add_u32 s55, s55, 16384
    s_add_u32 m0, m0, 1024
    v_xor_b32 v112, 224, v117
    buffer_load_dwordx4 v112, s[16:19], s55 offen nt lds
    s_add_u32 s55, s55, 16384
    s_add_u32 m0, m0, 1024
    v_xor_b32 v112, 192, v117
    buffer_load_dwordx4 v112, s[16:19], s55 offen nt lds
    s_add_u32 s55, s55, 16384
    s_add_u32 m0, m0, 1024
    v_xor_b32 v112, 224, v117
    buffer_load_dwordx4 v112, s[16:19], s55 offen nt lds
    s_add_u32 s55, s50, 0
    s_add_u32 m0, s51, 0
    s_nop 0
    buffer_load_dwordx4 v2, s[12:15], s55 offen lds
    s_add_u32 s55, s55, 16384
    s_add_u32 m0, m0, 1024
    s_nop 0
    buffer_load_dwordx4 v3, s[12:15], s55 offen lds
    s_add_u32 s55, s55, 16384
    s_add_u32 m0, m0, 1024
    s_nop 0
    buffer_load_dwordx4 v2, s[12:15], s55 offen lds
    s_add_u32 s55, s55, 16384
    s_add_u32 m0, m0, 1024
    s_nop 0
    buffer_load_dwordx4 v3, s[12:15], s55 offen lds
    s_add_u32 s55, s50, 262144
    s_add_u32 m0, s51, 16384
    s_nop 0
    buffer_load_dwordx4 v2, s[12:15], s55 offen lds
    s_add_u32 s55, s55, 16384
    s_add_u32 m0, m0, 1024
    s_nop 0
    buffer_load_dwordx4 v3, s[12:15], s55 offen lds
    s_add_u32 s55, s55, 16384
    s_add_u32 m0, m0, 1024
    s_nop 0
    buffer_load_dwordx4 v2, s[12:15], s55 offen lds
    s_add_u32 s55, s55, 16384
    s_add_u32 m0, m0, 1024
    s_nop 0
    buffer_load_dwordx4 v3, s[12:15], s55 offen lds
    v_and_b32 v112, 15, v0
    v_lshrrev_b32 v113, 4, v0
    v_xor_b32 v113, v112, v113
    v_lshlrev_b32 v113, 4, v113
    v_lshrrev_b32 v114, 2, v112
    v_lshlrev_b32 v114, 3, v114
    v_and_b32 v112, 3, v112
    v_add_u32 v114, v114, v112
    v_lshl_add_u32 v4, v114, 9, v113
    v_xor_b32 v5, 64, v4
    v_xor_b32 v6, 128, v4
    v_xor_b32 v7, 192, v4
    v_add_u32 v8, 0x10000, v4
    v_add_u32 v12, s53, v4
    v_add_u32 v9, 0x10000, v5
    v_add_u32 v13, s53, v5
    v_add_u32 v10, 0x10000, v6
    v_add_u32 v14, s53, v6
    v_add_u32 v11, 0x10000, v7
    v_add_u32 v15, s53, v7
    s_waitcnt vmcnt(8)
    ds_read_b128 v[48:51], v12 offset:0
    ds_read_b128 v[80:83], v12 offset:2048
    ds_read_b128 v[52:55], v13 offset:0
    ds_read_b128 v[84:87], v13 offset:2048
    ds_read_b128 v[56:59], v14 offset:0
    ds_read_b128 v[88:91], v14 offset:2048
    ds_read_b128 v[60:63], v15 offset:0
    ds_read_b128 v[92:95], v15 offset:2048
    ds_read_b128 v[64:67], v12 offset:256
    ds_read_b128 v[96:99], v12 offset:2304
    ds_read_b128 v[68:71], v13 offset:256
    ds_read_b128 v[100:103], v13 offset:2304
    ds_read_b128 v[72:75], v14 offset:256
    ds_read_b128 v[104:107], v14 offset:2304
    ds_read_b128 v[76:79], v15 offset:256
    ds_read_b128 v[108:111], v15 offset:2304
    s_waitcnt lgkmcnt(0)
    s_add_u32 s55, s52, 262144
    s_mov_b32 m0, s53
    v_xor_b32 v112, 0, v117
    buffer_load_dwordx4 v112, s[16:19], s55 offen nt lds
    s_add_u32 s55, s55, 16384
    s_add_u32 m0, m0, 1024
    v_xor_b32 v112, 32, v117
    buffer_load_dwordx4 v112, s[16:19], s55 offen nt lds
    s_add_u32 s55, s55, 16384
    s_add_u32 m0, m0, 1024
    v_xor_b32 v112, 0, v117
    buffer_load_dwordx4 v112, s[16:19], s55 offen nt lds
    s_add_u32 s55, s55, 16384
    s_add_u32 m0, m0, 1024
    v_xor_b32 v112, 32, v117
    buffer_load_dwordx4 v112, s[16:19], s55 offen nt lds
    s_add_u32 s55, s55, 16384
    s_add_u32 m0, m0, 1024
    v_xor_b32 v112, 64, v117
    buffer_load_dwordx4 v112, s[16:19], s55 offen nt lds
    s_add_u32 s55, s55, 16384
    s_add_u32 m0, m0, 1024
    v_xor_b32 v112, 96, v117
    buffer_load_dwordx4 v112, s[16:19], s55 offen nt lds
    s_add_u32 s55, s55, 16384
    s_add_u32 m0, m0, 1024
    v_xor_b32 v112, 64, v117
    buffer_load_dwordx4 v112, s[16:19], s55 offen nt lds
    s_add_u32 s55, s55, 16384
    s_add_u32 m0, m0, 1024
    v_xor_b32 v112, 96, v117
    buffer_load_dwordx4 v112, s[16:19], s55 offen nt lds
    s_add_u32 s55, s55, 16384
    s_add_u32 m0, m0, 1024
    v_xor_b32 v112, 128, v117
    buffer_load_dwordx4 v112, s[16:19], s55 offen nt lds
    s_add_u32 s55, s55, 16384
    s_add_u32 m0, m0, 1024
    v_xor_b32 v112, 160, v117
    buffer_load_dwordx4 v112, s[16:19], s55 offen nt lds
    s_add_u32 s55, s55, 16384
    s_add_u32 m0, m0, 1024
    v_xor_b32 v112, 128, v117
    buffer_load_dwordx4 v112, s[16:19], s55 offen nt lds
    s_add_u32 s55, s55, 16384
    s_add_u32 m0, m0, 1024
    v_xor_b32 v112, 160, v117
    buffer_load_dwordx4 v112, s[16:19], s55 offen nt lds
    s_add_u32 s55, s55, 16384
    s_add_u32 m0, m0, 1024
    v_xor_b32 v112, 192, v117
    buffer_load_dwordx4 v112, s[16:19], s55 offen nt lds
    s_add_u32 s55, s55, 16384
    s_add_u32 m0, m0, 1024
    v_xor_b32 v112, 224, v117
    buffer_load_dwordx4 v112, s[16:19], s55 offen nt lds
    s_add_u32 s55, s55, 16384
    s_add_u32 m0, m0, 1024
    v_xor_b32 v112, 192, v117
    buffer_load_dwordx4 v112, s[16:19], s55 offen nt lds
    s_add_u32 s55, s55, 16384
    s_add_u32 m0, m0, 1024
    v_xor_b32 v112, 224, v117
    buffer_load_dwordx4 v112, s[16:19], s55 offen nt lds
    s_add_u32 s55, s50, 524288
    s_add_u32 m0, s51, 32768
    s_nop 0
    buffer_load_dwordx4 v2, s[12:15], s55 offen lds
    s_add_u32 s55, s55, 16384
    s_add_u32 m0, m0, 1024
    s_nop 0
    buffer_load_dwordx4 v3, s[12:15], s55 offen lds
    s_add_u32 s55, s55, 16384
    s_add_u32 m0, m0, 1024
    s_nop 0
    buffer_load_dwordx4 v2, s[12:15], s55 offen lds
    s_add_u32 s55, s55, 16384
    s_add_u32 m0, m0, 1024
    s_nop 0
    buffer_load_dwordx4 v3, s[12:15], s55 offen lds
    s_add_u32 s55, s50, 786432
    s_add_u32 m0, s51, 49152
    s_nop 0
    buffer_load_dwordx4 v2, s[12:15], s55 offen lds
    s_add_u32 s55, s55, 16384
    s_add_u32 m0, m0, 1024
    s_nop 0
    buffer_load_dwordx4 v3, s[12:15], s55 offen lds
    s_add_u32 s55, s55, 16384
    s_add_u32 m0, m0, 1024
    s_nop 0
    buffer_load_dwordx4 v2, s[12:15], s55 offen lds
    s_add_u32 s55, s55, 16384
    s_add_u32 m0, m0, 1024
    s_nop 0
    buffer_load_dwordx4 v3, s[12:15], s55 offen lds
    s_add_u32 s55, s50, 1048576
    s_add_u32 m0, s51, 65536
    s_nop 0
    buffer_load_dwordx4 v2, s[12:15], s55 offen lds
    s_add_u32 s55, s55, 16384
    s_add_u32 m0, m0, 1024
    s_nop 0
    buffer_load_dwordx4 v3, s[12:15], s55 offen lds
    s_add_u32 s55, s55, 16384
    s_add_u32 m0, m0, 1024
    s_nop 0
    buffer_load_dwordx4 v2, s[12:15], s55 offen lds
    s_add_u32 s55, s55, 16384
    s_add_u32 m0, m0, 1024
    s_nop 0
    buffer_load_dwordx4 v3, s[12:15], s55 offen lds
    s_waitcnt vmcnt(32)
    s_barrier
    ds_read_b128 a[64:67], v4 offset:0
    ds_read_b128 a[68:71], v4 offset:2048
    ds_read_b128 a[72:75], v5 offset:0
    ds_read_b128 a[76:79], v5 offset:2048
    ds_read_b128 a[80:83], v6 offset:0
    s_waitcnt lgkmcnt(4)
    v_mfma_f32_16x16x32_bf16 v[16:19], a[64:67], v[48:51], 0
    ds_read_b128 a[84:87], v6 offset:2048
    v_mfma_f32_16x16x32_bf16 v[24:27], a[64:67], v[80:83], 0
    s_waitcnt lgkmcnt(4)
    v_mfma_f32_16x16x32_bf16 v[20:23], a[68:71], v[48:51], 0
    ds_read_b128 a[64:67], v7 offset:0
    v_mfma_f32_16x16x32_bf16 v[28:31], a[68:71], v[80:83], 0
    s_waitcnt lgkmcnt(4)
    v_mfma_f32_16x16x32_bf16 v[16:19], a[72:75], v[52:55], v[16:19]
    ds_read_b128 a[68:71], v7 offset:2048
    v_mfma_f32_16x16x32_bf16 v[24:27], a[72:75], v[84:87], v[24:27]
    s_waitcnt lgkmcnt(4)
    v_mfma_f32_16x16x32_bf16 v[20:23], a[76:79], v[52:55], v[20:23]
    ds_read_b128 a[72:75], v4 offset:256
    v_mfma_f32_16x16x32_bf16 v[28:31], a[76:79], v[84:87], v[28:31]
    s_waitcnt lgkmcnt(4)
    v_mfma_f32_16x16x32_bf16 v[16:19], a[80:83], v[56:59], v[16:19]
    ds_read_b128 a[76:79], v4 offset:2304
    v_mfma_f32_16x16x32_bf16 v[24:27], a[80:83], v[88:91], v[24:27]
    s_waitcnt lgkmcnt(4)
    v_mfma_f32_16x16x32_bf16 v[20:23], a[84:87], v[56:59], v[20:23]
    ds_read_b128 a[80:83], v5 offset:256
    v_mfma_f32_16x16x32_bf16 v[28:31], a[84:87], v[88:91], v[28:31]
    s_waitcnt lgkmcnt(4)
    v_mfma_f32_16x16x32_bf16 v[16:19], a[64:67], v[60:63], v[16:19]
    ds_read_b128 a[84:87], v5 offset:2304
    v_mfma_f32_16x16x32_bf16 v[24:27], a[64:67], v[92:95], v[24:27]
    s_waitcnt lgkmcnt(4)
    v_mfma_f32_16x16x32_bf16 v[20:23], a[68:71], v[60:63], v[20:23]
    ds_read_b128 a[64:67], v6 offset:256
    v_mfma_f32_16x16x32_bf16 v[28:31], a[68:71], v[92:95], v[28:31]
    s_waitcnt lgkmcnt(4)
    v_mfma_f32_16x16x32_bf16 v[16:19], a[72:75], v[64:67], v[16:19]
    ds_read_b128 a[68:71], v6 offset:2304
    v_mfma_f32_16x16x32_bf16 v[24:27], a[72:75], v[96:99], v[24:27]
    s_waitcnt lgkmcnt(4)
    v_mfma_f32_16x16x32_bf16 v[20:23], a[76:79], v[64:67], v[20:23]
    ds_read_b128 a[72:75], v7 offset:256
    v_mfma_f32_16x16x32_bf16 v[28:31], a[76:79], v[96:99], v[28:31]
    s_waitcnt lgkmcnt(4)
    v_mfma_f32_16x16x32_bf16 v[16:19], a[80:83], v[68:71], v[16:19]
    ds_read_b128 a[76:79], v7 offset:2304
    v_mfma_f32_16x16x32_bf16 v[24:27], a[80:83], v[100:103], v[24:27]
    s_waitcnt lgkmcnt(4)
    v_mfma_f32_16x16x32_bf16 v[20:23], a[84:87], v[68:71], v[20:23]
    ds_read_b128 a[80:83], v4 offset:0
    v_mfma_f32_16x16x32_bf16 v[28:31], a[84:87], v[100:103], v[28:31]
    s_waitcnt lgkmcnt(4)
    v_mfma_f32_16x16x32_bf16 v[16:19], a[64:67], v[72:75], v[16:19]
    ds_read_b128 a[84:87], v4 offset:2048
    v_mfma_f32_16x16x32_bf16 v[24:27], a[64:67], v[104:107], v[24:27]
    s_waitcnt lgkmcnt(4)
    v_mfma_f32_16x16x32_bf16 v[20:23], a[68:71], v[72:75], v[20:23]
    ds_read_b128 a[64:67], v5 offset:0
    v_mfma_f32_16x16x32_bf16 v[28:31], a[68:71], v[104:107], v[28:31]
    s_waitcnt lgkmcnt(4)
    v_mfma_f32_16x16x32_bf16 v[16:19], a[72:75], v[76:79], v[16:19]
    ds_read_b128 a[68:71], v5 offset:2048
    v_mfma_f32_16x16x32_bf16 v[24:27], a[72:75], v[108:111], v[24:27]
    s_waitcnt lgkmcnt(4)
    v_mfma_f32_16x16x32_bf16 v[20:23], a[76:79], v[76:79], v[20:23]
    ds_read_b128 a[72:75], v6 offset:0
    v_mfma_f32_16x16x32_bf16 v[28:31], a[76:79], v[108:111], v[28:31]
    s_waitcnt vmcnt(12)
    ds_read_b128 a[0:3], v12 offset:0
    ds_read_b128 a[32:35], v12 offset:2048
    ds_read_b128 a[4:7], v13 offset:0
    ds_read_b128 a[36:39], v13 offset:2048
    ds_read_b128 a[8:11], v14 offset:0
    ds_read_b128 a[40:43], v14 offset:2048
    ds_read_b128 a[12:15], v15 offset:0
    ds_read_b128 a[44:47], v15 offset:2048
    ds_read_b128 a[16:19], v12 offset:256
    ds_read_b128 a[48:51], v12 offset:2304
    ds_read_b128 a[20:23], v13 offset:256
    ds_read_b128 a[52:55], v13 offset:2304
    ds_read_b128 a[24:27], v14 offset:256
    ds_read_b128 a[56:59], v14 offset:2304
    ds_read_b128 a[28:31], v15 offset:256
    ds_read_b128 a[60:63], v15 offset:2304
    s_waitcnt lgkmcnt(0)
    v_add_u32 v14, s53, v1
    s_barrier
    v_mfma_f32_16x16x32_bf16 v[32:35], a[80:83], a[0:3], 0
    ds_read_b128 a[76:79], v6 offset:2048
    v_mfma_f32_16x16x32_bf16 v[40:43], a[80:83], a[32:35], 0
    v_mfma_f32_16x16x32_bf16 v[36:39], a[84:87], a[0:3], 0
    ds_read_b128 a[80:83], v7 offset:0
    v_mul_f32 v16, s54, v16
    v_mfma_f32_16x16x32_bf16 v[44:47], a[84:87], a[32:35], 0
    s_add_u32 s55, s50, 1310720
    s_add_u32 m0, s51, 81920
    v_mul_f32 v17, s54, v17
    v_mfma_f32_16x16x32_bf16 v[32:35], a[64:67], a[4:7], v[32:35]
    ds_read_b128 a[84:87], v7 offset:2048
    v_mul_f32 v18, s54, v18
    v_mfma_f32_16x16x32_bf16 v[40:43], a[64:67], a[36:39], v[40:43]
    v_mul_f32 v19, s54, v19
    v_mfma_f32_16x16x32_bf16 v[36:39], a[68:71], a[4:7], v[36:39]
    ds_read_b128 a[64:67], v4 offset:256
    v_mul_f32 v20, s54, v20
    v_mfma_f32_16x16x32_bf16 v[44:47], a[68:71], a[36:39], v[44:47]
    buffer_load_dwordx4 v2, s[12:15], s55 offen lds
    v_mul_f32 v21, s54, v21
    v_mfma_f32_16x16x32_bf16 v[32:35], a[72:75], a[8:11], v[32:35]
    ds_read_b128 a[68:71], v4 offset:2304
    v_mul_f32 v22, s54, v22
    v_mfma_f32_16x16x32_bf16 v[40:43], a[72:75], a[40:43], v[40:43]
    s_waitcnt lgkmcnt(4)
    v_mul_f32 v23, s54, v23
    v_mfma_f32_16x16x32_bf16 v[36:39], a[76:79], a[8:11], v[36:39]
    ds_read_b128 a[72:75], v5 offset:256
    v_cvt_pk_bf16_f32 v16, v16, v17
    v_mfma_f32_16x16x32_bf16 v[44:47], a[76:79], a[40:43], v[44:47]
    s_add_u32 s55, s55, 16384
    s_add_u32 m0, m0, 1024
    v_cvt_pk_bf16_f32 v18, v18, v19
    s_waitcnt lgkmcnt(4)
    v_mfma_f32_16x16x32_bf16 v[32:35], a[80:83], a[12:15], v[32:35]
    ds_read_b128 a[76:79], v5 offset:2304
    v_cvt_pk_bf16_f32 v20, v20, v21
    v_mfma_f32_16x16x32_bf16 v[40:43], a[80:83], a[44:47], v[40:43]
    s_waitcnt lgkmcnt(4)
    v_cvt_pk_bf16_f32 v22, v22, v23
    v_mfma_f32_16x16x32_bf16 v[36:39], a[84:87], a[12:15], v[36:39]
    ds_read_b128 a[80:83], v6 offset:256
    v_accvgpr_write_b32 a224, v16
    v_mfma_f32_16x16x32_bf16 v[44:47], a[84:87], a[44:47], v[44:47]
    buffer_load_dwordx4 v3, s[12:15], s55 offen lds
    v_accvgpr_write_b32 a225, v18
    s_waitcnt lgkmcnt(4)
    v_mfma_f32_16x16x32_bf16 v[32:35], a[64:67], a[16:19], v[32:35]
    ds_read_b128 a[84:87], v6 offset:2304
    v_accvgpr_write_b32 a226, v20
    v_mfma_f32_16x16x32_bf16 v[40:43], a[64:67], a[48:51], v[40:43]
    s_waitcnt lgkmcnt(4)
    v_accvgpr_write_b32 a227, v22
    v_mfma_f32_16x16x32_bf16 v[36:39], a[68:71], a[16:19], v[36:39]
    ds_read_b128 a[64:67], v7 offset:256
    v_mul_f32 v24, s54, v24
    v_mfma_f32_16x16x32_bf16 v[44:47], a[68:71], a[48:51], v[44:47]
    s_add_u32 s55, s55, 16384
    s_add_u32 m0, m0, 1024
    v_mul_f32 v25, s54, v25
    s_waitcnt lgkmcnt(4)
    v_mfma_f32_16x16x32_bf16 v[32:35], a[72:75], a[20:23], v[32:35]
    ds_read_b128 a[68:71], v7 offset:2304
    v_mul_f32 v26, s54, v26
    v_mfma_f32_16x16x32_bf16 v[40:43], a[72:75], a[52:55], v[40:43]
    s_waitcnt lgkmcnt(4)
    v_mul_f32 v27, s54, v27
    v_mfma_f32_16x16x32_bf16 v[36:39], a[76:79], a[20:23], v[36:39]
    ds_read_b128 a[72:75], v4 offset:16384
    v_mul_f32 v28, s54, v28
    v_mfma_f32_16x16x32_bf16 v[44:47], a[76:79], a[52:55], v[44:47]
    buffer_load_dwordx4 v2, s[12:15], s55 offen lds
    v_mul_f32 v29, s54, v29
    s_waitcnt lgkmcnt(4)
    v_mfma_f32_16x16x32_bf16 v[32:35], a[80:83], a[24:27], v[32:35]
    ds_read_b128 a[76:79], v4 offset:18432
    v_mul_f32 v30, s54, v30
    v_mfma_f32_16x16x32_bf16 v[40:43], a[80:83], a[56:59], v[40:43]
    s_waitcnt lgkmcnt(4)
    v_mul_f32 v31, s54, v31
    v_mfma_f32_16x16x32_bf16 v[36:39], a[84:87], a[24:27], v[36:39]
    ds_read_b128 a[80:83], v5 offset:16384
    v_cvt_pk_bf16_f32 v144, v24, v25
    v_mfma_f32_16x16x32_bf16 v[44:47], a[84:87], a[56:59], v[44:47]
    s_add_u32 s55, s55, 16384
    s_add_u32 m0, m0, 1024
    v_cvt_pk_bf16_f32 v145, v26, v27
    s_waitcnt lgkmcnt(4)
    v_mfma_f32_16x16x32_bf16 v[32:35], a[64:67], a[28:31], v[32:35]
    ds_read_b128 a[84:87], v5 offset:18432
    v_cvt_pk_bf16_f32 v146, v28, v29
    v_mfma_f32_16x16x32_bf16 v[40:43], a[64:67], a[60:63], v[40:43]
    buffer_load_dwordx4 v3, s[12:15], s55 offen lds
    v_cvt_pk_bf16_f32 v147, v30, v31
    s_waitcnt lgkmcnt(4)
    v_mfma_f32_16x16x32_bf16 v[36:39], a[68:71], a[28:31], v[36:39]
    ds_read_b128 a[64:67], v6 offset:16384
    v_mfma_f32_16x16x32_bf16 v[44:47], a[68:71], a[60:63], v[44:47]
    v_mov_b32 v114, 132
    global_load_dword v114, v114, s[46:47] sc1
    s_waitcnt lgkmcnt(4)
    v_mfma_f32_16x16x32_bf16 v[16:19], a[72:75], v[48:51], 0
    ds_read_b128 a[68:71], v6 offset:18432
    v_mfma_f32_16x16x32_bf16 v[24:27], a[72:75], v[80:83], 0
    s_waitcnt lgkmcnt(4)
    v_mfma_f32_16x16x32_bf16 v[20:23], a[76:79], v[48:51], 0
    ds_read_b128 a[72:75], v7 offset:16384
    v_mul_f32 v32, s54, v32
    v_mfma_f32_16x16x32_bf16 v[28:31], a[76:79], v[80:83], 0
    s_waitcnt lgkmcnt(4)
    v_mul_f32 v33, s54, v33
    v_mfma_f32_16x16x32_bf16 v[16:19], a[80:83], v[52:55], v[16:19]
    ds_read_b128 a[76:79], v7 offset:18432
    v_mul_f32 v34, s54, v34
    v_mfma_f32_16x16x32_bf16 v[24:27], a[80:83], v[84:87], v[24:27]
    s_waitcnt lgkmcnt(4)
    v_mul_f32 v35, s54, v35
    v_mfma_f32_16x16x32_bf16 v[20:23], a[84:87], v[52:55], v[20:23]
    ds_read_b128 a[80:83], v4 offset:16640
    v_mul_f32 v36, s54, v36
    v_mfma_f32_16x16x32_bf16 v[28:31], a[84:87], v[84:87], v[28:31]
    s_waitcnt lgkmcnt(4)
    v_mul_f32 v37, s54, v37
    v_mfma_f32_16x16x32_bf16 v[16:19], a[64:67], v[56:59], v[16:19]
    ds_read_b128 a[84:87], v4 offset:18688
    v_mul_f32 v38, s54, v38
    v_mfma_f32_16x16x32_bf16 v[24:27], a[64:67], v[88:91], v[24:27]
    s_waitcnt lgkmcnt(4)
    v_mul_f32 v39, s54, v39
    v_mfma_f32_16x16x32_bf16 v[20:23], a[68:71], v[56:59], v[20:23]
    ds_read_b128 a[64:67], v5 offset:16640
    v_cvt_pk_bf16_f32 v200, v32, v33
    v_mfma_f32_16x16x32_bf16 v[28:31], a[68:71], v[88:91], v[28:31]
    s_waitcnt lgkmcnt(4)
    v_cvt_pk_bf16_f32 v201, v34, v35
    v_mfma_f32_16x16x32_bf16 v[16:19], a[72:75], v[60:63], v[16:19]
    ds_read_b128 a[68:71], v5 offset:18688
    v_cvt_pk_bf16_f32 v202, v36, v37
    v_mfma_f32_16x16x32_bf16 v[24:27], a[72:75], v[92:95], v[24:27]
    s_waitcnt lgkmcnt(4)
    v_cvt_pk_bf16_f32 v203, v38, v39
    v_mfma_f32_16x16x32_bf16 v[20:23], a[76:79], v[60:63], v[20:23]
    ds_read_b128 a[72:75], v6 offset:16640
    v_mul_f32 v40, s54, v40
    v_mfma_f32_16x16x32_bf16 v[28:31], a[76:79], v[92:95], v[28:31]
    s_waitcnt lgkmcnt(4)
    v_mul_f32 v41, s54, v41
    v_mfma_f32_16x16x32_bf16 v[16:19], a[80:83], v[64:67], v[16:19]
    ds_read_b128 a[76:79], v6 offset:18688
    v_mul_f32 v42, s54, v42
    v_mfma_f32_16x16x32_bf16 v[24:27], a[80:83], v[96:99], v[24:27]
    s_waitcnt lgkmcnt(4)
    v_mul_f32 v43, s54, v43
    v_mfma_f32_16x16x32_bf16 v[20:23], a[84:87], v[64:67], v[20:23]
    ds_read_b128 a[80:83], v7 offset:16640
    v_mul_f32 v44, s54, v44
    v_mfma_f32_16x16x32_bf16 v[28:31], a[84:87], v[96:99], v[28:31]
    s_waitcnt lgkmcnt(4)
    v_mul_f32 v45, s54, v45
    v_mfma_f32_16x16x32_bf16 v[16:19], a[64:67], v[68:71], v[16:19]
    ds_read_b128 a[84:87], v7 offset:18688
    v_mul_f32 v46, s54, v46
    v_mfma_f32_16x16x32_bf16 v[24:27], a[64:67], v[100:103], v[24:27]
    s_waitcnt lgkmcnt(4)
    v_mul_f32 v47, s54, v47
    v_mfma_f32_16x16x32_bf16 v[20:23], a[68:71], v[68:71], v[20:23]
    ds_read_b128 a[64:67], v4 offset:16384
    v_cvt_pk_bf16_f32 v116, v40, v41
    v_mfma_f32_16x16x32_bf16 v[28:31], a[68:71], v[100:103], v[28:31]
    s_waitcnt lgkmcnt(4)
    v_cvt_pk_bf16_f32 v117, v42, v43
    v_mfma_f32_16x16x32_bf16 v[16:19], a[72:75], v[72:75], v[16:19]
    ds_read_b128 a[68:71], v4 offset:18432
    v_cvt_pk_bf16_f32 v118, v44, v45
    v_mfma_f32_16x16x32_bf16 v[24:27], a[72:75], v[104:107], v[24:27]
    s_waitcnt lgkmcnt(4)
    v_cvt_pk_bf16_f32 v119, v46, v47
    v_mfma_f32_16x16x32_bf16 v[20:23], a[76:79], v[72:75], v[20:23]
    ds_read_b128 a[72:75], v5 offset:16384
    ds_write_b128 v14, v[116:119] offset:0
    v_mfma_f32_16x16x32_bf16 v[28:31], a[76:79], v[104:107], v[28:31]
    s_waitcnt lgkmcnt(5)
    v_mfma_f32_16x16x32_bf16 v[16:19], a[80:83], v[76:79], v[16:19]
    ds_read_b128 a[76:79], v5 offset:18432
    v_mfma_f32_16x16x32_bf16 v[24:27], a[80:83], v[108:111], v[24:27]
    s_waitcnt lgkmcnt(5)
    v_mfma_f32_16x16x32_bf16 v[20:23], a[84:87], v[76:79], v[20:23]
    ds_read_b128 a[80:83], v6 offset:16384
    v_mfma_f32_16x16x32_bf16 v[28:31], a[84:87], v[108:111], v[28:31]
    s_waitcnt vmcnt(0)
    v_cmp_eq_u32 vcc, 0, v114
    s_cbranch_vccnz Lvwait_12
Lvok_11:
    s_lshl_b32 s36, s22, 2
    s_add_u32 s36, s36, s20
    s_lshl_b32 s36, s36, 2
    s_add_u32 s36, s36, s35
    v_mov_b32 v114, 0
    s_mov_b64 exec, 1
    buffer_store_dword v114, off, s[8:11], s36
    s_mov_b64 exec, -1
    s_barrier
    s_waitcnt lgkmcnt(5)
    v_mfma_f32_16x16x32_bf16 v[32:35], a[64:67], a[0:3], 0
    ds_read_b128 a[84:87], v6 offset:18432
    v_mfma_f32_16x16x32_bf16 v[40:43], a[64:67], a[32:35], 0
    s_waitcnt lgkmcnt(5)
    v_mfma_f32_16x16x32_bf16 v[36:39], a[68:71], a[0:3], 0
    ds_read_b128 a[64:67], v7 offset:16384
    v_mul_f32 v16, s54, v16
    v_mfma_f32_16x16x32_bf16 v[44:47], a[68:71], a[32:35], 0
    s_add_u32 s55, s50, 1572864
    s_add_u32 m0, s51, 0
    v_mul_f32 v17, s54, v17
    s_waitcnt lgkmcnt(5)
    v_mfma_f32_16x16x32_bf16 v[32:35], a[72:75], a[4:7], v[32:35]
    ds_read_b128 a[68:71], v7 offset:18432
    v_mul_f32 v18, s54, v18
    v_mfma_f32_16x16x32_bf16 v[40:43], a[72:75], a[36:39], v[40:43]
    s_waitcnt lgkmcnt(4)
    v_mul_f32 v19, s54, v19
    v_mfma_f32_16x16x32_bf16 v[36:39], a[76:79], a[4:7], v[36:39]
    ds_read_b128 a[72:75], v4 offset:16640
    v_mul_f32 v20, s54, v20
    v_mfma_f32_16x16x32_bf16 v[44:47], a[76:79], a[36:39], v[44:47]
    buffer_load_dwordx4 v2, s[12:15], s55 offen lds
    v_mul_f32 v21, s54, v21
    s_waitcnt lgkmcnt(4)
    v_mfma_f32_16x16x32_bf16 v[32:35], a[80:83], a[8:11], v[32:35]
    ds_read_b128 a[76:79], v4 offset:18688
    v_mul_f32 v22, s54, v22
    v_mfma_f32_16x16x32_bf16 v[40:43], a[80:83], a[40:43], v[40:43]
    s_waitcnt lgkmcnt(4)
    v_mul_f32 v23, s54, v23
    v_mfma_f32_16x16x32_bf16 v[36:39], a[84:87], a[8:11], v[36:39]
    ds_read_b128 a[80:83], v5 offset:16640
    v_cvt_pk_bf16_f32 v16, v16, v17
    v_mfma_f32_16x16x32_bf16 v[44:47], a[84:87], a[40:43], v[44:47]
    s_add_u32 s55, s55, 16384
    s_add_u32 m0, m0, 1024
    v_cvt_pk_bf16_f32 v18, v18, v19
    s_waitcnt lgkmcnt(4)
    v_mfma_f32_16x16x32_bf16 v[32:35], a[64:67], a[12:15], v[32:35]
    ds_read_b128 a[84:87], v5 offset:18688
    v_cvt_pk_bf16_f32 v20, v20, v21
    v_mfma_f32_16x16x32_bf16 v[40:43], a[64:67], a[44:47], v[40:43]
    s_waitcnt lgkmcnt(4)
    v_cvt_pk_bf16_f32 v22, v22, v23
    v_mfma_f32_16x16x32_bf16 v[36:39], a[68:71], a[12:15], v[36:39]
    ds_read_b128 a[64:67], v6 offset:16640
    v_accvgpr_write_b32 a228, v16
    v_mfma_f32_16x16x32_bf16 v[44:47], a[68:71], a[44:47], v[44:47]
    buffer_load_dwordx4 v3, s[12:15], s55 offen lds
    v_accvgpr_write_b32 a229, v18
    s_waitcnt lgkmcnt(4)
    v_mfma_f32_16x16x32_bf16 v[32:35], a[72:75], a[16:19], v[32:35]
    ds_read_b128 a[68:71], v6 offset:18688
    v_accvgpr_write_b32 a230, v20
    v_mfma_f32_16x16x32_bf16 v[40:43], a[72:75], a[48:51], v[40:43]
    s_waitcnt lgkmcnt(4)
    v_accvgpr_write_b32 a231, v22
    v_mfma_f32_16x16x32_bf16 v[36:39], a[76:79], a[16:19], v[36:39]
    ds_read_b128 a[72:75], v7 offset:16640
    v_mul_f32 v24, s54, v24
    v_mfma_f32_16x16x32_bf16 v[44:47], a[76:79], a[48:51], v[44:47]
    s_add_u32 s55, s55, 16384
    s_add_u32 m0, m0, 1024
    v_mul_f32 v25, s54, v25
    s_waitcnt lgkmcnt(4)
    v_mfma_f32_16x16x32_bf16 v[32:35], a[80:83], a[20:23], v[32:35]
    ds_read_b128 a[76:79], v7 offset:18688
    v_mul_f32 v26, s54, v26
    v_mfma_f32_16x16x32_bf16 v[40:43], a[80:83], a[52:55], v[40:43]
    s_waitcnt lgkmcnt(4)
    v_mul_f32 v27, s54, v27
    v_mfma_f32_16x16x32_bf16 v[36:39], a[84:87], a[20:23], v[36:39]
    ds_read_b128 a[80:83], v4 offset:32768
    v_mul_f32 v28, s54, v28
    v_mfma_f32_16x16x32_bf16 v[44:47], a[84:87], a[52:55], v[44:47]
    buffer_load_dwordx4 v2, s[12:15], s55 offen lds
    v_mul_f32 v29, s54, v29
    s_waitcnt lgkmcnt(4)
    v_mfma_f32_16x16x32_bf16 v[32:35], a[64:67], a[24:27], v[32:35]
    ds_read_b128 a[84:87], v4 offset:34816
    v_mul_f32 v30, s54, v30
    v_mfma_f32_16x16x32_bf16 v[40:43], a[64:67], a[56:59], v[40:43]
    s_waitcnt lgkmcnt(4)
    v_mul_f32 v31, s54, v31
    v_mfma_f32_16x16x32_bf16 v[36:39], a[68:71], a[24:27], v[36:39]
    ds_read_b128 a[64:67], v5 offset:32768
    v_cvt_pk_bf16_f32 v148, v24, v25
    v_mfma_f32_16x16x32_bf16 v[44:47], a[68:71], a[56:59], v[44:47]
    s_add_u32 s55, s55, 16384
    s_add_u32 m0, m0, 1024
    v_cvt_pk_bf16_f32 v149, v26, v27
    s_waitcnt lgkmcnt(4)
    v_mfma_f32_16x16x32_bf16 v[32:35], a[72:75], a[28:31], v[32:35]
    ds_read_b128 a[68:71], v5 offset:34816
    v_cvt_pk_bf16_f32 v150, v28, v29
    v_mfma_f32_16x16x32_bf16 v[40:43], a[72:75], a[60:63], v[40:43]
    s_waitcnt lgkmcnt(4)
    v_cvt_pk_bf16_f32 v151, v30, v31
    v_mfma_f32_16x16x32_bf16 v[36:39], a[76:79], a[28:31], v[36:39]
    ds_read_b128 a[72:75], v6 offset:32768
    v_mfma_f32_16x16x32_bf16 v[44:47], a[76:79], a[60:63], v[44:47]
    buffer_load_dwordx4 v3, s[12:15], s55 offen lds
    s_waitcnt lgkmcnt(4)
    v_mfma_f32_16x16x32_bf16 v[16:19], a[80:83], v[48:51], 0
    ds_read_b128 a[76:79], v6 offset:34816
    v_mfma_f32_16x16x32_bf16 v[24:27], a[80:83], v[80:83], 0
    s_waitcnt lgkmcnt(4)
    v_mfma_f32_16x16x32_bf16 v[20:23], a[84:87], v[48:51], 0
    ds_read_b128 a[80:83], v7 offset:32768
    v_mul_f32 v32, s54, v32
    v_mfma_f32_16x16x32_bf16 v[28:31], a[84:87], v[80:83], 0
    s_waitcnt lgkmcnt(4)
    v_mul_f32 v33, s54, v33
    v_mfma_f32_16x16x32_bf16 v[16:19], a[64:67], v[52:55], v[16:19]
    ds_read_b128 a[84:87], v7 offset:34816
    v_mul_f32 v34, s54, v34
    v_mfma_f32_16x16x32_bf16 v[24:27], a[64:67], v[84:87], v[24:27]
    s_waitcnt lgkmcnt(4)
    v_mul_f32 v35, s54, v35
    v_mfma_f32_16x16x32_bf16 v[20:23], a[68:71], v[52:55], v[20:23]
    ds_read_b128 a[64:67], v4 offset:33024
    v_mul_f32 v36, s54, v36
    v_mfma_f32_16x16x32_bf16 v[28:31], a[68:71], v[84:87], v[28:31]
    s_waitcnt lgkmcnt(4)
    v_mul_f32 v37, s54, v37
    v_mfma_f32_16x16x32_bf16 v[16:19], a[72:75], v[56:59], v[16:19]
    ds_read_b128 a[68:71], v4 offset:35072
    v_mul_f32 v38, s54, v38
    v_mfma_f32_16x16x32_bf16 v[24:27], a[72:75], v[88:91], v[24:27]
    s_waitcnt lgkmcnt(4)
    v_mul_f32 v39, s54, v39
    v_mfma_f32_16x16x32_bf16 v[20:23], a[76:79], v[56:59], v[20:23]
    ds_read_b128 a[72:75], v5 offset:33024
    v_cvt_pk_bf16_f32 v204, v32, v33
    v_mfma_f32_16x16x32_bf16 v[28:31], a[76:79], v[88:91], v[28:31]
    s_waitcnt lgkmcnt(4)
    v_cvt_pk_bf16_f32 v205, v34, v35
    v_mfma_f32_16x16x32_bf16 v[16:19], a[80:83], v[60:63], v[16:19]
    ds_read_b128 a[76:79], v5 offset:35072
    v_cvt_pk_bf16_f32 v206, v36, v37
    v_mfma_f32_16x16x32_bf16 v[24:27], a[80:83], v[92:95], v[24:27]
    s_waitcnt lgkmcnt(4)
    v_cvt_pk_bf16_f32 v207, v38, v39
    v_mfma_f32_16x16x32_bf16 v[20:23], a[84:87], v[60:63], v[20:23]
    ds_read_b128 a[80:83], v6 offset:33024
    v_mul_f32 v40, s54, v40
    v_mfma_f32_16x16x32_bf16 v[28:31], a[84:87], v[92:95], v[28:31]
    s_waitcnt lgkmcnt(4)
    v_mul_f32 v41, s54, v41
    v_mfma_f32_16x16x32_bf16 v[16:19], a[64:67], v[64:67], v[16:19]
    ds_read_b128 a[84:87], v6 offset:35072
    v_mul_f32 v42, s54, v42
    v_mfma_f32_16x16x32_bf16 v[24:27], a[64:67], v[96:99], v[24:27]
    s_waitcnt lgkmcnt(4)
    v_mul_f32 v43, s54, v43
    v_mfma_f32_16x16x32_bf16 v[20:23], a[68:71], v[64:67], v[20:23]
    ds_read_b128 a[64:67], v7 offset:33024
    v_mul_f32 v44, s54, v44
    v_mfma_f32_16x16x32_bf16 v[28:31], a[68:71], v[96:99], v[28:31]
    s_waitcnt lgkmcnt(4)
    v_mul_f32 v45, s54, v45
    v_mfma_f32_16x16x32_bf16 v[16:19], a[72:75], v[68:71], v[16:19]
    ds_read_b128 a[68:71], v7 offset:35072
    v_mul_f32 v46, s54, v46
    v_mfma_f32_16x16x32_bf16 v[24:27], a[72:75], v[100:103], v[24:27]
    s_waitcnt lgkmcnt(4)
    v_mul_f32 v47, s54, v47
    v_mfma_f32_16x16x32_bf16 v[20:23], a[76:79], v[68:71], v[20:23]
    ds_read_b128 a[72:75], v4 offset:32768
    v_cvt_pk_bf16_f32 v116, v40, v41
    v_mfma_f32_16x16x32_bf16 v[28:31], a[76:79], v[100:103], v[28:31]
    s_waitcnt lgkmcnt(4)
    v_cvt_pk_bf16_f32 v117, v42, v43
    v_mfma_f32_16x16x32_bf16 v[16:19], a[80:83], v[72:75], v[16:19]
    ds_read_b128 a[76:79], v4 offset:34816
    v_cvt_pk_bf16_f32 v118, v44, v45
    v_mfma_f32_16x16x32_bf16 v[24:27], a[80:83], v[104:107], v[24:27]
    s_waitcnt lgkmcnt(4)
    v_cvt_pk_bf16_f32 v119, v46, v47
    v_mfma_f32_16x16x32_bf16 v[20:23], a[84:87], v[72:75], v[20:23]
    ds_read_b128 a[80:83], v5 offset:32768
    ds_write_b128 v14, v[116:119] offset:1024
    v_mfma_f32_16x16x32_bf16 v[28:31], a[84:87], v[104:107], v[28:31]
    s_waitcnt lgkmcnt(5)
    v_mfma_f32_16x16x32_bf16 v[16:19], a[64:67], v[76:79], v[16:19]
    ds_read_b128 a[84:87], v5 offset:34816
    v_mfma_f32_16x16x32_bf16 v[24:27], a[64:67], v[108:111], v[24:27]
    s_waitcnt lgkmcnt(5)
    v_mfma_f32_16x16x32_bf16 v[20:23], a[68:71], v[76:79], v[20:23]
    ds_read_b128 a[64:67], v6 offset:32768
    v_mfma_f32_16x16x32_bf16 v[28:31], a[68:71], v[108:111], v[28:31]
    s_barrier
    s_waitcnt lgkmcnt(5)
    v_mfma_f32_16x16x32_bf16 v[32:35], a[72:75], a[0:3], 0
    ds_read_b128 a[68:71], v6 offset:34816
    v_mfma_f32_16x16x32_bf16 v[40:43], a[72:75], a[32:35], 0
    s_waitcnt lgkmcnt(5)
    v_mfma_f32_16x16x32_bf16 v[36:39], a[76:79], a[0:3], 0
    ds_read_b128 a[72:75], v7 offset:32768
    v_mul_f32 v16, s54, v16
    v_mfma_f32_16x16x32_bf16 v[44:47], a[76:79], a[32:35], 0
    s_add_u32 s55, s50, 1835008
    s_add_u32 m0, s51, 16384
    v_mul_f32 v17, s54, v17
    s_waitcnt lgkmcnt(5)
    v_mfma_f32_16x16x32_bf16 v[32:35], a[80:83], a[4:7], v[32:35]
    ds_read_b128 a[76:79], v7 offset:34816
    v_mul_f32 v18, s54, v18
    v_mfma_f32_16x16x32_bf16 v[40:43], a[80:83], a[36:39], v[40:43]
    s_waitcnt lgkmcnt(4)
    v_mul_f32 v19, s54, v19
    v_mfma_f32_16x16x32_bf16 v[36:39], a[84:87], a[4:7], v[36:39]
    ds_read_b128 a[80:83], v4 offset:33024
    v_mul_f32 v20, s54, v20
    v_mfma_f32_16x16x32_bf16 v[44:47], a[84:87], a[36:39], v[44:47]
    buffer_load_dwordx4 v2, s[12:15], s55 offen lds
    v_mul_f32 v21, s54, v21
    s_waitcnt lgkmcnt(4)
    v_mfma_f32_16x16x32_bf16 v[32:35], a[64:67], a[8:11], v[32:35]
    ds_read_b128 a[84:87], v4 offset:35072
    v_mul_f32 v22, s54, v22
    v_mfma_f32_16x16x32_bf16 v[40:43], a[64:67], a[40:43], v[40:43]
    s_waitcnt lgkmcnt(4)
    v_mul_f32 v23, s54, v23
    v_mfma_f32_16x16x32_bf16 v[36:39], a[68:71], a[8:11], v[36:39]
    ds_read_b128 a[64:67], v5 offset:33024
    v_cvt_pk_bf16_f32 v16, v16, v17
    v_mfma_f32_16x16x32_bf16 v[44:47], a[68:71], a[40:43], v[44:47]
    s_add_u32 s55, s55, 16384
    s_add_u32 m0, m0, 1024
    v_cvt_pk_bf16_f32 v18, v18, v19
    s_waitcnt lgkmcnt(4)
    v_mfma_f32_16x16x32_bf16 v[32:35], a[72:75], a[12:15], v[32:35]
    ds_read_b128 a[68:71], v5 offset:35072
    v_cvt_pk_bf16_f32 v20, v20, v21
    v_mfma_f32_16x16x32_bf16 v[40:43], a[72:75], a[44:47], v[40:43]
    s_waitcnt lgkmcnt(4)
    v_cvt_pk_bf16_f32 v22, v22, v23
    v_mfma_f32_16x16x32_bf16 v[36:39], a[76:79], a[12:15], v[36:39]
    ds_read_b128 a[72:75], v6 offset:33024
    v_accvgpr_write_b32 a232, v16
    v_mfma_f32_16x16x32_bf16 v[44:47], a[76:79], a[44:47], v[44:47]
    buffer_load_dwordx4 v3, s[12:15], s55 offen lds
    v_accvgpr_write_b32 a233, v18
    s_waitcnt lgkmcnt(4)
    v_mfma_f32_16x16x32_bf16 v[32:35], a[80:83], a[16:19], v[32:35]
    ds_read_b128 a[76:79], v6 offset:35072
    v_accvgpr_write_b32 a234, v20
    v_mfma_f32_16x16x32_bf16 v[40:43], a[80:83], a[48:51], v[40:43]
    s_waitcnt lgkmcnt(4)
    v_accvgpr_write_b32 a235, v22
    v_mfma_f32_16x16x32_bf16 v[36:39], a[84:87], a[16:19], v[36:39]
    ds_read_b128 a[80:83], v7 offset:33024
    v_mul_f32 v24, s54, v24
    v_mfma_f32_16x16x32_bf16 v[44:47], a[84:87], a[48:51], v[44:47]
    s_add_u32 s55, s55, 16384
    s_add_u32 m0, m0, 1024
    v_mul_f32 v25, s54, v25
    s_waitcnt lgkmcnt(4)
    v_mfma_f32_16x16x32_bf16 v[32:35], a[64:67], a[20:23], v[32:35]
    ds_read_b128 a[84:87], v7 offset:35072
    v_mul_f32 v26, s54, v26
    v_mfma_f32_16x16x32_bf16 v[40:43], a[64:67], a[52:55], v[40:43]
    s_waitcnt lgkmcnt(4)
    v_mul_f32 v27, s54, v27
    v_mfma_f32_16x16x32_bf16 v[36:39], a[68:71], a[20:23], v[36:39]
    ds_read_b128 a[64:67], v4 offset:49152
    v_mul_f32 v28, s54, v28
    v_mfma_f32_16x16x32_bf16 v[44:47], a[68:71], a[52:55], v[44:47]
    buffer_load_dwordx4 v2, s[12:15], s55 offen lds
    v_mul_f32 v29, s54, v29
    s_waitcnt lgkmcnt(4)
    v_mfma_f32_16x16x32_bf16 v[32:35], a[72:75], a[24:27], v[32:35]
    ds_read_b128 a[68:71], v4 offset:51200
    v_mul_f32 v30, s54, v30
    v_mfma_f32_16x16x32_bf16 v[40:43], a[72:75], a[56:59], v[40:43]
    s_waitcnt lgkmcnt(4)
    v_mul_f32 v31, s54, v31
    v_mfma_f32_16x16x32_bf16 v[36:39], a[76:79], a[24:27], v[36:39]
    ds_read_b128 a[72:75], v5 offset:49152
    v_cvt_pk_bf16_f32 v152, v24, v25
    v_mfma_f32_16x16x32_bf16 v[44:47], a[76:79], a[56:59], v[44:47]
    s_add_u32 s55, s55, 16384
    s_add_u32 m0, m0, 1024
    v_cvt_pk_bf16_f32 v153, v26, v27
    s_waitcnt lgkmcnt(4)
    v_mfma_f32_16x16x32_bf16 v[32:35], a[80:83], a[28:31], v[32:35]
    ds_read_b128 a[76:79], v5 offset:51200
    v_cvt_pk_bf16_f32 v154, v28, v29
    v_mfma_f32_16x16x32_bf16 v[40:43], a[80:83], a[60:63], v[40:43]
    s_waitcnt lgkmcnt(4)
    v_cvt_pk_bf16_f32 v155, v30, v31
    v_mfma_f32_16x16x32_bf16 v[36:39], a[84:87], a[28:31], v[36:39]
    ds_read_b128 a[80:83], v6 offset:49152
    v_mfma_f32_16x16x32_bf16 v[44:47], a[84:87], a[60:63], v[44:47]
    buffer_load_dwordx4 v3, s[12:15], s55 offen lds
    s_waitcnt lgkmcnt(4)
    v_mfma_f32_16x16x32_bf16 v[16:19], a[64:67], v[48:51], 0
    ds_read_b128 a[84:87], v6 offset:51200
    v_mfma_f32_16x16x32_bf16 v[24:27], a[64:67], v[80:83], 0
    s_waitcnt lgkmcnt(4)
    v_mfma_f32_16x16x32_bf16 v[20:23], a[68:71], v[48:51], 0
    ds_read_b128 a[64:67], v7 offset:49152
    v_mul_f32 v32, s54, v32
    v_mfma_f32_16x16x32_bf16 v[28:31], a[68:71], v[80:83], 0
    s_waitcnt lgkmcnt(4)
    v_mul_f32 v33, s54, v33
    v_mfma_f32_16x16x32_bf16 v[16:19], a[72:75], v[52:55], v[16:19]
    ds_read_b128 a[68:71], v7 offset:51200
    v_mul_f32 v34, s54, v34
    v_mfma_f32_16x16x32_bf16 v[24:27], a[72:75], v[84:87], v[24:27]
    s_waitcnt lgkmcnt(4)
    v_mul_f32 v35, s54, v35
    v_mfma_f32_16x16x32_bf16 v[20:23], a[76:79], v[52:55], v[20:23]
    ds_read_b128 a[72:75], v4 offset:49408
    v_mul_f32 v36, s54, v36
    v_mfma_f32_16x16x32_bf16 v[28:31], a[76:79], v[84:87], v[28:31]
    s_waitcnt lgkmcnt(4)
    v_mul_f32 v37, s54, v37
    v_mfma_f32_16x16x32_bf16 v[16:19], a[80:83], v[56:59], v[16:19]
    ds_read_b128 a[76:79], v4 offset:51456
    v_mul_f32 v38, s54, v38
    v_mfma_f32_16x16x32_bf16 v[24:27], a[80:83], v[88:91], v[24:27]
    s_waitcnt lgkmcnt(4)
    v_mul_f32 v39, s54, v39
    v_mfma_f32_16x16x32_bf16 v[20:23], a[84:87], v[56:59], v[20:23]
    ds_read_b128 a[80:83], v5 offset:49408
    v_cvt_pk_bf16_f32 v208, v32, v33
    v_mfma_f32_16x16x32_bf16 v[28:31], a[84:87], v[88:91], v[28:31]
    s_waitcnt lgkmcnt(4)
    v_cvt_pk_bf16_f32 v209, v34, v35
    v_mfma_f32_16x16x32_bf16 v[16:19], a[64:67], v[60:63], v[16:19]
    ds_read_b128 a[84:87], v5 offset:51456
    v_cvt_pk_bf16_f32 v210, v36, v37
    v_mfma_f32_16x16x32_bf16 v[24:27], a[64:67], v[92:95], v[24:27]
    s_waitcnt lgkmcnt(4)
    v_cvt_pk_bf16_f32 v211, v38, v39
    v_mfma_f32_16x16x32_bf16 v[20:23], a[68:71], v[60:63], v[20:23]
    ds_read_b128 a[64:67], v6 offset:49408
    v_mul_f32 v40, s54, v40
    v_mfma_f32_16x16x32_bf16 v[28:31], a[68:71], v[92:95], v[28:31]
    s_waitcnt lgkmcnt(4)
    v_mul_f32 v41, s54, v41
    v_mfma_f32_16x16x32_bf16 v[16:19], a[72:75], v[64:67], v[16:19]
    ds_read_b128 a[68:71], v6 offset:51456
    v_mul_f32 v42, s54, v42
    v_mfma_f32_16x16x32_bf16 v[24:27], a[72:75], v[96:99], v[24:27]
    s_waitcnt lgkmcnt(4)
    v_mul_f32 v43, s54, v43
    v_mfma_f32_16x16x32_bf16 v[20:23], a[76:79], v[64:67], v[20:23]
    ds_read_b128 a[72:75], v7 offset:49408
    v_mul_f32 v44, s54, v44
    v_mfma_f32_16x16x32_bf16 v[28:31], a[76:79], v[96:99], v[28:31]
    s_waitcnt lgkmcnt(4)
    v_mul_f32 v45, s54, v45
    v_mfma_f32_16x16x32_bf16 v[16:19], a[80:83], v[68:71], v[16:19]
    ds_read_b128 a[76:79], v7 offset:51456
    v_mul_f32 v46, s54, v46
    v_mfma_f32_16x16x32_bf16 v[24:27], a[80:83], v[100:103], v[24:27]
    s_waitcnt lgkmcnt(4)
    v_mul_f32 v47, s54, v47
    v_mfma_f32_16x16x32_bf16 v[20:23], a[84:87], v[68:71], v[20:23]
    ds_read_b128 a[80:83], v4 offset:49152
    v_cvt_pk_bf16_f32 v116, v40, v41
    v_mfma_f32_16x16x32_bf16 v[28:31], a[84:87], v[100:103], v[28:31]
    s_waitcnt lgkmcnt(4)
    v_cvt_pk_bf16_f32 v117, v42, v43
    v_mfma_f32_16x16x32_bf16 v[16:19], a[64:67], v[72:75], v[16:19]
    ds_read_b128 a[84:87], v4 offset:51200
    v_cvt_pk_bf16_f32 v118, v44, v45
    v_mfma_f32_16x16x32_bf16 v[24:27], a[64:67], v[104:107], v[24:27]
    s_waitcnt lgkmcnt(4)
    v_cvt_pk_bf16_f32 v119, v46, v47
    v_mfma_f32_16x16x32_bf16 v[20:23], a[68:71], v[72:75], v[20:23]
    ds_read_b128 a[64:67], v5 offset:49152
    ds_write_b128 v14, v[116:119] offset:2048
    v_mfma_f32_16x16x32_bf16 v[28:31], a[68:71], v[104:107], v[28:31]
    s_waitcnt lgkmcnt(5)
    v_mfma_f32_16x16x32_bf16 v[16:19], a[72:75], v[76:79], v[16:19]
    ds_read_b128 a[68:71], v5 offset:51200
    v_mfma_f32_16x16x32_bf16 v[24:27], a[72:75], v[108:111], v[24:27]
    s_waitcnt lgkmcnt(5)
    v_mfma_f32_16x16x32_bf16 v[20:23], a[76:79], v[76:79], v[20:23]
    ds_read_b128 a[72:75], v6 offset:49152
    v_mfma_f32_16x16x32_bf16 v[28:31], a[76:79], v[108:111], v[28:31]
    s_barrier
    s_waitcnt lgkmcnt(5)
    v_mfma_f32_16x16x32_bf16 v[32:35], a[80:83], a[0:3], 0
    ds_read_b128 a[76:79], v6 offset:51200
    v_mfma_f32_16x16x32_bf16 v[40:43], a[80:83], a[32:35], 0
    s_waitcnt lgkmcnt(5)
    v_mfma_f32_16x16x32_bf16 v[36:39], a[84:87], a[0:3], 0
    ds_read_b128 a[80:83], v7 offset:49152
    v_mul_f32 v16, s54, v16
    v_mfma_f32_16x16x32_bf16 v[44:47], a[84:87], a[32:35], 0
    s_add_u32 s55, s50, 2097152
    s_add_u32 m0, s51, 32768
    v_mul_f32 v17, s54, v17
    s_waitcnt lgkmcnt(5)
    v_mfma_f32_16x16x32_bf16 v[32:35], a[64:67], a[4:7], v[32:35]
    ds_read_b128 a[84:87], v7 offset:51200
    v_mul_f32 v18, s54, v18
    v_mfma_f32_16x16x32_bf16 v[40:43], a[64:67], a[36:39], v[40:43]
    s_waitcnt lgkmcnt(4)
    v_mul_f32 v19, s54, v19
    v_mfma_f32_16x16x32_bf16 v[36:39], a[68:71], a[4:7], v[36:39]
    ds_read_b128 a[64:67], v4 offset:49408
    v_mul_f32 v20, s54, v20
    v_mfma_f32_16x16x32_bf16 v[44:47], a[68:71], a[36:39], v[44:47]
    buffer_load_dwordx4 v2, s[12:15], s55 offen lds
    v_mul_f32 v21, s54, v21
    s_waitcnt lgkmcnt(4)
    v_mfma_f32_16x16x32_bf16 v[32:35], a[72:75], a[8:11], v[32:35]
    ds_read_b128 a[68:71], v4 offset:51456
    v_mul_f32 v22, s54, v22
    v_mfma_f32_16x16x32_bf16 v[40:43], a[72:75], a[40:43], v[40:43]
    s_waitcnt lgkmcnt(4)
    v_mul_f32 v23, s54, v23
    v_mfma_f32_16x16x32_bf16 v[36:39], a[76:79], a[8:11], v[36:39]
    ds_read_b128 a[72:75], v5 offset:49408
    v_cvt_pk_bf16_f32 v16, v16, v17
    v_mfma_f32_16x16x32_bf16 v[44:47], a[76:79], a[40:43], v[44:47]
    s_add_u32 s55, s55, 16384
    s_add_u32 m0, m0, 1024
    v_cvt_pk_bf16_f32 v18, v18, v19
    s_waitcnt lgkmcnt(4)
    v_mfma_f32_16x16x32_bf16 v[32:35], a[80:83], a[12:15], v[32:35]
    ds_read_b128 a[76:79], v5 offset:51456
    v_cvt_pk_bf16_f32 v20, v20, v21
    v_mfma_f32_16x16x32_bf16 v[40:43], a[80:83], a[44:47], v[40:43]
    s_waitcnt lgkmcnt(4)
    v_cvt_pk_bf16_f32 v22, v22, v23
    v_mfma_f32_16x16x32_bf16 v[36:39], a[84:87], a[12:15], v[36:39]
    ds_read_b128 a[80:83], v6 offset:49408
    v_accvgpr_write_b32 a236, v16
    v_mfma_f32_16x16x32_bf16 v[44:47], a[84:87], a[44:47], v[44:47]
    buffer_load_dwordx4 v3, s[12:15], s55 offen lds
    v_accvgpr_write_b32 a237, v18
    s_waitcnt lgkmcnt(4)
    v_mfma_f32_16x16x32_bf16 v[32:35], a[64:67], a[16:19], v[32:35]
    ds_read_b128 a[84:87], v6 offset:51456
    v_accvgpr_write_b32 a238, v20
    v_mfma_f32_16x16x32_bf16 v[40:43], a[64:67], a[48:51], v[40:43]
    s_waitcnt lgkmcnt(4)
    v_accvgpr_write_b32 a239, v22
    v_mfma_f32_16x16x32_bf16 v[36:39], a[68:71], a[16:19], v[36:39]
    ds_read_b128 a[64:67], v7 offset:49408
    v_mul_f32 v24, s54, v24
    v_mfma_f32_16x16x32_bf16 v[44:47], a[68:71], a[48:51], v[44:47]
    s_add_u32 s55, s55, 16384
    s_add_u32 m0, m0, 1024
    v_mul_f32 v25, s54, v25
    s_waitcnt lgkmcnt(4)
    v_mfma_f32_16x16x32_bf16 v[32:35], a[72:75], a[20:23], v[32:35]
    ds_read_b128 a[68:71], v7 offset:51456
    v_mul_f32 v26, s54, v26
    v_mfma_f32_16x16x32_bf16 v[40:43], a[72:75], a[52:55], v[40:43]
    s_waitcnt lgkmcnt(4)
    v_mul_f32 v27, s54, v27
    v_mfma_f32_16x16x32_bf16 v[36:39], a[76:79], a[20:23], v[36:39]
    ds_read_b128 a[72:75], v8 offset:0
    v_mul_f32 v28, s54, v28
    v_mfma_f32_16x16x32_bf16 v[44:47], a[76:79], a[52:55], v[44:47]
    buffer_load_dwordx4 v2, s[12:15], s55 offen lds
    v_mul_f32 v29, s54, v29
    s_waitcnt lgkmcnt(4)
    v_mfma_f32_16x16x32_bf16 v[32:35], a[80:83], a[24:27], v[32:35]
    ds_read_b128 a[76:79], v8 offset:2048
    v_mul_f32 v30, s54, v30
    v_mfma_f32_16x16x32_bf16 v[40:43], a[80:83], a[56:59], v[40:43]
    s_waitcnt lgkmcnt(4)
    v_mul_f32 v31, s54, v31
    v_mfma_f32_16x16x32_bf16 v[36:39], a[84:87], a[24:27], v[36:39]
    ds_read_b128 a[80:83], v9 offset:0
    v_cvt_pk_bf16_f32 v156, v24, v25
    v_mfma_f32_16x16x32_bf16 v[44:47], a[84:87], a[56:59], v[44:47]
    s_add_u32 s55, s55, 16384
    s_add_u32 m0, m0, 1024
    v_cvt_pk_bf16_f32 v157, v26, v27
    s_waitcnt lgkmcnt(4)
    v_mfma_f32_16x16x32_bf16 v[32:35], a[64:67], a[28:31], v[32:35]
    ds_read_b128 a[84:87], v9 offset:2048
    v_cvt_pk_bf16_f32 v158, v28, v29
    v_mfma_f32_16x16x32_bf16 v[40:43], a[64:67], a[60:63], v[40:43]
    s_waitcnt lgkmcnt(4)
    v_cvt_pk_bf16_f32 v159, v30, v31
    v_mfma_f32_16x16x32_bf16 v[36:39], a[68:71], a[28:31], v[36:39]
    ds_read_b128 a[64:67], v10 offset:0
    v_mfma_f32_16x16x32_bf16 v[44:47], a[68:71], a[60:63], v[44:47]
    buffer_load_dwordx4 v3, s[12:15], s55 offen lds
    s_waitcnt lgkmcnt(4)
    v_mfma_f32_16x16x32_bf16 v[16:19], a[72:75], v[48:51], 0
    ds_read_b128 a[68:71], v10 offset:2048
    v_mfma_f32_16x16x32_bf16 v[24:27], a[72:75], v[80:83], 0
    s_waitcnt lgkmcnt(4)
    v_mfma_f32_16x16x32_bf16 v[20:23], a[76:79], v[48:51], 0
    ds_read_b128 a[72:75], v11 offset:0
    v_mul_f32 v32, s54, v32
    v_mfma_f32_16x16x32_bf16 v[28:31], a[76:79], v[80:83], 0
    s_waitcnt lgkmcnt(4)
    v_mul_f32 v33, s54, v33
    v_mfma_f32_16x16x32_bf16 v[16:19], a[80:83], v[52:55], v[16:19]
    ds_read_b128 a[76:79], v11 offset:2048
    v_mul_f32 v34, s54, v34
    v_mfma_f32_16x16x32_bf16 v[24:27], a[80:83], v[84:87], v[24:27]
    s_waitcnt lgkmcnt(4)
    v_mul_f32 v35, s54, v35
    v_mfma_f32_16x16x32_bf16 v[20:23], a[84:87], v[52:55], v[20:23]
    ds_read_b128 a[80:83], v8 offset:256
    v_mul_f32 v36, s54, v36
    v_mfma_f32_16x16x32_bf16 v[28:31], a[84:87], v[84:87], v[28:31]
    s_waitcnt lgkmcnt(4)
    v_mul_f32 v37, s54, v37
    v_mfma_f32_16x16x32_bf16 v[16:19], a[64:67], v[56:59], v[16:19]
    ds_read_b128 a[84:87], v8 offset:2304
    v_mul_f32 v38, s54, v38
    v_mfma_f32_16x16x32_bf16 v[24:27], a[64:67], v[88:91], v[24:27]
    s_waitcnt lgkmcnt(4)
    v_mul_f32 v39, s54, v39
    v_mfma_f32_16x16x32_bf16 v[20:23], a[68:71], v[56:59], v[20:23]
    ds_read_b128 a[64:67], v9 offset:256
    v_cvt_pk_bf16_f32 v212, v32, v33
    v_mfma_f32_16x16x32_bf16 v[28:31], a[68:71], v[88:91], v[28:31]
    s_waitcnt lgkmcnt(4)
    v_cvt_pk_bf16_f32 v213, v34, v35
    v_mfma_f32_16x16x32_bf16 v[16:19], a[72:75], v[60:63], v[16:19]
    ds_read_b128 a[68:71], v9 offset:2304
    v_cvt_pk_bf16_f32 v214, v36, v37
    v_mfma_f32_16x16x32_bf16 v[24:27], a[72:75], v[92:95], v[24:27]
    s_waitcnt lgkmcnt(4)
    v_cvt_pk_bf16_f32 v215, v38, v39
    v_mfma_f32_16x16x32_bf16 v[20:23], a[76:79], v[60:63], v[20:23]
    ds_read_b128 a[72:75], v10 offset:256
    v_mul_f32 v40, s54, v40
    v_mfma_f32_16x16x32_bf16 v[28:31], a[76:79], v[92:95], v[28:31]
    s_waitcnt lgkmcnt(4)
    v_mul_f32 v41, s54, v41
    v_mfma_f32_16x16x32_bf16 v[16:19], a[80:83], v[64:67], v[16:19]
    ds_read_b128 a[76:79], v10 offset:2304
    v_mul_f32 v42, s54, v42
    v_mfma_f32_16x16x32_bf16 v[24:27], a[80:83], v[96:99], v[24:27]
    s_waitcnt lgkmcnt(4)
    v_mul_f32 v43, s54, v43
    v_mfma_f32_16x16x32_bf16 v[20:23], a[84:87], v[64:67], v[20:23]
    ds_read_b128 a[80:83], v11 offset:256
    v_mul_f32 v44, s54, v44
    v_mfma_f32_16x16x32_bf16 v[28:31], a[84:87], v[96:99], v[28:31]
    s_waitcnt lgkmcnt(4)
    v_mul_f32 v45, s54, v45
    v_mfma_f32_16x16x32_bf16 v[16:19], a[64:67], v[68:71], v[16:19]
    ds_read_b128 a[84:87], v11 offset:2304
    v_mul_f32 v46, s54, v46
    v_mfma_f32_16x16x32_bf16 v[24:27], a[64:67], v[100:103], v[24:27]
    s_waitcnt lgkmcnt(4)
    v_mul_f32 v47, s54, v47
    v_mfma_f32_16x16x32_bf16 v[20:23], a[68:71], v[68:71], v[20:23]
    ds_read_b128 a[64:67], v8 offset:0
    v_cvt_pk_bf16_f32 v116, v40, v41
    v_mfma_f32_16x16x32_bf16 v[28:31], a[68:71], v[100:103], v[28:31]
    s_waitcnt lgkmcnt(4)
    v_cvt_pk_bf16_f32 v117, v42, v43
    v_mfma_f32_16x16x32_bf16 v[16:19], a[72:75], v[72:75], v[16:19]
    ds_read_b128 a[68:71], v8 offset:2048
    v_cvt_pk_bf16_f32 v118, v44, v45
    v_mfma_f32_16x16x32_bf16 v[24:27], a[72:75], v[104:107], v[24:27]
    s_waitcnt lgkmcnt(4)
    v_cvt_pk_bf16_f32 v119, v46, v47
    v_mfma_f32_16x16x32_bf16 v[20:23], a[76:79], v[72:75], v[20:23]
    ds_read_b128 a[72:75], v9 offset:0
    ds_write_b128 v14, v[116:119] offset:3072
    v_mfma_f32_16x16x32_bf16 v[28:31], a[76:79], v[104:107], v[28:31]
    s_waitcnt lgkmcnt(5)
    v_mfma_f32_16x16x32_bf16 v[16:19], a[80:83], v[76:79], v[16:19]
    ds_read_b128 a[76:79], v9 offset:2048
    v_mfma_f32_16x16x32_bf16 v[24:27], a[80:83], v[108:111], v[24:27]
    s_waitcnt lgkmcnt(5)
    v_mfma_f32_16x16x32_bf16 v[20:23], a[84:87], v[76:79], v[20:23]
    ds_read_b128 a[80:83], v10 offset:0
    v_mfma_f32_16x16x32_bf16 v[28:31], a[84:87], v[108:111], v[28:31]
    s_barrier
    s_waitcnt lgkmcnt(5)
    v_mfma_f32_16x16x32_bf16 v[32:35], a[64:67], a[0:3], 0
    ds_read_b128 a[84:87], v10 offset:2048
    v_mfma_f32_16x16x32_bf16 v[40:43], a[64:67], a[32:35], 0
    s_waitcnt lgkmcnt(5)
    v_mfma_f32_16x16x32_bf16 v[36:39], a[68:71], a[0:3], 0
    ds_read_b128 a[64:67], v11 offset:0
    v_mul_f32 v16, s54, v16
    v_mfma_f32_16x16x32_bf16 v[44:47], a[68:71], a[32:35], 0
    s_add_u32 s55, s50, 2359296
    s_add_u32 m0, s51, 49152
    v_mul_f32 v17, s54, v17
    s_waitcnt lgkmcnt(5)
    v_mfma_f32_16x16x32_bf16 v[32:35], a[72:75], a[4:7], v[32:35]
    ds_read_b128 a[68:71], v11 offset:2048
    v_mul_f32 v18, s54, v18
    v_mfma_f32_16x16x32_bf16 v[40:43], a[72:75], a[36:39], v[40:43]
    s_waitcnt lgkmcnt(4)
    v_mul_f32 v19, s54, v19
    v_mfma_f32_16x16x32_bf16 v[36:39], a[76:79], a[4:7], v[36:39]
    ds_read_b128 a[72:75], v8 offset:256
    v_mul_f32 v20, s54, v20
    v_mfma_f32_16x16x32_bf16 v[44:47], a[76:79], a[36:39], v[44:47]
    buffer_load_dwordx4 v2, s[12:15], s55 offen lds
    v_mul_f32 v21, s54, v21
    s_waitcnt lgkmcnt(4)
    v_mfma_f32_16x16x32_bf16 v[32:35], a[80:83], a[8:11], v[32:35]
    ds_read_b128 a[76:79], v8 offset:2304
    v_mul_f32 v22, s54, v22
    v_mfma_f32_16x16x32_bf16 v[40:43], a[80:83], a[40:43], v[40:43]
    s_waitcnt lgkmcnt(4)
    v_mul_f32 v23, s54, v23
    v_mfma_f32_16x16x32_bf16 v[36:39], a[84:87], a[8:11], v[36:39]
    ds_read_b128 a[80:83], v9 offset:256
    v_cvt_pk_bf16_f32 v16, v16, v17
    v_mfma_f32_16x16x32_bf16 v[44:47], a[84:87], a[40:43], v[44:47]
    s_add_u32 s55, s55, 16384
    s_add_u32 m0, m0, 1024
    v_cvt_pk_bf16_f32 v18, v18, v19
    s_waitcnt lgkmcnt(4)
    v_mfma_f32_16x16x32_bf16 v[32:35], a[64:67], a[12:15], v[32:35]
    ds_read_b128 a[84:87], v9 offset:2304
    v_cvt_pk_bf16_f32 v20, v20, v21
    v_mfma_f32_16x16x32_bf16 v[40:43], a[64:67], a[44:47], v[40:43]
    s_waitcnt lgkmcnt(4)
    v_cvt_pk_bf16_f32 v22, v22, v23
    v_mfma_f32_16x16x32_bf16 v[36:39], a[68:71], a[12:15], v[36:39]
    ds_read_b128 a[64:67], v10 offset:256
    v_accvgpr_write_b32 a240, v16
    v_mfma_f32_16x16x32_bf16 v[44:47], a[68:71], a[44:47], v[44:47]
    buffer_load_dwordx4 v3, s[12:15], s55 offen lds
    v_accvgpr_write_b32 a241, v18
    s_waitcnt lgkmcnt(4)
    v_mfma_f32_16x16x32_bf16 v[32:35], a[72:75], a[16:19], v[32:35]
    ds_read_b128 a[68:71], v10 offset:2304
    v_accvgpr_write_b32 a242, v20
    v_mfma_f32_16x16x32_bf16 v[40:43], a[72:75], a[48:51], v[40:43]
    s_waitcnt lgkmcnt(4)
    v_accvgpr_write_b32 a243, v22
    v_mfma_f32_16x16x32_bf16 v[36:39], a[76:79], a[16:19], v[36:39]
    ds_read_b128 a[72:75], v11 offset:256
    v_mul_f32 v24, s54, v24
    v_mfma_f32_16x16x32_bf16 v[44:47], a[76:79], a[48:51], v[44:47]
    s_add_u32 s55, s55, 16384
    s_add_u32 m0, m0, 1024
    v_mul_f32 v25, s54, v25
    s_waitcnt lgkmcnt(4)
    v_mfma_f32_16x16x32_bf16 v[32:35], a[80:83], a[20:23], v[32:35]
    ds_read_b128 a[76:79], v11 offset:2304
    v_mul_f32 v26, s54, v26
    v_mfma_f32_16x16x32_bf16 v[40:43], a[80:83], a[52:55], v[40:43]
    s_waitcnt lgkmcnt(4)
    v_mul_f32 v27, s54, v27
    v_mfma_f32_16x16x32_bf16 v[36:39], a[84:87], a[20:23], v[36:39]
    ds_read_b128 a[80:83], v8 offset:16384
    v_mul_f32 v28, s54, v28
    v_mfma_f32_16x16x32_bf16 v[44:47], a[84:87], a[52:55], v[44:47]
    buffer_load_dwordx4 v2, s[12:15], s55 offen lds
    v_mul_f32 v29, s54, v29
    s_waitcnt lgkmcnt(4)
    v_mfma_f32_16x16x32_bf16 v[32:35], a[64:67], a[24:27], v[32:35]
    ds_read_b128 a[84:87], v8 offset:18432
    v_mul_f32 v30, s54, v30
    v_mfma_f32_16x16x32_bf16 v[40:43], a[64:67], a[56:59], v[40:43]
    s_waitcnt lgkmcnt(4)
    v_mul_f32 v31, s54, v31
    v_mfma_f32_16x16x32_bf16 v[36:39], a[68:71], a[24:27], v[36:39]
    ds_read_b128 a[64:67], v9 offset:16384
    v_cvt_pk_bf16_f32 v160, v24, v25
    v_mfma_f32_16x16x32_bf16 v[44:47], a[68:71], a[56:59], v[44:47]
    s_add_u32 s55, s55, 16384
    s_add_u32 m0, m0, 1024
    v_cvt_pk_bf16_f32 v161, v26, v27
    s_waitcnt lgkmcnt(4)
    v_mfma_f32_16x16x32_bf16 v[32:35], a[72:75], a[28:31], v[32:35]
    ds_read_b128 a[68:71], v9 offset:18432
    v_cvt_pk_bf16_f32 v162, v28, v29
    v_mfma_f32_16x16x32_bf16 v[40:43], a[72:75], a[60:63], v[40:43]
    s_waitcnt lgkmcnt(4)
    v_cvt_pk_bf16_f32 v163, v30, v31
    v_mfma_f32_16x16x32_bf16 v[36:39], a[76:79], a[28:31], v[36:39]
    ds_read_b128 a[72:75], v10 offset:16384
    v_mfma_f32_16x16x32_bf16 v[44:47], a[76:79], a[60:63], v[44:47]
    buffer_load_dwordx4 v3, s[12:15], s55 offen lds
    s_waitcnt lgkmcnt(4)
    v_mfma_f32_16x16x32_bf16 v[16:19], a[80:83], v[48:51], 0
    ds_read_b128 a[76:79], v10 offset:18432
    v_mfma_f32_16x16x32_bf16 v[24:27], a[80:83], v[80:83], 0
    s_waitcnt lgkmcnt(4)
    v_mfma_f32_16x16x32_bf16 v[20:23], a[84:87], v[48:51], 0
    ds_read_b128 a[80:83], v11 offset:16384
    v_mul_f32 v32, s54, v32
    v_mfma_f32_16x16x32_bf16 v[28:31], a[84:87], v[80:83], 0
    s_waitcnt lgkmcnt(4)
    v_mul_f32 v33, s54, v33
    v_mfma_f32_16x16x32_bf16 v[16:19], a[64:67], v[52:55], v[16:19]
    ds_read_b128 a[84:87], v11 offset:18432
    v_mul_f32 v34, s54, v34
    v_mfma_f32_16x16x32_bf16 v[24:27], a[64:67], v[84:87], v[24:27]
    s_waitcnt lgkmcnt(4)
    v_mul_f32 v35, s54, v35
    v_mfma_f32_16x16x32_bf16 v[20:23], a[68:71], v[52:55], v[20:23]
    ds_read_b128 a[64:67], v8 offset:16640
    v_mul_f32 v36, s54, v36
    v_mfma_f32_16x16x32_bf16 v[28:31], a[68:71], v[84:87], v[28:31]
    s_waitcnt lgkmcnt(4)
    v_mul_f32 v37, s54, v37
    v_mfma_f32_16x16x32_bf16 v[16:19], a[72:75], v[56:59], v[16:19]
    ds_read_b128 a[68:71], v8 offset:18688
    v_mul_f32 v38, s54, v38
    v_mfma_f32_16x16x32_bf16 v[24:27], a[72:75], v[88:91], v[24:27]
    s_waitcnt lgkmcnt(4)
    v_mul_f32 v39, s54, v39
    v_mfma_f32_16x16x32_bf16 v[20:23], a[76:79], v[56:59], v[20:23]
    ds_read_b128 a[72:75], v9 offset:16640
    v_cvt_pk_bf16_f32 v216, v32, v33
    v_mfma_f32_16x16x32_bf16 v[28:31], a[76:79], v[88:91], v[28:31]
    s_waitcnt lgkmcnt(4)
    v_cvt_pk_bf16_f32 v217, v34, v35
    v_mfma_f32_16x16x32_bf16 v[16:19], a[80:83], v[60:63], v[16:19]
    ds_read_b128 a[76:79], v9 offset:18688
    v_cvt_pk_bf16_f32 v218, v36, v37
    v_mfma_f32_16x16x32_bf16 v[24:27], a[80:83], v[92:95], v[24:27]
    s_waitcnt lgkmcnt(4)
    v_cvt_pk_bf16_f32 v219, v38, v39
    v_mfma_f32_16x16x32_bf16 v[20:23], a[84:87], v[60:63], v[20:23]
    ds_read_b128 a[80:83], v10 offset:16640
    v_mul_f32 v40, s54, v40
    v_mfma_f32_16x16x32_bf16 v[28:31], a[84:87], v[92:95], v[28:31]
    s_waitcnt lgkmcnt(4)
    v_mul_f32 v41, s54, v41
    v_mfma_f32_16x16x32_bf16 v[16:19], a[64:67], v[64:67], v[16:19]
    ds_read_b128 a[84:87], v10 offset:18688
    v_mul_f32 v42, s54, v42
    v_mfma_f32_16x16x32_bf16 v[24:27], a[64:67], v[96:99], v[24:27]
    s_waitcnt lgkmcnt(4)
    v_mul_f32 v43, s54, v43
    v_mfma_f32_16x16x32_bf16 v[20:23], a[68:71], v[64:67], v[20:23]
    ds_read_b128 a[64:67], v11 offset:16640
    v_mul_f32 v44, s54, v44
    v_mfma_f32_16x16x32_bf16 v[28:31], a[68:71], v[96:99], v[28:31]
    s_waitcnt lgkmcnt(4)
    v_mul_f32 v45, s54, v45
    v_mfma_f32_16x16x32_bf16 v[16:19], a[72:75], v[68:71], v[16:19]
    ds_read_b128 a[68:71], v11 offset:18688
    v_mul_f32 v46, s54, v46
    v_mfma_f32_16x16x32_bf16 v[24:27], a[72:75], v[100:103], v[24:27]
    s_waitcnt lgkmcnt(4)
    v_mul_f32 v47, s54, v47
    v_mfma_f32_16x16x32_bf16 v[20:23], a[76:79], v[68:71], v[20:23]
    ds_read_b128 a[72:75], v8 offset:16384
    v_cvt_pk_bf16_f32 v116, v40, v41
    v_mfma_f32_16x16x32_bf16 v[28:31], a[76:79], v[100:103], v[28:31]
    s_waitcnt lgkmcnt(4)
    v_cvt_pk_bf16_f32 v117, v42, v43
    v_mfma_f32_16x16x32_bf16 v[16:19], a[80:83], v[72:75], v[16:19]
    ds_read_b128 a[76:79], v8 offset:18432
    v_cvt_pk_bf16_f32 v118, v44, v45
    v_mfma_f32_16x16x32_bf16 v[24:27], a[80:83], v[104:107], v[24:27]
    s_waitcnt lgkmcnt(4)
    v_cvt_pk_bf16_f32 v119, v46, v47
    v_mfma_f32_16x16x32_bf16 v[20:23], a[84:87], v[72:75], v[20:23]
    ds_read_b128 a[80:83], v9 offset:16384
    ds_write_b128 v14, v[116:119] offset:4096
    v_mfma_f32_16x16x32_bf16 v[28:31], a[84:87], v[104:107], v[28:31]
    s_waitcnt lgkmcnt(5)
    v_mfma_f32_16x16x32_bf16 v[16:19], a[64:67], v[76:79], v[16:19]
    ds_read_b128 a[84:87], v9 offset:18432
    v_mfma_f32_16x16x32_bf16 v[24:27], a[64:67], v[108:111], v[24:27]
    s_waitcnt lgkmcnt(5)
    v_mfma_f32_16x16x32_bf16 v[20:23], a[68:71], v[76:79], v[20:23]
    ds_read_b128 a[64:67], v10 offset:16384
    v_mfma_f32_16x16x32_bf16 v[28:31], a[68:71], v[108:111], v[28:31]
    s_waitcnt vmcnt(12)
    s_barrier
    s_waitcnt lgkmcnt(5)
    v_mfma_f32_16x16x32_bf16 v[32:35], a[72:75], a[0:3], 0
    ds_read_b128 a[68:71], v10 offset:18432
    v_mfma_f32_16x16x32_bf16 v[40:43], a[72:75], a[32:35], 0
    s_waitcnt lgkmcnt(5)
    v_mfma_f32_16x16x32_bf16 v[36:39], a[76:79], a[0:3], 0
    ds_read_b128 a[72:75], v11 offset:16384
    v_mul_f32 v16, s54, v16
    v_mfma_f32_16x16x32_bf16 v[44:47], a[76:79], a[32:35], 0
    s_add_u32 s55, s50, 2621440
    s_add_u32 m0, s51, 65536
    v_mul_f32 v17, s54, v17
    s_waitcnt lgkmcnt(5)
    v_mfma_f32_16x16x32_bf16 v[32:35], a[80:83], a[4:7], v[32:35]
    ds_read_b128 a[76:79], v11 offset:18432
    v_mul_f32 v18, s54, v18
    v_mfma_f32_16x16x32_bf16 v[40:43], a[80:83], a[36:39], v[40:43]
    s_waitcnt lgkmcnt(4)
    v_mul_f32 v19, s54, v19
    v_mfma_f32_16x16x32_bf16 v[36:39], a[84:87], a[4:7], v[36:39]
    ds_read_b128 a[80:83], v8 offset:16640
    v_mul_f32 v20, s54, v20
    v_mfma_f32_16x16x32_bf16 v[44:47], a[84:87], a[36:39], v[44:47]
    buffer_load_dwordx4 v2, s[12:15], s55 offen lds
    v_mul_f32 v21, s54, v21
    s_waitcnt lgkmcnt(4)
    v_mfma_f32_16x16x32_bf16 v[32:35], a[64:67], a[8:11], v[32:35]
    ds_read_b128 a[84:87], v8 offset:18688
    v_mul_f32 v22, s54, v22
    v_mfma_f32_16x16x32_bf16 v[40:43], a[64:67], a[40:43], v[40:43]
    s_waitcnt lgkmcnt(4)
    v_mul_f32 v23, s54, v23
    v_mfma_f32_16x16x32_bf16 v[36:39], a[68:71], a[8:11], v[36:39]
    ds_read_b128 a[64:67], v9 offset:16640
    v_cvt_pk_bf16_f32 v16, v16, v17
    v_mfma_f32_16x16x32_bf16 v[44:47], a[68:71], a[40:43], v[44:47]
    s_add_u32 s55, s55, 16384
    s_add_u32 m0, m0, 1024
    v_cvt_pk_bf16_f32 v18, v18, v19
    s_waitcnt lgkmcnt(4)
    v_mfma_f32_16x16x32_bf16 v[32:35], a[72:75], a[12:15], v[32:35]
    ds_read_b128 a[68:71], v9 offset:18688
    v_cvt_pk_bf16_f32 v20, v20, v21
    v_mfma_f32_16x16x32_bf16 v[40:43], a[72:75], a[44:47], v[40:43]
    s_waitcnt lgkmcnt(4)
    v_cvt_pk_bf16_f32 v22, v22, v23
    v_mfma_f32_16x16x32_bf16 v[36:39], a[76:79], a[12:15], v[36:39]
    ds_read_b128 a[72:75], v10 offset:16640
    v_accvgpr_write_b32 a244, v16
    v_mfma_f32_16x16x32_bf16 v[44:47], a[76:79], a[44:47], v[44:47]
    buffer_load_dwordx4 v3, s[12:15], s55 offen lds
    v_accvgpr_write_b32 a245, v18
    s_waitcnt lgkmcnt(4)
    v_mfma_f32_16x16x32_bf16 v[32:35], a[80:83], a[16:19], v[32:35]
    ds_read_b128 a[76:79], v10 offset:18688
    v_accvgpr_write_b32 a246, v20
    v_mfma_f32_16x16x32_bf16 v[40:43], a[80:83], a[48:51], v[40:43]
    s_waitcnt lgkmcnt(4)
    v_accvgpr_write_b32 a247, v22
    v_mfma_f32_16x16x32_bf16 v[36:39], a[84:87], a[16:19], v[36:39]
    ds_read_b128 a[80:83], v11 offset:16640
    v_mul_f32 v24, s54, v24
    v_mfma_f32_16x16x32_bf16 v[44:47], a[84:87], a[48:51], v[44:47]
    s_add_u32 s55, s55, 16384
    s_add_u32 m0, m0, 1024
    v_mul_f32 v25, s54, v25
    s_waitcnt lgkmcnt(4)
    v_mfma_f32_16x16x32_bf16 v[32:35], a[64:67], a[20:23], v[32:35]
    ds_read_b128 a[84:87], v11 offset:18688
    v_mul_f32 v26, s54, v26
    v_mfma_f32_16x16x32_bf16 v[40:43], a[64:67], a[52:55], v[40:43]
    s_waitcnt lgkmcnt(4)
    v_mul_f32 v27, s54, v27
    v_mfma_f32_16x16x32_bf16 v[36:39], a[68:71], a[20:23], v[36:39]
    ds_read_b128 a[64:67], v4 offset:0
    v_mul_f32 v28, s54, v28
    v_mfma_f32_16x16x32_bf16 v[44:47], a[68:71], a[52:55], v[44:47]
    buffer_load_dwordx4 v2, s[12:15], s55 offen lds
    v_mul_f32 v29, s54, v29
    s_waitcnt lgkmcnt(4)
    v_mfma_f32_16x16x32_bf16 v[32:35], a[72:75], a[24:27], v[32:35]
    ds_read_b128 a[68:71], v4 offset:2048
    v_mul_f32 v30, s54, v30
    v_mfma_f32_16x16x32_bf16 v[40:43], a[72:75], a[56:59], v[40:43]
    s_waitcnt lgkmcnt(4)
    v_mul_f32 v31, s54, v31
    v_mfma_f32_16x16x32_bf16 v[36:39], a[76:79], a[24:27], v[36:39]
    ds_read_b128 a[72:75], v5 offset:0
    v_cvt_pk_bf16_f32 v164, v24, v25
    v_mfma_f32_16x16x32_bf16 v[44:47], a[76:79], a[56:59], v[44:47]
    s_add_u32 s55, s55, 16384
    s_add_u32 m0, m0, 1024
    v_cvt_pk_bf16_f32 v165, v26, v27
    s_waitcnt lgkmcnt(4)
    v_mfma_f32_16x16x32_bf16 v[32:35], a[80:83], a[28:31], v[32:35]
    ds_read_b128 a[76:79], v5 offset:2048
    v_cvt_pk_bf16_f32 v166, v28, v29
    v_mfma_f32_16x16x32_bf16 v[40:43], a[80:83], a[60:63], v[40:43]
    buffer_load_dwordx4 v3, s[12:15], s55 offen lds
    v_cvt_pk_bf16_f32 v167, v30, v31
    s_waitcnt lgkmcnt(4)
    v_mfma_f32_16x16x32_bf16 v[36:39], a[84:87], a[28:31], v[36:39]
    ds_read_b128 a[80:83], v6 offset:0
    v_mfma_f32_16x16x32_bf16 v[44:47], a[84:87], a[60:63], v[44:47]
    v_bfe_u32 v115, v1, 2, 6
    buffer_load_dword v115, v115, s[8:11], s43 offen sc1
    s_waitcnt vmcnt(0)
    v_cmp_eq_u32 vcc, -1, v115
    s_cbranch_vccnz Lvwait_14
Lvok_13:
    s_waitcnt lgkmcnt(4)
    v_mfma_f32_16x16x32_bf16 v[16:19], a[64:67], v[48:51], 0
    ds_read_b128 a[84:87], v6 offset:2048
    v_mfma_f32_16x16x32_bf16 v[24:27], a[64:67], v[80:83], 0
    s_waitcnt lgkmcnt(4)
    v_mfma_f32_16x16x32_bf16 v[20:23], a[68:71], v[48:51], 0
    ds_read_b128 a[64:67], v7 offset:0
    v_mul_f32 v32, s54, v32
    v_mfma_f32_16x16x32_bf16 v[28:31], a[68:71], v[80:83], 0
    s_add_u32 s40, s41, 22528
    buffer_load_dwordx4 a[88:91], v1, s[8:11], s40 offen sc1
    v_mul_f32 v33, s54, v33
    s_waitcnt lgkmcnt(4)
    v_mfma_f32_16x16x32_bf16 v[16:19], a[72:75], v[52:55], v[16:19]
    ds_read_b128 a[68:71], v7 offset:2048
    v_mul_f32 v34, s54, v34
    v_mfma_f32_16x16x32_bf16 v[24:27], a[72:75], v[84:87], v[24:27]
    s_waitcnt lgkmcnt(4)
    v_mul_f32 v35, s54, v35
    v_mfma_f32_16x16x32_bf16 v[20:23], a[76:79], v[52:55], v[20:23]
    ds_read_b128 a[72:75], v4 offset:256
    v_mul_f32 v36, s54, v36
    v_mfma_f32_16x16x32_bf16 v[28:31], a[76:79], v[84:87], v[28:31]
    s_add_u32 s40, s41, 23552
    buffer_load_dwordx4 a[92:95], v1, s[8:11], s40 offen sc1
    v_mul_f32 v37, s54, v37
    s_waitcnt lgkmcnt(4)
    v_mfma_f32_16x16x32_bf16 v[16:19], a[80:83], v[56:59], v[16:19]
    ds_read_b128 a[76:79], v4 offset:2304
    v_mul_f32 v38, s54, v38
    v_mfma_f32_16x16x32_bf16 v[24:27], a[80:83], v[88:91], v[24:27]
    s_waitcnt lgkmcnt(4)
    v_mul_f32 v39, s54, v39
    v_mfma_f32_16x16x32_bf16 v[20:23], a[84:87], v[56:59], v[20:23]
    ds_read_b128 a[80:83], v5 offset:256
    v_cvt_pk_bf16_f32 v220, v32, v33
    v_mfma_f32_16x16x32_bf16 v[28:31], a[84:87], v[88:91], v[28:31]
    s_add_u32 s40, s41, 24576
    buffer_load_dwordx4 a[96:99], v1, s[8:11], s40 offen sc1
    v_cvt_pk_bf16_f32 v221, v34, v35
    s_waitcnt lgkmcnt(4)
    v_mfma_f32_16x16x32_bf16 v[16:19], a[64:67], v[60:63], v[16:19]
    ds_read_b128 a[84:87], v5 offset:2304
    v_cvt_pk_bf16_f32 v222, v36, v37
    v_mfma_f32_16x16x32_bf16 v[24:27], a[64:67], v[92:95], v[24:27]
    s_waitcnt lgkmcnt(4)
    v_cvt_pk_bf16_f32 v223, v38, v39
    v_mfma_f32_16x16x32_bf16 v[20:23], a[68:71], v[60:63], v[20:23]
    ds_read_b128 a[64:67], v6 offset:256
    v_mul_f32 v40, s54, v40
    v_mfma_f32_16x16x32_bf16 v[28:31], a[68:71], v[92:95], v[28:31]
    s_waitcnt lgkmcnt(4)
    v_mul_f32 v41, s54, v41
    v_mfma_f32_16x16x32_bf16 v[16:19], a[72:75], v[64:67], v[16:19]
    ds_read_b128 a[68:71], v6 offset:2304
    v_mul_f32 v42, s54, v42
    v_mfma_f32_16x16x32_bf16 v[24:27], a[72:75], v[96:99], v[24:27]
    s_waitcnt lgkmcnt(4)
    v_mul_f32 v43, s54, v43
    v_mfma_f32_16x16x32_bf16 v[20:23], a[76:79], v[64:67], v[20:23]
    ds_read_b128 a[72:75], v7 offset:256
    v_mul_f32 v44, s54, v44
    v_mfma_f32_16x16x32_bf16 v[28:31], a[76:79], v[96:99], v[28:31]
    s_waitcnt lgkmcnt(4)
    v_mul_f32 v45, s54, v45
    v_mfma_f32_16x16x32_bf16 v[16:19], a[80:83], v[68:71], v[16:19]
    ds_read_b128 a[76:79], v7 offset:2304
    v_mul_f32 v46, s54, v46
    v_mfma_f32_16x16x32_bf16 v[24:27], a[80:83], v[100:103], v[24:27]
    s_waitcnt lgkmcnt(4)
    v_mul_f32 v47, s54, v47
    v_mfma_f32_16x16x32_bf16 v[20:23], a[84:87], v[68:71], v[20:23]
    ds_read_b128 a[80:83], v4 offset:0
    v_cvt_pk_bf16_f32 v116, v40, v41
    v_mfma_f32_16x16x32_bf16 v[28:31], a[84:87], v[100:103], v[28:31]
    s_waitcnt lgkmcnt(4)
    v_cvt_pk_bf16_f32 v117, v42, v43
    v_mfma_f32_16x16x32_bf16 v[16:19], a[64:67], v[72:75], v[16:19]
    ds_read_b128 a[84:87], v4 offset:2048
    v_cvt_pk_bf16_f32 v118, v44, v45
    v_mfma_f32_16x16x32_bf16 v[24:27], a[64:67], v[104:107], v[24:27]
    s_waitcnt lgkmcnt(4)
    v_cvt_pk_bf16_f32 v119, v46, v47
    v_mfma_f32_16x16x32_bf16 v[20:23], a[68:71], v[72:75], v[20:23]
    ds_read_b128 a[64:67], v5 offset:0
    ds_write_b128 v14, v[116:119] offset:5120
    v_mfma_f32_16x16x32_bf16 v[28:31], a[68:71], v[104:107], v[28:31]
    s_waitcnt lgkmcnt(5)
    v_mfma_f32_16x16x32_bf16 v[16:19], a[72:75], v[76:79], v[16:19]
    ds_read_b128 a[68:71], v5 offset:2048
    v_mfma_f32_16x16x32_bf16 v[24:27], a[72:75], v[108:111], v[24:27]
    s_waitcnt lgkmcnt(5)
    v_mfma_f32_16x16x32_bf16 v[20:23], a[76:79], v[76:79], v[20:23]
    ds_read_b128 a[72:75], v6 offset:0
    v_mfma_f32_16x16x32_bf16 v[28:31], a[76:79], v[108:111], v[28:31]
    s_barrier
    s_waitcnt lgkmcnt(5)
    v_mfma_f32_16x16x32_bf16 v[32:35], a[80:83], a[0:3], 0
    ds_read_b128 a[76:79], v6 offset:2048
    v_mfma_f32_16x16x32_bf16 v[40:43], a[80:83], a[32:35], 0
    s_waitcnt lgkmcnt(5)
    v_mfma_f32_16x16x32_bf16 v[36:39], a[84:87], a[0:3], 0
    ds_read_b128 a[80:83], v7 offset:0
    v_mul_f32 v16, s54, v16
    v_mfma_f32_16x16x32_bf16 v[44:47], a[84:87], a[32:35], 0
    s_add_u32 s55, s50, 2883584
    s_add_u32 m0, s51, 81920
    v_mul_f32 v17, s54, v17
    s_waitcnt lgkmcnt(5)
    v_mfma_f32_16x16x32_bf16 v[32:35], a[64:67], a[4:7], v[32:35]
    ds_read_b128 a[84:87], v7 offset:2048
    v_mul_f32 v18, s54, v18
    v_mfma_f32_16x16x32_bf16 v[40:43], a[64:67], a[36:39], v[40:43]
    s_waitcnt lgkmcnt(4)
    v_mul_f32 v19, s54, v19
    v_mfma_f32_16x16x32_bf16 v[36:39], a[68:71], a[4:7], v[36:39]
    ds_read_b128 a[64:67], v4 offset:256
    v_mul_f32 v20, s54, v20
    v_mfma_f32_16x16x32_bf16 v[44:47], a[68:71], a[36:39], v[44:47]
    buffer_load_dwordx4 v2, s[12:15], s55 offen lds
    v_mul_f32 v21, s54, v21
    s_waitcnt lgkmcnt(4)
    v_mfma_f32_16x16x32_bf16 v[32:35], a[72:75], a[8:11], v[32:35]
    ds_read_b128 a[68:71], v4 offset:2304
    v_mul_f32 v22, s54, v22
    v_mfma_f32_16x16x32_bf16 v[40:43], a[72:75], a[40:43], v[40:43]
    s_waitcnt lgkmcnt(4)
    v_mul_f32 v23, s54, v23
    v_mfma_f32_16x16x32_bf16 v[36:39], a[76:79], a[8:11], v[36:39]
    ds_read_b128 a[72:75], v5 offset:256
    v_cvt_pk_bf16_f32 v16, v16, v17
    v_mfma_f32_16x16x32_bf16 v[44:47], a[76:79], a[40:43], v[44:47]
    s_add_u32 s55, s55, 16384
    s_add_u32 m0, m0, 1024
    v_cvt_pk_bf16_f32 v18, v18, v19
    s_waitcnt lgkmcnt(4)
    v_mfma_f32_16x16x32_bf16 v[32:35], a[80:83], a[12:15], v[32:35]
    ds_read_b128 a[76:79], v5 offset:2304
    v_cvt_pk_bf16_f32 v20, v20, v21
    v_mfma_f32_16x16x32_bf16 v[40:43], a[80:83], a[44:47], v[40:43]
    s_waitcnt lgkmcnt(4)
    v_cvt_pk_bf16_f32 v22, v22, v23
    v_mfma_f32_16x16x32_bf16 v[36:39], a[84:87], a[12:15], v[36:39]
    ds_read_b128 a[80:83], v6 offset:256
    v_accvgpr_write_b32 a248, v16
    v_mfma_f32_16x16x32_bf16 v[44:47], a[84:87], a[44:47], v[44:47]
    buffer_load_dwordx4 v3, s[12:15], s55 offen lds
    v_accvgpr_write_b32 a249, v18
    s_waitcnt lgkmcnt(4)
    v_mfma_f32_16x16x32_bf16 v[32:35], a[64:67], a[16:19], v[32:35]
    ds_read_b128 a[84:87], v6 offset:2304
    v_accvgpr_write_b32 a250, v20
    v_mfma_f32_16x16x32_bf16 v[40:43], a[64:67], a[48:51], v[40:43]
    s_waitcnt lgkmcnt(4)
    v_accvgpr_write_b32 a251, v22
    v_mfma_f32_16x16x32_bf16 v[36:39], a[68:71], a[16:19], v[36:39]
    ds_read_b128 a[64:67], v7 offset:256
    v_mul_f32 v24, s54, v24
    v_mfma_f32_16x16x32_bf16 v[44:47], a[68:71], a[48:51], v[44:47]
    s_add_u32 s55, s55, 16384
    s_add_u32 m0, m0, 1024
    v_mul_f32 v25, s54, v25
    s_waitcnt lgkmcnt(4)
    v_mfma_f32_16x16x32_bf16 v[32:35], a[72:75], a[20:23], v[32:35]
    ds_read_b128 a[68:71], v7 offset:2304
    v_mul_f32 v26, s54, v26
    v_mfma_f32_16x16x32_bf16 v[40:43], a[72:75], a[52:55], v[40:43]
    buffer_load_dwordx4 v2, s[12:15], s55 offen lds
    v_mul_f32 v27, s54, v27
    s_waitcnt lgkmcnt(4)
    v_mfma_f32_16x16x32_bf16 v[36:39], a[76:79], a[20:23], v[36:39]
    ds_read_b128 a[72:75], v4 offset:16384
    v_mul_f32 v28, s54, v28
    v_mfma_f32_16x16x32_bf16 v[44:47], a[76:79], a[52:55], v[44:47]
    s_add_u32 s55, s55, 16384
    s_add_u32 m0, m0, 1024
    v_mul_f32 v29, s54, v29
    s_waitcnt lgkmcnt(4)
    v_mfma_f32_16x16x32_bf16 v[32:35], a[80:83], a[24:27], v[32:35]
    ds_read_b128 a[76:79], v4 offset:18432
    v_mul_f32 v30, s54, v30
    v_mfma_f32_16x16x32_bf16 v[40:43], a[80:83], a[56:59], v[40:43]
    buffer_load_dwordx4 v3, s[12:15], s55 offen lds
    v_mul_f32 v31, s54, v31
    s_waitcnt lgkmcnt(4)
    v_mfma_f32_16x16x32_bf16 v[36:39], a[84:87], a[24:27], v[36:39]
    ds_read_b128 a[80:83], v5 offset:16384
    v_cvt_pk_bf16_f32 v168, v24, v25
    v_mfma_f32_16x16x32_bf16 v[44:47], a[84:87], a[56:59], v[44:47]
    s_add_u32 s40, s41, 25600
    buffer_load_dwordx4 a[100:103], v1, s[8:11], s40 offen sc1
    v_cvt_pk_bf16_f32 v169, v26, v27
    s_waitcnt lgkmcnt(4)
    v_mfma_f32_16x16x32_bf16 v[32:35], a[64:67], a[28:31], v[32:35]
    ds_read_b128 a[84:87], v5 offset:18432
    v_cvt_pk_bf16_f32 v170, v28, v29
    v_mfma_f32_16x16x32_bf16 v[40:43], a[64:67], a[60:63], v[40:43]
    s_add_u32 s40, s41, 26624
    buffer_load_dwordx4 a[104:107], v1, s[8:11], s40 offen sc1
    v_cvt_pk_bf16_f32 v171, v30, v31
    s_waitcnt lgkmcnt(4)
    v_mfma_f32_16x16x32_bf16 v[36:39], a[68:71], a[28:31], v[36:39]
    ds_read_b128 a[64:67], v6 offset:16384
    v_mfma_f32_16x16x32_bf16 v[44:47], a[68:71], a[60:63], v[44:47]
    s_add_u32 s40, s41, 27648
    buffer_load_dwordx4 a[108:111], v1, s[8:11], s40 offen sc1
    s_waitcnt lgkmcnt(4)
    v_mfma_f32_16x16x32_bf16 v[16:19], a[72:75], v[48:51], 0
    ds_read_b128 a[68:71], v6 offset:18432
    v_mfma_f32_16x16x32_bf16 v[24:27], a[72:75], v[80:83], 0
    s_waitcnt lgkmcnt(4)
    v_mfma_f32_16x16x32_bf16 v[20:23], a[76:79], v[48:51], 0
    ds_read_b128 a[72:75], v7 offset:16384
    v_mul_f32 v32, s54, v32
    v_mfma_f32_16x16x32_bf16 v[28:31], a[76:79], v[80:83], 0
    s_add_u32 s40, s41, 28672
    buffer_load_dwordx4 a[112:115], v1, s[8:11], s40 offen sc1
    v_mul_f32 v33, s54, v33
    s_waitcnt lgkmcnt(4)
    v_mfma_f32_16x16x32_bf16 v[16:19], a[80:83], v[52:55], v[16:19]
    ds_read_b128 a[76:79], v7 offset:18432
    v_mul_f32 v34, s54, v34
    v_mfma_f32_16x16x32_bf16 v[24:27], a[80:83], v[84:87], v[24:27]
    s_waitcnt lgkmcnt(4)
    v_mul_f32 v35, s54, v35
    v_mfma_f32_16x16x32_bf16 v[20:23], a[84:87], v[52:55], v[20:23]
    ds_read_b128 a[80:83], v4 offset:16640
    v_mul_f32 v36, s54, v36
    v_mfma_f32_16x16x32_bf16 v[28:31], a[84:87], v[84:87], v[28:31]
    s_add_u32 s40, s41, 29696
    buffer_load_dwordx4 a[116:119], v1, s[8:11], s40 offen sc1
    v_mul_f32 v37, s54, v37
    s_waitcnt lgkmcnt(4)
    v_mfma_f32_16x16x32_bf16 v[16:19], a[64:67], v[56:59], v[16:19]
    ds_read_b128 a[84:87], v4 offset:18688
    v_mul_f32 v38, s54, v38
    v_mfma_f32_16x16x32_bf16 v[24:27], a[64:67], v[88:91], v[24:27]
    s_waitcnt lgkmcnt(4)
    v_mul_f32 v39, s54, v39
    v_mfma_f32_16x16x32_bf16 v[20:23], a[68:71], v[56:59], v[20:23]
    ds_read_b128 a[64:67], v5 offset:16640
    v_cvt_pk_bf16_f32 v224, v32, v33
    v_mfma_f32_16x16x32_bf16 v[28:31], a[68:71], v[88:91], v[28:31]
    s_add_u32 s40, s41, 30720
    buffer_load_dwordx4 a[120:123], v1, s[8:11], s40 offen sc1
    v_cvt_pk_bf16_f32 v225, v34, v35
    s_waitcnt lgkmcnt(4)
    v_mfma_f32_16x16x32_bf16 v[16:19], a[72:75], v[60:63], v[16:19]
    ds_read_b128 a[68:71], v5 offset:18688
    v_cvt_pk_bf16_f32 v226, v36, v37
    v_mfma_f32_16x16x32_bf16 v[24:27], a[72:75], v[92:95], v[24:27]
    s_waitcnt lgkmcnt(4)
    v_cvt_pk_bf16_f32 v227, v38, v39
    v_mfma_f32_16x16x32_bf16 v[20:23], a[76:79], v[60:63], v[20:23]
    ds_read_b128 a[72:75], v6 offset:16640
    v_mul_f32 v40, s54, v40
    v_mfma_f32_16x16x32_bf16 v[28:31], a[76:79], v[92:95], v[28:31]
    s_waitcnt lgkmcnt(4)
    v_mul_f32 v41, s54, v41
    v_mfma_f32_16x16x32_bf16 v[16:19], a[80:83], v[64:67], v[16:19]
    ds_read_b128 a[76:79], v6 offset:18688
    v_mul_f32 v42, s54, v42
    v_mfma_f32_16x16x32_bf16 v[24:27], a[80:83], v[96:99], v[24:27]
    s_waitcnt lgkmcnt(4)
    v_mul_f32 v43, s54, v43
    v_mfma_f32_16x16x32_bf16 v[20:23], a[84:87], v[64:67], v[20:23]
    ds_read_b128 a[80:83], v7 offset:16640
    v_mul_f32 v44, s54, v44
    v_mfma_f32_16x16x32_bf16 v[28:31], a[84:87], v[96:99], v[28:31]
    s_waitcnt lgkmcnt(4)
    v_mul_f32 v45, s54, v45
    v_mfma_f32_16x16x32_bf16 v[16:19], a[64:67], v[68:71], v[16:19]
    ds_read_b128 a[84:87], v7 offset:18688
    v_mul_f32 v46, s54, v46
    v_mfma_f32_16x16x32_bf16 v[24:27], a[64:67], v[100:103], v[24:27]
    s_waitcnt lgkmcnt(4)
    v_mul_f32 v47, s54, v47
    v_mfma_f32_16x16x32_bf16 v[20:23], a[68:71], v[68:71], v[20:23]
    ds_read_b128 a[64:67], v4 offset:16384
    v_cvt_pk_bf16_f32 v116, v40, v41
    v_mfma_f32_16x16x32_bf16 v[28:31], a[68:71], v[100:103], v[28:31]
    s_waitcnt lgkmcnt(4)
    v_cvt_pk_bf16_f32 v117, v42, v43
    v_mfma_f32_16x16x32_bf16 v[16:19], a[72:75], v[72:75], v[16:19]
    ds_read_b128 a[68:71], v4 offset:18432
    v_cvt_pk_bf16_f32 v118, v44, v45
    v_mfma_f32_16x16x32_bf16 v[24:27], a[72:75], v[104:107], v[24:27]
    s_waitcnt lgkmcnt(4)
    v_cvt_pk_bf16_f32 v119, v46, v47
    v_mfma_f32_16x16x32_bf16 v[20:23], a[76:79], v[72:75], v[20:23]
    ds_read_b128 a[72:75], v5 offset:16384
    ds_write_b128 v14, v[116:119] offset:6144
    v_mfma_f32_16x16x32_bf16 v[28:31], a[76:79], v[104:107], v[28:31]
    s_waitcnt lgkmcnt(5)
    v_mfma_f32_16x16x32_bf16 v[16:19], a[80:83], v[76:79], v[16:19]
    ds_read_b128 a[76:79], v5 offset:18432
    v_mfma_f32_16x16x32_bf16 v[24:27], a[80:83], v[108:111], v[24:27]
    s_waitcnt lgkmcnt(5)
    v_mfma_f32_16x16x32_bf16 v[20:23], a[84:87], v[76:79], v[20:23]
    ds_read_b128 a[80:83], v6 offset:16384
    v_mfma_f32_16x16x32_bf16 v[28:31], a[84:87], v[108:111], v[28:31]
    s_barrier
    s_waitcnt lgkmcnt(5)
    v_mfma_f32_16x16x32_bf16 v[32:35], a[64:67], a[0:3], 0
    ds_read_b128 a[84:87], v6 offset:18432
    v_mfma_f32_16x16x32_bf16 v[40:43], a[64:67], a[32:35], 0
    s_waitcnt lgkmcnt(5)
    v_mfma_f32_16x16x32_bf16 v[36:39], a[68:71], a[0:3], 0
    ds_read_b128 a[64:67], v7 offset:16384
    v_mul_f32 v16, s54, v16
    v_mfma_f32_16x16x32_bf16 v[44:47], a[68:71], a[32:35], 0
    s_add_u32 s55, s50, 3145728
    s_add_u32 m0, s51, 0
    v_mul_f32 v17, s54, v17
    s_waitcnt lgkmcnt(5)
    v_mfma_f32_16x16x32_bf16 v[32:35], a[72:75], a[4:7], v[32:35]
    ds_read_b128 a[68:71], v7 offset:18432
    v_mul_f32 v18, s54, v18
    v_mfma_f32_16x16x32_bf16 v[40:43], a[72:75], a[36:39], v[40:43]
    s_waitcnt lgkmcnt(4)
    v_mul_f32 v19, s54, v19
    v_mfma_f32_16x16x32_bf16 v[36:39], a[76:79], a[4:7], v[36:39]
    ds_read_b128 a[72:75], v4 offset:16640
    v_mul_f32 v20, s54, v20
    v_mfma_f32_16x16x32_bf16 v[44:47], a[76:79], a[36:39], v[44:47]
    buffer_load_dwordx4 v2, s[12:15], s55 offen lds
    v_mul_f32 v21, s54, v21
    s_waitcnt lgkmcnt(4)
    v_mfma_f32_16x16x32_bf16 v[32:35], a[80:83], a[8:11], v[32:35]
    ds_read_b128 a[76:79], v4 offset:18688
    v_mul_f32 v22, s54, v22
    v_mfma_f32_16x16x32_bf16 v[40:43], a[80:83], a[40:43], v[40:43]
    s_waitcnt lgkmcnt(4)
    v_mul_f32 v23, s54, v23
    v_mfma_f32_16x16x32_bf16 v[36:39], a[84:87], a[8:11], v[36:39]
    ds_read_b128 a[80:83], v5 offset:16640
    v_cvt_pk_bf16_f32 v16, v16, v17
    v_mfma_f32_16x16x32_bf16 v[44:47], a[84:87], a[40:43], v[44:47]
    s_add_u32 s55, s55, 16384
    s_add_u32 m0, m0, 1024
    v_cvt_pk_bf16_f32 v18, v18, v19
    s_waitcnt lgkmcnt(4)
    v_mfma_f32_16x16x32_bf16 v[32:35], a[64:67], a[12:15], v[32:35]
    ds_read_b128 a[84:87], v5 offset:18688
    v_cvt_pk_bf16_f32 v20, v20, v21
    v_mfma_f32_16x16x32_bf16 v[40:43], a[64:67], a[44:47], v[40:43]
    s_waitcnt lgkmcnt(4)
    v_cvt_pk_bf16_f32 v22, v22, v23
    v_mfma_f32_16x16x32_bf16 v[36:39], a[68:71], a[12:15], v[36:39]
    ds_read_b128 a[64:67], v6 offset:16640
    v_accvgpr_write_b32 a252, v16
    v_mfma_f32_16x16x32_bf16 v[44:47], a[68:71], a[44:47], v[44:47]
    buffer_load_dwordx4 v3, s[12:15], s55 offen lds
    v_accvgpr_write_b32 a253, v18
    s_waitcnt lgkmcnt(4)
    v_mfma_f32_16x16x32_bf16 v[32:35], a[72:75], a[16:19], v[32:35]
    ds_read_b128 a[68:71], v6 offset:18688
    v_accvgpr_write_b32 a254, v20
    v_mfma_f32_16x16x32_bf16 v[40:43], a[72:75], a[48:51], v[40:43]
    s_waitcnt lgkmcnt(4)
    v_accvgpr_write_b32 a255, v22
    v_mfma_f32_16x16x32_bf16 v[36:39], a[76:79], a[16:19], v[36:39]
    ds_read_b128 a[72:75], v7 offset:16640
    v_mul_f32 v24, s54, v24
    v_mfma_f32_16x16x32_bf16 v[44:47], a[76:79], a[48:51], v[44:47]
    s_add_u32 s55, s55, 16384
    s_add_u32 m0, m0, 1024
    v_mul_f32 v25, s54, v25
    s_waitcnt lgkmcnt(4)
    v_mfma_f32_16x16x32_bf16 v[32:35], a[80:83], a[20:23], v[32:35]
    ds_read_b128 a[76:79], v7 offset:18688
    v_mul_f32 v26, s54, v26
    v_mfma_f32_16x16x32_bf16 v[40:43], a[80:83], a[52:55], v[40:43]
    buffer_load_dwordx4 v2, s[12:15], s55 offen lds
    v_mul_f32 v27, s54, v27
    s_waitcnt lgkmcnt(4)
    v_mfma_f32_16x16x32_bf16 v[36:39], a[84:87], a[20:23], v[36:39]
    ds_read_b128 a[80:83], v4 offset:32768
    v_mul_f32 v28, s54, v28
    v_mfma_f32_16x16x32_bf16 v[44:47], a[84:87], a[52:55], v[44:47]
    s_add_u32 s55, s55, 16384
    s_add_u32 m0, m0, 1024
    v_mul_f32 v29, s54, v29
    s_waitcnt lgkmcnt(4)
    v_mfma_f32_16x16x32_bf16 v[32:35], a[64:67], a[24:27], v[32:35]
    ds_read_b128 a[84:87], v4 offset:34816
    v_mul_f32 v30, s54, v30
    v_mfma_f32_16x16x32_bf16 v[40:43], a[64:67], a[56:59], v[40:43]
    buffer_load_dwordx4 v3, s[12:15], s55 offen lds
    v_mul_f32 v31, s54, v31
    s_waitcnt lgkmcnt(4)
    v_mfma_f32_16x16x32_bf16 v[36:39], a[68:71], a[24:27], v[36:39]
    ds_read_b128 a[64:67], v5 offset:32768
    v_cvt_pk_bf16_f32 v172, v24, v25
    v_mfma_f32_16x16x32_bf16 v[44:47], a[68:71], a[56:59], v[44:47]
    s_add_u32 s40, s41, 31744
    buffer_load_dwordx4 a[124:127], v1, s[8:11], s40 offen sc1
    v_cvt_pk_bf16_f32 v173, v26, v27
    s_waitcnt lgkmcnt(4)
    v_mfma_f32_16x16x32_bf16 v[32:35], a[72:75], a[28:31], v[32:35]
    ds_read_b128 a[68:71], v5 offset:34816
    v_cvt_pk_bf16_f32 v174, v28, v29
    v_mfma_f32_16x16x32_bf16 v[40:43], a[72:75], a[60:63], v[40:43]
    s_add_u32 s40, s41, 32768
    buffer_load_dwordx4 a[128:131], v1, s[8:11], s40 offen sc1
    v_cvt_pk_bf16_f32 v175, v30, v31
    s_waitcnt lgkmcnt(4)
    v_mfma_f32_16x16x32_bf16 v[36:39], a[76:79], a[28:31], v[36:39]
    ds_read_b128 a[72:75], v6 offset:32768
    v_mfma_f32_16x16x32_bf16 v[44:47], a[76:79], a[60:63], v[44:47]
    s_add_u32 s40, s41, 33792
    buffer_load_dwordx4 a[132:135], v1, s[8:11], s40 offen sc1
    s_waitcnt lgkmcnt(4)
    v_mfma_f32_16x16x32_bf16 v[16:19], a[80:83], v[48:51], 0
    ds_read_b128 a[76:79], v6 offset:34816
    v_mfma_f32_16x16x32_bf16 v[24:27], a[80:83], v[80:83], 0
    s_waitcnt lgkmcnt(4)
    v_mfma_f32_16x16x32_bf16 v[20:23], a[84:87], v[48:51], 0
    ds_read_b128 a[80:83], v7 offset:32768
    v_mul_f32 v32, s54, v32
    v_mfma_f32_16x16x32_bf16 v[28:31], a[84:87], v[80:83], 0
    s_add_u32 s40, s41, 34816
    buffer_load_dwordx4 a[136:139], v1, s[8:11], s40 offen sc1
    v_mul_f32 v33, s54, v33
    s_waitcnt lgkmcnt(4)
    v_mfma_f32_16x16x32_bf16 v[16:19], a[64:67], v[52:55], v[16:19]
    ds_read_b128 a[84:87], v7 offset:34816
    v_mul_f32 v34, s54, v34
    v_mfma_f32_16x16x32_bf16 v[24:27], a[64:67], v[84:87], v[24:27]
    s_waitcnt lgkmcnt(4)
    v_mul_f32 v35, s54, v35
    v_mfma_f32_16x16x32_bf16 v[20:23], a[68:71], v[52:55], v[20:23]
    ds_read_b128 a[64:67], v4 offset:33024
    v_mul_f32 v36, s54, v36
    v_mfma_f32_16x16x32_bf16 v[28:31], a[68:71], v[84:87], v[28:31]
    s_add_u32 s40, s41, 35840
    buffer_load_dwordx4 a[140:143], v1, s[8:11], s40 offen sc1
    v_mul_f32 v37, s54, v37
    s_waitcnt lgkmcnt(4)
    v_mfma_f32_16x16x32_bf16 v[16:19], a[72:75], v[56:59], v[16:19]
    ds_read_b128 a[68:71], v4 offset:35072
    v_mul_f32 v38, s54, v38
    v_mfma_f32_16x16x32_bf16 v[24:27], a[72:75], v[88:91], v[24:27]
    s_waitcnt lgkmcnt(4)
    v_mul_f32 v39, s54, v39
    v_mfma_f32_16x16x32_bf16 v[20:23], a[76:79], v[56:59], v[20:23]
    ds_read_b128 a[72:75], v5 offset:33024
    v_cvt_pk_bf16_f32 v228, v32, v33
    v_mfma_f32_16x16x32_bf16 v[28:31], a[76:79], v[88:91], v[28:31]
    s_add_u32 s40, s41, 36864
    buffer_load_dwordx4 a[144:147], v1, s[8:11], s40 offen sc1
    v_cvt_pk_bf16_f32 v229, v34, v35
    s_waitcnt lgkmcnt(4)
    v_mfma_f32_16x16x32_bf16 v[16:19], a[80:83], v[60:63], v[16:19]
    ds_read_b128 a[76:79], v5 offset:35072
    v_cvt_pk_bf16_f32 v230, v36, v37
    v_mfma_f32_16x16x32_bf16 v[24:27], a[80:83], v[92:95], v[24:27]
    s_waitcnt lgkmcnt(4)
    v_cvt_pk_bf16_f32 v231, v38, v39
    v_mfma_f32_16x16x32_bf16 v[20:23], a[84:87], v[60:63], v[20:23]
    ds_read_b128 a[80:83], v6 offset:33024
    v_mul_f32 v40, s54, v40
    v_mfma_f32_16x16x32_bf16 v[28:31], a[84:87], v[92:95], v[28:31]
    s_waitcnt lgkmcnt(4)
    v_mul_f32 v41, s54, v41
    v_mfma_f32_16x16x32_bf16 v[16:19], a[64:67], v[64:67], v[16:19]
    ds_read_b128 a[84:87], v6 offset:35072
    v_mul_f32 v42, s54, v42
    v_mfma_f32_16x16x32_bf16 v[24:27], a[64:67], v[96:99], v[24:27]
    s_waitcnt lgkmcnt(4)
    v_mul_f32 v43, s54, v43
    v_mfma_f32_16x16x32_bf16 v[20:23], a[68:71], v[64:67], v[20:23]
    ds_read_b128 a[64:67], v7 offset:33024
    v_mul_f32 v44, s54, v44
    v_mfma_f32_16x16x32_bf16 v[28:31], a[68:71], v[96:99], v[28:31]
    s_waitcnt lgkmcnt(4)
    v_mul_f32 v45, s54, v45
    v_mfma_f32_16x16x32_bf16 v[16:19], a[72:75], v[68:71], v[16:19]
    ds_read_b128 a[68:71], v7 offset:35072
    v_mul_f32 v46, s54, v46
    v_mfma_f32_16x16x32_bf16 v[24:27], a[72:75], v[100:103], v[24:27]
    s_waitcnt lgkmcnt(4)
    v_mul_f32 v47, s54, v47
    v_mfma_f32_16x16x32_bf16 v[20:23], a[76:79], v[68:71], v[20:23]
    ds_read_b128 a[72:75], v4 offset:32768
    v_cvt_pk_bf16_f32 v116, v40, v41
    v_mfma_f32_16x16x32_bf16 v[28:31], a[76:79], v[100:103], v[28:31]
    s_waitcnt lgkmcnt(4)
    v_cvt_pk_bf16_f32 v117, v42, v43
    v_mfma_f32_16x16x32_bf16 v[16:19], a[80:83], v[72:75], v[16:19]
    ds_read_b128 a[76:79], v4 offset:34816
    v_cvt_pk_bf16_f32 v118, v44, v45
    v_mfma_f32_16x16x32_bf16 v[24:27], a[80:83], v[104:107], v[24:27]
    s_waitcnt lgkmcnt(4)
    v_cvt_pk_bf16_f32 v119, v46, v47
    v_mfma_f32_16x16x32_bf16 v[20:23], a[84:87], v[72:75], v[20:23]
    ds_read_b128 a[80:83], v5 offset:32768
    ds_write_b128 v14, v[116:119] offset:7168
    v_mfma_f32_16x16x32_bf16 v[28:31], a[84:87], v[104:107], v[28:31]
    s_waitcnt lgkmcnt(5)
    v_mfma_f32_16x16x32_bf16 v[16:19], a[64:67], v[76:79], v[16:19]
    ds_read_b128 a[84:87], v5 offset:34816
    v_mfma_f32_16x16x32_bf16 v[24:27], a[64:67], v[108:111], v[24:27]
    s_waitcnt lgkmcnt(5)
    v_mfma_f32_16x16x32_bf16 v[20:23], a[68:71], v[76:79], v[20:23]
    ds_read_b128 a[64:67], v6 offset:32768
    v_mfma_f32_16x16x32_bf16 v[28:31], a[68:71], v[108:111], v[28:31]
    s_barrier
    s_waitcnt lgkmcnt(5)
    v_mfma_f32_16x16x32_bf16 v[32:35], a[72:75], a[0:3], 0
    ds_read_b128 a[68:71], v6 offset:34816
    v_mfma_f32_16x16x32_bf16 v[40:43], a[72:75], a[32:35], 0
    s_waitcnt lgkmcnt(5)
    v_mfma_f32_16x16x32_bf16 v[36:39], a[76:79], a[0:3], 0
    ds_read_b128 a[72:75], v7 offset:32768
    v_mul_f32 v16, s54, v16
    v_mfma_f32_16x16x32_bf16 v[44:47], a[76:79], a[32:35], 0
    s_add_u32 s55, s50, 3407872
    s_add_u32 m0, s51, 16384
    v_mul_f32 v17, s54, v17
    s_waitcnt lgkmcnt(5)
    v_mfma_f32_16x16x32_bf16 v[32:35], a[80:83], a[4:7], v[32:35]
    ds_read_b128 a[76:79], v7 offset:34816
    v_mul_f32 v18, s54, v18
    v_mfma_f32_16x16x32_bf16 v[40:43], a[80:83], a[36:39], v[40:43]
    s_waitcnt lgkmcnt(4)
    v_mul_f32 v19, s54, v19
    v_mfma_f32_16x16x32_bf16 v[36:39], a[84:87], a[4:7], v[36:39]
    ds_read_b128 a[80:83], v4 offset:33024
    v_mul_f32 v20, s54, v20
    v_mfma_f32_16x16x32_bf16 v[44:47], a[84:87], a[36:39], v[44:47]
    buffer_load_dwordx4 v2, s[12:15], s55 offen lds
    v_mul_f32 v21, s54, v21
    s_waitcnt lgkmcnt(4)
    v_mfma_f32_16x16x32_bf16 v[32:35], a[64:67], a[8:11], v[32:35]
    ds_read_b128 a[84:87], v4 offset:35072
    v_mul_f32 v22, s54, v22
    v_mfma_f32_16x16x32_bf16 v[40:43], a[64:67], a[40:43], v[40:43]
    s_waitcnt lgkmcnt(4)
    v_mul_f32 v23, s54, v23
    v_mfma_f32_16x16x32_bf16 v[36:39], a[68:71], a[8:11], v[36:39]
    ds_read_b128 a[64:67], v5 offset:33024
    v_cvt_pk_bf16_f32 v120, v16, v17
    v_mfma_f32_16x16x32_bf16 v[44:47], a[68:71], a[40:43], v[44:47]
    s_add_u32 s55, s55, 16384
    s_add_u32 m0, m0, 1024
    v_cvt_pk_bf16_f32 v121, v18, v19
    s_waitcnt lgkmcnt(4)
    v_mfma_f32_16x16x32_bf16 v[32:35], a[72:75], a[12:15], v[32:35]
    ds_read_b128 a[68:71], v5 offset:35072
    v_cvt_pk_bf16_f32 v122, v20, v21
    v_mfma_f32_16x16x32_bf16 v[40:43], a[72:75], a[44:47], v[40:43]
    s_waitcnt lgkmcnt(4)
    v_cvt_pk_bf16_f32 v123, v22, v23
    v_mfma_f32_16x16x32_bf16 v[36:39], a[76:79], a[12:15], v[36:39]
    ds_read_b128 a[72:75], v6 offset:33024
    v_mul_f32 v24, s54, v24
    v_mfma_f32_16x16x32_bf16 v[44:47], a[76:79], a[44:47], v[44:47]
    buffer_load_dwordx4 v3, s[12:15], s55 offen lds
    v_mul_f32 v25, s54, v25
    s_waitcnt lgkmcnt(4)
    v_mfma_f32_16x16x32_bf16 v[32:35], a[80:83], a[16:19], v[32:35]
    ds_read_b128 a[76:79], v6 offset:35072
    v_mul_f32 v26, s54, v26
    v_mfma_f32_16x16x32_bf16 v[40:43], a[80:83], a[48:51], v[40:43]
    s_waitcnt lgkmcnt(4)
    v_mul_f32 v27, s54, v27
    v_mfma_f32_16x16x32_bf16 v[36:39], a[84:87], a[16:19], v[36:39]
    ds_read_b128 a[80:83], v7 offset:33024
    v_mul_f32 v28, s54, v28
    v_mfma_f32_16x16x32_bf16 v[44:47], a[84:87], a[48:51], v[44:47]
    s_add_u32 s55, s55, 16384
    s_add_u32 m0, m0, 1024
    v_mul_f32 v29, s54, v29
    s_waitcnt lgkmcnt(4)
    v_mfma_f32_16x16x32_bf16 v[32:35], a[64:67], a[20:23], v[32:35]
    ds_read_b128 a[84:87], v7 offset:35072
    v_mul_f32 v30, s54, v30
    v_mfma_f32_16x16x32_bf16 v[40:43], a[64:67], a[52:55], v[40:43]
    buffer_load_dwordx4 v2, s[12:15], s55 offen lds
    v_mul_f32 v31, s54, v31
    s_waitcnt lgkmcnt(4)
    v_mfma_f32_16x16x32_bf16 v[36:39], a[68:71], a[20:23], v[36:39]
    ds_read_b128 a[64:67], v4 offset:49152
    v_cvt_pk_bf16_f32 v176, v24, v25
    v_mfma_f32_16x16x32_bf16 v[44:47], a[68:71], a[52:55], v[44:47]
    s_add_u32 s55, s55, 16384
    s_add_u32 m0, m0, 1024
    v_cvt_pk_bf16_f32 v177, v26, v27
    s_waitcnt lgkmcnt(4)
    v_mfma_f32_16x16x32_bf16 v[32:35], a[72:75], a[24:27], v[32:35]
    ds_read_b128 a[68:71], v4 offset:51200
    v_cvt_pk_bf16_f32 v178, v28, v29
    v_mfma_f32_16x16x32_bf16 v[40:43], a[72:75], a[56:59], v[40:43]
    buffer_load_dwordx4 v3, s[12:15], s55 offen lds
    v_cvt_pk_bf16_f32 v179, v30, v31
    s_waitcnt lgkmcnt(4)
    v_mfma_f32_16x16x32_bf16 v[36:39], a[76:79], a[24:27], v[36:39]
    ds_read_b128 a[72:75], v5 offset:49152
    v_mfma_f32_16x16x32_bf16 v[44:47], a[76:79], a[56:59], v[44:47]
    s_add_u32 s40, s41, 37888
    buffer_load_dwordx4 a[148:151], v1, s[8:11], s40 offen sc1
    s_waitcnt lgkmcnt(4)
    v_mfma_f32_16x16x32_bf16 v[32:35], a[80:83], a[28:31], v[32:35]
    ds_read_b128 a[76:79], v5 offset:51200
    v_mfma_f32_16x16x32_bf16 v[40:43], a[80:83], a[60:63], v[40:43]
    s_add_u32 s40, s41, 38912
    buffer_load_dwordx4 a[152:155], v1, s[8:11], s40 offen sc1
    s_waitcnt lgkmcnt(4)
    v_mfma_f32_16x16x32_bf16 v[36:39], a[84:87], a[28:31], v[36:39]
    ds_read_b128 a[80:83], v6 offset:49152
    v_mfma_f32_16x16x32_bf16 v[44:47], a[84:87], a[60:63], v[44:47]
    s_add_u32 s40, s41, 39936
    buffer_load_dwordx4 a[156:159], v1, s[8:11], s40 offen sc1
    s_waitcnt lgkmcnt(4)
    v_mfma_f32_16x16x32_bf16 v[16:19], a[64:67], v[48:51], 0
    ds_read_b128 a[84:87], v6 offset:51200
    v_mfma_f32_16x16x32_bf16 v[24:27], a[64:67], v[80:83], 0
    s_waitcnt lgkmcnt(4)
    v_mfma_f32_16x16x32_bf16 v[20:23], a[68:71], v[48:51], 0
    ds_read_b128 a[64:67], v7 offset:49152
    v_mul_f32 v32, s54, v32
    v_mfma_f32_16x16x32_bf16 v[28:31], a[68:71], v[80:83], 0
    s_add_u32 s40, s41, 40960
    buffer_load_dwordx4 a[160:163], v1, s[8:11], s40 offen sc1
    v_mul_f32 v33, s54, v33
    s_waitcnt lgkmcnt(4)
    v_mfma_f32_16x16x32_bf16 v[16:19], a[72:75], v[52:55], v[16:19]
    ds_read_b128 a[68:71], v7 offset:51200
    v_mul_f32 v34, s54, v34
    v_mfma_f32_16x16x32_bf16 v[24:27], a[72:75], v[84:87], v[24:27]
    s_waitcnt lgkmcnt(4)
    v_mul_f32 v35, s54, v35
    v_mfma_f32_16x16x32_bf16 v[20:23], a[76:79], v[52:55], v[20:23]
    ds_read_b128 a[72:75], v4 offset:49408
    v_mul_f32 v36, s54, v36
    v_mfma_f32_16x16x32_bf16 v[28:31], a[76:79], v[84:87], v[28:31]
    s_add_u32 s40, s41, 41984
    buffer_load_dwordx4 a[164:167], v1, s[8:11], s40 offen sc1
    v_mul_f32 v37, s54, v37
    s_waitcnt lgkmcnt(4)
    v_mfma_f32_16x16x32_bf16 v[16:19], a[80:83], v[56:59], v[16:19]
    ds_read_b128 a[76:79], v4 offset:51456
    v_mul_f32 v38, s54, v38
    v_mfma_f32_16x16x32_bf16 v[24:27], a[80:83], v[88:91], v[24:27]
    s_waitcnt lgkmcnt(4)
    v_mul_f32 v39, s54, v39
    v_mfma_f32_16x16x32_bf16 v[20:23], a[84:87], v[56:59], v[20:23]
    ds_read_b128 a[80:83], v5 offset:49408
    v_cvt_pk_bf16_f32 v232, v32, v33
    v_mfma_f32_16x16x32_bf16 v[28:31], a[84:87], v[88:91], v[28:31]
    s_add_u32 s40, s41, 43008
    buffer_load_dwordx4 a[168:171], v1, s[8:11], s40 offen sc1
    v_cvt_pk_bf16_f32 v233, v34, v35
    s_waitcnt lgkmcnt(4)
    v_mfma_f32_16x16x32_bf16 v[16:19], a[64:67], v[60:63], v[16:19]
    ds_read_b128 a[84:87], v5 offset:51456
    v_cvt_pk_bf16_f32 v234, v36, v37
    v_mfma_f32_16x16x32_bf16 v[24:27], a[64:67], v[92:95], v[24:27]
    s_waitcnt lgkmcnt(4)
    v_cvt_pk_bf16_f32 v235, v38, v39
    v_mfma_f32_16x16x32_bf16 v[20:23], a[68:71], v[60:63], v[20:23]
    ds_read_b128 a[64:67], v6 offset:49408
    v_mul_f32 v40, s54, v40
    v_mfma_f32_16x16x32_bf16 v[28:31], a[68:71], v[92:95], v[28:31]
    s_waitcnt lgkmcnt(4)
    v_mul_f32 v41, s54, v41
    v_mfma_f32_16x16x32_bf16 v[16:19], a[72:75], v[64:67], v[16:19]
    ds_read_b128 a[68:71], v6 offset:51456
    v_mul_f32 v42, s54, v42
    v_mfma_f32_16x16x32_bf16 v[24:27], a[72:75], v[96:99], v[24:27]
    s_waitcnt lgkmcnt(4)
    v_mul_f32 v43, s54, v43
    v_mfma_f32_16x16x32_bf16 v[20:23], a[76:79], v[64:67], v[20:23]
    ds_read_b128 a[72:75], v7 offset:49408
    v_mul_f32 v44, s54, v44
    v_mfma_f32_16x16x32_bf16 v[28:31], a[76:79], v[96:99], v[28:31]
    s_waitcnt lgkmcnt(4)
    v_mul_f32 v45, s54, v45
    v_mfma_f32_16x16x32_bf16 v[16:19], a[80:83], v[68:71], v[16:19]
    ds_read_b128 a[76:79], v7 offset:51456
    v_mul_f32 v46, s54, v46
    v_mfma_f32_16x16x32_bf16 v[24:27], a[80:83], v[100:103], v[24:27]
    s_waitcnt lgkmcnt(4)
    v_mul_f32 v47, s54, v47
    v_mfma_f32_16x16x32_bf16 v[20:23], a[84:87], v[68:71], v[20:23]
    ds_read_b128 a[80:83], v4 offset:49152
    v_cvt_pk_bf16_f32 v116, v40, v41
    v_mfma_f32_16x16x32_bf16 v[28:31], a[84:87], v[100:103], v[28:31]
    s_waitcnt lgkmcnt(4)
    v_cvt_pk_bf16_f32 v117, v42, v43
    v_mfma_f32_16x16x32_bf16 v[16:19], a[64:67], v[72:75], v[16:19]
    ds_read_b128 a[84:87], v4 offset:51200
    v_cvt_pk_bf16_f32 v118, v44, v45
    v_mfma_f32_16x16x32_bf16 v[24:27], a[64:67], v[104:107], v[24:27]
    s_waitcnt lgkmcnt(4)
    v_cvt_pk_bf16_f32 v119, v46, v47
    v_mfma_f32_16x16x32_bf16 v[20:23], a[68:71], v[72:75], v[20:23]
    ds_read_b128 a[64:67], v5 offset:49152
    ds_write_b128 v14, v[116:119] offset:8192
    v_mfma_f32_16x16x32_bf16 v[28:31], a[68:71], v[104:107], v[28:31]
    s_waitcnt lgkmcnt(5)
    v_mfma_f32_16x16x32_bf16 v[16:19], a[72:75], v[76:79], v[16:19]
    ds_read_b128 a[68:71], v5 offset:51200
    v_mfma_f32_16x16x32_bf16 v[24:27], a[72:75], v[108:111], v[24:27]
    s_waitcnt lgkmcnt(5)
    v_mfma_f32_16x16x32_bf16 v[20:23], a[76:79], v[76:79], v[20:23]
    ds_read_b128 a[72:75], v6 offset:49152
    v_mfma_f32_16x16x32_bf16 v[28:31], a[76:79], v[108:111], v[28:31]
    s_barrier
    s_waitcnt lgkmcnt(5)
    v_mfma_f32_16x16x32_bf16 v[32:35], a[80:83], a[0:3], 0
    ds_read_b128 a[76:79], v6 offset:51200
    v_mfma_f32_16x16x32_bf16 v[40:43], a[80:83], a[32:35], 0
    s_waitcnt lgkmcnt(5)
    v_mfma_f32_16x16x32_bf16 v[36:39], a[84:87], a[0:3], 0
    ds_read_b128 a[80:83], v7 offset:49152
    v_mul_f32 v16, s54, v16
    v_mfma_f32_16x16x32_bf16 v[44:47], a[84:87], a[32:35], 0
    v_lshrrev_b32 v112, 1, v1
    buffer_load_dwordx2 v[112:113], v112, s[8:11], s39 offen sc1
    v_mul_f32 v17, s54, v17
    s_waitcnt lgkmcnt(5)
    v_mfma_f32_16x16x32_bf16 v[32:35], a[64:67], a[4:7], v[32:35]
    ds_read_b128 a[84:87], v7 offset:51200
    v_mul_f32 v18, s54, v18
    v_mfma_f32_16x16x32_bf16 v[40:43], a[64:67], a[36:39], v[40:43]
    s_waitcnt lgkmcnt(4)
    v_mul_f32 v19, s54, v19
    v_mfma_f32_16x16x32_bf16 v[36:39], a[68:71], a[4:7], v[36:39]
    ds_read_b128 a[64:67], v4 offset:49408
    v_mul_f32 v20, s54, v20
    v_mfma_f32_16x16x32_bf16 v[44:47], a[68:71], a[36:39], v[44:47]
    s_add_u32 s40, s41, 44032
    buffer_load_dwordx4 a[172:175], v1, s[8:11], s40 offen sc1
    v_mul_f32 v21, s54, v21
    s_waitcnt lgkmcnt(4)
    v_mfma_f32_16x16x32_bf16 v[32:35], a[72:75], a[8:11], v[32:35]
    ds_read_b128 a[68:71], v4 offset:51456
    v_mul_f32 v22, s54, v22
    v_mfma_f32_16x16x32_bf16 v[40:43], a[72:75], a[40:43], v[40:43]
    s_waitcnt lgkmcnt(4)
    v_mul_f32 v23, s54, v23
    v_mfma_f32_16x16x32_bf16 v[36:39], a[76:79], a[8:11], v[36:39]
    ds_read_b128 a[72:75], v5 offset:49408
    v_cvt_pk_bf16_f32 v124, v16, v17
    v_mfma_f32_16x16x32_bf16 v[44:47], a[76:79], a[40:43], v[44:47]
    s_add_u32 s40, s41, 45056
    buffer_load_dwordx4 a[176:179], v1, s[8:11], s40 offen sc1
    v_cvt_pk_bf16_f32 v125, v18, v19
    s_waitcnt lgkmcnt(4)
    v_mfma_f32_16x16x32_bf16 v[32:35], a[80:83], a[12:15], v[32:35]
    ds_read_b128 a[76:79], v5 offset:51456
    v_cvt_pk_bf16_f32 v126, v20, v21
    v_mfma_f32_16x16x32_bf16 v[40:43], a[80:83], a[44:47], v[40:43]
    s_waitcnt lgkmcnt(4)
    v_cvt_pk_bf16_f32 v127, v22, v23
    v_mfma_f32_16x16x32_bf16 v[36:39], a[84:87], a[12:15], v[36:39]
    ds_read_b128 a[80:83], v6 offset:49408
    v_mul_f32 v24, s54, v24
    v_mfma_f32_16x16x32_bf16 v[44:47], a[84:87], a[44:47], v[44:47]
    s_add_u32 s40, s41, 46080
    buffer_load_dwordx4 a[180:183], v1, s[8:11], s40 offen sc1
    v_mul_f32 v25, s54, v25
    s_waitcnt lgkmcnt(4)
    v_mfma_f32_16x16x32_bf16 v[32:35], a[64:67], a[16:19], v[32:35]
    ds_read_b128 a[84:87], v6 offset:51456
    v_mul_f32 v26, s54, v26
    v_mfma_f32_16x16x32_bf16 v[40:43], a[64:67], a[48:51], v[40:43]
    s_waitcnt lgkmcnt(4)
    v_mul_f32 v27, s54, v27
    v_mfma_f32_16x16x32_bf16 v[36:39], a[68:71], a[16:19], v[36:39]
    ds_read_b128 a[64:67], v7 offset:49408
    v_mul_f32 v28, s54, v28
    v_mfma_f32_16x16x32_bf16 v[44:47], a[68:71], a[48:51], v[44:47]
    s_waitcnt lgkmcnt(4)
    v_mul_f32 v29, s54, v29
    v_mfma_f32_16x16x32_bf16 v[32:35], a[72:75], a[20:23], v[32:35]
    ds_read_b128 a[68:71], v7 offset:51456
    v_mul_f32 v30, s54, v30
    v_mfma_f32_16x16x32_bf16 v[40:43], a[72:75], a[52:55], v[40:43]
    s_waitcnt lgkmcnt(4)
    v_mul_f32 v31, s54, v31
    v_mfma_f32_16x16x32_bf16 v[36:39], a[76:79], a[20:23], v[36:39]
    ds_read_b128 a[72:75], v8 offset:0
    v_cvt_pk_bf16_f32 v180, v24, v25
    v_mfma_f32_16x16x32_bf16 v[44:47], a[76:79], a[52:55], v[44:47]
    s_waitcnt lgkmcnt(4)
    v_cvt_pk_bf16_f32 v181, v26, v27
    v_mfma_f32_16x16x32_bf16 v[32:35], a[80:83], a[24:27], v[32:35]
    ds_read_b128 a[76:79], v8 offset:2048
    v_cvt_pk_bf16_f32 v182, v28, v29
    v_mfma_f32_16x16x32_bf16 v[40:43], a[80:83], a[56:59], v[40:43]
    s_waitcnt lgkmcnt(4)
    v_cvt_pk_bf16_f32 v183, v30, v31
    v_mfma_f32_16x16x32_bf16 v[36:39], a[84:87], a[24:27], v[36:39]
    ds_read_b128 a[80:83], v9 offset:0
    v_mfma_f32_16x16x32_bf16 v[44:47], a[84:87], a[56:59], v[44:47]
    s_waitcnt lgkmcnt(4)
    v_mfma_f32_16x16x32_bf16 v[32:35], a[64:67], a[28:31], v[32:35]
    ds_read_b128 a[84:87], v9 offset:2048
    v_mfma_f32_16x16x32_bf16 v[40:43], a[64:67], a[60:63], v[40:43]
    s_waitcnt lgkmcnt(4)
    v_mfma_f32_16x16x32_bf16 v[36:39], a[68:71], a[28:31], v[36:39]
    ds_read_b128 a[64:67], v10 offset:0
    v_mfma_f32_16x16x32_bf16 v[44:47], a[68:71], a[60:63], v[44:47]
    s_waitcnt lgkmcnt(4)
    v_mfma_f32_16x16x32_bf16 v[16:19], a[72:75], v[48:51], 0
    ds_read_b128 a[68:71], v10 offset:2048
    v_mfma_f32_16x16x32_bf16 v[24:27], a[72:75], v[80:83], 0
    s_waitcnt lgkmcnt(4)
    v_mfma_f32_16x16x32_bf16 v[20:23], a[76:79], v[48:51], 0
    ds_read_b128 a[72:75], v11 offset:0
    v_mul_f32 v32, s54, v32
    v_mfma_f32_16x16x32_bf16 v[28:31], a[76:79], v[80:83], 0
    s_add_u32 s40, s41, 47104
    buffer_load_dwordx4 a[184:187], v1, s[8:11], s40 offen sc1
    v_mul_f32 v33, s54, v33
    s_waitcnt lgkmcnt(4)
    v_mfma_f32_16x16x32_bf16 v[16:19], a[80:83], v[52:55], v[16:19]
    ds_read_b128 a[76:79], v11 offset:2048
    v_mul_f32 v34, s54, v34
    v_mfma_f32_16x16x32_bf16 v[24:27], a[80:83], v[84:87], v[24:27]
    s_waitcnt lgkmcnt(4)
    v_mul_f32 v35, s54, v35
    v_mfma_f32_16x16x32_bf16 v[20:23], a[84:87], v[52:55], v[20:23]
    ds_read_b128 a[80:83], v8 offset:256
    v_mul_f32 v36, s54, v36
    v_mfma_f32_16x16x32_bf16 v[28:31], a[84:87], v[84:87], v[28:31]
    s_add_u32 s40, s41, 48128
    buffer_load_dwordx4 a[188:191], v1, s[8:11], s40 offen sc1
    v_mul_f32 v37, s54, v37
    s_waitcnt lgkmcnt(4)
    v_mfma_f32_16x16x32_bf16 v[16:19], a[64:67], v[56:59], v[16:19]
    ds_read_b128 a[84:87], v8 offset:2304
    v_mul_f32 v38, s54, v38
    v_mfma_f32_16x16x32_bf16 v[24:27], a[64:67], v[88:91], v[24:27]
    s_waitcnt lgkmcnt(4)
    v_mul_f32 v39, s54, v39
    v_mfma_f32_16x16x32_bf16 v[20:23], a[68:71], v[56:59], v[20:23]
    ds_read_b128 a[64:67], v9 offset:256
    v_cvt_pk_bf16_f32 v236, v32, v33
    v_mfma_f32_16x16x32_bf16 v[28:31], a[68:71], v[88:91], v[28:31]
    s_add_u32 s40, s41, 49152
    buffer_load_dwordx4 a[192:195], v1, s[8:11], s40 offen sc1
    v_cvt_pk_bf16_f32 v237, v34, v35
    s_waitcnt lgkmcnt(4)
    v_mfma_f32_16x16x32_bf16 v[16:19], a[72:75], v[60:63], v[16:19]
    ds_read_b128 a[68:71], v9 offset:2304
    v_cvt_pk_bf16_f32 v238, v36, v37
    v_mfma_f32_16x16x32_bf16 v[24:27], a[72:75], v[92:95], v[24:27]
    s_waitcnt lgkmcnt(4)
    v_cvt_pk_bf16_f32 v239, v38, v39
    v_mfma_f32_16x16x32_bf16 v[20:23], a[76:79], v[60:63], v[20:23]
    ds_read_b128 a[72:75], v10 offset:256
    v_mul_f32 v40, s54, v40
    v_mfma_f32_16x16x32_bf16 v[28:31], a[76:79], v[92:95], v[28:31]
    s_waitcnt lgkmcnt(4)
    v_mul_f32 v41, s54, v41
    v_mfma_f32_16x16x32_bf16 v[16:19], a[80:83], v[64:67], v[16:19]
    ds_read_b128 a[76:79], v10 offset:2304
    v_mul_f32 v42, s54, v42
    v_mfma_f32_16x16x32_bf16 v[24:27], a[80:83], v[96:99], v[24:27]
    s_waitcnt lgkmcnt(4)
    v_mul_f32 v43, s54, v43
    v_mfma_f32_16x16x32_bf16 v[20:23], a[84:87], v[64:67], v[20:23]
    ds_read_b128 a[80:83], v11 offset:256
    v_mul_f32 v44, s54, v44
    v_mfma_f32_16x16x32_bf16 v[28:31], a[84:87], v[96:99], v[28:31]
    s_waitcnt lgkmcnt(4)
    v_mul_f32 v45, s54, v45
    v_mfma_f32_16x16x32_bf16 v[16:19], a[64:67], v[68:71], v[16:19]
    ds_read_b128 a[84:87], v11 offset:2304
    v_mul_f32 v46, s54, v46
    v_mfma_f32_16x16x32_bf16 v[24:27], a[64:67], v[100:103], v[24:27]
    s_waitcnt lgkmcnt(4)
    v_mul_f32 v47, s54, v47
    v_mfma_f32_16x16x32_bf16 v[20:23], a[68:71], v[68:71], v[20:23]
    ds_read_b128 a[64:67], v8 offset:0
    v_cvt_pk_bf16_f32 v116, v40, v41
    v_mfma_f32_16x16x32_bf16 v[28:31], a[68:71], v[100:103], v[28:31]
    s_waitcnt lgkmcnt(4)
    v_cvt_pk_bf16_f32 v117, v42, v43
    v_mfma_f32_16x16x32_bf16 v[16:19], a[72:75], v[72:75], v[16:19]
    ds_read_b128 a[68:71], v8 offset:2048
    v_cvt_pk_bf16_f32 v118, v44, v45
    v_mfma_f32_16x16x32_bf16 v[24:27], a[72:75], v[104:107], v[24:27]
    s_waitcnt lgkmcnt(4)
    v_cvt_pk_bf16_f32 v119, v46, v47
    v_mfma_f32_16x16x32_bf16 v[20:23], a[76:79], v[72:75], v[20:23]
    ds_read_b128 a[72:75], v9 offset:0
    ds_write_b128 v14, v[116:119] offset:9216
    v_mfma_f32_16x16x32_bf16 v[28:31], a[76:79], v[104:107], v[28:31]
    s_waitcnt lgkmcnt(5)
    v_mfma_f32_16x16x32_bf16 v[16:19], a[80:83], v[76:79], v[16:19]
    ds_read_b128 a[76:79], v9 offset:2048
    v_mfma_f32_16x16x32_bf16 v[24:27], a[80:83], v[108:111], v[24:27]
    s_waitcnt lgkmcnt(5)
    v_mfma_f32_16x16x32_bf16 v[20:23], a[84:87], v[76:79], v[20:23]
    ds_read_b128 a[80:83], v10 offset:0
    v_mfma_f32_16x16x32_bf16 v[28:31], a[84:87], v[108:111], v[28:31]
    s_waitcnt vmcnt(33)
    s_barrier
    s_waitcnt lgkmcnt(5)
    v_mfma_f32_16x16x32_bf16 v[32:35], a[64:67], a[0:3], 0
    ds_read_b128 a[84:87], v10 offset:2048
    v_mfma_f32_16x16x32_bf16 v[40:43], a[64:67], a[32:35], 0
    s_waitcnt lgkmcnt(5)
    v_mfma_f32_16x16x32_bf16 v[36:39], a[68:71], a[0:3], 0
    ds_read_b128 a[64:67], v11 offset:0
    v_mul_f32 v16, s54, v16
    v_mfma_f32_16x16x32_bf16 v[44:47], a[68:71], a[32:35], 0
    s_add_u32 s40, s41, 50176
    buffer_load_dwordx4 a[196:199], v1, s[8:11], s40 offen sc1
    v_mul_f32 v17, s54, v17
    s_waitcnt lgkmcnt(5)
    v_mfma_f32_16x16x32_bf16 v[32:35], a[72:75], a[4:7], v[32:35]
    ds_read_b128 a[68:71], v11 offset:2048
    v_mul_f32 v18, s54, v18
    v_mfma_f32_16x16x32_bf16 v[40:43], a[72:75], a[36:39], v[40:43]
    s_waitcnt lgkmcnt(4)
    v_mul_f32 v19, s54, v19
    v_mfma_f32_16x16x32_bf16 v[36:39], a[76:79], a[4:7], v[36:39]
    ds_read_b128 a[72:75], v8 offset:256
    v_mul_f32 v20, s54, v20
    v_mfma_f32_16x16x32_bf16 v[44:47], a[76:79], a[36:39], v[44:47]
    s_add_u32 s40, s41, 51200
    buffer_load_dwordx4 a[200:203], v1, s[8:11], s40 offen sc1
    v_mul_f32 v21, s54, v21
    s_waitcnt lgkmcnt(4)
    v_mfma_f32_16x16x32_bf16 v[32:35], a[80:83], a[8:11], v[32:35]
    ds_read_b128 a[76:79], v8 offset:2304
    v_mul_f32 v22, s54, v22
    v_mfma_f32_16x16x32_bf16 v[40:43], a[80:83], a[40:43], v[40:43]
    s_waitcnt lgkmcnt(4)
    v_mul_f32 v23, s54, v23
    v_mfma_f32_16x16x32_bf16 v[36:39], a[84:87], a[8:11], v[36:39]
    ds_read_b128 a[80:83], v9 offset:256
    v_cvt_pk_bf16_f32 v128, v16, v17
    v_mfma_f32_16x16x32_bf16 v[44:47], a[84:87], a[40:43], v[44:47]
    s_add_u32 s40, s41, 52224
    buffer_load_dwordx4 a[204:207], v1, s[8:11], s40 offen sc1
    v_cvt_pk_bf16_f32 v129, v18, v19
    s_waitcnt lgkmcnt(4)
    v_mfma_f32_16x16x32_bf16 v[32:35], a[64:67], a[12:15], v[32:35]
    ds_read_b128 a[84:87], v9 offset:2304
    v_cvt_pk_bf16_f32 v130, v20, v21
    v_mfma_f32_16x16x32_bf16 v[40:43], a[64:67], a[44:47], v[40:43]
    s_waitcnt lgkmcnt(4)
    v_cvt_pk_bf16_f32 v131, v22, v23
    v_mfma_f32_16x16x32_bf16 v[36:39], a[68:71], a[12:15], v[36:39]
    ds_read_b128 a[64:67], v10 offset:256
    v_mul_f32 v24, s54, v24
    v_mfma_f32_16x16x32_bf16 v[44:47], a[68:71], a[44:47], v[44:47]
    s_waitcnt lgkmcnt(4)
    v_mul_f32 v25, s54, v25
    v_mfma_f32_16x16x32_bf16 v[32:35], a[72:75], a[16:19], v[32:35]
    ds_read_b128 a[68:71], v10 offset:2304
    v_mul_f32 v26, s54, v26
    v_mfma_f32_16x16x32_bf16 v[40:43], a[72:75], a[48:51], v[40:43]
    s_waitcnt lgkmcnt(4)
    v_mul_f32 v27, s54, v27
    v_mfma_f32_16x16x32_bf16 v[36:39], a[76:79], a[16:19], v[36:39]
    ds_read_b128 a[72:75], v11 offset:256
    v_mul_f32 v28, s54, v28
    v_mfma_f32_16x16x32_bf16 v[44:47], a[76:79], a[48:51], v[44:47]
    s_waitcnt lgkmcnt(4)
    v_mul_f32 v29, s54, v29
    v_mfma_f32_16x16x32_bf16 v[32:35], a[80:83], a[20:23], v[32:35]
    ds_read_b128 a[76:79], v11 offset:2304
    v_mul_f32 v30, s54, v30
    v_mfma_f32_16x16x32_bf16 v[40:43], a[80:83], a[52:55], v[40:43]
    s_waitcnt lgkmcnt(4)
    v_mul_f32 v31, s54, v31
    v_mfma_f32_16x16x32_bf16 v[36:39], a[84:87], a[20:23], v[36:39]
    ds_read_b128 a[80:83], v8 offset:16384
    v_cvt_pk_bf16_f32 v184, v24, v25
    v_mfma_f32_16x16x32_bf16 v[44:47], a[84:87], a[52:55], v[44:47]
    s_waitcnt lgkmcnt(4)
    v_cvt_pk_bf16_f32 v185, v26, v27
    v_mfma_f32_16x16x32_bf16 v[32:35], a[64:67], a[24:27], v[32:35]
    ds_read_b128 a[84:87], v8 offset:18432
    v_cvt_pk_bf16_f32 v186, v28, v29
    v_mfma_f32_16x16x32_bf16 v[40:43], a[64:67], a[56:59], v[40:43]
    s_waitcnt lgkmcnt(4)
    v_cvt_pk_bf16_f32 v187, v30, v31
    v_mfma_f32_16x16x32_bf16 v[36:39], a[68:71], a[24:27], v[36:39]
    ds_read_b128 a[64:67], v9 offset:16384
    v_mfma_f32_16x16x32_bf16 v[44:47], a[68:71], a[56:59], v[44:47]
    s_waitcnt lgkmcnt(4)
    v_mfma_f32_16x16x32_bf16 v[32:35], a[72:75], a[28:31], v[32:35]
    ds_read_b128 a[68:71], v9 offset:18432
    v_mfma_f32_16x16x32_bf16 v[40:43], a[72:75], a[60:63], v[40:43]
    s_waitcnt lgkmcnt(4)
    v_mfma_f32_16x16x32_bf16 v[36:39], a[76:79], a[28:31], v[36:39]
    ds_read_b128 a[72:75], v10 offset:16384
    v_mfma_f32_16x16x32_bf16 v[44:47], a[76:79], a[60:63], v[44:47]
    s_waitcnt vmcnt(9)
    v_max_u32 v114, v112, v113
    v_cmp_eq_u32 vcc, -1, v114
    s_cbranch_vccnz Lvwait_16
Lvok_15:
    v_cmp_eq_u32 vcc, 1, v112
    s_bcnt1_i32_b64 s3, vcc
    s_cmp_ge_u32 s3, 4
    s_cselect_b32 s3, 8192, 0
    s_lshl_b32 s36, s23, 13
    s_xor_b32 s3, s3, s36
    v_lshrrev_b32 v112, 3, v0
    s_lshl_b32 s36, s20, 3
    v_add_u32 v112, s36, v112
    v_and_b32 v113, 7, v0
    v_mul_u32_u24 v15, 896, v112
    v_bfe_u32 v112, v112, 1, 3
    v_xor_b32 v112, v112, v113
    v_lshl_add_u32 v15, v112, 4, v15
    s_waitcnt lgkmcnt(4)
    v_mfma_f32_16x16x32_bf16 v[16:19], a[80:83], v[48:51], 0
    ds_read_b128 a[76:79], v10 offset:18432
    v_mfma_f32_16x16x32_bf16 v[24:27], a[80:83], v[80:83], 0
    s_waitcnt lgkmcnt(4)
    v_mfma_f32_16x16x32_bf16 v[20:23], a[84:87], v[48:51], 0
    ds_read_b128 a[80:83], v11 offset:16384
    v_mul_f32 v32, s54, v32
    v_mfma_f32_16x16x32_bf16 v[28:31], a[84:87], v[80:83], 0
    s_add_u32 m0, s37, 0
    s_nop 0
    buffer_load_dwordx4 v15, s[8:11], s38 offen offset:0 sc1 lds
    v_mul_f32 v33, s54, v33
    s_waitcnt lgkmcnt(4)
    v_mfma_f32_16x16x32_bf16 v[16:19], a[64:67], v[52:55], v[16:19]
    ds_read_b128 a[84:87], v11 offset:18432
    v_mul_f32 v34, s54, v34
    v_mfma_f32_16x16x32_bf16 v[24:27], a[64:67], v[84:87], v[24:27]
    s_waitcnt lgkmcnt(4)
    v_mul_f32 v35, s54, v35
    v_mfma_f32_16x16x32_bf16 v[20:23], a[68:71], v[52:55], v[20:23]
    ds_read_b128 a[64:67], v8 offset:16640
    v_mul_f32 v36, s54, v36
    v_mfma_f32_16x16x32_bf16 v[28:31], a[68:71], v[84:87], v[28:31]
    s_add_u32 m0, s37, 3968
    s_nop 0
    buffer_load_dwordx4 v15, s[8:11], s38 offen offset:128 sc1 lds
    v_mul_f32 v37, s54, v37
    s_waitcnt lgkmcnt(4)
    v_mfma_f32_16x16x32_bf16 v[16:19], a[72:75], v[56:59], v[16:19]
    ds_read_b128 a[68:71], v8 offset:18688
    v_mul_f32 v38, s54, v38
    v_mfma_f32_16x16x32_bf16 v[24:27], a[72:75], v[88:91], v[24:27]
    s_waitcnt lgkmcnt(4)
    v_mul_f32 v39, s54, v39
    v_mfma_f32_16x16x32_bf16 v[20:23], a[76:79], v[56:59], v[20:23]
    ds_read_b128 a[72:75], v9 offset:16640
    v_cvt_pk_bf16_f32 v240, v32, v33
    v_mfma_f32_16x16x32_bf16 v[28:31], a[76:79], v[88:91], v[28:31]
    s_add_u32 m0, s37, 7936
    s_nop 0
    buffer_load_dwordx4 v15, s[8:11], s38 offen offset:256 sc1 lds
    v_cvt_pk_bf16_f32 v241, v34, v35
    s_waitcnt lgkmcnt(4)
    v_mfma_f32_16x16x32_bf16 v[16:19], a[80:83], v[60:63], v[16:19]
    ds_read_b128 a[76:79], v9 offset:18688
    v_cvt_pk_bf16_f32 v242, v36, v37
    v_mfma_f32_16x16x32_bf16 v[24:27], a[80:83], v[92:95], v[24:27]
    s_waitcnt lgkmcnt(4)
    v_cvt_pk_bf16_f32 v243, v38, v39
    v_mfma_f32_16x16x32_bf16 v[20:23], a[84:87], v[60:63], v[20:23]
    ds_read_b128 a[80:83], v10 offset:16640
    v_mul_f32 v40, s54, v40
    v_mfma_f32_16x16x32_bf16 v[28:31], a[84:87], v[92:95], v[28:31]
    s_add_u32 m0, s37, 11904
    s_nop 0
    buffer_load_dwordx4 v15, s[8:11], s38 offen offset:384 sc1 lds
    v_mul_f32 v41, s54, v41
    s_waitcnt lgkmcnt(4)
    v_mfma_f32_16x16x32_bf16 v[16:19], a[64:67], v[64:67], v[16:19]
    ds_read_b128 a[84:87], v10 offset:18688
    v_mul_f32 v42, s54, v42
    v_mfma_f32_16x16x32_bf16 v[24:27], a[64:67], v[96:99], v[24:27]
    s_waitcnt lgkmcnt(4)
    v_mul_f32 v43, s54, v43
    v_mfma_f32_16x16x32_bf16 v[20:23], a[68:71], v[64:67], v[20:23]
    ds_read_b128 a[64:67], v11 offset:16640
    v_mul_f32 v44, s54, v44
    v_mfma_f32_16x16x32_bf16 v[28:31], a[68:71], v[96:99], v[28:31]
    s_add_u32 m0, s37, 15872
    s_nop 0
    buffer_load_dwordx4 v15, s[8:11], s38 offen offset:512 sc1 lds
    v_mul_f32 v45, s54, v45
    s_waitcnt lgkmcnt(4)
    v_mfma_f32_16x16x32_bf16 v[16:19], a[72:75], v[68:71], v[16:19]
    ds_read_b128 a[68:71], v11 offset:18688
    v_mul_f32 v46, s54, v46
    v_mfma_f32_16x16x32_bf16 v[24:27], a[72:75], v[100:103], v[24:27]
    s_waitcnt lgkmcnt(4)
    v_mul_f32 v47, s54, v47
    v_mfma_f32_16x16x32_bf16 v[20:23], a[76:79], v[68:71], v[20:23]
    ds_read_b128 a[72:75], v8 offset:16384
    v_cvt_pk_bf16_f32 v116, v40, v41
    v_mfma_f32_16x16x32_bf16 v[28:31], a[76:79], v[100:103], v[28:31]
    s_add_u32 m0, s37, 19840
    s_nop 0
    buffer_load_dwordx4 v15, s[8:11], s38 offen offset:640 sc1 lds
    v_cvt_pk_bf16_f32 v117, v42, v43
    s_waitcnt lgkmcnt(4)
    v_mfma_f32_16x16x32_bf16 v[16:19], a[80:83], v[72:75], v[16:19]
    ds_read_b128 a[76:79], v8 offset:18432
    v_cvt_pk_bf16_f32 v118, v44, v45
    v_mfma_f32_16x16x32_bf16 v[24:27], a[80:83], v[104:107], v[24:27]
    s_add_u32 m0, s37, 23808
    s_nop 0
    buffer_load_dwordx4 v15, s[8:11], s38 offen offset:768 sc1 lds
    v_cvt_pk_bf16_f32 v119, v46, v47
    s_waitcnt lgkmcnt(4)
    v_mfma_f32_16x16x32_bf16 v[20:23], a[84:87], v[72:75], v[20:23]
    ds_read_b128 a[80:83], v9 offset:16384
    ds_write_b128 v14, v[116:119] offset:10240
    v_mfma_f32_16x16x32_bf16 v[28:31], a[84:87], v[104:107], v[28:31]
    s_add_u32 s40, s41, 53248
    buffer_load_dwordx4 a[208:211], v1, s[8:11], s40 offen sc1
    s_waitcnt lgkmcnt(5)
    v_mfma_f32_16x16x32_bf16 v[16:19], a[64:67], v[76:79], v[16:19]
    ds_read_b128 a[84:87], v9 offset:18432
    v_mfma_f32_16x16x32_bf16 v[24:27], a[64:67], v[108:111], v[24:27]
    s_add_u32 s40, s41, 54272
    buffer_load_dwordx4 a[212:215], v1, s[8:11], s40 offen sc1
    s_waitcnt lgkmcnt(5)
    v_mfma_f32_16x16x32_bf16 v[20:23], a[68:71], v[76:79], v[20:23]
    ds_read_b128 a[64:67], v10 offset:16384
    v_mfma_f32_16x16x32_bf16 v[28:31], a[68:71], v[108:111], v[28:31]
    s_add_u32 s40, s41, 55296
    buffer_load_dwordx4 a[216:219], v1, s[8:11], s40 offen sc1
    s_barrier
    s_waitcnt lgkmcnt(5)
    v_mfma_f32_16x16x32_bf16 v[32:35], a[72:75], a[0:3], 0
    ds_read_b128 a[68:71], v10 offset:18432
    v_mfma_f32_16x16x32_bf16 v[40:43], a[72:75], a[32:35], 0
    s_waitcnt lgkmcnt(5)
    v_mfma_f32_16x16x32_bf16 v[36:39], a[76:79], a[0:3], 0
    ds_read_b128 a[72:75], v11 offset:16384
    v_mul_f32 v16, s54, v16
    v_mfma_f32_16x16x32_bf16 v[44:47], a[76:79], a[32:35], 0
    v_lshrrev_b32 v112, 1, v1
    buffer_load_dwordx2 v[112:113], v112, s[8:11], s35 offen sc1
    v_mul_f32 v17, s54, v17
    s_waitcnt lgkmcnt(5)
    v_mfma_f32_16x16x32_bf16 v[32:35], a[80:83], a[4:7], v[32:35]
    ds_read_b128 a[76:79], v11 offset:18432
    v_mul_f32 v18, s54, v18
    v_mfma_f32_16x16x32_bf16 v[40:43], a[80:83], a[36:39], v[40:43]
    s_waitcnt lgkmcnt(4)
    v_mul_f32 v19, s54, v19
    v_mfma_f32_16x16x32_bf16 v[36:39], a[84:87], a[4:7], v[36:39]
    ds_read_b128 a[80:83], v8 offset:16640
    v_mul_f32 v20, s54, v20
    v_mfma_f32_16x16x32_bf16 v[44:47], a[84:87], a[36:39], v[44:47]
    s_add_u32 s40, s41, 56320
    buffer_load_dwordx4 a[220:223], v1, s[8:11], s40 offen sc1
    v_mul_f32 v21, s54, v21
    s_waitcnt lgkmcnt(4)
    v_mfma_f32_16x16x32_bf16 v[32:35], a[64:67], a[8:11], v[32:35]
    ds_read_b128 a[84:87], v8 offset:18688
    v_mul_f32 v22, s54, v22
    v_mfma_f32_16x16x32_bf16 v[40:43], a[64:67], a[40:43], v[40:43]
    s_waitcnt lgkmcnt(4)
    v_mul_f32 v23, s54, v23
    v_mfma_f32_16x16x32_bf16 v[36:39], a[68:71], a[8:11], v[36:39]
    ds_read_b128 a[64:67], v9 offset:16640
    v_cvt_pk_bf16_f32 v132, v16, v17
    v_mfma_f32_16x16x32_bf16 v[44:47], a[68:71], a[40:43], v[44:47]
    s_waitcnt lgkmcnt(4)
    v_cvt_pk_bf16_f32 v133, v18, v19
    v_mfma_f32_16x16x32_bf16 v[32:35], a[72:75], a[12:15], v[32:35]
    ds_read_b128 a[68:71], v9 offset:18688
    v_cvt_pk_bf16_f32 v134, v20, v21
    v_mfma_f32_16x16x32_bf16 v[40:43], a[72:75], a[44:47], v[40:43]
    s_waitcnt lgkmcnt(4)
    v_cvt_pk_bf16_f32 v135, v22, v23
    v_mfma_f32_16x16x32_bf16 v[36:39], a[76:79], a[12:15], v[36:39]
    ds_read_b128 a[72:75], v10 offset:16640
    v_mul_f32 v24, s54, v24
    v_mfma_f32_16x16x32_bf16 v[44:47], a[76:79], a[44:47], v[44:47]
    s_waitcnt lgkmcnt(4)
    v_mul_f32 v25, s54, v25
    v_mfma_f32_16x16x32_bf16 v[32:35], a[80:83], a[16:19], v[32:35]
    ds_read_b128 a[76:79], v10 offset:18688
    v_mul_f32 v26, s54, v26
    v_mfma_f32_16x16x32_bf16 v[40:43], a[80:83], a[48:51], v[40:43]
    s_waitcnt lgkmcnt(4)
    v_mul_f32 v27, s54, v27
    v_mfma_f32_16x16x32_bf16 v[36:39], a[84:87], a[16:19], v[36:39]
    ds_read_b128 a[80:83], v11 offset:16640
    v_mul_f32 v28, s54, v28
    v_mfma_f32_16x16x32_bf16 v[44:47], a[84:87], a[48:51], v[44:47]
    s_waitcnt lgkmcnt(4)
    v_mul_f32 v29, s54, v29
    v_mfma_f32_16x16x32_bf16 v[32:35], a[64:67], a[20:23], v[32:35]
    ds_read_b128 a[84:87], v11 offset:18688
    v_mul_f32 v30, s54, v30
    v_mfma_f32_16x16x32_bf16 v[40:43], a[64:67], a[52:55], v[40:43]
    s_waitcnt lgkmcnt(4)
    v_mul_f32 v31, s54, v31
    v_mfma_f32_16x16x32_bf16 v[36:39], a[68:71], a[20:23], v[36:39]
    ds_read_b128 a[64:67], v4 offset:0
    v_cvt_pk_bf16_f32 v188, v24, v25
    v_mfma_f32_16x16x32_bf16 v[44:47], a[68:71], a[52:55], v[44:47]
    s_waitcnt lgkmcnt(4)
    v_cvt_pk_bf16_f32 v189, v26, v27
    v_mfma_f32_16x16x32_bf16 v[32:35], a[72:75], a[24:27], v[32:35]
    ds_read_b128 a[68:71], v4 offset:2048
    v_cvt_pk_bf16_f32 v190, v28, v29
    v_mfma_f32_16x16x32_bf16 v[40:43], a[72:75], a[56:59], v[40:43]
    s_waitcnt lgkmcnt(4)
    v_cvt_pk_bf16_f32 v191, v30, v31
    v_mfma_f32_16x16x32_bf16 v[36:39], a[76:79], a[24:27], v[36:39]
    ds_read_b128 a[72:75], v5 offset:0
    v_mfma_f32_16x16x32_bf16 v[44:47], a[76:79], a[56:59], v[44:47]
    s_waitcnt lgkmcnt(4)
    v_mfma_f32_16x16x32_bf16 v[32:35], a[80:83], a[28:31], v[32:35]
    ds_read_b128 a[76:79], v5 offset:2048
    v_mfma_f32_16x16x32_bf16 v[40:43], a[80:83], a[60:63], v[40:43]
    s_waitcnt lgkmcnt(4)
    v_mfma_f32_16x16x32_bf16 v[36:39], a[84:87], a[28:31], v[36:39]
    ds_read_b128 a[80:83], v6 offset:0
    v_mfma_f32_16x16x32_bf16 v[44:47], a[84:87], a[60:63], v[44:47]
    s_waitcnt lgkmcnt(4)
    v_mfma_f32_16x16x32_bf16 v[16:19], a[64:67], v[48:51], 0
    ds_read_b128 a[84:87], v6 offset:2048
    v_mfma_f32_16x16x32_bf16 v[24:27], a[64:67], v[80:83], 0
    s_waitcnt lgkmcnt(4)
    v_mfma_f32_16x16x32_bf16 v[20:23], a[68:71], v[48:51], 0
    ds_read_b128 a[64:67], v7 offset:0
    v_mul_f32 v32, s54, v32
    v_mfma_f32_16x16x32_bf16 v[28:31], a[68:71], v[80:83], 0
    s_waitcnt lgkmcnt(4)
    v_mul_f32 v33, s54, v33
    v_mfma_f32_16x16x32_bf16 v[16:19], a[72:75], v[52:55], v[16:19]
    ds_read_b128 a[68:71], v7 offset:2048
    v_mul_f32 v34, s54, v34
    v_mfma_f32_16x16x32_bf16 v[24:27], a[72:75], v[84:87], v[24:27]
    s_waitcnt lgkmcnt(4)
    v_mul_f32 v35, s54, v35
    v_mfma_f32_16x16x32_bf16 v[20:23], a[76:79], v[52:55], v[20:23]
    ds_read_b128 a[72:75], v4 offset:256
    v_mul_f32 v36, s54, v36
    v_mfma_f32_16x16x32_bf16 v[28:31], a[76:79], v[84:87], v[28:31]
    s_waitcnt lgkmcnt(4)
    v_mul_f32 v37, s54, v37
    v_mfma_f32_16x16x32_bf16 v[16:19], a[80:83], v[56:59], v[16:19]
    ds_read_b128 a[76:79], v4 offset:2304
    v_mul_f32 v38, s54, v38
    v_mfma_f32_16x16x32_bf16 v[24:27], a[80:83], v[88:91], v[24:27]
    s_waitcnt lgkmcnt(4)
    v_mul_f32 v39, s54, v39
    v_mfma_f32_16x16x32_bf16 v[20:23], a[84:87], v[56:59], v[20:23]
    ds_read_b128 a[80:83], v5 offset:256
    v_cvt_pk_bf16_f32 v244, v32, v33
    v_mfma_f32_16x16x32_bf16 v[28:31], a[84:87], v[88:91], v[28:31]
    s_waitcnt lgkmcnt(4)
    v_cvt_pk_bf16_f32 v245, v34, v35
    v_mfma_f32_16x16x32_bf16 v[16:19], a[64:67], v[60:63], v[16:19]
    ds_read_b128 a[84:87], v5 offset:2304
    v_cvt_pk_bf16_f32 v246, v36, v37
    v_mfma_f32_16x16x32_bf16 v[24:27], a[64:67], v[92:95], v[24:27]
    s_waitcnt lgkmcnt(4)
    v_cvt_pk_bf16_f32 v247, v38, v39
    v_mfma_f32_16x16x32_bf16 v[20:23], a[68:71], v[60:63], v[20:23]
    ds_read_b128 a[64:67], v6 offset:256
    v_mul_f32 v40, s54, v40
    v_mfma_f32_16x16x32_bf16 v[28:31], a[68:71], v[92:95], v[28:31]
    s_waitcnt lgkmcnt(4)
    v_mul_f32 v41, s54, v41
    v_mfma_f32_16x16x32_bf16 v[16:19], a[72:75], v[64:67], v[16:19]
    ds_read_b128 a[68:71], v6 offset:2304
    v_mul_f32 v42, s54, v42
    v_mfma_f32_16x16x32_bf16 v[24:27], a[72:75], v[96:99], v[24:27]
    s_waitcnt lgkmcnt(4)
    v_mul_f32 v43, s54, v43
    v_mfma_f32_16x16x32_bf16 v[20:23], a[76:79], v[64:67], v[20:23]
    ds_read_b128 a[72:75], v7 offset:256
    v_mul_f32 v44, s54, v44
    v_mfma_f32_16x16x32_bf16 v[28:31], a[76:79], v[96:99], v[28:31]
    s_waitcnt lgkmcnt(4)
    v_mul_f32 v45, s54, v45
    v_mfma_f32_16x16x32_bf16 v[16:19], a[80:83], v[68:71], v[16:19]
    ds_read_b128 a[76:79], v7 offset:2304
    v_mul_f32 v46, s54, v46
    v_mfma_f32_16x16x32_bf16 v[24:27], a[80:83], v[100:103], v[24:27]
    s_waitcnt lgkmcnt(4)
    v_mul_f32 v47, s54, v47
    v_mfma_f32_16x16x32_bf16 v[20:23], a[84:87], v[68:71], v[20:23]
    ds_read_b128 a[80:83], v4 offset:0
    v_cvt_pk_bf16_f32 v116, v40, v41
    v_mfma_f32_16x16x32_bf16 v[28:31], a[84:87], v[100:103], v[28:31]
    s_waitcnt lgkmcnt(4)
    v_cvt_pk_bf16_f32 v117, v42, v43
    v_mfma_f32_16x16x32_bf16 v[16:19], a[64:67], v[72:75], v[16:19]
    ds_read_b128 a[84:87], v4 offset:2048
    v_cvt_pk_bf16_f32 v118, v44, v45
    v_mfma_f32_16x16x32_bf16 v[24:27], a[64:67], v[104:107], v[24:27]
    s_waitcnt lgkmcnt(4)
    v_cvt_pk_bf16_f32 v119, v46, v47
    v_mfma_f32_16x16x32_bf16 v[20:23], a[68:71], v[72:75], v[20:23]
    ds_read_b128 a[64:67], v5 offset:0
    ds_write_b128 v14, v[116:119] offset:11264
    v_mfma_f32_16x16x32_bf16 v[28:31], a[68:71], v[104:107], v[28:31]
    s_waitcnt lgkmcnt(5)
    v_mfma_f32_16x16x32_bf16 v[16:19], a[72:75], v[76:79], v[16:19]
    ds_read_b128 a[68:71], v5 offset:2048
    v_mfma_f32_16x16x32_bf16 v[24:27], a[72:75], v[108:111], v[24:27]
    s_waitcnt lgkmcnt(5)
    v_mfma_f32_16x16x32_bf16 v[20:23], a[76:79], v[76:79], v[20:23]
    ds_read_b128 a[72:75], v6 offset:0
    v_mfma_f32_16x16x32_bf16 v[28:31], a[76:79], v[108:111], v[28:31]
    s_barrier
    s_waitcnt lgkmcnt(5)
    v_mfma_f32_16x16x32_bf16 v[32:35], a[80:83], a[0:3], 0
    ds_read_b128 a[76:79], v6 offset:2048
    v_mfma_f32_16x16x32_bf16 v[40:43], a[80:83], a[32:35], 0
    s_waitcnt lgkmcnt(5)
    v_mfma_f32_16x16x32_bf16 v[36:39], a[84:87], a[0:3], 0
    ds_read_b128 a[80:83], v7 offset:0
    v_mul_f32 v16, s54, v16
    v_mfma_f32_16x16x32_bf16 v[44:47], a[84:87], a[32:35], 0
    s_waitcnt lgkmcnt(5)
    v_mul_f32 v17, s54, v17
    v_mfma_f32_16x16x32_bf16 v[32:35], a[64:67], a[4:7], v[32:35]
    ds_read_b128 a[84:87], v7 offset:2048
    v_mul_f32 v18, s54, v18
    v_mfma_f32_16x16x32_bf16 v[40:43], a[64:67], a[36:39], v[40:43]
    s_waitcnt lgkmcnt(4)
    v_mul_f32 v19, s54, v19
    v_mfma_f32_16x16x32_bf16 v[36:39], a[68:71], a[4:7], v[36:39]
    ds_read_b128 a[64:67], v4 offset:256
    v_mul_f32 v20, s54, v20
    v_mfma_f32_16x16x32_bf16 v[44:47], a[68:71], a[36:39], v[44:47]
    s_waitcnt lgkmcnt(4)
    v_mul_f32 v21, s54, v21
    v_mfma_f32_16x16x32_bf16 v[32:35], a[72:75], a[8:11], v[32:35]
    ds_read_b128 a[68:71], v4 offset:2304
    v_mul_f32 v22, s54, v22
    v_mfma_f32_16x16x32_bf16 v[40:43], a[72:75], a[40:43], v[40:43]
    s_waitcnt lgkmcnt(4)
    v_mul_f32 v23, s54, v23
    v_mfma_f32_16x16x32_bf16 v[36:39], a[76:79], a[8:11], v[36:39]
    ds_read_b128 a[72:75], v5 offset:256
    v_cvt_pk_bf16_f32 v136, v16, v17
    v_mfma_f32_16x16x32_bf16 v[44:47], a[76:79], a[40:43], v[44:47]
    s_waitcnt lgkmcnt(4)
    v_cvt_pk_bf16_f32 v137, v18, v19
    v_mfma_f32_16x16x32_bf16 v[32:35], a[80:83], a[12:15], v[32:35]
    ds_read_b128 a[76:79], v5 offset:2304
    v_cvt_pk_bf16_f32 v138, v20, v21
    v_mfma_f32_16x16x32_bf16 v[40:43], a[80:83], a[44:47], v[40:43]
    s_waitcnt lgkmcnt(4)
    v_cvt_pk_bf16_f32 v139, v22, v23
    v_mfma_f32_16x16x32_bf16 v[36:39], a[84:87], a[12:15], v[36:39]
    ds_read_b128 a[80:83], v6 offset:256
    v_mul_f32 v24, s54, v24
    v_mfma_f32_16x16x32_bf16 v[44:47], a[84:87], a[44:47], v[44:47]
    s_waitcnt lgkmcnt(4)
    v_mul_f32 v25, s54, v25
    v_mfma_f32_16x16x32_bf16 v[32:35], a[64:67], a[16:19], v[32:35]
    ds_read_b128 a[84:87], v6 offset:2304
    v_mul_f32 v26, s54, v26
    v_mfma_f32_16x16x32_bf16 v[40:43], a[64:67], a[48:51], v[40:43]
    s_waitcnt lgkmcnt(4)
    v_mul_f32 v27, s54, v27
    v_mfma_f32_16x16x32_bf16 v[36:39], a[68:71], a[16:19], v[36:39]
    ds_read_b128 a[64:67], v7 offset:256
    v_mul_f32 v28, s54, v28
    v_mfma_f32_16x16x32_bf16 v[44:47], a[68:71], a[48:51], v[44:47]
    s_waitcnt lgkmcnt(4)
    v_mul_f32 v29, s54, v29
    v_mfma_f32_16x16x32_bf16 v[32:35], a[72:75], a[20:23], v[32:35]
    ds_read_b128 a[68:71], v7 offset:2304
    v_mul_f32 v30, s54, v30
    v_mfma_f32_16x16x32_bf16 v[40:43], a[72:75], a[52:55], v[40:43]
    s_waitcnt lgkmcnt(4)
    v_mul_f32 v31, s54, v31
    v_mfma_f32_16x16x32_bf16 v[36:39], a[76:79], a[20:23], v[36:39]
    ds_read_b128 a[72:75], v4 offset:16384
    v_cvt_pk_bf16_f32 v192, v24, v25
    v_mfma_f32_16x16x32_bf16 v[44:47], a[76:79], a[52:55], v[44:47]
    s_waitcnt lgkmcnt(4)
    v_cvt_pk_bf16_f32 v193, v26, v27
    v_mfma_f32_16x16x32_bf16 v[32:35], a[80:83], a[24:27], v[32:35]
    ds_read_b128 a[76:79], v4 offset:18432
    v_cvt_pk_bf16_f32 v194, v28, v29
    v_mfma_f32_16x16x32_bf16 v[40:43], a[80:83], a[56:59], v[40:43]
    s_waitcnt lgkmcnt(4)
    v_cvt_pk_bf16_f32 v195, v30, v31
    v_mfma_f32_16x16x32_bf16 v[36:39], a[84:87], a[24:27], v[36:39]
    ds_read_b128 a[80:83], v5 offset:16384
    v_mfma_f32_16x16x32_bf16 v[44:47], a[84:87], a[56:59], v[44:47]
    s_waitcnt lgkmcnt(4)
    v_mfma_f32_16x16x32_bf16 v[32:35], a[64:67], a[28:31], v[32:35]
    ds_read_b128 a[84:87], v5 offset:18432
    v_mfma_f32_16x16x32_bf16 v[40:43], a[64:67], a[60:63], v[40:43]
    s_waitcnt lgkmcnt(4)
    v_mfma_f32_16x16x32_bf16 v[36:39], a[68:71], a[28:31], v[36:39]
    ds_read_b128 a[64:67], v6 offset:16384
    v_mfma_f32_16x16x32_bf16 v[44:47], a[68:71], a[60:63], v[44:47]
    s_waitcnt lgkmcnt(4)
    v_mfma_f32_16x16x32_bf16 v[16:19], a[72:75], v[48:51], 0
    ds_read_b128 a[68:71], v6 offset:18432
    v_mfma_f32_16x16x32_bf16 v[24:27], a[72:75], v[80:83], 0
    s_waitcnt lgkmcnt(4)
    v_mfma_f32_16x16x32_bf16 v[20:23], a[76:79], v[48:51], 0
    ds_read_b128 a[72:75], v7 offset:16384
    v_mul_f32 v32, s54, v32
    v_mfma_f32_16x16x32_bf16 v[28:31], a[76:79], v[80:83], 0
    s_waitcnt lgkmcnt(4)
    v_mul_f32 v33, s54, v33
    v_mfma_f32_16x16x32_bf16 v[16:19], a[80:83], v[52:55], v[16:19]
    ds_read_b128 a[76:79], v7 offset:18432
    v_mul_f32 v34, s54, v34
    v_mfma_f32_16x16x32_bf16 v[24:27], a[80:83], v[84:87], v[24:27]
    s_waitcnt lgkmcnt(4)
    v_mul_f32 v35, s54, v35
    v_mfma_f32_16x16x32_bf16 v[20:23], a[84:87], v[52:55], v[20:23]
    ds_read_b128 a[80:83], v4 offset:16640
    v_mul_f32 v36, s54, v36
    v_mfma_f32_16x16x32_bf16 v[28:31], a[84:87], v[84:87], v[28:31]
    s_waitcnt lgkmcnt(4)
    v_mul_f32 v37, s54, v37
    v_mfma_f32_16x16x32_bf16 v[16:19], a[64:67], v[56:59], v[16:19]
    ds_read_b128 a[84:87], v4 offset:18688
    v_mul_f32 v38, s54, v38
    v_mfma_f32_16x16x32_bf16 v[24:27], a[64:67], v[88:91], v[24:27]
    s_waitcnt lgkmcnt(4)
    v_mul_f32 v39, s54, v39
    v_mfma_f32_16x16x32_bf16 v[20:23], a[68:71], v[56:59], v[20:23]
    ds_read_b128 a[64:67], v5 offset:16640
    v_cvt_pk_bf16_f32 v248, v32, v33
    v_mfma_f32_16x16x32_bf16 v[28:31], a[68:71], v[88:91], v[28:31]
    s_waitcnt lgkmcnt(4)
    v_cvt_pk_bf16_f32 v249, v34, v35
    v_mfma_f32_16x16x32_bf16 v[16:19], a[72:75], v[60:63], v[16:19]
    ds_read_b128 a[68:71], v5 offset:18688
    v_cvt_pk_bf16_f32 v250, v36, v37
    v_mfma_f32_16x16x32_bf16 v[24:27], a[72:75], v[92:95], v[24:27]
    s_waitcnt lgkmcnt(4)
    v_cvt_pk_bf16_f32 v251, v38, v39
    v_mfma_f32_16x16x32_bf16 v[20:23], a[76:79], v[60:63], v[20:23]
    ds_read_b128 a[72:75], v6 offset:16640
    v_mul_f32 v40, s54, v40
    v_mfma_f32_16x16x32_bf16 v[28:31], a[76:79], v[92:95], v[28:31]
    s_waitcnt lgkmcnt(4)
    v_mul_f32 v41, s54, v41
    v_mfma_f32_16x16x32_bf16 v[16:19], a[80:83], v[64:67], v[16:19]
    ds_read_b128 a[76:79], v6 offset:18688
    v_mul_f32 v42, s54, v42
    v_mfma_f32_16x16x32_bf16 v[24:27], a[80:83], v[96:99], v[24:27]
    s_waitcnt lgkmcnt(4)
    v_mul_f32 v43, s54, v43
    v_mfma_f32_16x16x32_bf16 v[20:23], a[84:87], v[64:67], v[20:23]
    ds_read_b128 a[80:83], v7 offset:16640
    v_mul_f32 v44, s54, v44
    v_mfma_f32_16x16x32_bf16 v[28:31], a[84:87], v[96:99], v[28:31]
    s_waitcnt lgkmcnt(4)
    v_mul_f32 v45, s54, v45
    v_mfma_f32_16x16x32_bf16 v[16:19], a[64:67], v[68:71], v[16:19]
    ds_read_b128 a[84:87], v7 offset:18688
    v_mul_f32 v46, s54, v46
    v_mfma_f32_16x16x32_bf16 v[24:27], a[64:67], v[100:103], v[24:27]
    s_waitcnt lgkmcnt(4)
    v_mul_f32 v47, s54, v47
    v_mfma_f32_16x16x32_bf16 v[20:23], a[68:71], v[68:71], v[20:23]
    ds_read_b128 a[64:67], v4 offset:16384
    v_cvt_pk_bf16_f32 v116, v40, v41
    v_mfma_f32_16x16x32_bf16 v[28:31], a[68:71], v[100:103], v[28:31]
    s_waitcnt lgkmcnt(4)
    v_cvt_pk_bf16_f32 v117, v42, v43
    v_mfma_f32_16x16x32_bf16 v[16:19], a[72:75], v[72:75], v[16:19]
    ds_read_b128 a[68:71], v4 offset:18432
    v_cvt_pk_bf16_f32 v118, v44, v45
    v_mfma_f32_16x16x32_bf16 v[24:27], a[72:75], v[104:107], v[24:27]
    s_waitcnt lgkmcnt(4)
    v_cvt_pk_bf16_f32 v119, v46, v47
    v_mfma_f32_16x16x32_bf16 v[20:23], a[76:79], v[72:75], v[20:23]
    ds_read_b128 a[72:75], v5 offset:16384
    ds_write_b128 v14, v[116:119] offset:12288
    v_mfma_f32_16x16x32_bf16 v[28:31], a[76:79], v[104:107], v[28:31]
    s_waitcnt lgkmcnt(5)
    v_mfma_f32_16x16x32_bf16 v[16:19], a[80:83], v[76:79], v[16:19]
    ds_read_b128 a[76:79], v5 offset:18432
    v_mfma_f32_16x16x32_bf16 v[24:27], a[80:83], v[108:111], v[24:27]
    s_waitcnt lgkmcnt(5)
    v_mfma_f32_16x16x32_bf16 v[20:23], a[84:87], v[76:79], v[20:23]
    ds_read_b128 a[80:83], v6 offset:16384
    v_mfma_f32_16x16x32_bf16 v[28:31], a[84:87], v[108:111], v[28:31]
    s_waitcnt lgkmcnt(5)
    v_mfma_f32_16x16x32_bf16 v[32:35], a[64:67], a[0:3], 0
    ds_read_b128 a[84:87], v6 offset:18432
    v_mfma_f32_16x16x32_bf16 v[40:43], a[64:67], a[32:35], 0
    s_waitcnt lgkmcnt(5)
    v_mfma_f32_16x16x32_bf16 v[36:39], a[68:71], a[0:3], 0
    ds_read_b128 a[64:67], v7 offset:16384
    v_mul_f32 v16, s54, v16
    v_mfma_f32_16x16x32_bf16 v[44:47], a[68:71], a[32:35], 0
    s_waitcnt lgkmcnt(5)
    v_mul_f32 v17, s54, v17
    v_mfma_f32_16x16x32_bf16 v[32:35], a[72:75], a[4:7], v[32:35]
    ds_read_b128 a[68:71], v7 offset:18432
    v_mul_f32 v18, s54, v18
    v_mfma_f32_16x16x32_bf16 v[40:43], a[72:75], a[36:39], v[40:43]
    s_waitcnt lgkmcnt(4)
    v_mul_f32 v19, s54, v19
    v_mfma_f32_16x16x32_bf16 v[36:39], a[76:79], a[4:7], v[36:39]
    ds_read_b128 a[72:75], v4 offset:16640
    v_mul_f32 v20, s54, v20
    v_mfma_f32_16x16x32_bf16 v[44:47], a[76:79], a[36:39], v[44:47]
    s_waitcnt lgkmcnt(4)
    v_mul_f32 v21, s54, v21
    v_mfma_f32_16x16x32_bf16 v[32:35], a[80:83], a[8:11], v[32:35]
    ds_read_b128 a[76:79], v4 offset:18688
    v_mul_f32 v22, s54, v22
    v_mfma_f32_16x16x32_bf16 v[40:43], a[80:83], a[40:43], v[40:43]
    s_waitcnt lgkmcnt(4)
    v_mul_f32 v23, s54, v23
    v_mfma_f32_16x16x32_bf16 v[36:39], a[84:87], a[8:11], v[36:39]
    ds_read_b128 a[80:83], v5 offset:16640
    v_cvt_pk_bf16_f32 v140, v16, v17
    v_mfma_f32_16x16x32_bf16 v[44:47], a[84:87], a[40:43], v[44:47]
    s_waitcnt lgkmcnt(4)
    v_cvt_pk_bf16_f32 v141, v18, v19
    v_mfma_f32_16x16x32_bf16 v[32:35], a[64:67], a[12:15], v[32:35]
    ds_read_b128 a[84:87], v5 offset:18688
    v_cvt_pk_bf16_f32 v142, v20, v21
    v_mfma_f32_16x16x32_bf16 v[40:43], a[64:67], a[44:47], v[40:43]
    s_waitcnt lgkmcnt(4)
    v_cvt_pk_bf16_f32 v143, v22, v23
    v_mfma_f32_16x16x32_bf16 v[36:39], a[68:71], a[12:15], v[36:39]
    ds_read_b128 a[64:67], v6 offset:16640
    v_mul_f32 v24, s54, v24
    v_mfma_f32_16x16x32_bf16 v[44:47], a[68:71], a[44:47], v[44:47]
    s_waitcnt lgkmcnt(4)
    v_mul_f32 v25, s54, v25
    v_mfma_f32_16x16x32_bf16 v[32:35], a[72:75], a[16:19], v[32:35]
    ds_read_b128 a[68:71], v6 offset:18688
    v_mul_f32 v26, s54, v26
    v_mfma_f32_16x16x32_bf16 v[40:43], a[72:75], a[48:51], v[40:43]
    s_waitcnt lgkmcnt(4)
    v_mul_f32 v27, s54, v27
    v_mfma_f32_16x16x32_bf16 v[36:39], a[76:79], a[16:19], v[36:39]
    ds_read_b128 a[72:75], v7 offset:16640
    v_mul_f32 v28, s54, v28
    v_mfma_f32_16x16x32_bf16 v[44:47], a[76:79], a[48:51], v[44:47]
    s_waitcnt lgkmcnt(4)
    v_mul_f32 v29, s54, v29
    v_mfma_f32_16x16x32_bf16 v[32:35], a[80:83], a[20:23], v[32:35]
    ds_read_b128 a[76:79], v7 offset:18688
    v_mul_f32 v30, s54, v30
    v_mfma_f32_16x16x32_bf16 v[40:43], a[80:83], a[52:55], v[40:43]
    s_waitcnt lgkmcnt(4)
    v_mul_f32 v31, s54, v31
    v_mfma_f32_16x16x32_bf16 v[36:39], a[84:87], a[20:23], v[36:39]
    v_cvt_pk_bf16_f32 v196, v24, v25
    v_mfma_f32_16x16x32_bf16 v[44:47], a[84:87], a[52:55], v[44:47]
    s_waitcnt lgkmcnt(3)
    v_cvt_pk_bf16_f32 v197, v26, v27
    v_mfma_f32_16x16x32_bf16 v[32:35], a[64:67], a[24:27], v[32:35]
    v_cvt_pk_bf16_f32 v198, v28, v29
    v_mfma_f32_16x16x32_bf16 v[40:43], a[64:67], a[56:59], v[40:43]
    s_waitcnt lgkmcnt(2)
    v_cvt_pk_bf16_f32 v199, v30, v31
    v_mfma_f32_16x16x32_bf16 v[36:39], a[68:71], a[24:27], v[36:39]
    v_mfma_f32_16x16x32_bf16 v[44:47], a[68:71], a[56:59], v[44:47]
    s_waitcnt lgkmcnt(1)
    v_mfma_f32_16x16x32_bf16 v[32:35], a[72:75], a[28:31], v[32:35]
    v_mfma_f32_16x16x32_bf16 v[40:43], a[72:75], a[60:63], v[40:43]
    s_waitcnt lgkmcnt(0)
    v_mfma_f32_16x16x32_bf16 v[36:39], a[76:79], a[28:31], v[36:39]
    v_mfma_f32_16x16x32_bf16 v[44:47], a[76:79], a[60:63], v[44:47]
    v_mul_f32 v32, s54, v32
    v_mul_f32 v33, s54, v33
    v_mul_f32 v34, s54, v34
    v_mul_f32 v35, s54, v35
    v_mul_f32 v36, s54, v36
    v_mul_f32 v37, s54, v37
    v_mul_f32 v38, s54, v38
    v_mul_f32 v39, s54, v39
    v_cvt_pk_bf16_f32 v252, v32, v33
    v_cvt_pk_bf16_f32 v253, v34, v35
    v_cvt_pk_bf16_f32 v254, v36, v37
    v_cvt_pk_bf16_f32 v255, v38, v39
    v_mul_f32 v40, s54, v40
    v_mul_f32 v41, s54, v41
    v_mul_f32 v42, s54, v42
    v_mul_f32 v43, s54, v43
    v_mul_f32 v44, s54, v44
    v_mul_f32 v45, s54, v45
    v_mul_f32 v46, s54, v46
    v_mul_f32 v47, s54, v47
    v_cvt_pk_bf16_f32 v116, v40, v41
    v_cvt_pk_bf16_f32 v117, v42, v43
    v_cvt_pk_bf16_f32 v118, v44, v45
    v_cvt_pk_bf16_f32 v119, v46, v47
    ds_write_b128 v14, v[116:119] offset:13312
    s_waitcnt vmcnt(1)
    v_max_u32 v114, v112, v113
    v_cmp_eq_u32 vcc, -1, v114
    s_cbranch_vccnz Lvwait_18
Lvok_17:
    s_waitcnt lgkmcnt(0)
    s_barrier
    s_branch Lpro_done
LX_pro:
    s_mov_b32 s12, s94
    s_mov_b32 s13, s95
    s_mov_b32 s14, 3670016
    s_mov_b32 s15, 0x20000
    s_mov_b32 s16, s92
    s_mov_b32 s17, s93
    s_mov_b32 s18, 3670016
    s_mov_b32 s19, 0x20000
    v_lshrrev_b32 v112, 5, v0
    v_and_b32 v117, 31, v0
    v_xor_b32 v117, v117, v112
    v_lshlrev_b32 v117, 4, v117
    v_lshl_add_u32 v117, v112, 13, v117
    s_lshl_b32 s48, s20, 6
    v_xor_b32 v2, s48, v117
    v_xor_b32 v3, 32, v2
    s_lshl_b32 s49, s25, 9
    s_lshl_b32 s50, s20, 16
    s_add_u32 s50, s50, s49
    s_lshl_b32 s51, s20, 12
    s_lshl_b32 s52, s71, 19
    s_add_u32 s52, s52, s49
    s_add_u32 s53, s20, 6
    s_lshl_b32 s53, s53, 14
    s_mov_b32 s54, 0x3db8aa3b
    s_add_u32 s55, s50, 0
    s_add_u32 m0, s51, 0
    s_nop 0
    buffer_load_dwordx4 v2, s[12:15], s55 offen lds
    s_add_u32 s55, s55, 16384
    s_add_u32 m0, m0, 1024
    s_nop 0
    buffer_load_dwordx4 v3, s[12:15], s55 offen lds
    s_add_u32 s55, s55, 16384
    s_add_u32 m0, m0, 1024
    s_nop 0
    buffer_load_dwordx4 v2, s[12:15], s55 offen lds
    s_add_u32 s55, s55, 16384
    s_add_u32 m0, m0, 1024
    s_nop 0
    buffer_load_dwordx4 v3, s[12:15], s55 offen lds
    s_add_u32 s55, s50, 262144
    s_add_u32 m0, s51, 16384
    s_nop 0
    buffer_load_dwordx4 v2, s[12:15], s55 offen lds
    s_add_u32 s55, s55, 16384
    s_add_u32 m0, m0, 1024
    s_nop 0
    buffer_load_dwordx4 v3, s[12:15], s55 offen lds
    s_add_u32 s55, s55, 16384
    s_add_u32 m0, m0, 1024
    s_nop 0
    buffer_load_dwordx4 v2, s[12:15], s55 offen lds
    s_add_u32 s55, s55, 16384
    s_add_u32 m0, m0, 1024
    s_nop 0
    buffer_load_dwordx4 v3, s[12:15], s55 offen lds
    s_add_u32 s55, s50, 524288
    s_add_u32 m0, s51, 32768
    s_nop 0
    buffer_load_dwordx4 v2, s[12:15], s55 offen lds
    s_add_u32 s55, s55, 16384
    s_add_u32 m0, m0, 1024
    s_nop 0
    buffer_load_dwordx4 v3, s[12:15], s55 offen lds
    s_add_u32 s55, s55, 16384
    s_add_u32 m0, m0, 1024
    s_nop 0
    buffer_load_dwordx4 v2, s[12:15], s55 offen lds
    s_add_u32 s55, s55, 16384
    s_add_u32 m0, m0, 1024
    s_nop 0
    buffer_load_dwordx4 v3, s[12:15], s55 offen lds
    s_add_u32 s55, s50, 786432
    s_add_u32 m0, s51, 49152
    s_nop 0
    buffer_load_dwordx4 v2, s[12:15], s55 offen lds
    s_add_u32 s55, s55, 16384
    s_add_u32 m0, m0, 1024
    s_nop 0
    buffer_load_dwordx4 v3, s[12:15], s55 offen lds
    s_add_u32 s55, s55, 16384
    s_add_u32 m0, m0, 1024
    s_nop 0
    buffer_load_dwordx4 v2, s[12:15], s55 offen lds
    s_add_u32 s55, s55, 16384
    s_add_u32 m0, m0, 1024
    s_nop 0
    buffer_load_dwordx4 v3, s[12:15], s55 offen lds
    s_add_u32 s55, s50, 1048576
    s_add_u32 m0, s51, 65536
    s_nop 0
    buffer_load_dwordx4 v2, s[12:15], s55 offen lds
    s_add_u32 s55, s55, 16384
    s_add_u32 m0, m0, 1024
    s_nop 0
    buffer_load_dwordx4 v3, s[12:15], s55 offen lds
    s_add_u32 s55, s55, 16384
    s_add_u32 m0, m0, 1024
    s_nop 0
    buffer_load_dwordx4 v2, s[12:15], s55 offen lds
    s_add_u32 s55, s55, 16384
    s_add_u32 m0, m0, 1024
    s_nop 0
    buffer_load_dwordx4 v3, s[12:15], s55 offen lds
    s_waitcnt vmcnt(16)
    s_barrier
    s_waitcnt vmcnt(12)
    s_barrier
    s_add_u32 s55, s50, 1310720
    s_add_u32 m0, s51, 81920
    s_nop 0
    buffer_load_dwordx4 v2, s[12:15], s55 offen lds
    s_add_u32 s55, s55, 16384
    s_add_u32 m0, m0, 1024
    s_nop 0
    buffer_load_dwordx4 v3, s[12:15], s55 offen lds
    s_add_u32 s55, s55, 16384
    s_add_u32 m0, m0, 1024
    s_nop 0
    buffer_load_dwordx4 v2, s[12:15], s55 offen lds
    s_add_u32 s55, s55, 16384
    s_add_u32 m0, m0, 1024
    s_nop 0
    buffer_load_dwordx4 v3, s[12:15], s55 offen lds
    v_mov_b32 v114, 132
    global_load_dword v114, v114, s[46:47] sc1
    s_waitcnt vmcnt(0)
    v_cmp_eq_u32 vcc, 0, v114
    s_cbranch_vccnz Lvwait_20
Lvok_19:
    s_lshl_b32 s36, s22, 2
    s_add_u32 s36, s36, s20
    s_lshl_b32 s36, s36, 2
    s_add_u32 s36, s36, s35
    v_mov_b32 v114, 0
    s_mov_b64 exec, 1
    buffer_store_dword v114, off, s[8:11], s36
    s_mov_b64 exec, -1
    s_barrier
    s_add_u32 s55, s50, 1572864
    s_add_u32 m0, s51, 0
    s_nop 0
    buffer_load_dwordx4 v2, s[12:15], s55 offen lds
    s_add_u32 s55, s55, 16384
    s_add_u32 m0, m0, 1024
    s_nop 0
    buffer_load_dwordx4 v3, s[12:15], s55 offen lds
    s_add_u32 s55, s55, 16384
    s_add_u32 m0, m0, 1024
    s_nop 0
    buffer_load_dwordx4 v2, s[12:15], s55 offen lds
    s_add_u32 s55, s55, 16384
    s_add_u32 m0, m0, 1024
    s_nop 0
    buffer_load_dwordx4 v3, s[12:15], s55 offen lds
    s_barrier
    s_add_u32 s55, s50, 1835008
    s_add_u32 m0, s51, 16384
    s_nop 0
    buffer_load_dwordx4 v2, s[12:15], s55 offen lds
    s_add_u32 s55, s55, 16384
    s_add_u32 m0, m0, 1024
    s_nop 0
    buffer_load_dwordx4 v3, s[12:15], s55 offen lds
    s_add_u32 s55, s55, 16384
    s_add_u32 m0, m0, 1024
    s_nop 0
    buffer_load_dwordx4 v2, s[12:15], s55 offen lds
    s_add_u32 s55, s55, 16384
    s_add_u32 m0, m0, 1024
    s_nop 0
    buffer_load_dwordx4 v3, s[12:15], s55 offen lds
    s_barrier
    s_add_u32 s55, s50, 2097152
    s_add_u32 m0, s51, 32768
    s_nop 0
    buffer_load_dwordx4 v2, s[12:15], s55 offen lds
    s_add_u32 s55, s55, 16384
    s_add_u32 m0, m0, 1024
    s_nop 0
    buffer_load_dwordx4 v3, s[12:15], s55 offen lds
    s_add_u32 s55, s55, 16384
    s_add_u32 m0, m0, 1024
    s_nop 0
    buffer_load_dwordx4 v2, s[12:15], s55 offen lds
    s_add_u32 s55, s55, 16384
    s_add_u32 m0, m0, 1024
    s_nop 0
    buffer_load_dwordx4 v3, s[12:15], s55 offen lds
    s_barrier
    s_add_u32 s55, s50, 2359296
    s_add_u32 m0, s51, 49152
    s_nop 0
    buffer_load_dwordx4 v2, s[12:15], s55 offen lds
    s_add_u32 s55, s55, 16384
    s_add_u32 m0, m0, 1024
    s_nop 0
    buffer_load_dwordx4 v3, s[12:15], s55 offen lds
    s_add_u32 s55, s55, 16384
    s_add_u32 m0, m0, 1024
    s_nop 0
    buffer_load_dwordx4 v2, s[12:15], s55 offen lds
    s_add_u32 s55, s55, 16384
    s_add_u32 m0, m0, 1024
    s_nop 0
    buffer_load_dwordx4 v3, s[12:15], s55 offen lds
    s_waitcnt vmcnt(12)
    s_barrier
    s_add_u32 s55, s50, 2621440
    s_add_u32 m0, s51, 65536
    s_nop 0
    buffer_load_dwordx4 v2, s[12:15], s55 offen lds
    s_add_u32 s55, s55, 16384
    s_add_u32 m0, m0, 1024
    s_nop 0
    buffer_load_dwordx4 v3, s[12:15], s55 offen lds
    s_add_u32 s55, s55, 16384
    s_add_u32 m0, m0, 1024
    s_nop 0
    buffer_load_dwordx4 v2, s[12:15], s55 offen lds
    s_add_u32 s55, s55, 16384
    s_add_u32 m0, m0, 1024
    s_nop 0
    buffer_load_dwordx4 v3, s[12:15], s55 offen lds
    v_bfe_u32 v115, v1, 2, 6
    buffer_load_dword v115, v115, s[8:11], s43 offen sc1
    s_waitcnt vmcnt(0)
    v_cmp_eq_u32 vcc, -1, v115
    s_cbranch_vccnz Lvwait_22
Lvok_21:
    s_add_u32 s40, s41, 0
    buffer_load_dwordx4 a[0:3], v1, s[8:11], s40 offen sc1
    s_add_u32 s40, s41, 1024
    buffer_load_dwordx4 a[4:7], v1, s[8:11], s40 offen sc1
    s_add_u32 s40, s41, 2048
    buffer_load_dwordx4 a[8:11], v1, s[8:11], s40 offen sc1
    s_add_u32 s40, s41, 3072
    buffer_load_dwordx4 a[12:15], v1, s[8:11], s40 offen sc1
    s_add_u32 s40, s41, 4096
    buffer_load_dwordx4 a[16:19], v1, s[8:11], s40 offen sc1
    s_barrier
    s_add_u32 s55, s50, 2883584
    s_add_u32 m0, s51, 81920
    s_nop 0
    buffer_load_dwordx4 v2, s[12:15], s55 offen lds
    s_add_u32 s55, s55, 16384
    s_add_u32 m0, m0, 1024
    s_nop 0
    buffer_load_dwordx4 v3, s[12:15], s55 offen lds
    s_add_u32 s55, s55, 16384
    s_add_u32 m0, m0, 1024
    s_nop 0
    buffer_load_dwordx4 v2, s[12:15], s55 offen lds
    s_add_u32 s55, s55, 16384
    s_add_u32 m0, m0, 1024
    s_nop 0
    buffer_load_dwordx4 v3, s[12:15], s55 offen lds
    s_add_u32 s40, s41, 5120
    buffer_load_dwordx4 a[20:23], v1, s[8:11], s40 offen sc1
    s_add_u32 s40, s41, 6144
    buffer_load_dwordx4 a[24:27], v1, s[8:11], s40 offen sc1
    s_add_u32 s40, s41, 7168
    buffer_load_dwordx4 a[28:31], v1, s[8:11], s40 offen sc1
    s_add_u32 s40, s41, 8192
    buffer_load_dwordx4 a[32:35], v1, s[8:11], s40 offen sc1
    s_add_u32 s40, s41, 9216
    buffer_load_dwordx4 a[36:39], v1, s[8:11], s40 offen sc1
    s_add_u32 s40, s41, 10240
    buffer_load_dwordx4 a[40:43], v1, s[8:11], s40 offen sc1
    s_add_u32 s40, s41, 11264
    buffer_load_dwordx4 a[44:47], v1, s[8:11], s40 offen sc1
    s_add_u32 s40, s41, 12288
    buffer_load_dwordx4 a[48:51], v1, s[8:11], s40 offen sc1
    s_add_u32 s40, s41, 13312
    buffer_load_dwordx4 a[52:55], v1, s[8:11], s40 offen sc1
    s_add_u32 s40, s41, 14336
    buffer_load_dwordx4 a[56:59], v1, s[8:11], s40 offen sc1
    s_barrier
    s_add_u32 s55, s50, 3145728
    s_add_u32 m0, s51, 0
    s_nop 0
    buffer_load_dwordx4 v2, s[12:15], s55 offen lds
    s_add_u32 s55, s55, 16384
    s_add_u32 m0, m0, 1024
    s_nop 0
    buffer_load_dwordx4 v3, s[12:15], s55 offen lds
    s_add_u32 s55, s55, 16384
    s_add_u32 m0, m0, 1024
    s_nop 0
    buffer_load_dwordx4 v2, s[12:15], s55 offen lds
    s_add_u32 s55, s55, 16384
    s_add_u32 m0, m0, 1024
    s_nop 0
    buffer_load_dwordx4 v3, s[12:15], s55 offen lds
    s_add_u32 s40, s41, 15360
    buffer_load_dwordx4 a[60:63], v1, s[8:11], s40 offen sc1
    s_add_u32 s40, s41, 16384
    buffer_load_dwordx4 a[64:67], v1, s[8:11], s40 offen sc1
    s_add_u32 s40, s41, 17408
    buffer_load_dwordx4 a[68:71], v1, s[8:11], s40 offen sc1
    s_add_u32 s40, s41, 18432
    buffer_load_dwordx4 a[72:75], v1, s[8:11], s40 offen sc1
    s_add_u32 s40, s41, 19456
    buffer_load_dwordx4 a[76:79], v1, s[8:11], s40 offen sc1
    s_add_u32 s40, s41, 20480
    buffer_load_dwordx4 a[80:83], v1, s[8:11], s40 offen sc1
    s_add_u32 s40, s41, 21504
    buffer_load_dwordx4 a[84:87], v1, s[8:11], s40 offen sc1
    s_add_u32 s40, s41, 22528
    buffer_load_dwordx4 a[88:91], v1, s[8:11], s40 offen sc1
    s_add_u32 s40, s41, 23552
    buffer_load_dwordx4 a[92:95], v1, s[8:11], s40 offen sc1
    s_add_u32 s40, s41, 24576
    buffer_load_dwordx4 a[96:99], v1, s[8:11], s40 offen sc1
    s_barrier
    s_add_u32 s55, s50, 3407872
    s_add_u32 m0, s51, 16384
    s_nop 0
    buffer_load_dwordx4 v2, s[12:15], s55 offen lds
    s_add_u32 s55, s55, 16384
    s_add_u32 m0, m0, 1024
    s_nop 0
    buffer_load_dwordx4 v3, s[12:15], s55 offen lds
    s_add_u32 s55, s55, 16384
    s_add_u32 m0, m0, 1024
    s_nop 0
    buffer_load_dwordx4 v2, s[12:15], s55 offen lds
    s_add_u32 s55, s55, 16384
    s_add_u32 m0, m0, 1024
    s_nop 0
    buffer_load_dwordx4 v3, s[12:15], s55 offen lds
    s_add_u32 s40, s41, 25600
    buffer_load_dwordx4 a[100:103], v1, s[8:11], s40 offen sc1
    s_add_u32 s40, s41, 26624
    buffer_load_dwordx4 a[104:107], v1, s[8:11], s40 offen sc1
    s_add_u32 s40, s41, 27648
    buffer_load_dwordx4 a[108:111], v1, s[8:11], s40 offen sc1
    s_add_u32 s40, s41, 28672
    buffer_load_dwordx4 a[112:115], v1, s[8:11], s40 offen sc1
    s_add_u32 s40, s41, 29696
    buffer_load_dwordx4 a[116:119], v1, s[8:11], s40 offen sc1
    s_add_u32 s40, s41, 30720
    buffer_load_dwordx4 a[120:123], v1, s[8:11], s40 offen sc1
    s_add_u32 s40, s41, 31744
    buffer_load_dwordx4 a[124:127], v1, s[8:11], s40 offen sc1
    s_add_u32 s40, s41, 32768
    buffer_load_dwordx4 a[128:131], v1, s[8:11], s40 offen sc1
    s_add_u32 s40, s41, 33792
    buffer_load_dwordx4 a[132:135], v1, s[8:11], s40 offen sc1
    s_add_u32 s40, s41, 34816
    buffer_load_dwordx4 a[136:139], v1, s[8:11], s40 offen sc1
    s_barrier
    v_lshrrev_b32 v112, 1, v1
    buffer_load_dwordx2 v[112:113], v112, s[8:11], s39 offen sc1
    s_add_u32 s40, s41, 35840
    buffer_load_dwordx4 a[140:143], v1, s[8:11], s40 offen sc1
    s_add_u32 s40, s41, 36864
    buffer_load_dwordx4 a[144:147], v1, s[8:11], s40 offen sc1
    s_add_u32 s40, s41, 37888
    buffer_load_dwordx4 a[148:151], v1, s[8:11], s40 offen sc1
    s_add_u32 s40, s41, 38912
    buffer_load_dwordx4 a[152:155], v1, s[8:11], s40 offen sc1
    s_add_u32 s40, s41, 39936
    buffer_load_dwordx4 a[156:159], v1, s[8:11], s40 offen sc1
    s_add_u32 s40, s41, 40960
    buffer_load_dwordx4 a[160:163], v1, s[8:11], s40 offen sc1
    s_add_u32 s40, s41, 41984
    buffer_load_dwordx4 a[164:167], v1, s[8:11], s40 offen sc1
    s_add_u32 s40, s41, 43008
    buffer_load_dwordx4 a[168:171], v1, s[8:11], s40 offen sc1
    s_add_u32 s40, s41, 44032
    buffer_load_dwordx4 a[172:175], v1, s[8:11], s40 offen sc1
    s_add_u32 s40, s41, 45056
    buffer_load_dwordx4 a[176:179], v1, s[8:11], s40 offen sc1
    s_waitcnt vmcnt(49)
    s_barrier
    s_add_u32 s40, s41, 46080
    buffer_load_dwordx4 a[180:183], v1, s[8:11], s40 offen sc1
    s_add_u32 s40, s41, 47104
    buffer_load_dwordx4 a[184:187], v1, s[8:11], s40 offen sc1
    s_add_u32 s40, s41, 48128
    buffer_load_dwordx4 a[188:191], v1, s[8:11], s40 offen sc1
    s_add_u32 s40, s41, 49152
    buffer_load_dwordx4 a[192:195], v1, s[8:11], s40 offen sc1
    s_add_u32 s40, s41, 50176
    buffer_load_dwordx4 a[196:199], v1, s[8:11], s40 offen sc1
    s_waitcnt vmcnt(15)
    v_max_u32 v114, v112, v113
    v_cmp_eq_u32 vcc, -1, v114
    s_cbranch_vccnz Lvwait_24
Lvok_23:
    v_cmp_eq_u32 vcc, 1, v112
    s_bcnt1_i32_b64 s3, vcc
    s_cmp_ge_u32 s3, 4
    s_cselect_b32 s3, 8192, 0
    s_lshl_b32 s36, s23, 13
    s_xor_b32 s3, s3, s36
    v_lshrrev_b32 v112, 3, v0
    s_lshl_b32 s36, s20, 3
    v_add_u32 v112, s36, v112
    v_and_b32 v113, 7, v0
    v_mul_u32_u24 v15, 896, v112
    v_bfe_u32 v112, v112, 1, 3
    v_xor_b32 v112, v112, v113
    v_lshl_add_u32 v15, v112, 4, v15
    s_add_u32 m0, s37, 0
    s_nop 0
    buffer_load_dwordx4 v15, s[8:11], s38 offen offset:0 sc1 lds
    s_add_u32 m0, s37, 3968
    s_nop 0
    buffer_load_dwordx4 v15, s[8:11], s38 offen offset:128 sc1 lds
    s_add_u32 m0, s37, 7936
    s_nop 0
    buffer_load_dwordx4 v15, s[8:11], s38 offen offset:256 sc1 lds
    s_add_u32 m0, s37, 11904
    s_nop 0
    buffer_load_dwordx4 v15, s[8:11], s38 offen offset:384 sc1 lds
    s_add_u32 m0, s37, 15872
    s_nop 0
    buffer_load_dwordx4 v15, s[8:11], s38 offen offset:512 sc1 lds
    s_add_u32 m0, s37, 19840
    s_nop 0
    buffer_load_dwordx4 v15, s[8:11], s38 offen offset:640 sc1 lds
    s_add_u32 m0, s37, 23808
    s_nop 0
    buffer_load_dwordx4 v15, s[8:11], s38 offen offset:768 sc1 lds
    s_add_u32 s40, s41, 51200
    buffer_load_dwordx4 a[200:203], v1, s[8:11], s40 offen sc1
    s_add_u32 s40, s41, 52224
    buffer_load_dwordx4 a[204:207], v1, s[8:11], s40 offen sc1
    s_add_u32 s40, s41, 53248
    buffer_load_dwordx4 a[208:211], v1, s[8:11], s40 offen sc1
    s_add_u32 s40, s41, 54272
    buffer_load_dwordx4 a[212:215], v1, s[8:11], s40 offen sc1
    s_add_u32 s40, s41, 55296
    buffer_load_dwordx4 a[216:219], v1, s[8:11], s40 offen sc1
    s_barrier
    v_lshrrev_b32 v112, 1, v1
    buffer_load_dwordx2 v[112:113], v112, s[8:11], s35 offen sc1
    s_add_u32 s40, s41, 56320
    buffer_load_dwordx4 a[220:223], v1, s[8:11], s40 offen sc1
    s_barrier
    s_waitcnt vmcnt(1)
    v_max_u32 v114, v112, v113
    v_cmp_eq_u32 vcc, -1, v114
    s_cbranch_vccnz Lvwait_26
Lvok_25:
    s_waitcnt lgkmcnt(0)
    s_barrier
Lpro_done:
    s_mov_b32 s28, s24
    s_mov_b32 s29, 0
    s_add_u32 s58, s6, 9715712
    s_addc_u32 s59, s7, 0
    s_cmp_eq_u32 s23, 0
    s_cselect_b32 s12, s4, s58
    s_cselect_b32 s13, s5, s59
    s_mov_b32 s14, 1835008
    s_mov_b32 s15, 0x20000
    s_mov_b32 s68, 0x00ff00ff
    s_mov_b32 s69, 0x00ff00ff
    s_lshl_b32 s51, s25, 7
    s_add_u32 s51, s51, s30
    s_add_u32 s51, s51, 262144
    s_mov_b32 s92, 0x30003
    s_mov_b32 s93, 0x30003
    s_mov_b32 s94, 0xc000c
    s_mov_b32 s95, 0xc000c
    s_mov_b32 s96, 0x300030
    s_mov_b32 s97, 0x300030
    s_mov_b32 s98, 0xc000c0
    s_mov_b32 s99, 0xc000c0
    v_lshrrev_b32 v48, 3, v0
    s_lshl_b32 s58, s20, 3
    v_add_u32 v48, s58, v48
    v_and_b32 v49, 7, v0
    v_mul_u32_u24 v2, 896, v48
    v_bfe_u32 v50, v48, 1, 3
    v_xor_b32 v50, v50, v49
    v_lshl_add_u32 v2, v50, 4, v2
    s_lshl_b32 s19, s20, 10
    s_add_u32 s19, s19, 32768
    v_add_u32 v3, s19, v1
    v_and_b32 v48, 15, v0
    v_lshrrev_b32 v49, 4, v0
    v_lshrrev_b32 v50, 1, v48
    v_xor_b32 v50, v50, v49
    v_lshlrev_b32 v50, 4, v50
    v_lshl_add_u32 v4, v48, 7, v50
    v_add_u32 v4, 32768, v4
    v_xor_b32 v5, 64, v4
    v_mov_b32 v6, 0x4444
    v_mov_b32 v50, 0xeeee
    v_cndmask_b32 v6, v50, v6, s[68:69]
    s_lshl_b32 s58, s20, 10
    v_add_u32 v7, s58, v1
    s_mov_b32 s59, 4096
    s_cmp_eq_u32 s20, 3
    s_cselect_b32 s59, -3072, s59
    v_add_u32 v8, s59, v7
    v_add_u32 v9, s42, v1
    v_and_b32 v50, 7, v48
    v_lshl_add_u32 v51, v49, 3, v50
    v_lshlrev_b32 v51, 4, v51
    v_mov_b32 v54, 1073741824
    v_lshlrev_b32 v25, 4, v48
    s_mov_b32 s100, -1
    s_mov_b32 s101, 0
    v_lshrrev_b32 v51, 1, v51
    s_lshl_b32 s58, s20, 8
    v_add_u32 v27, s58, v51
    v_and_b32 v51, 1, v0
    v_cvt_f32_u32 v29, v51
    v_sub_f32 v28, 1.0, v29
    v_lshlrev_b32 v13, 2, v0
    v_lshrrev_b32 v51, 3, v48
    v_lshrrev_b32 v52, 1, v49
    v_lshl_add_u32 v51, v51, 1, v52
    v_lshlrev_b32 v51, 8, v51
    v_lshl_add_u32 v51, v50, 4, v51
    v_and_b32 v52, 1, v49
    v_lshl_add_u32 v51, v52, 3, v51
    s_lshl_b32 s58, s71, 10
    s_add_u32 s58, s58, 0
    v_add_u32 v17, s58, v51
    s_mul_i32 s58, s20, 1056
    s_add_u32 s58, s58, 20480
    v_add_u32 v18, s58, v1
    v_and_b32 v51, 3, v0
    v_mul_u32_u24 v52, 1056, v51
    v_and_b32 v53, 60, v0
    v_add_u32 v52, v52, v53
    s_lshr_b32 s58, s20, 1
    s_lshl_b32 s58, s58, 8
    s_and_b32 s59, s20, 1
    s_lshl_b32 s59, s59, 6
    s_add_u32 s58, s58, s59
    s_add_u32 s58, s58, 20480
    v_add_u32 v19, s58, v52
    s_lshl_b32 s58, s20, 6
    v_add_u32 v53, s58, v53
    v_cmp_eq_u32 vcc, 0, v51
    s_nop 1
    v_cndmask_b32 v24, v54, v53, vcc
    v_lshlrev_b32 v51, 8, v51
    v_bfe_u32 v52, v0, 2, 3
    v_lshl_add_u32 v51, v52, 4, v51
    v_lshrrev_b32 v52, 5, v0
    v_lshl_add_u32 v51, v52, 3, v51
    v_add_u32 v10, 8192, v51
    s_lshl_b32 s58, s20, 11
    v_add_u32 v11, s58, v1
    v_lshrrev_b32 v52, 2, v0
    v_bfe_u32 v51, v0, 1, 1
    v_lshlrev_b32 v51, 8, v51
    v_lshl_add_u32 v51, v52, 4, v51
    v_and_b32 v53, 1, v0
    v_lshl_add_u32 v51, v53, 3, v51
    s_lshl_b32 s58, s20, 9
    v_add_u32 v12, s58, v51
    s_lshr_b32 s58, s20, 1
    s_mul_i32 s58, s58, 14336
    s_and_b32 s59, s20, 1
    s_lshl_b32 s59, s59, 4
    s_add_u32 s58, s58, s59
    v_mul_u32_u24 v52, 896, v52
    v_and_b32 v53, 3, v0
    v_lshl_add_u32 v52, v53, 2, v52
    v_add_u32 v14, s58, v52
    s_cmp_eq_u32 s71, 7
    s_cbranch_scc1 LX
    v_and_b32 v51, 1, v48
    v_lshlrev_b32 v51, 4, v51
    v_mov_b32 v52, 0x3f80
    v_lshlrev_b32 v51, v51, v52
    v_bfe_u32 v52, v48, 2, 1
    v_and_b32 v53, 1, v49
    v_cmp_eq_u32 vcc, v52, v53
    s_nop 1
    v_cndmask_b32 v51, 0, v51, vcc
    v_lshrrev_b32 v52, 3, v48
    v_bfe_u32 v53, v48, 1, 1
    v_lshl_add_u32 v52, v52, 1, v53
    v_cmp_eq_u32 vcc, 0, v52
    s_nop 1
    v_cndmask_b32 v20, 0, v51, vcc
    v_cmp_eq_u32 vcc, 1, v52
    s_nop 1
    v_cndmask_b32 v21, 0, v51, vcc
    v_cmp_eq_u32 vcc, 2, v52
    s_nop 1
    v_cndmask_b32 v22, 0, v51, vcc
    v_cmp_eq_u32 vcc, 3, v52
    s_nop 1
    v_cndmask_b32 v23, 0, v51, vcc
    s_lshl_b32 s58, s71, 2
    s_add_u32 s51, s51, s58
    s_sub_u32 s58, 3, s20
    s_mul_i32 s60, s58, 7168
    s_lshl_b32 s59, s20, 7
    s_add_u32 s60, s60, s59
    s_and_b32 s61, s58, 1
    s_lshl_b32 s61, s61, 6
    s_lshl_b32 s62, s58, 10
    s_lshl_b32 s59, s20, 12
    s_add_u32 s62, s62, s59
    s_mul_i32 s58, s28, 28672
    s_mov_b32 s32, 7880704
    s_cmp_eq_u32 s23, 0
    s_cselect_b32 s32, 11550720, s32
    s_add_u32 s32, s32, s58
    s_cmp_ge_u32 s27, 28
    s_cbranch_scc1 LB
    s_add_u32 s40, s41, 0
    buffer_load_dwordx4 a[0:3], v1, s[8:11], s40 offen sc1
    s_add_u32 s40, s41, 1024
    buffer_load_dwordx4 a[4:7], v1, s[8:11], s40 offen sc1
    s_add_u32 s40, s41, 2048
    buffer_load_dwordx4 a[8:11], v1, s[8:11], s40 offen sc1
    s_add_u32 s40, s41, 3072
    buffer_load_dwordx4 a[12:15], v1, s[8:11], s40 offen sc1
    s_add_u32 s40, s41, 4096
    buffer_load_dwordx4 a[16:19], v1, s[8:11], s40 offen sc1
    s_add_u32 s40, s41, 5120
    buffer_load_dwordx4 a[20:23], v1, s[8:11], s40 offen sc1
    s_add_u32 s40, s41, 6144
    buffer_load_dwordx4 a[24:27], v1, s[8:11], s40 offen sc1
    s_add_u32 s40, s41, 7168
    buffer_load_dwordx4 a[28:31], v1, s[8:11], s40 offen sc1
    s_add_u32 s40, s41, 8192
    buffer_load_dwordx4 a[32:35], v1, s[8:11], s40 offen sc1
    s_add_u32 s40, s41, 9216
    buffer_load_dwordx4 a[36:39], v1, s[8:11], s40 offen sc1
    s_add_u32 s40, s41, 10240
    buffer_load_dwordx4 a[40:43], v1, s[8:11], s40 offen sc1
    s_add_u32 s40, s41, 11264
    buffer_load_dwordx4 a[44:47], v1, s[8:11], s40 offen sc1
    s_add_u32 s40, s41, 12288
    buffer_load_dwordx4 a[48:51], v1, s[8:11], s40 offen sc1
    s_add_u32 s40, s41, 13312
    buffer_load_dwordx4 a[52:55], v1, s[8:11], s40 offen sc1
    s_add_u32 s40, s41, 14336
    buffer_load_dwordx4 a[56:59], v1, s[8:11], s40 offen sc1
    s_add_u32 s40, s41, 15360
    buffer_load_dwordx4 a[60:63], v1, s[8:11], s40 offen sc1
    s_add_u32 s40, s41, 16384
    buffer_load_dwordx4 a[64:67], v1, s[8:11], s40 offen sc1
    s_add_u32 s40, s41, 17408
    buffer_load_dwordx4 a[68:71], v1, s[8:11], s40 offen sc1
    s_add_u32 s40, s41, 18432
    buffer_load_dwordx4 a[72:75], v1, s[8:11], s40 offen sc1
    s_add_u32 s40, s41, 19456
    buffer_load_dwordx4 a[76:79], v1, s[8:11], s40 offen sc1
    s_add_u32 s40, s41, 20480
    buffer_load_dwordx4 a[80:83], v1, s[8:11], s40 offen sc1
    s_add_u32 s40, s41, 21504
    buffer_load_dwordx4 a[84:87], v1, s[8:11], s40 offen sc1
    s_lshl_b32 s58, s22, 2
    s_add_u32 s58, s58, s20
    s_mul_i32 s58, s58, 3072
    s_add_u32 s58, s58, s30
    v_min_u32 v16, 92, v13
    v_lshlrev_b32 v16, 5, v16
    buffer_load_dword v15, v16, s[8:11], s58 offen sc1
    s_lshl_b32 s58, s22, 2
    s_add_u32 s58, s58, s20
    s_lshl_b32 s59, s58, 13
    s_add_u32 s59, s59, s31
    v_lshlrev_b32 v16, 3, v1
    buffer_load_dword v15, v16, s[8:11], s59 offen sc1
    s_getpc_b64 s[64:65]
Lpc_27:
    s_sub_u32 s64, s64, Lpc_27-Lstart
    s_subb_u32 s65, s65, 0
    s_mov_b32 s66, Lend-Lstart
    s_mov_b32 s67, 0x20000
    s_and_b32 s58, s58, 15
    s_lshl_b32 s58, s58, 13
    buffer_load_dword v15, v16, s[64:67], s58 offen
    s_cmp_eq_u32 s23, 0
    s_cbranch_scc1 LA_l0
    buffer_load_dwordx4 v[80:83], v2, s[8:11], s32 offen offset:0 sc1
    buffer_load_dwordx4 v[84:87], v2, s[8:11], s32 offen offset:128 sc1
    buffer_load_dwordx4 v[88:91], v2, s[8:11], s32 offen offset:256 sc1
    buffer_load_dwordx4 v[92:95], v2, s[8:11], s32 offen offset:384 sc1
    buffer_load_dwordx4 v[96:99], v2, s[8:11], s32 offen offset:512 sc1
    buffer_load_dwordx4 v[100:103], v2, s[8:11], s32 offen offset:640 sc1
    buffer_load_dwordx4 v[104:107], v2, s[8:11], s32 offen offset:768 sc1
    s_cmp_eq_u32 s26, 1
    s_cbranch_scc1 Lxsu_30
    s_waitcnt vmcnt(6)
    ds_write_b128 v3, v[80:83] offset:0
    s_waitcnt vmcnt(5)
    ds_write_b128 v3, v[84:87] offset:4096
    s_waitcnt vmcnt(4)
    ds_write_b128 v3, v[88:91] offset:8192
    s_waitcnt vmcnt(3)
    ds_write_b128 v3, v[92:95] offset:12288
    s_waitcnt vmcnt(2)
    ds_write_b128 v3, v[96:99] offset:16384
    s_waitcnt vmcnt(1)
    ds_write_b128 v3, v[100:103] offset:20480
    s_waitcnt vmcnt(0)
    ds_write_b128 v3, v[104:107] offset:24576
    v_max3_u32 v16, v80, v81, v82
    v_max3_u32 v16, v16, v83, v84
    v_max3_u32 v16, v16, v85, v86
    v_max3_u32 v16, v16, v87, v88
    v_max3_u32 v16, v16, v89, v90
    v_max3_u32 v16, v16, v91, v92
    v_max3_u32 v16, v16, v93, v94
    v_max3_u32 v16, v16, v95, v96
    v_max3_u32 v16, v16, v97, v98
    v_max3_u32 v16, v16, v99, v100
    v_max3_u32 v16, v16, v101, v102
    v_max3_u32 v16, v16, v103, v104
    v_max3_u32 v16, v16, v105, v106
    v_max_u32 v16, v16, v107
    v_cmp_eq_u32 vcc, -1, v16
    s_cbranch_vccnz Lxsretry_29
Lxsok_28:
    s_waitcnt lgkmcnt(0)
    s_barrier
LA_l0:
    s_branch LA_first
LA_job:
    ds_read_b128 v[80:83], v4 offset:0
    ds_read_b128 v[108:111], v9 offset:0
    ds_read_b128 v[84:87], v5 offset:0
    s_waitcnt lgkmcnt(2)
    v_mfma_f32_16x16x32_bf16 v[64:67], a[224:227], v[80:83], 0
    ds_read_b128 v[112:115], v9 offset:1024
    s_and_b32 s58, s29, 1
    s_mov_b32 s57, s35
    v_mfma_f32_16x16x32_bf16 v[68:71], v[144:147], v[80:83], 0
    ds_read_b128 v[88:91], v4 offset:4096
    s_mul_i32 s49, s58, 458752
    buffer_load_dword v15, v14, s[12:15], s48 offen sc1
    v_mfma_f32_16x16x32_bf16 v[72:75], v[200:203], v[80:83], 0
    s_mul_i32 s59, s25, 28672
    v_mov_b32 v16, -1
    s_waitcnt lgkmcnt(3)
    v_mfma_f32_16x16x32_bf16 v[76:79], v[108:111], v[80:83], 0
    s_add_u32 s49, s49, s59
    buffer_store_dword v16, v24, s[8:11], s37 offen
    s_waitcnt lgkmcnt(2)
    v_mfma_f32_16x16x32_bf16 v[64:67], a[228:231], v[84:87], v[64:67]
    ds_read_b128 v[108:111], v9 offset:2048
    s_add_u32 s49, s49, s31
    v_mfma_f32_16x16x32_bf16 v[68:71], v[148:151], v[84:87], v[68:71]
    ds_read_b128 v[80:83], v5 offset:4096
    s_lshl_b32 s59, s71, 12
    v_mfma_f32_16x16x32_bf16 v[72:75], v[204:207], v[84:87], v[72:75]
    s_add_u32 s49, s49, s59
    s_waitcnt lgkmcnt(3)
    v_mfma_f32_16x16x32_bf16 v[76:79], v[112:115], v[84:87], v[76:79]
    s_waitcnt lgkmcnt(2)
    v_mfma_f32_16x16x32_bf16 v[64:67], a[232:235], v[88:91], v[64:67]
    ds_read_b128 v[112:115], v9 offset:3072
    v_mfma_f32_16x16x32_bf16 v[68:71], v[152:155], v[88:91], v[68:71]
    ds_read_b128 v[84:87], v4 offset:8192
    v_mfma_f32_16x16x32_bf16 v[72:75], v[208:211], v[88:91], v[72:75]
    s_waitcnt lgkmcnt(3)
    v_mfma_f32_16x16x32_bf16 v[76:79], v[108:111], v[88:91], v[76:79]
    s_waitcnt lgkmcnt(2)
    v_mfma_f32_16x16x32_bf16 v[64:67], a[236:239], v[80:83], v[64:67]
    ds_read_b128 v[108:111], v9 offset:4096
    v_mfma_f32_16x16x32_bf16 v[68:71], v[156:159], v[80:83], v[68:71]
    ds_read_b128 v[88:91], v5 offset:8192
    v_mfma_f32_16x16x32_bf16 v[72:75], v[212:215], v[80:83], v[72:75]
    s_waitcnt lgkmcnt(3)
    v_mfma_f32_16x16x32_bf16 v[76:79], v[112:115], v[80:83], v[76:79]
    s_waitcnt lgkmcnt(2)
    v_mfma_f32_16x16x32_bf16 v[64:67], a[240:243], v[84:87], v[64:67]
    ds_read_b128 v[112:115], v9 offset:5120
    v_mfma_f32_16x16x32_bf16 v[68:71], v[160:163], v[84:87], v[68:71]
    ds_read_b128 v[80:83], v4 offset:12288
    v_mfma_f32_16x16x32_bf16 v[72:75], v[216:219], v[84:87], v[72:75]
    s_waitcnt lgkmcnt(3)
    v_mfma_f32_16x16x32_bf16 v[76:79], v[108:111], v[84:87], v[76:79]
    s_waitcnt lgkmcnt(2)
    v_mfma_f32_16x16x32_bf16 v[64:67], a[244:247], v[88:91], v[64:67]
    ds_read_b128 v[108:111], v9 offset:6144
    buffer_load_dwordx4 v[48:51], v1, s[8:11], s54 offen offset:0 sc1
    v_mfma_f32_16x16x32_bf16 v[68:71], v[164:167], v[88:91], v[68:71]
    ds_read_b128 v[84:87], v5 offset:12288
    v_mfma_f32_16x16x32_bf16 v[72:75], v[220:223], v[88:91], v[72:75]
    s_waitcnt lgkmcnt(3)
    v_mfma_f32_16x16x32_bf16 v[76:79], v[112:115], v[88:91], v[76:79]
    s_waitcnt lgkmcnt(2)
    v_mfma_f32_16x16x32_bf16 v[64:67], a[248:251], v[80:83], v[64:67]
    ds_read_b128 v[112:115], v9 offset:7168
    buffer_load_dwordx4 v[52:55], v1, s[8:11], s54 offen offset:1024 sc1
    v_mfma_f32_16x16x32_bf16 v[68:71], v[168:171], v[80:83], v[68:71]
    ds_read_b128 v[88:91], v4 offset:16384
    v_mfma_f32_16x16x32_bf16 v[72:75], v[224:227], v[80:83], v[72:75]
    s_waitcnt lgkmcnt(3)
    v_mfma_f32_16x16x32_bf16 v[76:79], v[108:111], v[80:83], v[76:79]
    s_waitcnt lgkmcnt(2)
    v_mfma_f32_16x16x32_bf16 v[64:67], a[252:255], v[84:87], v[64:67]
    ds_read_b128 v[108:111], v9 offset:8192
    buffer_load_dwordx4 v[56:59], v1, s[8:11], s54 offen offset:2048 sc1
    v_mfma_f32_16x16x32_bf16 v[68:71], v[172:175], v[84:87], v[68:71]
    ds_read_b128 v[80:83], v5 offset:16384
    v_mfma_f32_16x16x32_bf16 v[72:75], v[228:231], v[84:87], v[72:75]
    s_waitcnt lgkmcnt(3)
    v_mfma_f32_16x16x32_bf16 v[76:79], v[112:115], v[84:87], v[76:79]
    s_waitcnt lgkmcnt(2)
    v_mfma_f32_16x16x32_bf16 v[64:67], v[120:123], v[88:91], v[64:67]
    ds_read_b128 v[112:115], v9 offset:9216
    buffer_load_dwordx4 v[60:63], v1, s[8:11], s54 offen offset:3072 sc1
    v_mfma_f32_16x16x32_bf16 v[68:71], v[176:179], v[88:91], v[68:71]
    ds_read_b128 v[84:87], v4 offset:20480
    v_mfma_f32_16x16x32_bf16 v[72:75], v[232:235], v[88:91], v[72:75]
    s_waitcnt lgkmcnt(3)
    v_mfma_f32_16x16x32_bf16 v[76:79], v[108:111], v[88:91], v[76:79]
    s_waitcnt lgkmcnt(2)
    v_mfma_f32_16x16x32_bf16 v[64:67], v[124:127], v[80:83], v[64:67]
    ds_read_b128 v[108:111], v9 offset:10240
    v_mfma_f32_16x16x32_bf16 v[68:71], v[180:183], v[80:83], v[68:71]
    ds_read_b128 v[88:91], v5 offset:20480
    v_mfma_f32_16x16x32_bf16 v[72:75], v[236:239], v[80:83], v[72:75]
    s_waitcnt lgkmcnt(3)
    v_mfma_f32_16x16x32_bf16 v[76:79], v[112:115], v[80:83], v[76:79]
    s_waitcnt lgkmcnt(2)
    v_mfma_f32_16x16x32_bf16 v[64:67], v[128:131], v[84:87], v[64:67]
    ds_read_b128 v[112:115], v9 offset:11264
    v_mfma_f32_16x16x32_bf16 v[68:71], v[184:187], v[84:87], v[68:71]
    ds_read_b128 v[80:83], v4 offset:24576
    v_mfma_f32_16x16x32_bf16 v[72:75], v[240:243], v[84:87], v[72:75]
    s_waitcnt lgkmcnt(3)
    v_mfma_f32_16x16x32_bf16 v[76:79], v[108:111], v[84:87], v[76:79]
    s_waitcnt lgkmcnt(2)
    v_mfma_f32_16x16x32_bf16 v[64:67], v[132:135], v[88:91], v[64:67]
    ds_read_b128 v[108:111], v9 offset:12288
    v_mfma_f32_16x16x32_bf16 v[68:71], v[188:191], v[88:91], v[68:71]
    ds_read_b128 v[84:87], v5 offset:24576
    v_mfma_f32_16x16x32_bf16 v[72:75], v[244:247], v[88:91], v[72:75]
    s_waitcnt lgkmcnt(3)
    v_mfma_f32_16x16x32_bf16 v[76:79], v[112:115], v[88:91], v[76:79]
    s_waitcnt lgkmcnt(2)
    v_mfma_f32_16x16x32_bf16 v[64:67], v[136:139], v[80:83], v[64:67]
    ds_read_b128 v[112:115], v9 offset:13312
    v_mfma_f32_16x16x32_bf16 v[68:71], v[192:195], v[80:83], v[68:71]
    ds_read_b128 v[88:91], v4 offset:2048
    v_mfma_f32_16x16x32_bf16 v[72:75], v[248:251], v[80:83], v[72:75]
    s_waitcnt lgkmcnt(3)
    v_mfma_f32_16x16x32_bf16 v[76:79], v[108:111], v[80:83], v[76:79]
    s_waitcnt lgkmcnt(2)
    v_mfma_f32_16x16x32_bf16 v[64:67], v[140:143], v[84:87], v[64:67]
    ds_read_b128 v[108:111], v9 offset:0
    s_waitcnt vmcnt(3)
    v_mfma_f32_16x16x32_bf16 v[48:51], v[32:35], v[48:51], 0
    s_waitcnt vmcnt(2)
    v_mfma_f32_16x16x32_bf16 v[52:55], v[32:35], v[52:55], 0
    s_waitcnt vmcnt(1)
    v_mfma_f32_16x16x32_bf16 v[56:59], v[36:39], v[56:59], 0
    s_waitcnt vmcnt(0)
    v_mfma_f32_16x16x32_bf16 v[60:63], v[36:39], v[60:63], 0
    v_mfma_f32_16x16x32_bf16 v[68:71], v[196:199], v[84:87], v[68:71]
    ds_read_b128 v[80:83], v5 offset:2048
    v_mfma_f32_16x16x32_bf16 v[72:75], v[252:255], v[84:87], v[72:75]
    s_waitcnt lgkmcnt(3)
    v_mfma_f32_16x16x32_bf16 v[76:79], v[112:115], v[84:87], v[76:79]
    s_waitcnt lgkmcnt(2)
    v_mfma_f32_16x16x32_bf16 v[92:95], a[224:227], v[88:91], 0
    ds_read_b128 v[112:115], v9 offset:1024
    v_mfma_f32_16x16x32_bf16 v[96:99], v[144:147], v[88:91], 0
    ds_read_b128 v[84:87], v4 offset:6144
    v_cvt_pk_bf16_f32 v64, v64, v65
    v_cvt_pk_bf16_f32 v65, v66, v67
    v_mfma_f32_16x16x32_bf16 v[100:103], v[200:203], v[88:91], 0
    s_waitcnt lgkmcnt(3)
    v_cvt_pk_bf16_f32 v66, v68, v69
    v_cvt_pk_bf16_f32 v67, v70, v71
    v_mfma_f32_16x16x32_bf16 v[104:107], v[108:111], v[88:91], 0
    buffer_store_dwordx4 v[64:67], v1, s[8:11], s49 offen offset:0
    v_cvt_pk_bf16_f32 v72, v72, v73
    s_waitcnt lgkmcnt(2)
    v_mfma_f32_16x16x32_bf16 v[92:95], a[228:231], v[80:83], v[92:95]
    ds_read_b128 v[108:111], v9 offset:2048
    v_cvt_pk_bf16_f32 v73, v74, v75
    v_cvt_pk_bf16_f32 v74, v76, v77
    v_mfma_f32_16x16x32_bf16 v[96:99], v[148:151], v[80:83], v[96:99]
    ds_read_b128 v[88:91], v5 offset:6144
    v_cvt_pk_bf16_f32 v75, v78, v79
    buffer_store_dwordx4 v[72:75], v1, s[8:11], s49 offen offset:2048
    v_mfma_f32_16x16x32_bf16 v[100:103], v[204:207], v[80:83], v[100:103]
    s_waitcnt lgkmcnt(3)
    v_mfma_f32_16x16x32_bf16 v[104:107], v[112:115], v[80:83], v[104:107]
    buffer_load_dwordx4 v[64:67], v1, s[8:11], s55 offen offset:0 sc1
    s_waitcnt lgkmcnt(2)
    v_mfma_f32_16x16x32_bf16 v[92:95], a[232:235], v[84:87], v[92:95]
    ds_read_b128 v[112:115], v9 offset:3072
    v_mfma_f32_16x16x32_bf16 v[96:99], v[152:155], v[84:87], v[96:99]
    ds_read_b128 v[80:83], v4 offset:10240
    v_mfma_f32_16x16x32_bf16 v[100:103], v[208:211], v[84:87], v[100:103]
    buffer_load_dwordx4 v[68:71], v1, s[8:11], s55 offen offset:1024 sc1
    s_waitcnt lgkmcnt(3)
    v_mfma_f32_16x16x32_bf16 v[104:107], v[108:111], v[84:87], v[104:107]
    s_waitcnt lgkmcnt(2)
    v_mfma_f32_16x16x32_bf16 v[92:95], a[236:239], v[88:91], v[92:95]
    ds_read_b128 v[108:111], v9 offset:4096
    v_mfma_f32_16x16x32_bf16 v[96:99], v[156:159], v[88:91], v[96:99]
    ds_read_b128 v[84:87], v5 offset:10240
    buffer_load_dwordx4 v[72:75], v1, s[8:11], s55 offen offset:2048 sc1
    v_mfma_f32_16x16x32_bf16 v[100:103], v[212:215], v[88:91], v[100:103]
    s_waitcnt lgkmcnt(3)
    v_mfma_f32_16x16x32_bf16 v[104:107], v[112:115], v[88:91], v[104:107]
    s_waitcnt lgkmcnt(2)
    v_mfma_f32_16x16x32_bf16 v[92:95], a[240:243], v[80:83], v[92:95]
    ds_read_b128 v[112:115], v9 offset:5120
    buffer_load_dwordx4 v[76:79], v1, s[8:11], s55 offen offset:3072 sc1
    v_mfma_f32_16x16x32_bf16 v[96:99], v[160:163], v[80:83], v[96:99]
    ds_read_b128 v[88:91], v4 offset:14336
    v_mfma_f32_16x16x32_bf16 v[100:103], v[216:219], v[80:83], v[100:103]
    s_waitcnt lgkmcnt(3)
    v_mfma_f32_16x16x32_bf16 v[104:107], v[108:111], v[80:83], v[104:107]
    buffer_load_dwordx4 v[32:35], v25, s[8:11], s56 offen offset:2048 sc1
    s_waitcnt lgkmcnt(2)
    v_mfma_f32_16x16x32_bf16 v[92:95], a[244:247], v[84:87], v[92:95]
    ds_read_b128 v[108:111], v9 offset:6144
    v_mfma_f32_16x16x32_bf16 v[96:99], v[164:167], v[84:87], v[96:99]
    ds_read_b128 v[80:83], v5 offset:14336
    v_mfma_f32_16x16x32_bf16 v[100:103], v[220:223], v[84:87], v[100:103]
    s_lshl_b32 s58, s29, 1
    s_or_b32 s58, s58, 0
    buffer_load_dwordx4 v[36:39], v25, s[8:11], s56 offen offset:2304 sc1
    s_waitcnt lgkmcnt(3)
    v_mfma_f32_16x16x32_bf16 v[104:107], v[112:115], v[84:87], v[104:107]
    s_waitcnt lgkmcnt(2)
    v_mov_b32 v26, s58
    v_mfma_f32_16x16x32_bf16 v[92:95], a[248:251], v[88:91], v[92:95]
    ds_read_b128 v[112:115], v9 offset:7168
    s_waitcnt vmcnt(6)
    s_mov_b64 exec, 1
    buffer_store_dword v26, off, s[8:11], s51
    s_mov_b64 exec, -1
    v_mfma_f32_16x16x32_bf16 v[96:99], v[168:171], v[88:91], v[96:99]
    ds_read_b128 v[84:87], v4 offset:18432
    v_mfma_f32_16x16x32_bf16 v[100:103], v[224:227], v[88:91], v[100:103]
    s_waitcnt lgkmcnt(3)
    v_mfma_f32_16x16x32_bf16 v[104:107], v[108:111], v[88:91], v[104:107]
    s_waitcnt lgkmcnt(2)
    v_mfma_f32_16x16x32_bf16 v[92:95], a[252:255], v[80:83], v[92:95]
    ds_read_b128 v[108:111], v9 offset:8192
    v_mfma_f32_16x16x32_bf16 v[96:99], v[172:175], v[80:83], v[96:99]
    ds_read_b128 v[88:91], v5 offset:18432
    v_mfma_f32_16x16x32_bf16 v[100:103], v[228:231], v[80:83], v[100:103]
    s_waitcnt lgkmcnt(3)
    v_mfma_f32_16x16x32_bf16 v[104:107], v[112:115], v[80:83], v[104:107]
    s_waitcnt lgkmcnt(2)
    v_mfma_f32_16x16x32_bf16 v[92:95], v[120:123], v[84:87], v[92:95]
    ds_read_b128 v[112:115], v9 offset:9216
    s_waitcnt vmcnt(6)
    v_mfma_f32_16x16x32_bf16 v[64:67], v[40:43], v[64:67], 0
    s_waitcnt vmcnt(5)
    v_mfma_f32_16x16x32_bf16 v[68:71], v[40:43], v[68:71], 0
    s_waitcnt vmcnt(4)
    v_mfma_f32_16x16x32_bf16 v[72:75], v[44:47], v[72:75], 0
    s_waitcnt vmcnt(3)
    v_mfma_f32_16x16x32_bf16 v[76:79], v[44:47], v[76:79], 0
    v_mfma_f32_16x16x32_bf16 v[96:99], v[176:179], v[84:87], v[96:99]
    ds_read_b128 v[80:83], v4 offset:22528
    buffer_load_dwordx4 v[40:43], v1, s[8:11], s56 offen offset:0 sc1
    v_mfma_f32_16x16x32_bf16 v[100:103], v[232:235], v[84:87], v[100:103]
    s_waitcnt lgkmcnt(3)
    v_mfma_f32_16x16x32_bf16 v[104:107], v[108:111], v[84:87], v[104:107]
    buffer_load_dwordx4 v[44:47], v1, s[8:11], s56 offen offset:1024 sc1
    s_waitcnt lgkmcnt(2)
    v_mfma_f32_16x16x32_bf16 v[92:95], v[124:127], v[88:91], v[92:95]
    ds_read_b128 v[108:111], v9 offset:10240
    v_mfma_f32_16x16x32_bf16 v[96:99], v[180:183], v[88:91], v[96:99]
    ds_read_b128 v[84:87], v5 offset:22528
    v_mfma_f32_16x16x32_bf16 v[100:103], v[236:239], v[88:91], v[100:103]
    s_waitcnt vmcnt(4)
    v_max3_u32 v16, v32, v33, v34
    s_waitcnt vmcnt(3)
    v_max3_u32 v16, v16, v35, v36
    s_waitcnt lgkmcnt(3)
    v_mfma_f32_16x16x32_bf16 v[104:107], v[112:115], v[88:91], v[104:107]
    s_waitcnt lgkmcnt(2)
    v_max3_u32 v16, v16, v37, v38
    v_max3_u32 v16, v16, v39, v15
    v_mfma_f32_16x16x32_bf16 v[92:95], v[128:131], v[80:83], v[92:95]
    ds_read_b128 v[112:115], v9 offset:11264
    v_cmp_eq_u32 vcc, -1, v16
    s_cbranch_vccnz Lalretry_33
Lalok_32:
    v_mfma_f32_16x16x32_bf16 v[96:99], v[184:187], v[80:83], v[96:99]
    ds_read_b128 v[88:91], v4 offset:26624
    v_mul_f32 v48, v48, v32
    v_mul_f32 v49, v49, v32
    v_mfma_f32_16x16x32_bf16 v[100:103], v[240:243], v[80:83], v[100:103]
    s_waitcnt lgkmcnt(3)
    v_mul_f32 v50, v50, v32
    v_mul_f32 v51, v51, v32
    v_mfma_f32_16x16x32_bf16 v[104:107], v[108:111], v[80:83], v[104:107]
    s_waitcnt lgkmcnt(2)
    v_mul_f32 v52, v52, v36
    v_mul_f32 v53, v53, v36
    v_mfma_f32_16x16x32_bf16 v[92:95], v[132:135], v[84:87], v[92:95]
    ds_read_b128 v[108:111], v9 offset:12288
    v_mul_f32 v54, v54, v36
    v_mul_f32 v55, v55, v36
    v_mfma_f32_16x16x32_bf16 v[96:99], v[188:191], v[84:87], v[96:99]
    ds_read_b128 v[80:83], v5 offset:26624
    v_fmac_f32 v48, v64, v34
    v_fmac_f32 v49, v65, v34
    v_mfma_f32_16x16x32_bf16 v[100:103], v[244:247], v[84:87], v[100:103]
    s_waitcnt lgkmcnt(3)
    v_fmac_f32 v50, v66, v34
    v_fmac_f32 v51, v67, v34
    v_mfma_f32_16x16x32_bf16 v[104:107], v[112:115], v[84:87], v[104:107]
    s_waitcnt lgkmcnt(2)
    v_fmac_f32 v52, v68, v38
    v_fmac_f32 v53, v69, v38
    v_mfma_f32_16x16x32_bf16 v[92:95], v[136:139], v[88:91], v[92:95]
    ds_read_b128 v[112:115], v9 offset:13312
    v_fmac_f32 v54, v70, v38
    v_fmac_f32 v55, v71, v38
    v_mfma_f32_16x16x32_bf16 v[96:99], v[192:195], v[88:91], v[96:99]
    ds_read_b128 v[84:87], v4 offset:0
    v_fmac_f32 v48, v72, v35
    v_fmac_f32 v49, v73, v35
    v_mfma_f32_16x16x32_bf16 v[100:103], v[248:251], v[88:91], v[100:103]
    s_waitcnt lgkmcnt(3)
    v_fmac_f32 v50, v74, v35
    v_fmac_f32 v51, v75, v35
    v_mfma_f32_16x16x32_bf16 v[104:107], v[108:111], v[88:91], v[104:107]
    s_waitcnt lgkmcnt(2)
    v_fmac_f32 v52, v76, v39
    v_fmac_f32 v53, v77, v39
    v_mfma_f32_16x16x32_bf16 v[92:95], v[140:143], v[80:83], v[92:95]
    v_fmac_f32 v54, v78, v39
    v_fmac_f32 v55, v79, v39
    v_mfma_f32_16x16x32_bf16 v[96:99], v[196:199], v[80:83], v[96:99]
    ds_read_b128 v[88:91], v5 offset:0
    v_fmac_f32 v48, v56, v33
    v_fmac_f32 v49, v57, v33
    v_mfma_f32_16x16x32_bf16 v[100:103], v[252:255], v[80:83], v[100:103]
    s_waitcnt lgkmcnt(2)
    v_fmac_f32 v50, v58, v33
    v_fmac_f32 v51, v59, v33
    v_mfma_f32_16x16x32_bf16 v[104:107], v[112:115], v[80:83], v[104:107]
    s_waitcnt lgkmcnt(1)
    v_fmac_f32 v52, v60, v37
    v_fmac_f32 v53, v61, v37
    v_mfma_f32_16x16x32_bf16 v[64:67], v[84:87], a[0:3], 0
    v_fmac_f32 v54, v62, v37
    v_fmac_f32 v55, v63, v37
    v_mfma_f32_16x16x32_bf16 v[68:71], v[84:87], a[56:59], 0
    ds_read_b128 v[80:83], v4 offset:4096
    v_cvt_pk_bf16_f32 v92, v92, v93
    v_cvt_pk_bf16_f32 v93, v94, v95
    s_waitcnt vmcnt(1)
    v_max3_u32 v16, v40, v41, v42
    s_waitcnt vmcnt(0)
    v_max3_u32 v16, v16, v43, v44
    v_mfma_f32_16x16x32_bf16 v[72:75], v[84:87], a[112:115], 0
    v_cvt_pk_bf16_f32 v94, v96, v97
    v_cvt_pk_bf16_f32 v95, v98, v99
    v_max3_u32 v16, v16, v45, v46
    v_max_u32 v16, v16, v47
    v_mfma_f32_16x16x32_bf16 v[76:79], v[84:87], a[168:171], 0
    buffer_store_dwordx4 v[92:95], v1, s[8:11], s49 offen offset:1024
    v_cvt_pk_bf16_f32 v100, v100, v101
    v_cmp_eq_u32 vcc, -1, v16
    s_cbranch_vccnz Lpretry_35
Lpok_34:
    v_mfma_f32_16x16x32_bf16 v[48:51], v[116:119], v[40:43], v[48:51]
    v_mfma_f32_16x16x32_bf16 v[52:55], v[116:119], v[44:47], v[52:55]
    s_waitcnt lgkmcnt(1)
    v_mfma_f32_16x16x32_bf16 v[64:67], v[88:91], a[4:7], v[64:67]
    v_cvt_pk_bf16_f32 v101, v102, v103
    v_cvt_pk_bf16_f32 v102, v104, v105
    ds_write_b128 v11, v[48:51] offset:12288
    v_mfma_f32_16x16x32_bf16 v[68:71], v[88:91], a[60:63], v[68:71]
    ds_read_b128 v[84:87], v5 offset:4096
    v_cvt_pk_bf16_f32 v103, v106, v107
    buffer_store_dwordx4 v[100:103], v1, s[8:11], s49 offen offset:3072
    ds_write_b128 v11, v[52:55] offset:13312
    v_mfma_f32_16x16x32_bf16 v[72:75], v[88:91], a[116:119], v[72:75]
    v_lshlrev_b32 v32, 16, v15
    v_and_b32 v33, 0xffff0000, v15
    v_mfma_f32_16x16x32_bf16 v[76:79], v[88:91], a[172:175], v[76:79]
    s_waitcnt lgkmcnt(3)
    v_mfma_f32_16x16x32_bf16 v[64:67], v[80:83], a[8:11], v[64:67]
    v_mfma_f32_16x16x32_bf16 v[68:71], v[80:83], a[64:67], v[68:71]
    ds_read_b128 v[88:91], v4 offset:8192
    v_mfma_f32_16x16x32_bf16 v[72:75], v[80:83], a[120:123], v[72:75]
    v_mfma_f32_16x16x32_bf16 v[76:79], v[80:83], a[176:179], v[76:79]
    s_waitcnt lgkmcnt(0)
    s_barrier
    ds_read_b64 v[56:57], v12 offset:12288
    ds_read_b64 v[58:59], v12 offset:14336
    v_mfma_f32_16x16x32_bf16 v[64:67], v[84:87], a[12:15], v[64:67]
    ds_read_b64 v[60:61], v12 offset:16384
    ds_read_b64 v[62:63], v12 offset:18432
    v_mfma_f32_16x16x32_bf16 v[68:71], v[84:87], a[68:71], v[68:71]
    ds_read_b128 v[80:83], v5 offset:8192
    v_mfma_f32_16x16x32_bf16 v[72:75], v[84:87], a[124:127], v[72:75]
    v_mfma_f32_16x16x32_bf16 v[76:79], v[84:87], a[180:183], v[76:79]
    v_mfma_f32_16x16x32_bf16 v[64:67], v[88:91], a[16:19], v[64:67]
    s_waitcnt lgkmcnt(4)
    v_add_f32 v32, v32, v56
    v_add_f32 v33, v33, v57
    v_mfma_f32_16x16x32_bf16 v[68:71], v[88:91], a[72:75], v[68:71]
    ds_read_b128 v[84:87], v4 offset:12288
    s_waitcnt lgkmcnt(4)
    v_add_f32 v32, v32, v58
    v_add_f32 v33, v33, v59
    v_mfma_f32_16x16x32_bf16 v[72:75], v[88:91], a[128:131], v[72:75]
    s_waitcnt lgkmcnt(3)
    v_add_f32 v32, v32, v60
    v_add_f32 v33, v33, v61
    v_mfma_f32_16x16x32_bf16 v[76:79], v[88:91], a[184:187], v[76:79]
    s_waitcnt lgkmcnt(2)
    v_add_f32 v32, v32, v62
    v_add_f32 v33, v33, v63
    s_waitcnt lgkmcnt(1)
    v_mfma_f32_16x16x32_bf16 v[64:67], v[80:83], a[20:23], v[64:67]
    v_cvt_pk_bf16_f32 v32, v32, v33
    buffer_store_dword v32, v13, s[8:11], s57 offen sc1
    v_mfma_f32_16x16x32_bf16 v[68:71], v[80:83], a[76:79], v[68:71]
    ds_read_b128 v[88:91], v5 offset:12288
    v_mfma_f32_16x16x32_bf16 v[72:75], v[80:83], a[132:135], v[72:75]
    s_lshl_b32 s58, s29, 1
    s_or_b32 s58, s58, 1
    v_mfma_f32_16x16x32_bf16 v[76:79], v[80:83], a[188:191], v[76:79]
    s_waitcnt lgkmcnt(1)
    v_mov_b32 v26, s58
    v_mfma_f32_16x16x32_bf16 v[64:67], v[84:87], a[24:27], v[64:67]
    s_waitcnt vmcnt(1)
    s_mov_b64 exec, 1
    buffer_store_dword v26, off, s[8:11], s51
    s_mov_b64 exec, -1
LA_p1:
    v_mfma_f32_16x16x32_bf16 v[68:71], v[84:87], a[80:83], v[68:71]
    ds_read_b128 v[80:83], v4 offset:16384
    s_mul_i32 s58, s28, 28672
    s_lshl_b32 s59, s27, 5
    v_mfma_f32_16x16x32_bf16 v[72:75], v[84:87], a[136:139], v[72:75]
    s_add_u32 s48, s58, s59
    s_mul_i32 s35, s23, 1835008
    v_mfma_f32_16x16x32_bf16 v[76:79], v[84:87], a[192:195], v[76:79]
    s_add_u32 s35, s35, s58
    s_lshl_b32 s59, s27, 10
    s_waitcnt lgkmcnt(1)
    v_mfma_f32_16x16x32_bf16 v[64:67], v[88:91], a[28:31], v[64:67]
    s_add_u32 s35, s35, s59
    s_lshl_b32 s59, s20, 8
    v_mfma_f32_16x16x32_bf16 v[68:71], v[88:91], a[84:87], v[68:71]
    ds_read_b128 v[84:87], v5 offset:16384
    s_add_u32 s35, s35, s59
    s_add_u32 s35, s35, 4210688
    v_mfma_f32_16x16x32_bf16 v[72:75], v[88:91], a[140:143], v[72:75]
    s_lshl_b32 s33, s28, 14
    s_add_u32 s33, s33, s3
    v_mfma_f32_16x16x32_bf16 v[76:79], v[88:91], a[196:199], v[76:79]
    s_lshl_b32 s59, s27, 8
    s_add_u32 s34, s33, s59
    s_waitcnt lgkmcnt(1)
    v_mfma_f32_16x16x32_bf16 v[64:67], v[80:83], a[32:35], v[64:67]
    s_add_u32 s34, s34, 16384
    s_add_u32 s53, s33, 7168
    v_mfma_f32_16x16x32_bf16 v[68:71], v[80:83], a[88:91], v[68:71]
    ds_read_b128 v[88:91], v4 offset:20480
    s_and_b32 s58, s29, 1
    s_mul_i32 s50, s58, 114688
    v_mfma_f32_16x16x32_bf16 v[72:75], v[80:83], a[144:147], v[72:75]
    s_mul_i32 s59, s25, 7168
    s_add_u32 s50, s50, s59
    v_mfma_f32_16x16x32_bf16 v[76:79], v[80:83], a[200:203], v[76:79]
    s_add_u32 s50, s50, s30
    s_lshl_b32 s18, s58, 15
    s_waitcnt lgkmcnt(1)
    v_mfma_f32_16x16x32_bf16 v[64:67], v[84:87], a[36:39], v[64:67]
    s_add_u32 s18, s18, s31
    s_add_u32 s18, s18, 917504
    v_mfma_f32_16x16x32_bf16 v[68:71], v[84:87], a[92:95], v[68:71]
    ds_read_b128 v[80:83], v5 offset:20480
    s_lshl_b32 s59, s20, 13
    s_add_u32 s54, s18, s59
    v_mfma_f32_16x16x32_bf16 v[72:75], v[84:87], a[148:151], v[72:75]
    s_add_u32 s55, s54, 4096
    s_mul_i32 s58, s58, 16384
    v_mfma_f32_16x16x32_bf16 v[76:79], v[84:87], a[204:207], v[76:79]
    s_add_u32 s58, s58, s30
    s_add_u32 s58, s58, 229376
    s_waitcnt lgkmcnt(1)
    v_mfma_f32_16x16x32_bf16 v[64:67], v[88:91], a[40:43], v[64:67]
    s_lshl_b32 s59, s20, 12
    s_add_u32 s56, s58, s59
    v_mfma_f32_16x16x32_bf16 v[68:71], v[88:91], a[96:99], v[68:71]
    ds_read_b128 v[84:87], v4 offset:24576
    s_lshl_b32 s59, s71, 10
    s_add_u32 s50, s50, s59
    v_mfma_f32_16x16x32_bf16 v[72:75], v[88:91], a[152:155], v[72:75]
    s_cmp_eq_u32 s26, 1
    s_cselect_b32 s50, 1073741824, s50
    v_mfma_f32_16x16x32_bf16 v[76:79], v[88:91], a[208:211], v[76:79]
    s_add_u32 s64, s53, 16384
    s_lshl_b32 s59, s22, 2
    s_waitcnt lgkmcnt(1)
    v_mfma_f32_16x16x32_bf16 v[64:67], v[80:83], a[44:47], v[64:67]
    s_add_u32 s59, s59, s20
    s_cmp_eq_u32 s59, 1
    v_mfma_f32_16x16x32_bf16 v[68:71], v[80:83], a[100:103], v[68:71]
    ds_read_b128 v[88:91], v5 offset:24576
    s_cselect_b32 s64, s64, 1073741824
    s_and_b32 s58, s29, 3
    v_mfma_f32_16x16x32_bf16 v[72:75], v[80:83], a[156:159], v[72:75]
    s_mul_i32 s58, s58, 17408
    s_add_u32 s58, s58, s30
    v_mfma_f32_16x16x32_bf16 v[76:79], v[80:83], a[212:215], v[76:79]
    s_add_u32 s58, s58, 264192
    s_add_u32 s18, s29, 3
    s_waitcnt lgkmcnt(1)
    v_mfma_f32_16x16x32_bf16 v[64:67], v[84:87], a[48:51], v[64:67]
    s_and_b32 s18, s18, 3
    s_mul_i32 s18, s18, 17408
    v_mfma_f32_16x16x32_bf16 v[68:71], v[84:87], a[104:107], v[68:71]
    ds_read_b128 v[80:83], v4 offset:2048
    s_add_u32 s18, s18, s30
    s_add_u32 s18, s18, 264192
    v_mfma_f32_16x16x32_bf16 v[72:75], v[84:87], a[160:163], v[72:75]
    s_lshl_b32 s59, s26, 4
    s_add_u32 s59, s59, s25
    v_mfma_f32_16x16x32_bf16 v[76:79], v[84:87], a[216:219], v[76:79]
    s_lshl_b32 s59, s59, 8
    s_add_u32 s36, s58, s59
    s_waitcnt lgkmcnt(1)
    v_mfma_f32_16x16x32_bf16 v[64:67], v[88:91], a[52:55], v[64:67]
    s_add_u32 s37, s18, s59
    s_lshl_b32 s59, s20, 10
    v_mfma_f32_16x16x32_bf16 v[68:71], v[88:91], a[108:111], v[68:71]
    ds_read_b128 v[84:87], v5 offset:2048
    s_add_u32 s38, s58, s59
    s_add_u32 s39, s38, 4096
    v_mfma_f32_16x16x32_bf16 v[72:75], v[88:91], a[164:167], v[72:75]
    s_lshl_b32 s59, s20, 11
    s_add_u32 s40, s58, s59
    v_mfma_f32_16x16x32_bf16 v[76:79], v[88:91], a[220:223], v[76:79]
    s_add_u32 s40, s40, 8192
    s_add_u32 s41, s58, 16384
    s_waitcnt lgkmcnt(1)
    v_mfma_f32_16x16x32_bf16 v[48:51], v[80:83], a[0:3], 0
    v_mfma_f32_16x16x32_bf16 v[52:55], v[80:83], a[56:59], 0
    ds_read_b128 v[88:91], v4 offset:6144
    v_mfma_f32_16x16x32_bf16 v[56:59], v[80:83], a[112:115], 0
    v_mfma_f32_16x16x32_bf16 v[60:63], v[80:83], a[168:171], 0
    s_cmp_eq_u32 s26, 1
    s_cbranch_scc1 LA_u1
    s_waitcnt lgkmcnt(1)
    v_mfma_f32_16x16x32_bf16 v[48:51], v[84:87], a[4:7], v[48:51]
    s_xor_b32 s19, s19, 98304
    s_add_u32 s91, s32, 86016
    v_mfma_f32_16x16x32_bf16 v[52:55], v[84:87], a[60:63], v[52:55]
    ds_read_b128 v[80:83], v5 offset:6144
    v_mfma_f32_16x16x32_bf16 v[56:59], v[84:87], a[116:119], v[56:59]
    s_cmp_lt_u32 s28, 61
    s_cselect_b32 s91, s91, 1073741824
    v_mfma_f32_16x16x32_bf16 v[60:63], v[84:87], a[172:175], v[60:63]
    s_waitcnt lgkmcnt(1)
    v_mfma_f32_16x16x32_bf16 v[48:51], v[88:91], a[8:11], v[48:51]
    s_add_u32 m0, s19, 0
    v_mfma_f32_16x16x32_bf16 v[52:55], v[88:91], a[64:67], v[52:55]
    ds_read_b128 v[84:87], v4 offset:10240
    v_mfma_f32_16x16x32_bf16 v[56:59], v[88:91], a[120:123], v[56:59]
    buffer_load_dwordx4 v2, s[8:11], s91 offen offset:0 sc1 lds
    v_mfma_f32_16x16x32_bf16 v[60:63], v[88:91], a[176:179], v[60:63]
    s_waitcnt lgkmcnt(1)
    v_mfma_f32_16x16x32_bf16 v[48:51], v[80:83], a[12:15], v[48:51]
    s_add_u32 m0, s19, 3968
    v_mfma_f32_16x16x32_bf16 v[52:55], v[80:83], a[68:71], v[52:55]
    ds_read_b128 v[88:91], v5 offset:10240
    v_mfma_f32_16x16x32_bf16 v[56:59], v[80:83], a[124:127], v[56:59]
    buffer_load_dwordx4 v2, s[8:11], s91 offen offset:128 sc1 lds
    v_mfma_f32_16x16x32_bf16 v[60:63], v[80:83], a[180:183], v[60:63]
    s_waitcnt lgkmcnt(1)
    v_mfma_f32_16x16x32_bf16 v[48:51], v[84:87], a[16:19], v[48:51]
    s_add_u32 m0, s19, 7936
    v_mfma_f32_16x16x32_bf16 v[52:55], v[84:87], a[72:75], v[52:55]
    ds_read_b128 v[80:83], v4 offset:14336
    v_mfma_f32_16x16x32_bf16 v[56:59], v[84:87], a[128:131], v[56:59]
    buffer_load_dwordx4 v2, s[8:11], s91 offen offset:256 sc1 lds
    v_mfma_f32_16x16x32_bf16 v[60:63], v[84:87], a[184:187], v[60:63]
    s_waitcnt lgkmcnt(1)
    v_mfma_f32_16x16x32_bf16 v[48:51], v[88:91], a[20:23], v[48:51]
    s_add_u32 m0, s19, 11904
    v_mfma_f32_16x16x32_bf16 v[52:55], v[88:91], a[76:79], v[52:55]
    ds_read_b128 v[84:87], v5 offset:14336
    v_mfma_f32_16x16x32_bf16 v[56:59], v[88:91], a[132:135], v[56:59]
    buffer_load_dwordx4 v2, s[8:11], s91 offen offset:384 sc1 lds
    v_mfma_f32_16x16x32_bf16 v[60:63], v[88:91], a[188:191], v[60:63]
    s_waitcnt lgkmcnt(1)
    v_mfma_f32_16x16x32_bf16 v[48:51], v[80:83], a[24:27], v[48:51]
    s_add_u32 m0, s19, 15872
    v_mfma_f32_16x16x32_bf16 v[52:55], v[80:83], a[80:83], v[52:55]
    ds_read_b128 v[88:91], v4 offset:18432
    v_mfma_f32_16x16x32_bf16 v[56:59], v[80:83], a[136:139], v[56:59]
    buffer_load_dwordx4 v2, s[8:11], s91 offen offset:512 sc1 lds
    v_mfma_f32_16x16x32_bf16 v[60:63], v[80:83], a[192:195], v[60:63]
    s_waitcnt lgkmcnt(1)
    v_mfma_f32_16x16x32_bf16 v[48:51], v[84:87], a[28:31], v[48:51]
    s_add_u32 m0, s19, 19840
    v_mfma_f32_16x16x32_bf16 v[52:55], v[84:87], a[84:87], v[52:55]
    ds_read_b128 v[80:83], v5 offset:18432
    v_mfma_f32_16x16x32_bf16 v[56:59], v[84:87], a[140:143], v[56:59]
    buffer_load_dwordx4 v2, s[8:11], s91 offen offset:640 sc1 lds
    v_mfma_f32_16x16x32_bf16 v[60:63], v[84:87], a[196:199], v[60:63]
    s_waitcnt lgkmcnt(1)
    v_mfma_f32_16x16x32_bf16 v[48:51], v[88:91], a[32:35], v[48:51]
    s_add_u32 m0, s19, 23808
    v_mfma_f32_16x16x32_bf16 v[52:55], v[88:91], a[88:91], v[52:55]
    ds_read_b128 v[84:87], v4 offset:22528
    v_mfma_f32_16x16x32_bf16 v[56:59], v[88:91], a[144:147], v[56:59]
    buffer_load_dwordx4 v2, s[8:11], s91 offen offset:768 sc1 lds
    v_mfma_f32_16x16x32_bf16 v[60:63], v[88:91], a[200:203], v[60:63]
    s_waitcnt lgkmcnt(1)
    v_mfma_f32_16x16x32_bf16 v[48:51], v[80:83], a[36:39], v[48:51]
    v_mfma_f32_16x16x32_bf16 v[52:55], v[80:83], a[92:95], v[52:55]
    ds_read_b128 v[88:91], v5 offset:22528
    v_mfma_f32_16x16x32_bf16 v[56:59], v[80:83], a[148:151], v[56:59]
    v_mfma_f32_16x16x32_bf16 v[60:63], v[80:83], a[204:207], v[60:63]
    s_waitcnt lgkmcnt(1)
    v_mfma_f32_16x16x32_bf16 v[48:51], v[84:87], a[40:43], v[48:51]
    v_mfma_f32_16x16x32_bf16 v[52:55], v[84:87], a[96:99], v[52:55]
    ds_read_b128 v[80:83], v4 offset:26624
    v_mfma_f32_16x16x32_bf16 v[56:59], v[84:87], a[152:155], v[56:59]
    v_mfma_f32_16x16x32_bf16 v[60:63], v[84:87], a[208:211], v[60:63]
    s_waitcnt lgkmcnt(1)
    v_mfma_f32_16x16x32_bf16 v[48:51], v[88:91], a[44:47], v[48:51]
    v_mfma_f32_16x16x32_bf16 v[52:55], v[88:91], a[100:103], v[52:55]
    ds_read_b128 v[84:87], v5 offset:26624
    v_mfma_f32_16x16x32_bf16 v[56:59], v[88:91], a[156:159], v[56:59]
    v_mfma_f32_16x16x32_bf16 v[60:63], v[88:91], a[212:215], v[60:63]
    s_waitcnt lgkmcnt(1)
    v_mfma_f32_16x16x32_bf16 v[48:51], v[80:83], a[48:51], v[48:51]
    v_mfma_f32_16x16x32_bf16 v[52:55], v[80:83], a[104:107], v[52:55]
    v_mfma_f32_16x16x32_bf16 v[56:59], v[80:83], a[160:163], v[56:59]
    v_mfma_f32_16x16x32_bf16 v[60:63], v[80:83], a[216:219], v[60:63]
    s_waitcnt lgkmcnt(0)
    v_mfma_f32_16x16x32_bf16 v[48:51], v[84:87], a[52:55], v[48:51]
    v_mfma_f32_16x16x32_bf16 v[52:55], v[84:87], a[108:111], v[52:55]
    v_mfma_f32_16x16x32_bf16 v[56:59], v[84:87], a[164:167], v[56:59]
    v_mfma_f32_16x16x32_bf16 v[60:63], v[84:87], a[220:223], v[60:63]
    buffer_load_dword v0, off, s[8:11], s53 sc1
    v_cvt_pk_bf16_f32 v32, v64, v48
    v_cvt_pk_bf16_f32 v33, v65, v49
    v_cvt_pk_bf16_f32 v34, v66, v50
    v_cvt_pk_bf16_f32 v35, v67, v51
    v_cvt_pk_bf16_f32 v36, v68, v52
    v_cvt_pk_bf16_f32 v37, v69, v53
    v_cvt_pk_bf16_f32 v38, v70, v54
    v_cvt_pk_bf16_f32 v39, v71, v55
    v_cvt_pk_bf16_f32 v40, v72, v56
    v_cvt_pk_bf16_f32 v41, v73, v57
    v_cvt_pk_bf16_f32 v42, v74, v58
    v_cvt_pk_bf16_f32 v43, v75, v59
    v_cvt_pk_bf16_f32 v44, v76, v60
    v_cvt_pk_bf16_f32 v45, v77, v61
    v_cvt_pk_bf16_f32 v46, v78, v62
    v_cvt_pk_bf16_f32 v47, v79, v63
    s_cmp_eq_u32 s23, 0
    s_cbranch_scc1 Lnoprobe_36
    v_xor_b32 v26, 98304, v3
    s_waitcnt vmcnt(1)
    ds_read_b128 v[80:83], v26 offset:0
    ds_read_b128 v[84:87], v26 offset:4096
    ds_read_b128 v[88:91], v26 offset:8192
    ds_read_b128 v[92:95], v26 offset:12288
    ds_read_b128 v[96:99], v26 offset:16384
    ds_read_b128 v[100:103], v26 offset:20480
    ds_read_b128 v[104:107], v26 offset:24576
    s_waitcnt lgkmcnt(6)
    v_max3_u32 v16, v80, v81, v82
    s_waitcnt lgkmcnt(5)
    v_max3_u32 v16, v16, v83, v84
    v_max3_u32 v16, v16, v85, v86
    s_waitcnt lgkmcnt(4)
    v_max3_u32 v16, v16, v87, v88
    v_max3_u32 v16, v16, v89, v90
    s_waitcnt lgkmcnt(3)
    v_max3_u32 v16, v16, v91, v92
    v_max3_u32 v16, v16, v93, v94
    s_waitcnt lgkmcnt(2)
    v_max3_u32 v16, v16, v95, v96
    v_max3_u32 v16, v16, v97, v98
    s_waitcnt lgkmcnt(1)
    v_max3_u32 v16, v16, v99, v100
    v_max3_u32 v16, v16, v101, v102
    s_waitcnt lgkmcnt(0)
    v_max3_u32 v16, v16, v103, v104
    v_max3_u32 v16, v16, v105, v106
    v_max_u32 v16, v16, v107
    v_cmp_eq_u32 vcc, -1, v16
    s_mov_b64 s[66:67], vcc
Lnoprobe_36:
    s_branch LA_gend
LA_u1:
    s_waitcnt lgkmcnt(1)
    v_mfma_f32_16x16x32_bf16 v[48:51], v[84:87], a[4:7], v[48:51]
    s_xor_b32 s19, s19, 98304
    s_add_u32 s91, s32, 86016
    v_mfma_f32_16x16x32_bf16 v[52:55], v[84:87], a[60:63], v[52:55]
    ds_read_b128 v[80:83], v5 offset:6144
    v_mfma_f32_16x16x32_bf16 v[56:59], v[84:87], a[116:119], v[56:59]
    s_cmp_lt_u32 s28, 61
    s_cselect_b32 s91, s91, 1073741824
    v_mfma_f32_16x16x32_bf16 v[60:63], v[84:87], a[172:175], v[60:63]
    s_waitcnt lgkmcnt(1)
    v_mfma_f32_16x16x32_bf16 v[48:51], v[88:91], a[8:11], v[48:51]
    s_add_u32 m0, s19, 0
    v_mfma_f32_16x16x32_bf16 v[52:55], v[88:91], a[64:67], v[52:55]
    ds_read_b128 v[84:87], v4 offset:10240
    v_mfma_f32_16x16x32_bf16 v[56:59], v[88:91], a[120:123], v[56:59]
    buffer_load_dwordx4 v2, s[8:11], s91 offen offset:0 sc1 lds
    v_mfma_f32_16x16x32_bf16 v[60:63], v[88:91], a[176:179], v[60:63]
    s_waitcnt lgkmcnt(1)
    v_mfma_f32_16x16x32_bf16 v[48:51], v[80:83], a[12:15], v[48:51]
    s_add_u32 m0, s19, 3968
    v_mfma_f32_16x16x32_bf16 v[52:55], v[80:83], a[68:71], v[52:55]
    ds_read_b128 v[88:91], v5 offset:10240
    v_mfma_f32_16x16x32_bf16 v[56:59], v[80:83], a[124:127], v[56:59]
    buffer_load_dwordx4 v2, s[8:11], s91 offen offset:128 sc1 lds
    v_mfma_f32_16x16x32_bf16 v[60:63], v[80:83], a[180:183], v[60:63]
    s_waitcnt lgkmcnt(1)
    v_mfma_f32_16x16x32_bf16 v[48:51], v[84:87], a[16:19], v[48:51]
    s_add_u32 m0, s19, 7936
    v_mfma_f32_16x16x32_bf16 v[52:55], v[84:87], a[72:75], v[52:55]
    ds_read_b128 v[80:83], v4 offset:14336
    v_mfma_f32_16x16x32_bf16 v[56:59], v[84:87], a[128:131], v[56:59]
    buffer_load_dwordx4 v2, s[8:11], s91 offen offset:256 sc1 lds
    v_mfma_f32_16x16x32_bf16 v[60:63], v[84:87], a[184:187], v[60:63]
    s_waitcnt lgkmcnt(1)
    v_mfma_f32_16x16x32_bf16 v[48:51], v[88:91], a[20:23], v[48:51]
    s_add_u32 m0, s19, 11904
    v_mfma_f32_16x16x32_bf16 v[52:55], v[88:91], a[76:79], v[52:55]
    ds_read_b128 v[84:87], v5 offset:14336
    v_mfma_f32_16x16x32_bf16 v[56:59], v[88:91], a[132:135], v[56:59]
    buffer_load_dwordx4 v2, s[8:11], s91 offen offset:384 sc1 lds
    v_mfma_f32_16x16x32_bf16 v[60:63], v[88:91], a[188:191], v[60:63]
    s_waitcnt lgkmcnt(1)
    v_mfma_f32_16x16x32_bf16 v[48:51], v[80:83], a[24:27], v[48:51]
    s_add_u32 m0, s19, 15872
    v_mfma_f32_16x16x32_bf16 v[52:55], v[80:83], a[80:83], v[52:55]
    ds_read_b128 v[88:91], v4 offset:18432
    v_mfma_f32_16x16x32_bf16 v[56:59], v[80:83], a[136:139], v[56:59]
    buffer_load_dwordx4 v2, s[8:11], s91 offen offset:512 sc1 lds
    v_mfma_f32_16x16x32_bf16 v[60:63], v[80:83], a[192:195], v[60:63]
    s_waitcnt lgkmcnt(1)
    v_mfma_f32_16x16x32_bf16 v[48:51], v[84:87], a[28:31], v[48:51]
    s_add_u32 m0, s19, 19840
    v_mfma_f32_16x16x32_bf16 v[52:55], v[84:87], a[84:87], v[52:55]
    ds_read_b128 v[80:83], v5 offset:18432
    v_mfma_f32_16x16x32_bf16 v[56:59], v[84:87], a[140:143], v[56:59]
    buffer_load_dwordx4 v2, s[8:11], s91 offen offset:640 sc1 lds
    v_mfma_f32_16x16x32_bf16 v[60:63], v[84:87], a[196:199], v[60:63]
    s_waitcnt lgkmcnt(1)
    v_mfma_f32_16x16x32_bf16 v[48:51], v[88:91], a[32:35], v[48:51]
    s_add_u32 m0, s19, 23808
    v_mfma_f32_16x16x32_bf16 v[52:55], v[88:91], a[88:91], v[52:55]
    ds_read_b128 v[84:87], v4 offset:22528
    v_mfma_f32_16x16x32_bf16 v[56:59], v[88:91], a[144:147], v[56:59]
    buffer_load_dwordx4 v2, s[8:11], s91 offen offset:768 sc1 lds
    v_mfma_f32_16x16x32_bf16 v[60:63], v[88:91], a[200:203], v[60:63]
    s_waitcnt lgkmcnt(1)
    v_mfma_f32_16x16x32_bf16 v[48:51], v[80:83], a[36:39], v[48:51]
    s_add_u32 s91, s91, s60
    v_xor_b32 v26, s61, v2
    s_add_u32 s58, s19, s62
    v_mfma_f32_16x16x32_bf16 v[52:55], v[80:83], a[92:95], v[52:55]
    ds_read_b128 v[88:91], v5 offset:22528
    v_mfma_f32_16x16x32_bf16 v[56:59], v[80:83], a[148:151], v[56:59]
    s_add_u32 m0, s58, 0
    v_mfma_f32_16x16x32_bf16 v[60:63], v[80:83], a[204:207], v[60:63]
    s_waitcnt lgkmcnt(1)
    v_mfma_f32_16x16x32_bf16 v[48:51], v[84:87], a[40:43], v[48:51]
    buffer_load_dwordx4 v26, s[8:11], s91 offen offset:0 sc1 lds
    v_mfma_f32_16x16x32_bf16 v[52:55], v[84:87], a[96:99], v[52:55]
    ds_read_b128 v[80:83], v4 offset:26624
    v_mfma_f32_16x16x32_bf16 v[56:59], v[84:87], a[152:155], v[56:59]
    s_add_u32 m0, s58, 7936
    v_mfma_f32_16x16x32_bf16 v[60:63], v[84:87], a[208:211], v[60:63]
    s_waitcnt lgkmcnt(1)
    v_mfma_f32_16x16x32_bf16 v[48:51], v[88:91], a[44:47], v[48:51]
    buffer_load_dwordx4 v26, s[8:11], s91 offen offset:256 sc1 lds
    v_mfma_f32_16x16x32_bf16 v[52:55], v[88:91], a[100:103], v[52:55]
    ds_read_b128 v[84:87], v5 offset:26624
    v_mfma_f32_16x16x32_bf16 v[56:59], v[88:91], a[156:159], v[56:59]
    s_add_u32 m0, s58, 15872
    v_mfma_f32_16x16x32_bf16 v[60:63], v[88:91], a[212:215], v[60:63]
    s_waitcnt lgkmcnt(1)
    v_mfma_f32_16x16x32_bf16 v[48:51], v[80:83], a[48:51], v[48:51]
    buffer_load_dwordx4 v26, s[8:11], s91 offen offset:512 sc1 lds
    v_mfma_f32_16x16x32_bf16 v[52:55], v[80:83], a[104:107], v[52:55]
    v_mfma_f32_16x16x32_bf16 v[56:59], v[80:83], a[160:163], v[56:59]
    v_mfma_f32_16x16x32_bf16 v[60:63], v[80:83], a[216:219], v[60:63]
    s_waitcnt lgkmcnt(0)
    v_mfma_f32_16x16x32_bf16 v[48:51], v[84:87], a[52:55], v[48:51]
    v_mfma_f32_16x16x32_bf16 v[52:55], v[84:87], a[108:111], v[52:55]
    v_mfma_f32_16x16x32_bf16 v[56:59], v[84:87], a[164:167], v[56:59]
    v_mfma_f32_16x16x32_bf16 v[60:63], v[84:87], a[220:223], v[60:63]
    buffer_load_dword v0, off, s[8:11], s53 sc1
    v_cvt_pk_bf16_f32 v32, v64, v48
    v_cvt_pk_bf16_f32 v33, v65, v49
    v_cvt_pk_bf16_f32 v34, v66, v50
    v_cvt_pk_bf16_f32 v35, v67, v51
    v_cvt_pk_bf16_f32 v36, v68, v52
    v_cvt_pk_bf16_f32 v37, v69, v53
    v_cvt_pk_bf16_f32 v38, v70, v54
    v_cvt_pk_bf16_f32 v39, v71, v55
    v_cvt_pk_bf16_f32 v40, v72, v56
    v_cvt_pk_bf16_f32 v41, v73, v57
    v_cvt_pk_bf16_f32 v42, v74, v58
    v_cvt_pk_bf16_f32 v43, v75, v59
    v_cvt_pk_bf16_f32 v44, v76, v60
    v_cvt_pk_bf16_f32 v45, v77, v61
    v_cvt_pk_bf16_f32 v46, v78, v62
    v_cvt_pk_bf16_f32 v47, v79, v63
    s_cmp_eq_u32 s23, 0
    s_cbranch_scc1 Lnoprobe_37
    v_xor_b32 v26, 98304, v3
    s_waitcnt vmcnt(1)
    ds_read_b128 v[80:83], v26 offset:0
    ds_read_b128 v[84:87], v26 offset:4096
    ds_read_b128 v[88:91], v26 offset:8192
    ds_read_b128 v[92:95], v26 offset:12288
    ds_read_b128 v[96:99], v26 offset:16384
    ds_read_b128 v[100:103], v26 offset:20480
    ds_read_b128 v[104:107], v26 offset:24576
    v_add_u32 v26, s62, v26
    ds_read_b128 v[48:51], v26 offset:0
    ds_read_b128 v[52:55], v26 offset:8192
    ds_read_b128 v[56:59], v26 offset:16384
    s_waitcnt lgkmcnt(9)
    v_max3_u32 v16, v80, v81, v82
    s_waitcnt lgkmcnt(8)
    v_max3_u32 v16, v16, v83, v84
    v_max3_u32 v16, v16, v85, v86
    s_waitcnt lgkmcnt(7)
    v_max3_u32 v16, v16, v87, v88
    v_max3_u32 v16, v16, v89, v90
    s_waitcnt lgkmcnt(6)
    v_max3_u32 v16, v16, v91, v92
    v_max3_u32 v16, v16, v93, v94
    s_waitcnt lgkmcnt(5)
    v_max3_u32 v16, v16, v95, v96
    v_max3_u32 v16, v16, v97, v98
    s_waitcnt lgkmcnt(4)
    v_max3_u32 v16, v16, v99, v100
    v_max3_u32 v16, v16, v101, v102
    s_waitcnt lgkmcnt(3)
    v_max3_u32 v16, v16, v103, v104
    v_max3_u32 v16, v16, v105, v106
    s_waitcnt lgkmcnt(2)
    v_max3_u32 v16, v16, v107, v48
    v_max3_u32 v16, v16, v49, v50
    s_waitcnt lgkmcnt(1)
    v_max3_u32 v16, v16, v51, v52
    v_max3_u32 v16, v16, v53, v54
    s_waitcnt lgkmcnt(0)
    v_max3_u32 v16, v16, v55, v56
    v_max3_u32 v16, v16, v57, v58
    v_max_u32 v16, v16, v59
    v_cmp_eq_u32 vcc, -1, v16
    s_mov_b64 s[66:67], vcc
Lnoprobe_37:
LA_gend:
LA_chain:
    s_cmp_eq_u32 s20, 1
    s_cbranch_scc1 LA_k1
    s_cmp_eq_u32 s20, 2
    s_cbranch_scc1 LA_k2
    s_cmp_eq_u32 s20, 3
    s_cbranch_scc1 LA_k3
LA_k0:
    ds_read_b128 v[72:75], v9 offset:0
    ds_read_b128 v[76:79], v9 offset:1024
    ds_read_b128 v[112:115], v9 offset:8192
    ds_read_b128 v[116:119], v9 offset:9216
    v_mov_b32 v48, 0
    v_mov_b32 v49, 0
    v_mov_b32 v50, 0
    v_mov_b32 v51, 0
    v_mov_b32 v52, 0
    v_mov_b32 v53, 0
    v_mov_b32 v54, 0
    v_mov_b32 v55, 0
    v_mov_b32 v56, 0
    v_mov_b32 v57, 0
    v_mov_b32 v58, 0
    v_mov_b32 v59, 0
    v_mov_b32 v60, 0
    v_mov_b32 v61, 0
    v_mov_b32 v62, 0
    v_mov_b32 v63, 0
    v_mov_b32 v64, 0
    v_mov_b32 v65, 0
    v_mov_b32 v66, 0
    v_mov_b32 v67, 0
    v_mov_b32 v68, 0
    v_mov_b32 v69, 0
    v_mov_b32 v70, 0
    v_mov_b32 v71, 0
    s_waitcnt vmcnt(0) lgkmcnt(0)
    v_cmp_eq_u32 vcc, -1, v0
    s_mov_b32 s70, 0
    s_cbranch_vccz Lmpoll_38
    s_mov_b32 s70, 0
Lpoll_40:
    buffer_load_dword v0, off, s[8:11], s53 sc1
    s_add_u32 s70, s70, 1
    s_cmp_gt_u32 s70, 131072
    s_cbranch_scc1 Lfail
    s_waitcnt vmcnt(0)
    v_cmp_eq_u32 vcc, -1, v0
    s_cbranch_vccnz Lpoll_40
Lmpoll_38:
    buffer_load_dwordx4 v[80:83], v7, s[8:11], s33 offen sc1
    buffer_load_dwordx4 v[96:99], v8, s[8:11], s33 offen sc1
    s_add_u32 s70, s70, 1
    s_cmp_gt_u32 s70, 262144
    s_cbranch_scc1 Lfail
    s_waitcnt vmcnt(1)
    ds_write_b128 v7, v[80:83] offset:0
    v_max3_u32 v16, v80, v81, v82
    s_waitcnt vmcnt(0)
    v_max3_u32 v16, v16, v83, v96
    v_max3_u32 v16, v16, v97, v98
    v_max_u32 v16, v16, v99
    v_cmp_eq_u32 vcc, -1, v16
    ds_write_b128 v8, v[96:99] offset:0
    s_cbranch_vccnz Lmpoll_38
    v_smfmac_f32_16x16x64_bf16 v[60:63], v[80:83], v[72:79], v6
    ds_read_b128 v[72:75], v9 offset:2048
    v_smfmac_f32_16x16x64_bf16 v[60:63], v[96:99], v[112:119], v6
    ds_read_b128 v[76:79], v9 offset:3072
    v_smfmac_f32_16x16x64_bf16 v[48:51], v[80:83], a[224:231], v6
    ds_read_b128 v[112:115], v9 offset:4096
    v_smfmac_f32_16x16x64_bf16 v[48:51], v[96:99], v[120:127], v6
    ds_read_b128 v[116:119], v9 offset:5120
    v_smfmac_f32_16x16x64_bf16 v[56:59], v[80:83], v[200:207], v6
    v_smfmac_f32_16x16x64_bf16 v[56:59], v[96:99], v[232:239], v6
    s_waitcnt lgkmcnt(4)
    s_barrier
    ds_read_b128 v[84:87], v1 offset:1024
    ds_read_b128 v[88:91], v1 offset:2048
    v_smfmac_f32_16x16x64_bf16 v[52:55], v[80:83], v[144:151], v6
    ds_read_b128 v[92:95], v1 offset:3072
    v_smfmac_f32_16x16x64_bf16 v[52:55], v[96:99], v[176:183], v6
    ds_read_b128 v[100:103], v1 offset:5120
    ds_read_b128 v[104:107], v1 offset:6144
    s_waitcnt lgkmcnt(4)
    v_smfmac_f32_16x16x64_bf16 v[48:51], v[84:87], a[232:239], v6
    v_smfmac_f32_16x16x64_bf16 v[60:63], v[84:87], v[72:79], v6
    ds_read_b128 v[72:75], v9 offset:6144
    s_waitcnt lgkmcnt(4)
    v_smfmac_f32_16x16x64_bf16 v[48:51], v[88:91], a[240:247], v6
    ds_read_b128 v[76:79], v9 offset:7168
    v_smfmac_f32_16x16x64_bf16 v[60:63], v[88:91], v[112:119], v6
    ds_read_b128 v[112:115], v9 offset:10240
    s_waitcnt lgkmcnt(5)
    v_smfmac_f32_16x16x64_bf16 v[48:51], v[92:95], a[248:255], v6
    ds_read_b128 v[116:119], v9 offset:11264
    s_waitcnt lgkmcnt(5)
    v_smfmac_f32_16x16x64_bf16 v[48:51], v[100:103], v[128:135], v6
    s_waitcnt lgkmcnt(4)
    v_smfmac_f32_16x16x64_bf16 v[48:51], v[104:107], v[136:143], v6
    v_smfmac_f32_16x16x64_bf16 v[56:59], v[84:87], v[208:215], v6
    s_waitcnt lgkmcnt(2)
    v_smfmac_f32_16x16x64_bf16 v[60:63], v[92:95], v[72:79], v6
    ds_read_b128 v[72:75], v9 offset:12288
    v_cvt_pk_bf16_f32 v108, v48, v49
    v_smfmac_f32_16x16x64_bf16 v[56:59], v[88:91], v[216:223], v6
    ds_read_b128 v[76:79], v9 offset:13312
    v_cvt_pk_bf16_f32 v109, v50, v51
    v_smfmac_f32_16x16x64_bf16 v[56:59], v[92:95], v[224:231], v6
    v_smfmac_f32_16x16x64_bf16 v[56:59], v[100:103], v[240:247], v6
    v_smfmac_f32_16x16x64_bf16 v[56:59], v[104:107], v[248:255], v6
    s_waitcnt lgkmcnt(2)
    v_smfmac_f32_16x16x64_bf16 v[60:63], v[100:103], v[112:119], v6
    s_waitcnt lgkmcnt(0)
    v_smfmac_f32_16x16x64_bf16 v[60:63], v[104:107], v[72:79], v6
    v_cvt_pk_bf16_f32 v110, v56, v57
    v_smfmac_f32_16x16x64_bf16 v[52:55], v[84:87], v[152:159], v6
    v_cvt_pk_bf16_f32 v111, v58, v59
    v_smfmac_f32_16x16x64_bf16 v[52:55], v[88:91], v[160:167], v6
    v_cvt_pk_bf16_f32 v114, v60, v61
    v_mfma_f32_16x16x32_bf16 v[48:51], v[108:111], v[20:23], 0
    ds_read2_b32 v[108:109], v17 offset0:0 offset1:32
    v_cvt_pk_bf16_f32 v115, v62, v63
    v_mov_b32 v72, 0
    v_smfmac_f32_16x16x64_bf16 v[52:55], v[92:95], v[168:175], v6
    ds_read2_b32 v[110:111], v17 offset0:1 offset1:33
    v_mov_b32 v73, 0
    v_smfmac_f32_16x16x64_bf16 v[52:55], v[100:103], v[184:191], v6
    v_mov_b32 v74, 0
    v_smfmac_f32_16x16x64_bf16 v[52:55], v[104:107], v[192:199], v6
    v_smfmac_f32_16x16x64_bf16 v[64:67], v[80:83], a[0:7], v6
    v_smfmac_f32_16x16x64_bf16 v[68:71], v[80:83], a[112:119], v6
    v_cvt_pk_bf16_f32 v116, v48, v49
    v_cvt_pk_bf16_f32 v117, v50, v51
    v_cvt_pk_bf16_f32 v112, v52, v53
    v_cvt_pk_bf16_f32 v113, v54, v55
    v_mov_b32 v75, 0
    v_mov_b32 v76, 0
    v_mfma_f32_16x16x32_bf16 v[52:55], v[112:115], v[20:23], 0
    s_waitcnt lgkmcnt(0)
    v_mov_b32 v77, 0
    v_smfmac_f32_16x16x64_bf16 v[64:67], v[84:87], a[8:15], v6
    v_smfmac_f32_16x16x64_bf16 v[68:71], v[84:87], a[120:127], v6
    v_cvt_pk_bf16_f32 v118, v52, v53
    v_cvt_pk_bf16_f32 v119, v54, v55
    v_mov_b32 v78, 0
    v_mov_b32 v79, 0
    v_mfma_f32_16x16x32_bf16 v[56:59], v[116:119], v[108:111], 0
    v_smfmac_f32_16x16x64_bf16 v[64:67], v[88:91], a[16:23], v6
    v_smfmac_f32_16x16x64_bf16 v[68:71], v[88:91], a[128:135], v6
    ds_write_b128 v18, v[56:59]
    v_smfmac_f32_16x16x64_bf16 v[64:67], v[92:95], a[24:31], v6
    s_branch LA_kt
LA_k1:
    ds_read_b128 v[72:75], v9 offset:2048
    ds_read_b128 v[76:79], v9 offset:3072
    ds_read_b128 v[112:115], v9 offset:10240
    ds_read_b128 v[116:119], v9 offset:11264
    v_mov_b32 v48, 0
    v_mov_b32 v49, 0
    v_mov_b32 v50, 0
    v_mov_b32 v51, 0
    v_mov_b32 v52, 0
    v_mov_b32 v53, 0
    v_mov_b32 v54, 0
    v_mov_b32 v55, 0
    v_mov_b32 v56, 0
    v_mov_b32 v57, 0
    v_mov_b32 v58, 0
    v_mov_b32 v59, 0
    v_mov_b32 v60, 0
    v_mov_b32 v61, 0
    v_mov_b32 v62, 0
    v_mov_b32 v63, 0
    v_mov_b32 v64, 0
    v_mov_b32 v65, 0
    v_mov_b32 v66, 0
    v_mov_b32 v67, 0
    v_mov_b32 v68, 0
    v_mov_b32 v69, 0
    v_mov_b32 v70, 0
    v_mov_b32 v71, 0
    s_waitcnt vmcnt(0) lgkmcnt(0)
    v_cmp_eq_u32 vcc, -1, v0
    s_mov_b32 s70, 0
    s_cbranch_vccz Lmpoll_41
    s_mov_b32 s70, 0
Lpoll_43:
    buffer_load_dword v0, off, s[8:11], s53 sc1
    s_add_u32 s70, s70, 1
    s_cmp_gt_u32 s70, 131072
    s_cbranch_scc1 Lfail
    s_waitcnt vmcnt(0)
    v_cmp_eq_u32 vcc, -1, v0
    s_cbranch_vccnz Lpoll_43
Lmpoll_41:
    buffer_load_dwordx4 v[84:87], v7, s[8:11], s33 offen sc1
    buffer_load_dwordx4 v[100:103], v8, s[8:11], s33 offen sc1
    s_add_u32 s70, s70, 1
    s_cmp_gt_u32 s70, 262144
    s_cbranch_scc1 Lfail
    s_waitcnt vmcnt(1)
    ds_write_b128 v7, v[84:87] offset:0
    v_max3_u32 v16, v84, v85, v86
    s_waitcnt vmcnt(0)
    v_max3_u32 v16, v16, v87, v100
    v_max3_u32 v16, v16, v101, v102
    v_max_u32 v16, v16, v103
    v_cmp_eq_u32 vcc, -1, v16
    ds_write_b128 v8, v[100:103] offset:0
    s_cbranch_vccnz Lmpoll_41
    v_smfmac_f32_16x16x64_bf16 v[60:63], v[84:87], v[72:79], v6
    ds_read_b128 v[72:75], v9 offset:0
    v_smfmac_f32_16x16x64_bf16 v[60:63], v[100:103], v[112:119], v6
    ds_read_b128 v[76:79], v9 offset:1024
    v_smfmac_f32_16x16x64_bf16 v[48:51], v[84:87], a[232:239], v6
    ds_read_b128 v[112:115], v9 offset:4096
    v_smfmac_f32_16x16x64_bf16 v[48:51], v[100:103], v[128:135], v6
    ds_read_b128 v[116:119], v9 offset:5120
    v_smfmac_f32_16x16x64_bf16 v[56:59], v[84:87], v[208:215], v6
    v_smfmac_f32_16x16x64_bf16 v[56:59], v[100:103], v[240:247], v6
    s_waitcnt lgkmcnt(4)
    s_barrier
    ds_read_b128 v[80:83], v1 offset:0
    ds_read_b128 v[88:91], v1 offset:2048
    v_smfmac_f32_16x16x64_bf16 v[52:55], v[84:87], v[152:159], v6
    ds_read_b128 v[92:95], v1 offset:3072
    v_smfmac_f32_16x16x64_bf16 v[52:55], v[100:103], v[184:191], v6
    ds_read_b128 v[96:99], v1 offset:4096
    ds_read_b128 v[104:107], v1 offset:6144
    s_waitcnt lgkmcnt(4)
    v_smfmac_f32_16x16x64_bf16 v[48:51], v[80:83], a[224:231], v6
    v_smfmac_f32_16x16x64_bf16 v[60:63], v[80:83], v[72:79], v6
    ds_read_b128 v[72:75], v9 offset:6144
    s_waitcnt lgkmcnt(4)
    v_smfmac_f32_16x16x64_bf16 v[48:51], v[88:91], a[240:247], v6
    ds_read_b128 v[76:79], v9 offset:7168
    v_smfmac_f32_16x16x64_bf16 v[60:63], v[88:91], v[112:119], v6
    ds_read_b128 v[112:115], v9 offset:8192
    s_waitcnt lgkmcnt(5)
    v_smfmac_f32_16x16x64_bf16 v[48:51], v[92:95], a[248:255], v6
    ds_read_b128 v[116:119], v9 offset:9216
    s_waitcnt lgkmcnt(5)
    v_smfmac_f32_16x16x64_bf16 v[48:51], v[96:99], v[120:127], v6
    s_waitcnt lgkmcnt(4)
    v_smfmac_f32_16x16x64_bf16 v[48:51], v[104:107], v[136:143], v6
    v_smfmac_f32_16x16x64_bf16 v[56:59], v[80:83], v[200:207], v6
    s_waitcnt lgkmcnt(2)
    v_smfmac_f32_16x16x64_bf16 v[60:63], v[92:95], v[72:79], v6
    ds_read_b128 v[72:75], v9 offset:12288
    v_cvt_pk_bf16_f32 v108, v48, v49
    v_smfmac_f32_16x16x64_bf16 v[56:59], v[88:91], v[216:223], v6
    ds_read_b128 v[76:79], v9 offset:13312
    v_cvt_pk_bf16_f32 v109, v50, v51
    v_smfmac_f32_16x16x64_bf16 v[56:59], v[92:95], v[224:231], v6
    v_smfmac_f32_16x16x64_bf16 v[56:59], v[96:99], v[232:239], v6
    v_smfmac_f32_16x16x64_bf16 v[56:59], v[104:107], v[248:255], v6
    s_waitcnt lgkmcnt(2)
    v_smfmac_f32_16x16x64_bf16 v[60:63], v[96:99], v[112:119], v6
    s_waitcnt lgkmcnt(0)
    v_smfmac_f32_16x16x64_bf16 v[60:63], v[104:107], v[72:79], v6
    v_cvt_pk_bf16_f32 v110, v56, v57
    v_smfmac_f32_16x16x64_bf16 v[52:55], v[80:83], v[144:151], v6
    v_cvt_pk_bf16_f32 v111, v58, v59
    v_smfmac_f32_16x16x64_bf16 v[52:55], v[88:91], v[160:167], v6
    v_cvt_pk_bf16_f32 v114, v60, v61
    v_mfma_f32_16x16x32_bf16 v[48:51], v[108:111], v[20:23], 0
    ds_read2_b32 v[108:109], v17 offset0:0 offset1:32
    v_cvt_pk_bf16_f32 v115, v62, v63
    v_mov_b32 v72, 0
    v_smfmac_f32_16x16x64_bf16 v[52:55], v[92:95], v[168:175], v6
    ds_read2_b32 v[110:111], v17 offset0:1 offset1:33
    v_mov_b32 v73, 0
    v_smfmac_f32_16x16x64_bf16 v[52:55], v[96:99], v[176:183], v6
    v_mov_b32 v74, 0
    v_smfmac_f32_16x16x64_bf16 v[52:55], v[104:107], v[192:199], v6
    v_smfmac_f32_16x16x64_bf16 v[64:67], v[80:83], a[0:7], v6
    v_smfmac_f32_16x16x64_bf16 v[68:71], v[80:83], a[112:119], v6
    v_cvt_pk_bf16_f32 v116, v48, v49
    v_cvt_pk_bf16_f32 v117, v50, v51
    v_cvt_pk_bf16_f32 v112, v52, v53
    v_cvt_pk_bf16_f32 v113, v54, v55
    v_mov_b32 v75, 0
    v_mov_b32 v76, 0
    v_mfma_f32_16x16x32_bf16 v[52:55], v[112:115], v[20:23], 0
    s_waitcnt lgkmcnt(0)
    v_mov_b32 v77, 0
    v_smfmac_f32_16x16x64_bf16 v[64:67], v[84:87], a[8:15], v6
    v_smfmac_f32_16x16x64_bf16 v[68:71], v[84:87], a[120:127], v6
    v_cvt_pk_bf16_f32 v118, v52, v53
    v_cvt_pk_bf16_f32 v119, v54, v55
    v_mov_b32 v78, 0
    v_mov_b32 v79, 0
    v_mfma_f32_16x16x32_bf16 v[56:59], v[116:119], v[108:111], 0
    v_smfmac_f32_16x16x64_bf16 v[64:67], v[88:91], a[16:23], v6
    v_smfmac_f32_16x16x64_bf16 v[68:71], v[88:91], a[128:135], v6
    ds_write_b128 v18, v[56:59]
    v_smfmac_f32_16x16x64_bf16 v[64:67], v[92:95], a[24:31], v6
    s_branch LA_kt
LA_k2:
    ds_read_b128 v[72:75], v9 offset:4096
    ds_read_b128 v[76:79], v9 offset:5120
    ds_read_b128 v[112:115], v9 offset:12288
    ds_read_b128 v[116:119], v9 offset:13312
    v_mov_b32 v48, 0
    v_mov_b32 v49, 0
    v_mov_b32 v50, 0
    v_mov_b32 v51, 0
    v_mov_b32 v52, 0
    v_mov_b32 v53, 0
    v_mov_b32 v54, 0
    v_mov_b32 v55, 0
    v_mov_b32 v56, 0
    v_mov_b32 v57, 0
    v_mov_b32 v58, 0
    v_mov_b32 v59, 0
    v_mov_b32 v60, 0
    v_mov_b32 v61, 0
    v_mov_b32 v62, 0
    v_mov_b32 v63, 0
    v_mov_b32 v64, 0
    v_mov_b32 v65, 0
    v_mov_b32 v66, 0
    v_mov_b32 v67, 0
    v_mov_b32 v68, 0
    v_mov_b32 v69, 0
    v_mov_b32 v70, 0
    v_mov_b32 v71, 0
    s_waitcnt vmcnt(0) lgkmcnt(0)
    v_cmp_eq_u32 vcc, -1, v0
    s_mov_b32 s70, 0
    s_cbranch_vccz Lmpoll_44
    s_mov_b32 s70, 0
Lpoll_46:
    buffer_load_dword v0, off, s[8:11], s53 sc1
    s_add_u32 s70, s70, 1
    s_cmp_gt_u32 s70, 131072
    s_cbranch_scc1 Lfail
    s_waitcnt vmcnt(0)
    v_cmp_eq_u32 vcc, -1, v0
    s_cbranch_vccnz Lpoll_46
Lmpoll_44:
    buffer_load_dwordx4 v[88:91], v7, s[8:11], s33 offen sc1
    buffer_load_dwordx4 v[104:107], v8, s[8:11], s33 offen sc1
    s_add_u32 s70, s70, 1
    s_cmp_gt_u32 s70, 262144
    s_cbranch_scc1 Lfail
    s_waitcnt vmcnt(1)
    ds_write_b128 v7, v[88:91] offset:0
    v_max3_u32 v16, v88, v89, v90
    s_waitcnt vmcnt(0)
    v_max3_u32 v16, v16, v91, v104
    v_max3_u32 v16, v16, v105, v106
    v_max_u32 v16, v16, v107
    v_cmp_eq_u32 vcc, -1, v16
    ds_write_b128 v8, v[104:107] offset:0
    s_cbranch_vccnz Lmpoll_44
    v_smfmac_f32_16x16x64_bf16 v[60:63], v[88:91], v[72:79], v6
    ds_read_b128 v[72:75], v9 offset:0
    v_smfmac_f32_16x16x64_bf16 v[60:63], v[104:107], v[112:119], v6
    ds_read_b128 v[76:79], v9 offset:1024
    v_smfmac_f32_16x16x64_bf16 v[48:51], v[88:91], a[240:247], v6
    ds_read_b128 v[112:115], v9 offset:2048
    v_smfmac_f32_16x16x64_bf16 v[48:51], v[104:107], v[136:143], v6
    ds_read_b128 v[116:119], v9 offset:3072
    v_smfmac_f32_16x16x64_bf16 v[56:59], v[88:91], v[216:223], v6
    v_smfmac_f32_16x16x64_bf16 v[56:59], v[104:107], v[248:255], v6
    s_waitcnt lgkmcnt(4)
    s_barrier
    ds_read_b128 v[80:83], v1 offset:0
    ds_read_b128 v[84:87], v1 offset:1024
    v_smfmac_f32_16x16x64_bf16 v[52:55], v[88:91], v[160:167], v6
    ds_read_b128 v[92:95], v1 offset:3072
    v_smfmac_f32_16x16x64_bf16 v[52:55], v[104:107], v[192:199], v6
    ds_read_b128 v[96:99], v1 offset:4096
    ds_read_b128 v[100:103], v1 offset:5120
    s_waitcnt lgkmcnt(4)
    v_smfmac_f32_16x16x64_bf16 v[48:51], v[80:83], a[224:231], v6
    v_smfmac_f32_16x16x64_bf16 v[60:63], v[80:83], v[72:79], v6
    ds_read_b128 v[72:75], v9 offset:6144
    s_waitcnt lgkmcnt(4)
    v_smfmac_f32_16x16x64_bf16 v[48:51], v[84:87], a[232:239], v6
    ds_read_b128 v[76:79], v9 offset:7168
    v_smfmac_f32_16x16x64_bf16 v[60:63], v[84:87], v[112:119], v6
    ds_read_b128 v[112:115], v9 offset:8192
    s_waitcnt lgkmcnt(5)
    v_smfmac_f32_16x16x64_bf16 v[48:51], v[92:95], a[248:255], v6
    ds_read_b128 v[116:119], v9 offset:9216
    s_waitcnt lgkmcnt(5)
    v_smfmac_f32_16x16x64_bf16 v[48:51], v[96:99], v[120:127], v6
    s_waitcnt lgkmcnt(4)
    v_smfmac_f32_16x16x64_bf16 v[48:51], v[100:103], v[128:135], v6
    v_smfmac_f32_16x16x64_bf16 v[56:59], v[80:83], v[200:207], v6
    s_waitcnt lgkmcnt(2)
    v_smfmac_f32_16x16x64_bf16 v[60:63], v[92:95], v[72:79], v6
    ds_read_b128 v[72:75], v9 offset:10240
    v_cvt_pk_bf16_f32 v108, v48, v49
    v_smfmac_f32_16x16x64_bf16 v[56:59], v[84:87], v[208:215], v6
    ds_read_b128 v[76:79], v9 offset:11264
    v_cvt_pk_bf16_f32 v109, v50, v51
    v_smfmac_f32_16x16x64_bf16 v[56:59], v[92:95], v[224:231], v6
    v_smfmac_f32_16x16x64_bf16 v[56:59], v[96:99], v[232:239], v6
    v_smfmac_f32_16x16x64_bf16 v[56:59], v[100:103], v[240:247], v6
    s_waitcnt lgkmcnt(2)
    v_smfmac_f32_16x16x64_bf16 v[60:63], v[96:99], v[112:119], v6
    s_waitcnt lgkmcnt(0)
    v_smfmac_f32_16x16x64_bf16 v[60:63], v[100:103], v[72:79], v6
    v_cvt_pk_bf16_f32 v110, v56, v57
    v_smfmac_f32_16x16x64_bf16 v[52:55], v[80:83], v[144:151], v6
    v_cvt_pk_bf16_f32 v111, v58, v59
    v_smfmac_f32_16x16x64_bf16 v[52:55], v[84:87], v[152:159], v6
    v_cvt_pk_bf16_f32 v114, v60, v61
    v_mfma_f32_16x16x32_bf16 v[48:51], v[108:111], v[20:23], 0
    ds_read2_b32 v[108:109], v17 offset0:0 offset1:32
    v_cvt_pk_bf16_f32 v115, v62, v63
    v_mov_b32 v72, 0
    v_smfmac_f32_16x16x64_bf16 v[52:55], v[92:95], v[168:175], v6
    ds_read2_b32 v[110:111], v17 offset0:1 offset1:33
    v_mov_b32 v73, 0
    v_smfmac_f32_16x16x64_bf16 v[52:55], v[96:99], v[176:183], v6
    v_mov_b32 v74, 0
    v_smfmac_f32_16x16x64_bf16 v[52:55], v[100:103], v[184:191], v6
    v_smfmac_f32_16x16x64_bf16 v[64:67], v[80:83], a[0:7], v6
    v_smfmac_f32_16x16x64_bf16 v[68:71], v[80:83], a[112:119], v6
    v_cvt_pk_bf16_f32 v116, v48, v49
    v_cvt_pk_bf16_f32 v117, v50, v51
    v_cvt_pk_bf16_f32 v112, v52, v53
    v_cvt_pk_bf16_f32 v113, v54, v55
    v_mov_b32 v75, 0
    v_mov_b32 v76, 0
    v_mfma_f32_16x16x32_bf16 v[52:55], v[112:115], v[20:23], 0
    s_waitcnt lgkmcnt(0)
    v_mov_b32 v77, 0
    v_smfmac_f32_16x16x64_bf16 v[64:67], v[84:87], a[8:15], v6
    v_smfmac_f32_16x16x64_bf16 v[68:71], v[84:87], a[120:127], v6
    v_cvt_pk_bf16_f32 v118, v52, v53
    v_cvt_pk_bf16_f32 v119, v54, v55
    v_mov_b32 v78, 0
    v_mov_b32 v79, 0
    v_mfma_f32_16x16x32_bf16 v[56:59], v[116:119], v[108:111], 0
    v_smfmac_f32_16x16x64_bf16 v[64:67], v[88:91], a[16:23], v6
    v_smfmac_f32_16x16x64_bf16 v[68:71], v[88:91], a[128:135], v6
    ds_write_b128 v18, v[56:59]
    v_smfmac_f32_16x16x64_bf16 v[64:67], v[92:95], a[24:31], v6
    s_branch LA_kt
LA_k3:
    ds_read_b128 v[72:75], v9 offset:6144
    ds_read_b128 v[76:79], v9 offset:7168
    ds_read_b128 v[112:115], v9 offset:0
    ds_read_b128 v[116:119], v9 offset:1024
    v_mov_b32 v48, 0
    v_mov_b32 v49, 0
    v_mov_b32 v50, 0
    v_mov_b32 v51, 0
    v_mov_b32 v52, 0
    v_mov_b32 v53, 0
    v_mov_b32 v54, 0
    v_mov_b32 v55, 0
    v_mov_b32 v56, 0
    v_mov_b32 v57, 0
    v_mov_b32 v58, 0
    v_mov_b32 v59, 0
    v_mov_b32 v60, 0
    v_mov_b32 v61, 0
    v_mov_b32 v62, 0
    v_mov_b32 v63, 0
    v_mov_b32 v64, 0
    v_mov_b32 v65, 0
    v_mov_b32 v66, 0
    v_mov_b32 v67, 0
    v_mov_b32 v68, 0
    v_mov_b32 v69, 0
    v_mov_b32 v70, 0
    v_mov_b32 v71, 0
    s_waitcnt vmcnt(0) lgkmcnt(0)
    v_cmp_eq_u32 vcc, -1, v0
    s_mov_b32 s70, 0
    s_cbranch_vccz Lmpoll_47
    s_mov_b32 s70, 0
Lpoll_49:
    buffer_load_dword v0, off, s[8:11], s53 sc1
    s_add_u32 s70, s70, 1
    s_cmp_gt_u32 s70, 131072
    s_cbranch_scc1 Lfail
    s_waitcnt vmcnt(0)
    v_cmp_eq_u32 vcc, -1, v0
    s_cbranch_vccnz Lpoll_49
Lmpoll_47:
    buffer_load_dwordx4 v[92:95], v7, s[8:11], s33 offen sc1
    buffer_load_dwordx4 v[80:83], v8, s[8:11], s33 offen sc1
    s_add_u32 s70, s70, 1
    s_cmp_gt_u32 s70, 262144
    s_cbranch_scc1 Lfail
    s_waitcnt vmcnt(1)
    ds_write_b128 v7, v[92:95] offset:0
    v_max3_u32 v16, v92, v93, v94
    s_waitcnt vmcnt(0)
    v_max3_u32 v16, v16, v95, v80
    v_max3_u32 v16, v16, v81, v82
    v_max_u32 v16, v16, v83
    v_cmp_eq_u32 vcc, -1, v16
    ds_write_b128 v8, v[80:83] offset:0
    s_cbranch_vccnz Lmpoll_47
    v_smfmac_f32_16x16x64_bf16 v[60:63], v[92:95], v[72:79], v6
    ds_read_b128 v[72:75], v9 offset:2048
    v_smfmac_f32_16x16x64_bf16 v[60:63], v[80:83], v[112:119], v6
    ds_read_b128 v[76:79], v9 offset:3072
    v_smfmac_f32_16x16x64_bf16 v[48:51], v[92:95], a[248:255], v6
    ds_read_b128 v[112:115], v9 offset:4096
    v_smfmac_f32_16x16x64_bf16 v[48:51], v[80:83], a[224:231], v6
    ds_read_b128 v[116:119], v9 offset:5120
    v_smfmac_f32_16x16x64_bf16 v[56:59], v[92:95], v[224:231], v6
    v_smfmac_f32_16x16x64_bf16 v[56:59], v[80:83], v[200:207], v6
    s_waitcnt lgkmcnt(4)
    s_barrier
    ds_read_b128 v[84:87], v1 offset:1024
    ds_read_b128 v[88:91], v1 offset:2048
    v_smfmac_f32_16x16x64_bf16 v[52:55], v[92:95], v[168:175], v6
    ds_read_b128 v[96:99], v1 offset:4096
    v_smfmac_f32_16x16x64_bf16 v[52:55], v[80:83], v[144:151], v6
    ds_read_b128 v[100:103], v1 offset:5120
    ds_read_b128 v[104:107], v1 offset:6144
    s_waitcnt lgkmcnt(4)
    v_smfmac_f32_16x16x64_bf16 v[48:51], v[84:87], a[232:239], v6
    v_smfmac_f32_16x16x64_bf16 v[60:63], v[84:87], v[72:79], v6
    ds_read_b128 v[72:75], v9 offset:8192
    s_waitcnt lgkmcnt(4)
    v_smfmac_f32_16x16x64_bf16 v[48:51], v[88:91], a[240:247], v6
    ds_read_b128 v[76:79], v9 offset:9216
    v_smfmac_f32_16x16x64_bf16 v[60:63], v[88:91], v[112:119], v6
    ds_read_b128 v[112:115], v9 offset:10240
    s_waitcnt lgkmcnt(5)
    v_smfmac_f32_16x16x64_bf16 v[48:51], v[96:99], v[120:127], v6
    ds_read_b128 v[116:119], v9 offset:11264
    s_waitcnt lgkmcnt(5)
    v_smfmac_f32_16x16x64_bf16 v[48:51], v[100:103], v[128:135], v6
    s_waitcnt lgkmcnt(4)
    v_smfmac_f32_16x16x64_bf16 v[48:51], v[104:107], v[136:143], v6
    v_smfmac_f32_16x16x64_bf16 v[56:59], v[84:87], v[208:215], v6
    s_waitcnt lgkmcnt(2)
    v_smfmac_f32_16x16x64_bf16 v[60:63], v[96:99], v[72:79], v6
    ds_read_b128 v[72:75], v9 offset:12288
    v_cvt_pk_bf16_f32 v108, v48, v49
    v_smfmac_f32_16x16x64_bf16 v[56:59], v[88:91], v[216:223], v6
    ds_read_b128 v[76:79], v9 offset:13312
    v_cvt_pk_bf16_f32 v109, v50, v51
    v_smfmac_f32_16x16x64_bf16 v[56:59], v[96:99], v[232:239], v6
    v_smfmac_f32_16x16x64_bf16 v[56:59], v[100:103], v[240:247], v6
    v_smfmac_f32_16x16x64_bf16 v[56:59], v[104:107], v[248:255], v6
    s_waitcnt lgkmcnt(2)
    v_smfmac_f32_16x16x64_bf16 v[60:63], v[100:103], v[112:119], v6
    s_waitcnt lgkmcnt(0)
    v_smfmac_f32_16x16x64_bf16 v[60:63], v[104:107], v[72:79], v6
    v_cvt_pk_bf16_f32 v110, v56, v57
    v_smfmac_f32_16x16x64_bf16 v[52:55], v[84:87], v[152:159], v6
    v_cvt_pk_bf16_f32 v111, v58, v59
    v_smfmac_f32_16x16x64_bf16 v[52:55], v[88:91], v[160:167], v6
    v_cvt_pk_bf16_f32 v114, v60, v61
    v_mfma_f32_16x16x32_bf16 v[48:51], v[108:111], v[20:23], 0
    ds_read2_b32 v[108:109], v17 offset0:0 offset1:32
    v_cvt_pk_bf16_f32 v115, v62, v63
    v_mov_b32 v72, 0
    v_smfmac_f32_16x16x64_bf16 v[52:55], v[96:99], v[176:183], v6
    ds_read2_b32 v[110:111], v17 offset0:1 offset1:33
    v_mov_b32 v73, 0
    v_smfmac_f32_16x16x64_bf16 v[52:55], v[100:103], v[184:191], v6
    v_mov_b32 v74, 0
    v_smfmac_f32_16x16x64_bf16 v[52:55], v[104:107], v[192:199], v6
    v_smfmac_f32_16x16x64_bf16 v[64:67], v[80:83], a[0:7], v6
    v_smfmac_f32_16x16x64_bf16 v[68:71], v[80:83], a[112:119], v6
    v_cvt_pk_bf16_f32 v116, v48, v49
    v_cvt_pk_bf16_f32 v117, v50, v51
    v_cvt_pk_bf16_f32 v112, v52, v53
    v_cvt_pk_bf16_f32 v113, v54, v55
    v_mov_b32 v75, 0
    v_mov_b32 v76, 0
    v_mfma_f32_16x16x32_bf16 v[52:55], v[112:115], v[20:23], 0
    s_waitcnt lgkmcnt(0)
    v_mov_b32 v77, 0
    v_smfmac_f32_16x16x64_bf16 v[64:67], v[84:87], a[8:15], v6
    v_smfmac_f32_16x16x64_bf16 v[68:71], v[84:87], a[120:127], v6
    v_cvt_pk_bf16_f32 v118, v52, v53
    v_cvt_pk_bf16_f32 v119, v54, v55
    v_mov_b32 v78, 0
    v_mov_b32 v79, 0
    v_mfma_f32_16x16x32_bf16 v[56:59], v[116:119], v[108:111], 0
    v_smfmac_f32_16x16x64_bf16 v[64:67], v[88:91], a[16:23], v6
    v_smfmac_f32_16x16x64_bf16 v[68:71], v[88:91], a[128:135], v6
    ds_write_b128 v18, v[56:59]
    v_smfmac_f32_16x16x64_bf16 v[64:67], v[92:95], a[24:31], v6
LA_kt:
    v_smfmac_f32_16x16x64_bf16 v[68:71], v[92:95], a[136:143], v6
    v_smfmac_f32_16x16x64_bf16 v[64:67], v[96:99], a[32:39], v6
    v_smfmac_f32_16x16x64_bf16 v[68:71], v[96:99], a[144:151], v6
    v_smfmac_f32_16x16x64_bf16 v[64:67], v[100:103], a[40:47], v6
    s_waitcnt lgkmcnt(0)
    s_barrier
    ds_read2_b32 v[30:31], v19 offset0:0 offset1:160
    v_smfmac_f32_16x16x64_bf16 v[68:71], v[100:103], a[152:159], v6
    buffer_load_dwordx4 v[108:111], v1, s[8:11], s40 offen offset:0 sc1
    v_smfmac_f32_16x16x64_bf16 v[64:67], v[104:107], a[48:55], v6
    buffer_load_dwordx4 v[112:115], v1, s[8:11], s40 offen offset:1024 sc1
    v_smfmac_f32_16x16x64_bf16 v[68:71], v[104:107], a[160:167], v6
    s_cmp_ge_u32 s27, 28
    s_waitcnt lgkmcnt(0)
    v_add_f32 v30, v30, v31
    v_smfmac_f32_16x16x64_bf16 v[72:75], v[80:83], a[56:63], v6
    s_nop 0
    v_add_f32_dpp v30, v30, v30 quad_perm:[1,0,3,2] row_mask:0xf bank_mask:0xf
    v_smfmac_f32_16x16x64_bf16 v[76:79], v[80:83], a[168:175], v6
    s_nop 0
    v_add_f32_dpp v30, v30, v30 quad_perm:[2,3,0,1] row_mask:0xf bank_mask:0xf
    buffer_store_dword v30, v24, s[8:11], s36 offen
    s_cbranch_scc1 LB_after
    v_smfmac_f32_16x16x64_bf16 v[72:75], v[84:87], a[64:71], v6
    v_permlane32_swap_b32 v64, v68
    v_smfmac_f32_16x16x64_bf16 v[76:79], v[84:87], a[176:183], v6
    v_permlane32_swap_b32 v65, v69
    v_smfmac_f32_16x16x64_bf16 v[72:75], v[88:91], a[72:79], v6
    v_permlane32_swap_b32 v66, v70
    v_smfmac_f32_16x16x64_bf16 v[76:79], v[88:91], a[184:191], v6
    v_permlane32_swap_b32 v67, v71
    v_smfmac_f32_16x16x64_bf16 v[72:75], v[92:95], a[80:87], v6
    v_add_f32 v64, v64, v68
    v_smfmac_f32_16x16x64_bf16 v[76:79], v[92:95], a[192:199], v6
    v_add_f32 v65, v65, v69
    v_smfmac_f32_16x16x64_bf16 v[72:75], v[96:99], a[88:95], v6
    v_add_f32 v66, v66, v70
    buffer_load_dword v30, v27, s[8:11], s41 offen offset:0 sc1
    buffer_load_dword v31, v27, s[8:11], s41 offen offset:4 sc1
    buffer_load_dwordx4 v[80:83], v1, s[8:11], s38 offen sc1
    buffer_load_dwordx4 v[84:87], v1, s[8:11], s39 offen sc1
    v_smfmac_f32_16x16x64_bf16 v[76:79], v[96:99], a[200:207], v6
    v_add_f32 v67, v67, v71
    s_waitcnt vmcnt(5)
Leok_50:
    v_mfma_f32_16x16x32_bf16 v[48:51], v[108:111], v[32:35], 0
    v_max3_u32 v16, v108, v109, v110
    v_max3_u32 v16, v16, v111, v112
    v_mfma_f32_16x16x32_bf16 v[52:55], v[112:115], v[36:39], 0
    v_max3_u32 v16, v16, v113, v114
    v_max_u32 v16, v16, v115
    v_mfma_f32_16x16x32_bf16 v[56:59], v[108:111], v[40:43], 0
    v_cmp_eq_u32 vcc, -1, v16
    v_mfma_f32_16x16x32_bf16 v[60:63], v[112:115], v[44:47], 0
    s_cbranch_vccnz Leretry_51
    v_smfmac_f32_16x16x64_bf16 v[72:75], v[100:103], a[96:103], v6
    v_cvt_pk_bf16_f32 v64, v64, v65
    v_smfmac_f32_16x16x64_bf16 v[76:79], v[100:103], a[208:215], v6
    v_cvt_pk_bf16_f32 v65, v66, v67
    v_smfmac_f32_16x16x64_bf16 v[72:75], v[104:107], a[104:111], v6
    v_cvt_pk_bf16_f32 v88, v48, v49
    buffer_load_dwordx4 v[68:71], v1, s[8:11], s38 offen sc1
    buffer_load_dwordx4 v[112:115], v1, s[8:11], s39 offen sc1
    v_smfmac_f32_16x16x64_bf16 v[76:79], v[104:107], a[216:223], v6
    v_cvt_pk_bf16_f32 v89, v50, v51
    v_cvt_pk_bf16_f32 v90, v52, v53
    v_cvt_pk_bf16_f32 v91, v54, v55
    v_cvt_pk_bf16_f32 v108, v56, v57
    v_cvt_pk_bf16_f32 v109, v58, v59
    v_cvt_pk_bf16_f32 v110, v60, v61
    v_cvt_pk_bf16_f32 v111, v62, v63
    v_cndmask_b32 v88, v108, v88, s[100:101]
    v_cndmask_b32 v90, v110, v90, s[100:101]
    v_cndmask_b32 v89, v109, v89, s[100:101]
    v_cndmask_b32 v91, v111, v91, s[100:101]
    v_permlane16_swap_b32 v88, v90
    v_permlane32_swap_b32 v72, v76
    v_permlane16_swap_b32 v89, v91
    v_permlane32_swap_b32 v73, v77
    v_permlane32_swap_b32 v74, v78
    v_permlane32_swap_b32 v75, v79
    v_add_f32 v72, v72, v76
    v_add_f32 v73, v73, v77
    v_add_f32 v74, v74, v78
    v_add_f32 v75, v75, v79
    v_cvt_pk_bf16_f32 v66, v72, v73
    v_cvt_pk_bf16_f32 v67, v74, v75
    s_nop 0
    v_permlane16_swap_b32 v64, v66
    v_permlane16_swap_b32 v65, v67
    buffer_store_dwordx4 v[116:119], v1, s[8:11], s50 offen
    ds_write_b128 v7, v[116:119] offset:25600
    s_waitcnt vmcnt(3)
    v_pk_add_f32 v[96:97], v[80:81], v[84:85]
    v_pk_add_f32 v[98:99], v[82:83], v[86:87]
    v_max3_f32 v100, v96, v97, v98
    v_max3_f32 v100, v100, v99, v30
    v_pk_fma_f32 v[104:105], v[96:97], v[30:31], v[98:99]
    v_cmp_u_f32 vcc, v104, v105
    v_max_f32_dpp v100, v100, v100 row_ror:8 row_mask:0xf bank_mask:0xf
    v_sub_f32 v102, v30, v100
    v_pk_add_f32 v[96:97], v[96:97], v[100:101] op_sel_hi:[1,0] neg_lo:[0,1] neg_hi:[0,1]
    v_pk_add_f32 v[98:99], v[98:99], v[100:101] op_sel_hi:[1,0] neg_lo:[0,1] neg_hi:[0,1]
    s_cbranch_vccnz Lsretry_54
Lsok_53:
    v_exp_f32 v96, v96
    v_exp_f32 v97, v97
    v_exp_f32 v98, v98
    v_exp_f32 v99, v99
    v_exp_f32 v102, v102
    v_pk_add_f32 v[104:105], v[96:97], v[98:99]
    v_add_f32 v104, v104, v105
    v_fmac_f32 v104, v102, v31
    v_pk_mul_f32 v[102:103], v[102:103], v[28:29] op_sel_hi:[0,1]
    buffer_store_dword v13, off, s[8:11], s64 sc1
    v_add_f32_dpp v104, v104, v104 row_ror:8 row_mask:0xf bank_mask:0xf
    v_rcp_f32 v104, v104
    s_nop 0
    v_pk_mul_f32 v[96:97], v[96:97], v[104:105] op_sel_hi:[1,0]
    v_pk_mul_f32 v[98:99], v[98:99], v[104:105] op_sel_hi:[1,0]
    v_pk_mul_f32 v[102:103], v[102:103], v[104:105] op_sel_hi:[1,0]
    v_cvt_pk_bf16_f32 v48, v96, v97
    v_cvt_pk_bf16_f32 v49, v98, v99
    v_cvt_pk_bf16_f32 v102, v102, v103
    v_mov_b32_dpp v50, v48 row_ror:8 row_mask:0xf bank_mask:0xf
    v_mov_b32_dpp v51, v49 row_ror:8 row_mask:0xf bank_mask:0xf
    v_cndmask_b32 v92, 0, v102, s[92:93]
    v_cndmask_b32 v93, 0, v102, s[94:95]
    v_mfma_f32_16x16x32_bf16 v[60:63], v[64:67], v[48:51], 0
    v_cndmask_b32 v94, 0, v102, s[96:97]
    v_cndmask_b32 v95, 0, v102, s[98:99]
    s_nop 1
    v_mfma_f32_16x16x32_bf16 v[60:63], v[88:91], v[92:95], v[60:63]
    s_nop 7
    ds_write_b128 v7, v[60:63] offset:8192
    v_mov_b32 v116, v64
    v_mov_b32 v117, v65
    v_mov_b32 v118, v66
    v_mov_b32 v119, v67
    s_cmp_lg_u32 s20, 0
    s_waitcnt lgkmcnt(0)
    s_barrier
    s_cbranch_scc1 Lnored_55
    ds_read_b64 v[52:53], v10 offset:0
    ds_read_b64 v[54:55], v10 offset:1024
    ds_read_b64 v[56:57], v10 offset:2048
    ds_read_b64 v[58:59], v10 offset:3072
    s_waitcnt lgkmcnt(2)
    v_pk_add_f32 v[52:53], v[52:53], v[54:55]
    s_waitcnt lgkmcnt(1)
    v_pk_add_f32 v[52:53], v[52:53], v[56:57]
    s_waitcnt lgkmcnt(0)
    v_pk_add_f32 v[52:53], v[52:53], v[58:59]
    v_cvt_pk_bf16_f32 v52, v52, v53
    buffer_store_dword v52, v13, s[8:11], s34 offen sc1
    s_barrier
    s_waitcnt vmcnt(2)
    s_branch Lred_56
Lnored_55:
    s_barrier
    s_waitcnt vmcnt(1)
Lred_56:
    s_add_u32 s28, s28, 3
    s_add_u32 s32, s32, 86016
    v_xor_b32 v3, 98304, v3
    s_cmp_ge_u32 s28, 64
    s_cbranch_scc1 LA_last
    v_xor_b32 v4, 98304, v4
    v_xor_b32 v5, 98304, v5
    s_add_u32 s29, s29, 1
    s_cmp_eq_u32 s23, 0
    s_cbranch_scc1 LA_have
    s_cmp_eq_u64 s[66:67], 0
    s_cbranch_scc1 Lxsok_57
    buffer_load_dwordx4 v[80:83], v2, s[8:11], s32 offen offset:0 sc1
    buffer_load_dwordx4 v[84:87], v2, s[8:11], s32 offen offset:128 sc1
    buffer_load_dwordx4 v[88:91], v2, s[8:11], s32 offen offset:256 sc1
    buffer_load_dwordx4 v[92:95], v2, s[8:11], s32 offen offset:384 sc1
    buffer_load_dwordx4 v[96:99], v2, s[8:11], s32 offen offset:512 sc1
    buffer_load_dwordx4 v[100:103], v2, s[8:11], s32 offen offset:640 sc1
    buffer_load_dwordx4 v[104:107], v2, s[8:11], s32 offen offset:768 sc1
    s_cmp_eq_u32 s26, 1
    s_cbranch_scc1 Lxsu_59
    s_waitcnt vmcnt(6)
    ds_write_b128 v3, v[80:83] offset:0
    s_waitcnt vmcnt(5)
    ds_write_b128 v3, v[84:87] offset:4096
    s_waitcnt vmcnt(4)
    ds_write_b128 v3, v[88:91] offset:8192
    s_waitcnt vmcnt(3)
    ds_write_b128 v3, v[92:95] offset:12288
    s_waitcnt vmcnt(2)
    ds_write_b128 v3, v[96:99] offset:16384
    s_waitcnt vmcnt(1)
    ds_write_b128 v3, v[100:103] offset:20480
    s_waitcnt vmcnt(0)
    ds_write_b128 v3, v[104:107] offset:24576
    v_max3_u32 v16, v80, v81, v82
    v_max3_u32 v16, v16, v83, v84
    v_max3_u32 v16, v16, v85, v86
    v_max3_u32 v16, v16, v87, v88
    v_max3_u32 v16, v16, v89, v90
    v_max3_u32 v16, v16, v91, v92
    v_max3_u32 v16, v16, v93, v94
    v_max3_u32 v16, v16, v95, v96
    v_max3_u32 v16, v16, v97, v98
    v_max3_u32 v16, v16, v99, v100
    v_max3_u32 v16, v16, v101, v102
    v_max3_u32 v16, v16, v103, v104
    v_max3_u32 v16, v16, v105, v106
    v_max_u32 v16, v16, v107
    v_cmp_eq_u32 vcc, -1, v16
    s_cbranch_vccnz Lxsretry_58
Lxsok_57:
    s_waitcnt lgkmcnt(0)
    s_barrier
LA_have:
    s_branch LA_job
Lxsretry_29:
    s_mul_i32 s58, s25, 37
    s_lshr_b32 s58, s58, 8
    s_mul_i32 s58, s58, 7
    s_sub_u32 s58, s25, s58
    s_lshl_b32 s58, s58, 7
    s_add_u32 s58, s58, s32
    s_mov_b32 s70, 0
Lpoll_61:
    buffer_load_dwordx4 v[80:83], v2, s[8:11], s58 offen sc1
    s_add_u32 s70, s70, 1
    s_cmp_gt_u32 s70, 131072
    s_cbranch_scc1 Lfail
    s_waitcnt vmcnt(0)
    v_max3_u32 v16, v80, v81, v82
    v_max_u32 v16, v16, v83
    v_cmp_eq_u32 vcc, -1, v16
    s_cbranch_vccnz Lpoll_61
    s_mov_b32 s70, 0
Lpoll_62:
    buffer_load_dwordx4 v[80:83], v2, s[8:11], s32 offen offset:0 sc1
    buffer_load_dwordx4 v[84:87], v2, s[8:11], s32 offen offset:128 sc1
    buffer_load_dwordx4 v[88:91], v2, s[8:11], s32 offen offset:256 sc1
    buffer_load_dwordx4 v[92:95], v2, s[8:11], s32 offen offset:384 sc1
    buffer_load_dwordx4 v[96:99], v2, s[8:11], s32 offen offset:512 sc1
    buffer_load_dwordx4 v[100:103], v2, s[8:11], s32 offen offset:640 sc1
    buffer_load_dwordx4 v[104:107], v2, s[8:11], s32 offen offset:768 sc1
    s_add_u32 s70, s70, 1
    s_cmp_gt_u32 s70, 131072
    s_cbranch_scc1 Lfail
    s_waitcnt vmcnt(6)
    v_max3_u32 v16, v80, v81, v82
    s_waitcnt vmcnt(5)
    v_max3_u32 v16, v16, v83, v84
    v_max3_u32 v16, v16, v85, v86
    s_waitcnt vmcnt(4)
    v_max3_u32 v16, v16, v87, v88
    v_max3_u32 v16, v16, v89, v90
    s_waitcnt vmcnt(3)
    v_max3_u32 v16, v16, v91, v92
    v_max3_u32 v16, v16, v93, v94
    s_waitcnt vmcnt(2)
    v_max3_u32 v16, v16, v95, v96
    v_max3_u32 v16, v16, v97, v98
    s_waitcnt vmcnt(1)
    v_max3_u32 v16, v16, v99, v100
    v_max3_u32 v16, v16, v101, v102
    s_waitcnt vmcnt(0)
    v_max3_u32 v16, v16, v103, v104
    v_max3_u32 v16, v16, v105, v106
    v_max_u32 v16, v16, v107
    v_cmp_eq_u32 vcc, -1, v16
    s_cbranch_vccnz Lpoll_62
    ds_write_b128 v3, v[80:83] offset:0
    ds_write_b128 v3, v[84:87] offset:4096
    ds_write_b128 v3, v[88:91] offset:8192
    ds_write_b128 v3, v[92:95] offset:12288
    ds_write_b128 v3, v[96:99] offset:16384
    ds_write_b128 v3, v[100:103] offset:20480
    ds_write_b128 v3, v[104:107] offset:24576
    s_branch Lxsok_28
Lxsu_30:
    s_add_u32 s18, s32, s60
    v_xor_b32 v60, s61, v2
    buffer_load_dwordx4 v[48:51], v60, s[8:11], s18 offen offset:0 sc1
    buffer_load_dwordx4 v[52:55], v60, s[8:11], s18 offen offset:256 sc1
    buffer_load_dwordx4 v[56:59], v60, s[8:11], s18 offen offset:512 sc1
    v_add_u32 v0, s62, v3
    s_waitcnt vmcnt(9)
    ds_write_b128 v3, v[80:83] offset:0
    s_waitcnt vmcnt(8)
    ds_write_b128 v3, v[84:87] offset:4096
    s_waitcnt vmcnt(7)
    ds_write_b128 v3, v[88:91] offset:8192
    s_waitcnt vmcnt(6)
    ds_write_b128 v3, v[92:95] offset:12288
    s_waitcnt vmcnt(5)
    ds_write_b128 v3, v[96:99] offset:16384
    s_waitcnt vmcnt(4)
    ds_write_b128 v3, v[100:103] offset:20480
    s_waitcnt vmcnt(3)
    ds_write_b128 v3, v[104:107] offset:24576
    s_waitcnt vmcnt(2)
    ds_write_b128 v0, v[48:51] offset:0
    s_waitcnt vmcnt(1)
    ds_write_b128 v0, v[52:55] offset:8192
    s_waitcnt vmcnt(0)
    ds_write_b128 v0, v[56:59] offset:16384
    v_max3_u32 v16, v80, v81, v82
    v_max3_u32 v16, v16, v83, v84
    v_max3_u32 v16, v16, v85, v86
    v_max3_u32 v16, v16, v87, v88
    v_max3_u32 v16, v16, v89, v90
    v_max3_u32 v16, v16, v91, v92
    v_max3_u32 v16, v16, v93, v94
    v_max3_u32 v16, v16, v95, v96
    v_max3_u32 v16, v16, v97, v98
    v_max3_u32 v16, v16, v99, v100
    v_max3_u32 v16, v16, v101, v102
    v_max3_u32 v16, v16, v103, v104
    v_max3_u32 v16, v16, v105, v106
    v_max3_u32 v16, v16, v107, v48
    v_max3_u32 v16, v16, v49, v50
    v_max3_u32 v16, v16, v51, v52
    v_max3_u32 v16, v16, v53, v54
    v_max3_u32 v16, v16, v55, v56
    v_max3_u32 v16, v16, v57, v58
    v_max_u32 v16, v16, v59
    v_cmp_eq_u32 vcc, -1, v16
    s_cbranch_vccz Lxsok_28
    s_mul_i32 s58, s25, 37
    s_lshr_b32 s58, s58, 8
    s_mul_i32 s58, s58, 7
    s_sub_u32 s58, s25, s58
    s_lshl_b32 s58, s58, 7
    s_add_u32 s58, s58, s32
    s_mov_b32 s70, 0
Lpoll_63:
    buffer_load_dwordx4 v[80:83], v2, s[8:11], s58 offen sc1
    s_add_u32 s70, s70, 1
    s_cmp_gt_u32 s70, 131072
    s_cbranch_scc1 Lfail
    s_waitcnt vmcnt(0)
    v_max3_u32 v16, v80, v81, v82
    v_max_u32 v16, v16, v83
    v_cmp_eq_u32 vcc, -1, v16
    s_cbranch_vccnz Lpoll_63
    s_mov_b32 s70, 0
Lpoll_64:
    buffer_load_dwordx4 v[80:83], v2, s[8:11], s32 offen offset:0 sc1
    buffer_load_dwordx4 v[84:87], v2, s[8:11], s32 offen offset:128 sc1
    buffer_load_dwordx4 v[88:91], v2, s[8:11], s32 offen offset:256 sc1
    buffer_load_dwordx4 v[92:95], v2, s[8:11], s32 offen offset:384 sc1
    buffer_load_dwordx4 v[96:99], v2, s[8:11], s32 offen offset:512 sc1
    buffer_load_dwordx4 v[100:103], v2, s[8:11], s32 offen offset:640 sc1
    buffer_load_dwordx4 v[104:107], v2, s[8:11], s32 offen offset:768 sc1
    buffer_load_dwordx4 v[48:51], v60, s[8:11], s18 offen offset:0 sc1
    buffer_load_dwordx4 v[52:55], v60, s[8:11], s18 offen offset:256 sc1
    buffer_load_dwordx4 v[56:59], v60, s[8:11], s18 offen offset:512 sc1
    s_add_u32 s70, s70, 1
    s_cmp_gt_u32 s70, 131072
    s_cbranch_scc1 Lfail
    s_waitcnt vmcnt(9)
    v_max3_u32 v16, v80, v81, v82
    s_waitcnt vmcnt(8)
    v_max3_u32 v16, v16, v83, v84
    v_max3_u32 v16, v16, v85, v86
    s_waitcnt vmcnt(7)
    v_max3_u32 v16, v16, v87, v88
    v_max3_u32 v16, v16, v89, v90
    s_waitcnt vmcnt(6)
    v_max3_u32 v16, v16, v91, v92
    v_max3_u32 v16, v16, v93, v94
    s_waitcnt vmcnt(5)
    v_max3_u32 v16, v16, v95, v96
    v_max3_u32 v16, v16, v97, v98
    s_waitcnt vmcnt(4)
    v_max3_u32 v16, v16, v99, v100
    v_max3_u32 v16, v16, v101, v102
    s_waitcnt vmcnt(3)
    v_max3_u32 v16, v16, v103, v104
    v_max3_u32 v16, v16, v105, v106
    s_waitcnt vmcnt(2)
    v_max3_u32 v16, v16, v107, v48
    v_max3_u32 v16, v16, v49, v50
    s_waitcnt vmcnt(1)
    v_max3_u32 v16, v16, v51, v52
    v_max3_u32 v16, v16, v53, v54
    s_waitcnt vmcnt(0)
    v_max3_u32 v16, v16, v55, v56
    v_max3_u32 v16, v16, v57, v58
    v_max_u32 v16, v16, v59
    v_cmp_eq_u32 vcc, -1, v16
    s_cbranch_vccnz Lpoll_64
    ds_write_b128 v3, v[80:83] offset:0
    ds_write_b128 v3, v[84:87] offset:4096
    ds_write_b128 v3, v[88:91] offset:8192
    ds_write_b128 v3, v[92:95] offset:12288
    ds_write_b128 v3, v[96:99] offset:16384
    ds_write_b128 v3, v[100:103] offset:20480
    ds_write_b128 v3, v[104:107] offset:24576
    ds_write_b128 v0, v[48:51] offset:0
    ds_write_b128 v0, v[52:55] offset:8192
    ds_write_b128 v0, v[56:59] offset:16384
    s_branch Lxsok_28
Lalretry_33:
    s_mov_b32 s70, 0
Lpoll_65:
    buffer_load_dword v15, v14, s[12:15], s48 offen sc1
    buffer_load_dwordx4 v[32:35], v25, s[8:11], s56 offen offset:2048 sc1
    buffer_load_dwordx4 v[36:39], v25, s[8:11], s56 offen offset:2304 sc1
    s_add_u32 s70, s70, 1
    s_cmp_gt_u32 s70, 131072
    s_cbranch_scc1 Lfail
    s_waitcnt vmcnt(1)
    v_max3_u32 v16, v32, v33, v34
    s_waitcnt vmcnt(0)
    v_max3_u32 v16, v16, v35, v36
    v_max3_u32 v16, v16, v37, v38
    v_max3_u32 v16, v16, v39, v15
    v_cmp_eq_u32 vcc, -1, v16
    s_cbranch_vccnz Lpoll_65
    buffer_load_dwordx4 v[40:43], v1, s[8:11], s56 offen offset:0 sc1
    buffer_load_dwordx4 v[44:47], v1, s[8:11], s56 offen offset:1024 sc1
    s_waitcnt vmcnt(0)
    s_branch Lalok_32
Lpretry_35:
    s_mov_b32 s70, 0
Lpoll_66:
    buffer_load_dwordx4 v[40:43], v1, s[8:11], s56 offen offset:0 sc1
    buffer_load_dwordx4 v[44:47], v1, s[8:11], s56 offen offset:1024 sc1
    s_add_u32 s70, s70, 1
    s_cmp_gt_u32 s70, 131072
    s_cbranch_scc1 Lfail
    s_waitcnt vmcnt(1)
    v_max3_u32 v16, v40, v41, v42
    s_waitcnt vmcnt(0)
    v_max3_u32 v16, v16, v43, v44
    v_max3_u32 v16, v16, v45, v46
    v_max_u32 v16, v16, v47
    v_cmp_eq_u32 vcc, -1, v16
    s_cbranch_vccnz Lpoll_66
    s_branch Lpok_34
LA_first:
    ds_read_b128 v[80:83], v4 offset:0
    ds_read_b128 v[108:111], v9 offset:0
    ds_read_b128 v[84:87], v5 offset:0
    s_waitcnt lgkmcnt(2)
    v_mfma_f32_16x16x32_bf16 v[64:67], a[224:227], v[80:83], 0
    ds_read_b128 v[112:115], v9 offset:1024
    s_and_b32 s58, s29, 1
    v_mfma_f32_16x16x32_bf16 v[68:71], v[144:147], v[80:83], 0
    ds_read_b128 v[88:91], v4 offset:4096
    s_mul_i32 s49, s58, 458752
    v_mfma_f32_16x16x32_bf16 v[72:75], v[200:203], v[80:83], 0
    s_mul_i32 s59, s25, 28672
    s_waitcnt lgkmcnt(3)
    v_mfma_f32_16x16x32_bf16 v[76:79], v[108:111], v[80:83], 0
    s_add_u32 s49, s49, s59
    s_waitcnt lgkmcnt(2)
    v_mfma_f32_16x16x32_bf16 v[64:67], a[228:231], v[84:87], v[64:67]
    ds_read_b128 v[108:111], v9 offset:2048
    s_add_u32 s49, s49, s31
    v_mfma_f32_16x16x32_bf16 v[68:71], v[148:151], v[84:87], v[68:71]
    ds_read_b128 v[80:83], v5 offset:4096
    s_lshl_b32 s59, s71, 12
    v_mfma_f32_16x16x32_bf16 v[72:75], v[204:207], v[84:87], v[72:75]
    s_add_u32 s49, s49, s59
    s_waitcnt lgkmcnt(3)
    v_mfma_f32_16x16x32_bf16 v[76:79], v[112:115], v[84:87], v[76:79]
    s_waitcnt lgkmcnt(2)
    v_mfma_f32_16x16x32_bf16 v[64:67], a[232:235], v[88:91], v[64:67]
    ds_read_b128 v[112:115], v9 offset:3072
    v_mfma_f32_16x16x32_bf16 v[68:71], v[152:155], v[88:91], v[68:71]
    ds_read_b128 v[84:87], v4 offset:8192
    v_mfma_f32_16x16x32_bf16 v[72:75], v[208:211], v[88:91], v[72:75]
    s_waitcnt lgkmcnt(3)
    v_mfma_f32_16x16x32_bf16 v[76:79], v[108:111], v[88:91], v[76:79]
    s_waitcnt lgkmcnt(2)
    v_mfma_f32_16x16x32_bf16 v[64:67], a[236:239], v[80:83], v[64:67]
    ds_read_b128 v[108:111], v9 offset:4096
    v_mfma_f32_16x16x32_bf16 v[68:71], v[156:159], v[80:83], v[68:71]
    ds_read_b128 v[88:91], v5 offset:8192
    v_mfma_f32_16x16x32_bf16 v[72:75], v[212:215], v[80:83], v[72:75]
    s_waitcnt lgkmcnt(3)
    v_mfma_f32_16x16x32_bf16 v[76:79], v[112:115], v[80:83], v[76:79]
    s_waitcnt lgkmcnt(2)
    v_mfma_f32_16x16x32_bf16 v[64:67], a[240:243], v[84:87], v[64:67]
    ds_read_b128 v[112:115], v9 offset:5120
    v_mfma_f32_16x16x32_bf16 v[68:71], v[160:163], v[84:87], v[68:71]
    ds_read_b128 v[80:83], v4 offset:12288
    v_mfma_f32_16x16x32_bf16 v[72:75], v[216:219], v[84:87], v[72:75]
    s_waitcnt lgkmcnt(3)
    v_mfma_f32_16x16x32_bf16 v[76:79], v[108:111], v[84:87], v[76:79]
    s_waitcnt lgkmcnt(2)
    v_mfma_f32_16x16x32_bf16 v[64:67], a[244:247], v[88:91], v[64:67]
    ds_read_b128 v[108:111], v9 offset:6144
    v_mfma_f32_16x16x32_bf16 v[68:71], v[164:167], v[88:91], v[68:71]
    ds_read_b128 v[84:87], v5 offset:12288
    v_mfma_f32_16x16x32_bf16 v[72:75], v[220:223], v[88:91], v[72:75]
    s_waitcnt lgkmcnt(3)
    v_mfma_f32_16x16x32_bf16 v[76:79], v[112:115], v[88:91], v[76:79]
    s_waitcnt lgkmcnt(2)
    v_mfma_f32_16x16x32_bf16 v[64:67], a[248:251], v[80:83], v[64:67]
    ds_read_b128 v[112:115], v9 offset:7168
    v_mfma_f32_16x16x32_bf16 v[68:71], v[168:171], v[80:83], v[68:71]
    ds_read_b128 v[88:91], v4 offset:16384
    v_mfma_f32_16x16x32_bf16 v[72:75], v[224:227], v[80:83], v[72:75]
    s_waitcnt lgkmcnt(3)
    v_mfma_f32_16x16x32_bf16 v[76:79], v[108:111], v[80:83], v[76:79]
    s_waitcnt lgkmcnt(2)
    v_mfma_f32_16x16x32_bf16 v[64:67], a[252:255], v[84:87], v[64:67]
    ds_read_b128 v[108:111], v9 offset:8192
    v_mfma_f32_16x16x32_bf16 v[68:71], v[172:175], v[84:87], v[68:71]
    ds_read_b128 v[80:83], v5 offset:16384
    v_mfma_f32_16x16x32_bf16 v[72:75], v[228:231], v[84:87], v[72:75]
    s_waitcnt lgkmcnt(3)
    v_mfma_f32_16x16x32_bf16 v[76:79], v[112:115], v[84:87], v[76:79]
    s_waitcnt lgkmcnt(2)
    v_mfma_f32_16x16x32_bf16 v[64:67], v[120:123], v[88:91], v[64:67]
    ds_read_b128 v[112:115], v9 offset:9216
    v_mfma_f32_16x16x32_bf16 v[68:71], v[176:179], v[88:91], v[68:71]
    ds_read_b128 v[84:87], v4 offset:20480
    v_mfma_f32_16x16x32_bf16 v[72:75], v[232:235], v[88:91], v[72:75]
    s_waitcnt lgkmcnt(3)
    v_mfma_f32_16x16x32_bf16 v[76:79], v[108:111], v[88:91], v[76:79]
    s_waitcnt lgkmcnt(2)
    v_mfma_f32_16x16x32_bf16 v[64:67], v[124:127], v[80:83], v[64:67]
    ds_read_b128 v[108:111], v9 offset:10240
    v_mfma_f32_16x16x32_bf16 v[68:71], v[180:183], v[80:83], v[68:71]
    ds_read_b128 v[88:91], v5 offset:20480
    v_mfma_f32_16x16x32_bf16 v[72:75], v[236:239], v[80:83], v[72:75]
    s_waitcnt lgkmcnt(3)
    v_mfma_f32_16x16x32_bf16 v[76:79], v[112:115], v[80:83], v[76:79]
    s_waitcnt lgkmcnt(2)
    v_mfma_f32_16x16x32_bf16 v[64:67], v[128:131], v[84:87], v[64:67]
    ds_read_b128 v[112:115], v9 offset:11264
    v_mfma_f32_16x16x32_bf16 v[68:71], v[184:187], v[84:87], v[68:71]
    ds_read_b128 v[80:83], v4 offset:24576
    v_mfma_f32_16x16x32_bf16 v[72:75], v[240:243], v[84:87], v[72:75]
    s_waitcnt lgkmcnt(3)
    v_mfma_f32_16x16x32_bf16 v[76:79], v[108:111], v[84:87], v[76:79]
    s_waitcnt lgkmcnt(2)
    v_mfma_f32_16x16x32_bf16 v[64:67], v[132:135], v[88:91], v[64:67]
    ds_read_b128 v[108:111], v9 offset:12288
    v_mfma_f32_16x16x32_bf16 v[68:71], v[188:191], v[88:91], v[68:71]
    ds_read_b128 v[84:87], v5 offset:24576
    v_mfma_f32_16x16x32_bf16 v[72:75], v[244:247], v[88:91], v[72:75]
    s_waitcnt lgkmcnt(3)
    v_mfma_f32_16x16x32_bf16 v[76:79], v[112:115], v[88:91], v[76:79]
    s_waitcnt lgkmcnt(2)
    v_mfma_f32_16x16x32_bf16 v[64:67], v[136:139], v[80:83], v[64:67]
    ds_read_b128 v[112:115], v9 offset:13312
    v_mfma_f32_16x16x32_bf16 v[68:71], v[192:195], v[80:83], v[68:71]
    ds_read_b128 v[88:91], v4 offset:2048
    v_mfma_f32_16x16x32_bf16 v[72:75], v[248:251], v[80:83], v[72:75]
    s_waitcnt lgkmcnt(3)
    v_mfma_f32_16x16x32_bf16 v[76:79], v[108:111], v[80:83], v[76:79]
    s_waitcnt lgkmcnt(2)
    v_mfma_f32_16x16x32_bf16 v[64:67], v[140:143], v[84:87], v[64:67]
    ds_read_b128 v[108:111], v9 offset:0
    v_mfma_f32_16x16x32_bf16 v[68:71], v[196:199], v[84:87], v[68:71]
    ds_read_b128 v[80:83], v5 offset:2048
    v_mfma_f32_16x16x32_bf16 v[72:75], v[252:255], v[84:87], v[72:75]
    s_waitcnt lgkmcnt(3)
    v_mfma_f32_16x16x32_bf16 v[76:79], v[112:115], v[84:87], v[76:79]
    s_waitcnt lgkmcnt(2)
    v_mfma_f32_16x16x32_bf16 v[92:95], a[224:227], v[88:91], 0
    ds_read_b128 v[112:115], v9 offset:1024
    v_mfma_f32_16x16x32_bf16 v[96:99], v[144:147], v[88:91], 0
    ds_read_b128 v[84:87], v4 offset:6144
    v_cvt_pk_bf16_f32 v64, v64, v65
    v_cvt_pk_bf16_f32 v65, v66, v67
    v_mfma_f32_16x16x32_bf16 v[100:103], v[200:203], v[88:91], 0
    s_waitcnt lgkmcnt(3)
    v_cvt_pk_bf16_f32 v66, v68, v69
    v_cvt_pk_bf16_f32 v67, v70, v71
    v_mfma_f32_16x16x32_bf16 v[104:107], v[108:111], v[88:91], 0
    buffer_store_dwordx4 v[64:67], v1, s[8:11], s49 offen offset:0
    v_cvt_pk_bf16_f32 v72, v72, v73
    s_waitcnt lgkmcnt(2)
    v_mfma_f32_16x16x32_bf16 v[92:95], a[228:231], v[80:83], v[92:95]
    ds_read_b128 v[108:111], v9 offset:2048
    v_cvt_pk_bf16_f32 v73, v74, v75
    v_cvt_pk_bf16_f32 v74, v76, v77
    v_mfma_f32_16x16x32_bf16 v[96:99], v[148:151], v[80:83], v[96:99]
    ds_read_b128 v[88:91], v5 offset:6144
    v_cvt_pk_bf16_f32 v75, v78, v79
    buffer_store_dwordx4 v[72:75], v1, s[8:11], s49 offen offset:2048
    v_mfma_f32_16x16x32_bf16 v[100:103], v[204:207], v[80:83], v[100:103]
    s_waitcnt lgkmcnt(3)
    v_mfma_f32_16x16x32_bf16 v[104:107], v[112:115], v[80:83], v[104:107]
    s_waitcnt lgkmcnt(2)
    v_mfma_f32_16x16x32_bf16 v[92:95], a[232:235], v[84:87], v[92:95]
    ds_read_b128 v[112:115], v9 offset:3072
    v_mfma_f32_16x16x32_bf16 v[96:99], v[152:155], v[84:87], v[96:99]
    ds_read_b128 v[80:83], v4 offset:10240
    v_mfma_f32_16x16x32_bf16 v[100:103], v[208:211], v[84:87], v[100:103]
    s_waitcnt lgkmcnt(3)
    v_mfma_f32_16x16x32_bf16 v[104:107], v[108:111], v[84:87], v[104:107]
    s_waitcnt lgkmcnt(2)
    v_mfma_f32_16x16x32_bf16 v[92:95], a[236:239], v[88:91], v[92:95]
    ds_read_b128 v[108:111], v9 offset:4096
    v_mfma_f32_16x16x32_bf16 v[96:99], v[156:159], v[88:91], v[96:99]
    ds_read_b128 v[84:87], v5 offset:10240
    v_mfma_f32_16x16x32_bf16 v[100:103], v[212:215], v[88:91], v[100:103]
    s_waitcnt lgkmcnt(3)
    v_mfma_f32_16x16x32_bf16 v[104:107], v[112:115], v[88:91], v[104:107]
    s_waitcnt lgkmcnt(2)
    v_mfma_f32_16x16x32_bf16 v[92:95], a[240:243], v[80:83], v[92:95]
    ds_read_b128 v[112:115], v9 offset:5120
    v_mfma_f32_16x16x32_bf16 v[96:99], v[160:163], v[80:83], v[96:99]
    ds_read_b128 v[88:91], v4 offset:14336
    v_mfma_f32_16x16x32_bf16 v[100:103], v[216:219], v[80:83], v[100:103]
    s_waitcnt lgkmcnt(3)
    v_mfma_f32_16x16x32_bf16 v[104:107], v[108:111], v[80:83], v[104:107]
    s_waitcnt lgkmcnt(2)
    v_mfma_f32_16x16x32_bf16 v[92:95], a[244:247], v[84:87], v[92:95]
    ds_read_b128 v[108:111], v9 offset:6144
    v_mfma_f32_16x16x32_bf16 v[96:99], v[164:167], v[84:87], v[96:99]
    ds_read_b128 v[80:83], v5 offset:14336
    v_mfma_f32_16x16x32_bf16 v[100:103], v[220:223], v[84:87], v[100:103]
    s_waitcnt lgkmcnt(3)
    v_mfma_f32_16x16x32_bf16 v[104:107], v[112:115], v[84:87], v[104:107]
    s_waitcnt lgkmcnt(2)
    v_mfma_f32_16x16x32_bf16 v[92:95], a[248:251], v[88:91], v[92:95]
    ds_read_b128 v[112:115], v9 offset:7168
    v_mfma_f32_16x16x32_bf16 v[96:99], v[168:171], v[88:91], v[96:99]
    ds_read_b128 v[84:87], v4 offset:18432
    v_mfma_f32_16x16x32_bf16 v[100:103], v[224:227], v[88:91], v[100:103]
    s_waitcnt lgkmcnt(3)
    v_mfma_f32_16x16x32_bf16 v[104:107], v[108:111], v[88:91], v[104:107]
    s_waitcnt lgkmcnt(2)
    v_mfma_f32_16x16x32_bf16 v[92:95], a[252:255], v[80:83], v[92:95]
    ds_read_b128 v[108:111], v9 offset:8192
    v_mfma_f32_16x16x32_bf16 v[96:99], v[172:175], v[80:83], v[96:99]
    ds_read_b128 v[88:91], v5 offset:18432
    v_mfma_f32_16x16x32_bf16 v[100:103], v[228:231], v[80:83], v[100:103]
    s_waitcnt lgkmcnt(3)
    v_mfma_f32_16x16x32_bf16 v[104:107], v[112:115], v[80:83], v[104:107]
    s_waitcnt lgkmcnt(2)
    v_mfma_f32_16x16x32_bf16 v[92:95], v[120:123], v[84:87], v[92:95]
    ds_read_b128 v[112:115], v9 offset:9216
    v_mfma_f32_16x16x32_bf16 v[96:99], v[176:179], v[84:87], v[96:99]
    ds_read_b128 v[80:83], v4 offset:22528
    v_mfma_f32_16x16x32_bf16 v[100:103], v[232:235], v[84:87], v[100:103]
    s_waitcnt lgkmcnt(3)
    v_mfma_f32_16x16x32_bf16 v[104:107], v[108:111], v[84:87], v[104:107]
    s_waitcnt lgkmcnt(2)
    v_mfma_f32_16x16x32_bf16 v[92:95], v[124:127], v[88:91], v[92:95]
    ds_read_b128 v[108:111], v9 offset:10240
    v_mfma_f32_16x16x32_bf16 v[96:99], v[180:183], v[88:91], v[96:99]
    ds_read_b128 v[84:87], v5 offset:22528
    v_mfma_f32_16x16x32_bf16 v[100:103], v[236:239], v[88:91], v[100:103]
    s_waitcnt lgkmcnt(3)
    v_mfma_f32_16x16x32_bf16 v[104:107], v[112:115], v[88:91], v[104:107]
    s_waitcnt lgkmcnt(2)
    v_mfma_f32_16x16x32_bf16 v[92:95], v[128:131], v[80:83], v[92:95]
    ds_read_b128 v[112:115], v9 offset:11264
    v_mfma_f32_16x16x32_bf16 v[96:99], v[184:187], v[80:83], v[96:99]
    ds_read_b128 v[88:91], v4 offset:26624
    v_mfma_f32_16x16x32_bf16 v[100:103], v[240:243], v[80:83], v[100:103]
    s_waitcnt lgkmcnt(3)
    v_mfma_f32_16x16x32_bf16 v[104:107], v[108:111], v[80:83], v[104:107]
    s_waitcnt lgkmcnt(2)
    v_mfma_f32_16x16x32_bf16 v[92:95], v[132:135], v[84:87], v[92:95]
    ds_read_b128 v[108:111], v9 offset:12288
    s_lshl_b32 s58, s29, 1
    s_or_b32 s58, s58, 0
    v_mfma_f32_16x16x32_bf16 v[96:99], v[188:191], v[84:87], v[96:99]
    ds_read_b128 v[80:83], v5 offset:26624
    v_mov_b32 v26, s58
    v_mfma_f32_16x16x32_bf16 v[100:103], v[244:247], v[84:87], v[100:103]
    s_waitcnt vmcnt(0)
    s_mov_b64 exec, 1
    buffer_store_dword v26, off, s[8:11], s51
    s_mov_b64 exec, -1
    s_waitcnt lgkmcnt(3)
    v_mfma_f32_16x16x32_bf16 v[104:107], v[112:115], v[84:87], v[104:107]
    s_waitcnt lgkmcnt(2)
    v_mfma_f32_16x16x32_bf16 v[92:95], v[136:139], v[88:91], v[92:95]
    ds_read_b128 v[112:115], v9 offset:13312
    v_mfma_f32_16x16x32_bf16 v[96:99], v[192:195], v[88:91], v[96:99]
    ds_read_b128 v[84:87], v4 offset:0
    v_mfma_f32_16x16x32_bf16 v[100:103], v[248:251], v[88:91], v[100:103]
    s_waitcnt lgkmcnt(3)
    v_mfma_f32_16x16x32_bf16 v[104:107], v[108:111], v[88:91], v[104:107]
    s_waitcnt lgkmcnt(2)
    v_mfma_f32_16x16x32_bf16 v[92:95], v[140:143], v[80:83], v[92:95]
    v_mfma_f32_16x16x32_bf16 v[96:99], v[196:199], v[80:83], v[96:99]
    ds_read_b128 v[88:91], v5 offset:0
    v_mfma_f32_16x16x32_bf16 v[100:103], v[252:255], v[80:83], v[100:103]
    s_waitcnt vmcnt(0)
    s_waitcnt lgkmcnt(2)
    v_mfma_f32_16x16x32_bf16 v[104:107], v[112:115], v[80:83], v[104:107]
    s_waitcnt lgkmcnt(1)
    v_mfma_f32_16x16x32_bf16 v[64:67], v[84:87], a[0:3], 0
    v_mfma_f32_16x16x32_bf16 v[68:71], v[84:87], a[56:59], 0
    ds_read_b128 v[80:83], v4 offset:4096
    v_cvt_pk_bf16_f32 v92, v92, v93
    v_cvt_pk_bf16_f32 v93, v94, v95
    v_mfma_f32_16x16x32_bf16 v[72:75], v[84:87], a[112:115], 0
    v_cvt_pk_bf16_f32 v94, v96, v97
    v_cvt_pk_bf16_f32 v95, v98, v99
    v_mfma_f32_16x16x32_bf16 v[76:79], v[84:87], a[168:171], 0
    buffer_store_dwordx4 v[92:95], v1, s[8:11], s49 offen offset:1024
    v_cvt_pk_bf16_f32 v100, v100, v101
    s_waitcnt lgkmcnt(1)
    v_mfma_f32_16x16x32_bf16 v[64:67], v[88:91], a[4:7], v[64:67]
    v_cvt_pk_bf16_f32 v101, v102, v103
    v_cvt_pk_bf16_f32 v102, v104, v105
    v_mfma_f32_16x16x32_bf16 v[68:71], v[88:91], a[60:63], v[68:71]
    ds_read_b128 v[84:87], v5 offset:4096
    v_cvt_pk_bf16_f32 v103, v106, v107
    buffer_store_dwordx4 v[100:103], v1, s[8:11], s49 offen offset:3072
    v_mfma_f32_16x16x32_bf16 v[72:75], v[88:91], a[116:119], v[72:75]
    v_mfma_f32_16x16x32_bf16 v[76:79], v[88:91], a[172:175], v[76:79]
    s_waitcnt lgkmcnt(1)
    v_mfma_f32_16x16x32_bf16 v[64:67], v[80:83], a[8:11], v[64:67]
    v_mfma_f32_16x16x32_bf16 v[68:71], v[80:83], a[64:67], v[68:71]
    ds_read_b128 v[88:91], v4 offset:8192
    v_mfma_f32_16x16x32_bf16 v[72:75], v[80:83], a[120:123], v[72:75]
    v_mfma_f32_16x16x32_bf16 v[76:79], v[80:83], a[176:179], v[76:79]
    s_waitcnt lgkmcnt(1)
    v_mfma_f32_16x16x32_bf16 v[64:67], v[84:87], a[12:15], v[64:67]
    v_mfma_f32_16x16x32_bf16 v[68:71], v[84:87], a[68:71], v[68:71]
    ds_read_b128 v[80:83], v5 offset:8192
    v_mfma_f32_16x16x32_bf16 v[72:75], v[84:87], a[124:127], v[72:75]
    v_mfma_f32_16x16x32_bf16 v[76:79], v[84:87], a[180:183], v[76:79]
    s_waitcnt lgkmcnt(1)
    v_mfma_f32_16x16x32_bf16 v[64:67], v[88:91], a[16:19], v[64:67]
    v_mfma_f32_16x16x32_bf16 v[68:71], v[88:91], a[72:75], v[68:71]
    ds_read_b128 v[84:87], v4 offset:12288
    v_mfma_f32_16x16x32_bf16 v[72:75], v[88:91], a[128:131], v[72:75]
    v_mfma_f32_16x16x32_bf16 v[76:79], v[88:91], a[184:187], v[76:79]
    s_waitcnt lgkmcnt(1)
    v_mfma_f32_16x16x32_bf16 v[64:67], v[80:83], a[20:23], v[64:67]
    v_mfma_f32_16x16x32_bf16 v[68:71], v[80:83], a[76:79], v[68:71]
    ds_read_b128 v[88:91], v5 offset:12288
    v_mfma_f32_16x16x32_bf16 v[72:75], v[80:83], a[132:135], v[72:75]
    s_lshl_b32 s58, s29, 1
    s_or_b32 s58, s58, 1
    v_mfma_f32_16x16x32_bf16 v[76:79], v[80:83], a[188:191], v[76:79]
    s_waitcnt lgkmcnt(1)
    v_mov_b32 v26, s58
    v_mfma_f32_16x16x32_bf16 v[64:67], v[84:87], a[24:27], v[64:67]
    s_waitcnt vmcnt(0)
    s_mov_b64 exec, 1
    buffer_store_dword v26, off, s[8:11], s51
    s_mov_b64 exec, -1
    s_waitcnt lgkmcnt(0)
    s_nop 7
    s_branch LA_p1
LA_last:
    buffer_load_dword v15, v14, s[12:15], s48 offen sc1
    buffer_load_dwordx4 v[48:51], v1, s[8:11], s54 offen offset:0 sc1
    buffer_load_dwordx4 v[52:55], v1, s[8:11], s54 offen offset:1024 sc1
    buffer_load_dwordx4 v[56:59], v1, s[8:11], s54 offen offset:2048 sc1
    buffer_load_dwordx4 v[60:63], v1, s[8:11], s54 offen offset:3072 sc1
    buffer_load_dwordx4 v[64:67], v1, s[8:11], s55 offen offset:0 sc1
    buffer_load_dwordx4 v[68:71], v1, s[8:11], s55 offen offset:1024 sc1
    buffer_load_dwordx4 v[72:75], v1, s[8:11], s55 offen offset:2048 sc1
    buffer_load_dwordx4 v[76:79], v1, s[8:11], s55 offen offset:3072 sc1
    s_waitcnt vmcnt(7)
    v_mfma_f32_16x16x32_bf16 v[48:51], v[32:35], v[48:51], 0
    s_waitcnt vmcnt(6)
    v_mfma_f32_16x16x32_bf16 v[52:55], v[32:35], v[52:55], 0
    s_waitcnt vmcnt(5)
    v_mfma_f32_16x16x32_bf16 v[56:59], v[36:39], v[56:59], 0
    s_waitcnt vmcnt(4)
    v_mfma_f32_16x16x32_bf16 v[60:63], v[36:39], v[60:63], 0
    s_waitcnt vmcnt(3)
    v_mfma_f32_16x16x32_bf16 v[64:67], v[40:43], v[64:67], 0
    s_waitcnt vmcnt(2)
    v_mfma_f32_16x16x32_bf16 v[68:71], v[40:43], v[68:71], 0
    s_waitcnt vmcnt(1)
    v_mfma_f32_16x16x32_bf16 v[72:75], v[44:47], v[72:75], 0
    s_waitcnt vmcnt(0)
    v_mfma_f32_16x16x32_bf16 v[76:79], v[44:47], v[76:79], 0
    buffer_load_dwordx4 v[32:35], v25, s[8:11], s56 offen offset:2048 sc1
    buffer_load_dwordx4 v[36:39], v25, s[8:11], s56 offen offset:2304 sc1
    buffer_load_dwordx4 v[40:43], v1, s[8:11], s56 offen offset:0 sc1
    buffer_load_dwordx4 v[44:47], v1, s[8:11], s56 offen offset:1024 sc1
    s_waitcnt vmcnt(3)
    v_max3_u32 v16, v32, v33, v34
    s_waitcnt vmcnt(2)
    v_max3_u32 v16, v16, v35, v36
    v_max3_u32 v16, v16, v37, v38
    s_waitcnt vmcnt(1)
    v_max3_u32 v16, v16, v39, v40
    v_max3_u32 v16, v16, v41, v42
    s_waitcnt vmcnt(0)
    v_max3_u32 v16, v16, v43, v44
    v_max3_u32 v16, v16, v45, v46
    v_max3_u32 v16, v16, v47, v15
    v_cmp_eq_u32 vcc, -1, v16
    s_cbranch_vccnz Llateretry_68
Llateok_67:
    v_pk_mul_f32 v[48:49], v[48:49], v[32:33] op_sel:[0,0] op_sel_hi:[1,0]
    v_pk_mul_f32 v[50:51], v[50:51], v[32:33] op_sel:[0,0] op_sel_hi:[1,0]
    v_pk_mul_f32 v[52:53], v[52:53], v[36:37] op_sel:[0,0] op_sel_hi:[1,0]
    v_pk_mul_f32 v[54:55], v[54:55], v[36:37] op_sel:[0,0] op_sel_hi:[1,0]
    v_pk_fma_f32 v[48:49], v[56:57], v[32:33], v[48:49] op_sel:[0,1,0] op_sel_hi:[1,1,1]
    v_pk_fma_f32 v[50:51], v[58:59], v[32:33], v[50:51] op_sel:[0,1,0] op_sel_hi:[1,1,1]
    v_pk_fma_f32 v[52:53], v[60:61], v[36:37], v[52:53] op_sel:[0,1,0] op_sel_hi:[1,1,1]
    v_pk_fma_f32 v[54:55], v[62:63], v[36:37], v[54:55] op_sel:[0,1,0] op_sel_hi:[1,1,1]
    v_pk_fma_f32 v[48:49], v[64:65], v[34:35], v[48:49] op_sel:[0,0,0] op_sel_hi:[1,0,1]
    v_pk_fma_f32 v[50:51], v[66:67], v[34:35], v[50:51] op_sel:[0,0,0] op_sel_hi:[1,0,1]
    v_pk_fma_f32 v[52:53], v[68:69], v[38:39], v[52:53] op_sel:[0,0,0] op_sel_hi:[1,0,1]
    v_pk_fma_f32 v[54:55], v[70:71], v[38:39], v[54:55] op_sel:[0,0,0] op_sel_hi:[1,0,1]
    v_pk_fma_f32 v[48:49], v[72:73], v[34:35], v[48:49] op_sel:[0,1,0] op_sel_hi:[1,1,1]
    v_pk_fma_f32 v[50:51], v[74:75], v[34:35], v[50:51] op_sel:[0,1,0] op_sel_hi:[1,1,1]
    v_pk_fma_f32 v[52:53], v[76:77], v[38:39], v[52:53] op_sel:[0,1,0] op_sel_hi:[1,1,1]
    v_pk_fma_f32 v[54:55], v[78:79], v[38:39], v[54:55] op_sel:[0,1,0] op_sel_hi:[1,1,1]
    v_lshlrev_b32 v32, 16, v15
    v_and_b32 v33, 0xffff0000, v15
    v_mfma_f32_16x16x32_bf16 v[48:51], v[116:119], v[40:43], v[48:51]
    v_mfma_f32_16x16x32_bf16 v[52:55], v[116:119], v[44:47], v[52:55]
    s_nop 3
    ds_write_b128 v11, v[48:51] offset:12288
    s_nop 2
    ds_write_b128 v11, v[52:55] offset:13312
    s_waitcnt lgkmcnt(0)
    s_barrier
    ds_read_b64 v[56:57], v12 offset:12288
    ds_read_b64 v[58:59], v12 offset:14336
    ds_read_b64 v[60:61], v12 offset:16384
    ds_read_b64 v[62:63], v12 offset:18432
    s_waitcnt lgkmcnt(3)
    v_add_f32 v32, v32, v56
    v_add_f32 v33, v33, v57
    s_waitcnt lgkmcnt(2)
    v_add_f32 v32, v32, v58
    v_add_f32 v33, v33, v59
    s_waitcnt lgkmcnt(1)
    v_add_f32 v32, v32, v60
    v_add_f32 v33, v33, v61
    s_waitcnt lgkmcnt(0)
    v_add_f32 v32, v32, v62
    v_add_f32 v33, v33, v63
    v_cvt_pk_bf16_f32 v32, v32, v33
    buffer_store_dword v32, v13, s[8:11], s35 offen sc1
    s_branch Ldone
Llateretry_68:
    s_mov_b32 s70, 0
Lpoll_69:
    buffer_load_dword v15, v14, s[12:15], s48 offen sc1
    buffer_load_dwordx4 v[32:35], v25, s[8:11], s56 offen offset:2048 sc1
    buffer_load_dwordx4 v[36:39], v25, s[8:11], s56 offen offset:2304 sc1
    buffer_load_dwordx4 v[40:43], v1, s[8:11], s56 offen offset:0 sc1
    buffer_load_dwordx4 v[44:47], v1, s[8:11], s56 offen offset:1024 sc1
    s_add_u32 s70, s70, 1
    s_cmp_gt_u32 s70, 131072
    s_cbranch_scc1 Lfail
    s_waitcnt vmcnt(3)
    v_max3_u32 v16, v32, v33, v34
    s_waitcnt vmcnt(2)
    v_max3_u32 v16, v16, v35, v36
    v_max3_u32 v16, v16, v37, v38
    s_waitcnt vmcnt(1)
    v_max3_u32 v16, v16, v39, v40
    v_max3_u32 v16, v16, v41, v42
    s_waitcnt vmcnt(0)
    v_max3_u32 v16, v16, v43, v44
    v_max3_u32 v16, v16, v45, v46
    v_max3_u32 v16, v16, v47, v15
    v_cmp_eq_u32 vcc, -1, v16
    s_cbranch_vccnz Lpoll_69
    s_branch Llateok_67
Leretry_51:
    s_mov_b32 s70, 0
Lpoll_70:
    buffer_load_dwordx4 v[108:111], v1, s[8:11], s40 offen offset:0 sc1
    buffer_load_dwordx4 v[112:115], v1, s[8:11], s40 offen offset:1024 sc1
    s_add_u32 s70, s70, 1
    s_cmp_gt_u32 s70, 131072
    s_cbranch_scc1 Lfail
    s_waitcnt vmcnt(1)
    v_max3_u32 v16, v108, v109, v110
    s_waitcnt vmcnt(0)
    v_max3_u32 v16, v16, v111, v112
    v_max3_u32 v16, v16, v113, v114
    v_max_u32 v16, v16, v115
    v_cmp_eq_u32 vcc, -1, v16
    s_cbranch_vccnz Lpoll_70
    s_branch Leok_50
Lsretry_54:
    buffer_load_dwordx4 v[80:83], v1, s[8:11], s38 offen sc1
    buffer_load_dwordx4 v[84:87], v1, s[8:11], s39 offen sc1
    s_waitcnt vmcnt(3)
    v_pk_add_f32 v[96:97], v[68:69], v[112:113]
    v_pk_add_f32 v[98:99], v[70:71], v[114:115]
    v_max3_f32 v100, v96, v97, v98
    v_max3_f32 v100, v100, v99, v30
    v_pk_fma_f32 v[104:105], v[96:97], v[30:31], v[98:99]
    v_cmp_u_f32 vcc, v104, v105
    v_max_f32_dpp v100, v100, v100 row_ror:8 row_mask:0xf bank_mask:0xf
    v_sub_f32 v102, v30, v100
    v_pk_add_f32 v[96:97], v[96:97], v[100:101] op_sel_hi:[1,0] neg_lo:[0,1] neg_hi:[0,1]
    v_pk_add_f32 v[98:99], v[98:99], v[100:101] op_sel_hi:[1,0] neg_lo:[0,1] neg_hi:[0,1]
    s_cbranch_vccz Lsok_53
    buffer_load_dwordx4 v[68:71], v1, s[8:11], s38 offen sc1
    buffer_load_dwordx4 v[112:115], v1, s[8:11], s39 offen sc1
    s_waitcnt vmcnt(2)
    v_pk_add_f32 v[96:97], v[80:81], v[84:85]
    v_pk_add_f32 v[98:99], v[82:83], v[86:87]
    v_max3_f32 v100, v96, v97, v98
    v_max3_f32 v100, v100, v99, v30
    v_pk_fma_f32 v[104:105], v[96:97], v[30:31], v[98:99]
    v_cmp_u_f32 vcc, v104, v105
    v_max_f32_dpp v100, v100, v100 row_ror:8 row_mask:0xf bank_mask:0xf
    v_sub_f32 v102, v30, v100
    v_pk_add_f32 v[96:97], v[96:97], v[100:101] op_sel_hi:[1,0] neg_lo:[0,1] neg_hi:[0,1]
    v_pk_add_f32 v[98:99], v[98:99], v[100:101] op_sel_hi:[1,0] neg_lo:[0,1] neg_hi:[0,1]
    s_cbranch_vccz Lsok_53
    buffer_load_dwordx4 v[80:83], v1, s[8:11], s38 offen sc1
    buffer_load_dwordx4 v[84:87], v1, s[8:11], s39 offen sc1
    s_waitcnt vmcnt(2)
    v_pk_add_f32 v[96:97], v[68:69], v[112:113]
    v_pk_add_f32 v[98:99], v[70:71], v[114:115]
    v_max3_f32 v100, v96, v97, v98
    v_max3_f32 v100, v100, v99, v30
    v_pk_fma_f32 v[104:105], v[96:97], v[30:31], v[98:99]
    v_cmp_u_f32 vcc, v104, v105
    v_max_f32_dpp v100, v100, v100 row_ror:8 row_mask:0xf bank_mask:0xf
    v_sub_f32 v102, v30, v100
    v_pk_add_f32 v[96:97], v[96:97], v[100:101] op_sel_hi:[1,0] neg_lo:[0,1] neg_hi:[0,1]
    v_pk_add_f32 v[98:99], v[98:99], v[100:101] op_sel_hi:[1,0] neg_lo:[0,1] neg_hi:[0,1]
    s_cbranch_vccz Lsok_53
    buffer_load_dwordx4 v[68:71], v1, s[8:11], s38 offen sc1
    buffer_load_dwordx4 v[112:115], v1, s[8:11], s39 offen sc1
    s_waitcnt vmcnt(2)
    v_pk_add_f32 v[96:97], v[80:81], v[84:85]
    v_pk_add_f32 v[98:99], v[82:83], v[86:87]
    v_max3_f32 v100, v96, v97, v98
    v_max3_f32 v100, v100, v99, v30
    v_pk_fma_f32 v[104:105], v[96:97], v[30:31], v[98:99]
    v_cmp_u_f32 vcc, v104, v105
    v_max_f32_dpp v100, v100, v100 row_ror:8 row_mask:0xf bank_mask:0xf
    v_sub_f32 v102, v30, v100
    v_pk_add_f32 v[96:97], v[96:97], v[100:101] op_sel_hi:[1,0] neg_lo:[0,1] neg_hi:[0,1]
    v_pk_add_f32 v[98:99], v[98:99], v[100:101] op_sel_hi:[1,0] neg_lo:[0,1] neg_hi:[0,1]
    s_cbranch_vccz Lsok_53
    s_mov_b32 s70, 0
Lpoll_71:
    buffer_load_dword v30, v27, s[8:11], s41 offen offset:0 sc1
    buffer_load_dword v31, v27, s[8:11], s41 offen offset:4 sc1
    buffer_load_dwordx4 v[80:83], v1, s[8:11], s38 offen sc1
    buffer_load_dwordx4 v[84:87], v1, s[8:11], s39 offen sc1
    s_add_u32 s70, s70, 1
    s_cmp_gt_u32 s70, 131072
    s_cbranch_scc1 Lfail
    s_waitcnt vmcnt(1)
    v_max3_u32 v16, v30, v31, v80
    v_max3_u32 v16, v16, v81, v82
    s_waitcnt vmcnt(0)
    v_max3_u32 v16, v16, v83, v84
    v_max3_u32 v16, v16, v85, v86
    v_max_u32 v16, v16, v87
    v_cmp_eq_u32 vcc, -1, v16
    s_cbranch_vccnz Lpoll_71
    s_waitcnt vmcnt(0)
    v_pk_add_f32 v[96:97], v[80:81], v[84:85]
    v_pk_add_f32 v[98:99], v[82:83], v[86:87]
    v_max3_f32 v100, v96, v97, v98
    v_max3_f32 v100, v100, v99, v30
    v_pk_fma_f32 v[104:105], v[96:97], v[30:31], v[98:99]
    v_cmp_u_f32 vcc, v104, v105
    v_max_f32_dpp v100, v100, v100 row_ror:8 row_mask:0xf bank_mask:0xf
    v_sub_f32 v102, v30, v100
    v_pk_add_f32 v[96:97], v[96:97], v[100:101] op_sel_hi:[1,0] neg_lo:[0,1] neg_hi:[0,1]
    v_pk_add_f32 v[98:99], v[98:99], v[100:101] op_sel_hi:[1,0] neg_lo:[0,1] neg_hi:[0,1]
    s_branch Lsok_53
Lxsretry_58:
    s_mul_i32 s58, s25, 37
    s_lshr_b32 s58, s58, 8
    s_mul_i32 s58, s58, 7
    s_sub_u32 s58, s25, s58
    s_lshl_b32 s58, s58, 7
    s_add_u32 s58, s58, s32
    s_mov_b32 s70, 0
Lpoll_72:
    buffer_load_dwordx4 v[80:83], v2, s[8:11], s58 offen sc1
    s_add_u32 s70, s70, 1
    s_cmp_gt_u32 s70, 131072
    s_cbranch_scc1 Lfail
    s_waitcnt vmcnt(0)
    v_max3_u32 v16, v80, v81, v82
    v_max_u32 v16, v16, v83
    v_cmp_eq_u32 vcc, -1, v16
    s_cbranch_vccnz Lpoll_72
    s_mov_b32 s70, 0
Lpoll_73:
    buffer_load_dwordx4 v[80:83], v2, s[8:11], s32 offen offset:0 sc1
    buffer_load_dwordx4 v[84:87], v2, s[8:11], s32 offen offset:128 sc1
    buffer_load_dwordx4 v[88:91], v2, s[8:11], s32 offen offset:256 sc1
    buffer_load_dwordx4 v[92:95], v2, s[8:11], s32 offen offset:384 sc1
    buffer_load_dwordx4 v[96:99], v2, s[8:11], s32 offen offset:512 sc1
    buffer_load_dwordx4 v[100:103], v2, s[8:11], s32 offen offset:640 sc1
    buffer_load_dwordx4 v[104:107], v2, s[8:11], s32 offen offset:768 sc1
    s_add_u32 s70, s70, 1
    s_cmp_gt_u32 s70, 131072
    s_cbranch_scc1 Lfail
    s_waitcnt vmcnt(6)
    v_max3_u32 v16, v80, v81, v82
    s_waitcnt vmcnt(5)
    v_max3_u32 v16, v16, v83, v84
    v_max3_u32 v16, v16, v85, v86
    s_waitcnt vmcnt(4)
    v_max3_u32 v16, v16, v87, v88
    v_max3_u32 v16, v16, v89, v90
    s_waitcnt vmcnt(3)
    v_max3_u32 v16, v16, v91, v92
    v_max3_u32 v16, v16, v93, v94
    s_waitcnt vmcnt(2)
    v_max3_u32 v16, v16, v95, v96
    v_max3_u32 v16, v16, v97, v98
    s_waitcnt vmcnt(1)
    v_max3_u32 v16, v16, v99, v100
    v_max3_u32 v16, v16, v101, v102
    s_waitcnt vmcnt(0)
    v_max3_u32 v16, v16, v103, v104
    v_max3_u32 v16, v16, v105, v106
    v_max_u32 v16, v16, v107
    v_cmp_eq_u32 vcc, -1, v16
    s_cbranch_vccnz Lpoll_73
    ds_write_b128 v3, v[80:83] offset:0
    ds_write_b128 v3, v[84:87] offset:4096
    ds_write_b128 v3, v[88:91] offset:8192
    ds_write_b128 v3, v[92:95] offset:12288
    ds_write_b128 v3, v[96:99] offset:16384
    ds_write_b128 v3, v[100:103] offset:20480
    ds_write_b128 v3, v[104:107] offset:24576
    s_branch Lxsok_57
Lxsu_59:
    s_add_u32 s18, s32, s60
    v_xor_b32 v60, s61, v2
    buffer_load_dwordx4 v[48:51], v60, s[8:11], s18 offen offset:0 sc1
    buffer_load_dwordx4 v[52:55], v60, s[8:11], s18 offen offset:256 sc1
    buffer_load_dwordx4 v[56:59], v60, s[8:11], s18 offen offset:512 sc1
    v_add_u32 v0, s62, v3
    s_waitcnt vmcnt(9)
    ds_write_b128 v3, v[80:83] offset:0
    s_waitcnt vmcnt(8)
    ds_write_b128 v3, v[84:87] offset:4096
    s_waitcnt vmcnt(7)
    ds_write_b128 v3, v[88:91] offset:8192
    s_waitcnt vmcnt(6)
    ds_write_b128 v3, v[92:95] offset:12288
    s_waitcnt vmcnt(5)
    ds_write_b128 v3, v[96:99] offset:16384
    s_waitcnt vmcnt(4)
    ds_write_b128 v3, v[100:103] offset:20480
    s_waitcnt vmcnt(3)
    ds_write_b128 v3, v[104:107] offset:24576
    s_waitcnt vmcnt(2)
    ds_write_b128 v0, v[48:51] offset:0
    s_waitcnt vmcnt(1)
    ds_write_b128 v0, v[52:55] offset:8192
    s_waitcnt vmcnt(0)
    ds_write_b128 v0, v[56:59] offset:16384
    v_max3_u32 v16, v80, v81, v82
    v_max3_u32 v16, v16, v83, v84
    v_max3_u32 v16, v16, v85, v86
    v_max3_u32 v16, v16, v87, v88
    v_max3_u32 v16, v16, v89, v90
    v_max3_u32 v16, v16, v91, v92
    v_max3_u32 v16, v16, v93, v94
    v_max3_u32 v16, v16, v95, v96
    v_max3_u32 v16, v16, v97, v98
    v_max3_u32 v16, v16, v99, v100
    v_max3_u32 v16, v16, v101, v102
    v_max3_u32 v16, v16, v103, v104
    v_max3_u32 v16, v16, v105, v106
    v_max3_u32 v16, v16, v107, v48
    v_max3_u32 v16, v16, v49, v50
    v_max3_u32 v16, v16, v51, v52
    v_max3_u32 v16, v16, v53, v54
    v_max3_u32 v16, v16, v55, v56
    v_max3_u32 v16, v16, v57, v58
    v_max_u32 v16, v16, v59
    v_cmp_eq_u32 vcc, -1, v16
    s_cbranch_vccz Lxsok_57
    s_mul_i32 s58, s25, 37
    s_lshr_b32 s58, s58, 8
    s_mul_i32 s58, s58, 7
    s_sub_u32 s58, s25, s58
    s_lshl_b32 s58, s58, 7
    s_add_u32 s58, s58, s32
    s_mov_b32 s70, 0
Lpoll_74:
    buffer_load_dwordx4 v[80:83], v2, s[8:11], s58 offen sc1
    s_add_u32 s70, s70, 1
    s_cmp_gt_u32 s70, 131072
    s_cbranch_scc1 Lfail
    s_waitcnt vmcnt(0)
    v_max3_u32 v16, v80, v81, v82
    v_max_u32 v16, v16, v83
    v_cmp_eq_u32 vcc, -1, v16
    s_cbranch_vccnz Lpoll_74
    s_mov_b32 s70, 0
Lpoll_75:
    buffer_load_dwordx4 v[80:83], v2, s[8:11], s32 offen offset:0 sc1
    buffer_load_dwordx4 v[84:87], v2, s[8:11], s32 offen offset:128 sc1
    buffer_load_dwordx4 v[88:91], v2, s[8:11], s32 offen offset:256 sc1
    buffer_load_dwordx4 v[92:95], v2, s[8:11], s32 offen offset:384 sc1
    buffer_load_dwordx4 v[96:99], v2, s[8:11], s32 offen offset:512 sc1
    buffer_load_dwordx4 v[100:103], v2, s[8:11], s32 offen offset:640 sc1
    buffer_load_dwordx4 v[104:107], v2, s[8:11], s32 offen offset:768 sc1
    buffer_load_dwordx4 v[48:51], v60, s[8:11], s18 offen offset:0 sc1
    buffer_load_dwordx4 v[52:55], v60, s[8:11], s18 offen offset:256 sc1
    buffer_load_dwordx4 v[56:59], v60, s[8:11], s18 offen offset:512 sc1
    s_add_u32 s70, s70, 1
    s_cmp_gt_u32 s70, 131072
    s_cbranch_scc1 Lfail
    s_waitcnt vmcnt(9)
    v_max3_u32 v16, v80, v81, v82
    s_waitcnt vmcnt(8)
    v_max3_u32 v16, v16, v83, v84
    v_max3_u32 v16, v16, v85, v86
    s_waitcnt vmcnt(7)
    v_max3_u32 v16, v16, v87, v88
    v_max3_u32 v16, v16, v89, v90
    s_waitcnt vmcnt(6)
    v_max3_u32 v16, v16, v91, v92
    v_max3_u32 v16, v16, v93, v94
    s_waitcnt vmcnt(5)
    v_max3_u32 v16, v16, v95, v96
    v_max3_u32 v16, v16, v97, v98
    s_waitcnt vmcnt(4)
    v_max3_u32 v16, v16, v99, v100
    v_max3_u32 v16, v16, v101, v102
    s_waitcnt vmcnt(3)
    v_max3_u32 v16, v16, v103, v104
    v_max3_u32 v16, v16, v105, v106
    s_waitcnt vmcnt(2)
    v_max3_u32 v16, v16, v107, v48
    v_max3_u32 v16, v16, v49, v50
    s_waitcnt vmcnt(1)
    v_max3_u32 v16, v16, v51, v52
    v_max3_u32 v16, v16, v53, v54
    s_waitcnt vmcnt(0)
    v_max3_u32 v16, v16, v55, v56
    v_max3_u32 v16, v16, v57, v58
    v_max_u32 v16, v16, v59
    v_cmp_eq_u32 vcc, -1, v16
    s_cbranch_vccnz Lpoll_75
    ds_write_b128 v3, v[80:83] offset:0
    ds_write_b128 v3, v[84:87] offset:4096
    ds_write_b128 v3, v[88:91] offset:8192
    ds_write_b128 v3, v[92:95] offset:12288
    ds_write_b128 v3, v[96:99] offset:16384
    ds_write_b128 v3, v[100:103] offset:20480
    ds_write_b128 v3, v[104:107] offset:24576
    ds_write_b128 v0, v[48:51] offset:0
    ds_write_b128 v0, v[52:55] offset:8192
    ds_write_b128 v0, v[56:59] offset:16384
    s_branch Lxsok_57
LB:
    s_lshl_b32 s58, s22, 2
    s_add_u32 s58, s58, s20
    s_mul_i32 s58, s58, 3072
    s_add_u32 s58, s58, s30
    v_min_u32 v16, 92, v13
    v_lshlrev_b32 v16, 5, v16
    buffer_load_dword v15, v16, s[8:11], s58 offen sc1
    s_lshl_b32 s58, s22, 2
    s_add_u32 s58, s58, s20
    s_lshl_b32 s59, s58, 13
    s_add_u32 s59, s59, s31
    v_lshlrev_b32 v16, 3, v1
    buffer_load_dword v15, v16, s[8:11], s59 offen sc1
    s_getpc_b64 s[64:65]
Lpc_76:
    s_sub_u32 s64, s64, Lpc_76-Lstart
    s_subb_u32 s65, s65, 0
    s_mov_b32 s66, Lend-Lstart
    s_mov_b32 s67, 0x20000
    s_and_b32 s58, s58, 15
    s_lshl_b32 s58, s58, 13
    buffer_load_dword v15, v16, s[64:67], s58 offen
    s_mov_b64 s[66:67], 1
    s_waitcnt vmcnt(0)
    s_cmp_eq_u32 s23, 0
    s_cbranch_scc1 LB_job
LB_load:
    s_cmp_eq_u64 s[66:67], 0
    s_cbranch_scc1 Lxsok_77
    buffer_load_dwordx4 v[80:83], v2, s[8:11], s32 offen offset:0 sc1
    buffer_load_dwordx4 v[84:87], v2, s[8:11], s32 offen offset:128 sc1
    buffer_load_dwordx4 v[88:91], v2, s[8:11], s32 offen offset:256 sc1
    buffer_load_dwordx4 v[92:95], v2, s[8:11], s32 offen offset:384 sc1
    buffer_load_dwordx4 v[96:99], v2, s[8:11], s32 offen offset:512 sc1
    buffer_load_dwordx4 v[100:103], v2, s[8:11], s32 offen offset:640 sc1
    buffer_load_dwordx4 v[104:107], v2, s[8:11], s32 offen offset:768 sc1
    s_waitcnt vmcnt(6)
    ds_write_b128 v3, v[80:83] offset:0
    s_waitcnt vmcnt(5)
    ds_write_b128 v3, v[84:87] offset:4096
    s_waitcnt vmcnt(4)
    ds_write_b128 v3, v[88:91] offset:8192
    s_waitcnt vmcnt(3)
    ds_write_b128 v3, v[92:95] offset:12288
    s_waitcnt vmcnt(2)
    ds_write_b128 v3, v[96:99] offset:16384
    s_waitcnt vmcnt(1)
    ds_write_b128 v3, v[100:103] offset:20480
    s_waitcnt vmcnt(0)
    ds_write_b128 v3, v[104:107] offset:24576
    v_max3_u32 v16, v80, v81, v82
    v_max3_u32 v16, v16, v83, v84
    v_max3_u32 v16, v16, v85, v86
    v_max3_u32 v16, v16, v87, v88
    v_max3_u32 v16, v16, v89, v90
    v_max3_u32 v16, v16, v91, v92
    v_max3_u32 v16, v16, v93, v94
    v_max3_u32 v16, v16, v95, v96
    v_max3_u32 v16, v16, v97, v98
    v_max3_u32 v16, v16, v99, v100
    v_max3_u32 v16, v16, v101, v102
    v_max3_u32 v16, v16, v103, v104
    v_max3_u32 v16, v16, v105, v106
    v_max_u32 v16, v16, v107
    v_cmp_eq_u32 vcc, -1, v16
    s_cbranch_vccnz Lxsretry_78
Lxsok_77:
    s_waitcnt lgkmcnt(0)
    s_barrier
LB_job:
    ds_read_b128 v[80:83], v4 offset:0
    ds_read_b128 v[108:111], v9 offset:0
    ds_read_b128 v[84:87], v5 offset:0
    s_waitcnt lgkmcnt(2)
    v_mfma_f32_16x16x32_bf16 v[64:67], a[224:227], v[80:83], 0
    ds_read_b128 v[112:115], v9 offset:1024
    s_and_b32 s58, s29, 1
    v_mfma_f32_16x16x32_bf16 v[68:71], v[144:147], v[80:83], 0
    ds_read_b128 v[88:91], v4 offset:4096
    s_mul_i32 s49, s58, 458752
    v_mfma_f32_16x16x32_bf16 v[72:75], v[200:203], v[80:83], 0
    s_mul_i32 s59, s25, 28672
    s_waitcnt lgkmcnt(3)
    v_mfma_f32_16x16x32_bf16 v[76:79], v[108:111], v[80:83], 0
    s_add_u32 s49, s49, s59
    s_waitcnt lgkmcnt(2)
    v_mfma_f32_16x16x32_bf16 v[64:67], a[228:231], v[84:87], v[64:67]
    ds_read_b128 v[108:111], v9 offset:2048
    s_add_u32 s49, s49, s31
    v_mfma_f32_16x16x32_bf16 v[68:71], v[148:151], v[84:87], v[68:71]
    ds_read_b128 v[80:83], v5 offset:4096
    s_lshl_b32 s59, s71, 12
    v_mfma_f32_16x16x32_bf16 v[72:75], v[204:207], v[84:87], v[72:75]
    s_add_u32 s49, s49, s59
    s_waitcnt lgkmcnt(3)
    v_mfma_f32_16x16x32_bf16 v[76:79], v[112:115], v[84:87], v[76:79]
    s_waitcnt lgkmcnt(2)
    v_mfma_f32_16x16x32_bf16 v[64:67], a[232:235], v[88:91], v[64:67]
    ds_read_b128 v[112:115], v9 offset:3072
    v_mfma_f32_16x16x32_bf16 v[68:71], v[152:155], v[88:91], v[68:71]
    ds_read_b128 v[84:87], v4 offset:8192
    v_mfma_f32_16x16x32_bf16 v[72:75], v[208:211], v[88:91], v[72:75]
    s_mul_i32 s58, s28, 28672
    s_lshl_b32 s59, s27, 5
    s_waitcnt lgkmcnt(3)
    v_mfma_f32_16x16x32_bf16 v[76:79], v[108:111], v[88:91], v[76:79]
    s_add_u32 s48, s58, s59
    s_mul_i32 s35, s23, 1835008
    s_waitcnt lgkmcnt(2)
    v_mfma_f32_16x16x32_bf16 v[64:67], a[236:239], v[80:83], v[64:67]
    ds_read_b128 v[108:111], v9 offset:4096
    s_add_u32 s35, s35, s58
    s_lshl_b32 s59, s27, 10
    v_mfma_f32_16x16x32_bf16 v[68:71], v[156:159], v[80:83], v[68:71]
    ds_read_b128 v[88:91], v5 offset:8192
    s_add_u32 s35, s35, s59
    s_lshl_b32 s59, s20, 8
    v_mfma_f32_16x16x32_bf16 v[72:75], v[212:215], v[80:83], v[72:75]
    s_add_u32 s35, s35, s59
    s_add_u32 s35, s35, 4210688
    s_waitcnt lgkmcnt(3)
    v_mfma_f32_16x16x32_bf16 v[76:79], v[112:115], v[80:83], v[76:79]
    s_lshl_b32 s33, s28, 14
    s_add_u32 s33, s33, s3
    s_waitcnt lgkmcnt(2)
    v_mfma_f32_16x16x32_bf16 v[64:67], a[240:243], v[84:87], v[64:67]
    ds_read_b128 v[112:115], v9 offset:5120
    s_lshl_b32 s59, s27, 8
    s_add_u32 s34, s33, s59
    v_mfma_f32_16x16x32_bf16 v[68:71], v[160:163], v[84:87], v[68:71]
    ds_read_b128 v[80:83], v4 offset:12288
    s_add_u32 s34, s34, 16384
    s_add_u32 s53, s33, 7168
    v_mfma_f32_16x16x32_bf16 v[72:75], v[216:219], v[84:87], v[72:75]
    s_and_b32 s58, s29, 1
    s_mul_i32 s50, s58, 114688
    s_waitcnt lgkmcnt(3)
    v_mfma_f32_16x16x32_bf16 v[76:79], v[108:111], v[84:87], v[76:79]
    s_mul_i32 s59, s25, 7168
    s_add_u32 s50, s50, s59
    s_waitcnt lgkmcnt(2)
    v_mfma_f32_16x16x32_bf16 v[64:67], a[244:247], v[88:91], v[64:67]
    ds_read_b128 v[108:111], v9 offset:6144
    s_add_u32 s50, s50, s30
    s_lshl_b32 s18, s58, 15
    v_mfma_f32_16x16x32_bf16 v[68:71], v[164:167], v[88:91], v[68:71]
    ds_read_b128 v[84:87], v5 offset:12288
    s_add_u32 s18, s18, s31
    s_add_u32 s18, s18, 917504
    v_mfma_f32_16x16x32_bf16 v[72:75], v[220:223], v[88:91], v[72:75]
    s_lshl_b32 s59, s20, 13
    s_add_u32 s54, s18, s59
    s_waitcnt lgkmcnt(3)
    v_mfma_f32_16x16x32_bf16 v[76:79], v[112:115], v[88:91], v[76:79]
    s_add_u32 s55, s54, 4096
    s_mul_i32 s58, s58, 16384
    s_waitcnt lgkmcnt(2)
    v_mfma_f32_16x16x32_bf16 v[64:67], a[248:251], v[80:83], v[64:67]
    ds_read_b128 v[112:115], v9 offset:7168
    s_add_u32 s58, s58, s30
    s_add_u32 s58, s58, 229376
    v_mfma_f32_16x16x32_bf16 v[68:71], v[168:171], v[80:83], v[68:71]
    ds_read_b128 v[88:91], v4 offset:16384
    s_lshl_b32 s59, s20, 12
    s_add_u32 s56, s58, s59
    v_mfma_f32_16x16x32_bf16 v[72:75], v[224:227], v[80:83], v[72:75]
    s_lshl_b32 s59, s71, 10
    s_add_u32 s50, s50, s59
    s_waitcnt lgkmcnt(3)
    v_mfma_f32_16x16x32_bf16 v[76:79], v[108:111], v[80:83], v[76:79]
    s_cmp_eq_u32 s26, 1
    s_cselect_b32 s50, 1073741824, s50
    s_waitcnt lgkmcnt(2)
    v_mfma_f32_16x16x32_bf16 v[64:67], a[252:255], v[84:87], v[64:67]
    ds_read_b128 v[108:111], v9 offset:8192
    s_add_u32 s64, s53, 16384
    s_lshl_b32 s59, s22, 2
    v_mfma_f32_16x16x32_bf16 v[68:71], v[172:175], v[84:87], v[68:71]
    ds_read_b128 v[80:83], v5 offset:16384
    s_add_u32 s59, s59, s20
    s_cmp_eq_u32 s59, 1
    v_mfma_f32_16x16x32_bf16 v[72:75], v[228:231], v[84:87], v[72:75]
    s_cselect_b32 s64, s64, 1073741824
    s_and_b32 s58, s29, 3
    s_waitcnt lgkmcnt(3)
    v_mfma_f32_16x16x32_bf16 v[76:79], v[112:115], v[84:87], v[76:79]
    s_mul_i32 s58, s58, 17408
    s_add_u32 s58, s58, s30
    s_waitcnt lgkmcnt(2)
    v_mfma_f32_16x16x32_bf16 v[64:67], v[120:123], v[88:91], v[64:67]
    ds_read_b128 v[112:115], v9 offset:9216
    s_add_u32 s58, s58, 264192
    s_add_u32 s18, s29, 3
    v_mfma_f32_16x16x32_bf16 v[68:71], v[176:179], v[88:91], v[68:71]
    ds_read_b128 v[84:87], v4 offset:20480
    s_and_b32 s18, s18, 3
    s_mul_i32 s18, s18, 17408
    v_mfma_f32_16x16x32_bf16 v[72:75], v[232:235], v[88:91], v[72:75]
    s_add_u32 s18, s18, s30
    s_add_u32 s18, s18, 264192
    s_waitcnt lgkmcnt(3)
    v_mfma_f32_16x16x32_bf16 v[76:79], v[108:111], v[88:91], v[76:79]
    s_lshl_b32 s59, s26, 4
    s_add_u32 s59, s59, s25
    s_waitcnt lgkmcnt(2)
    v_mfma_f32_16x16x32_bf16 v[64:67], v[124:127], v[80:83], v[64:67]
    ds_read_b128 v[108:111], v9 offset:10240
    s_lshl_b32 s59, s59, 8
    s_add_u32 s36, s58, s59
    v_mfma_f32_16x16x32_bf16 v[68:71], v[180:183], v[80:83], v[68:71]
    ds_read_b128 v[88:91], v5 offset:20480
    s_add_u32 s37, s18, s59
    s_lshl_b32 s59, s20, 10
    v_mfma_f32_16x16x32_bf16 v[72:75], v[236:239], v[80:83], v[72:75]
    s_add_u32 s38, s58, s59
    s_add_u32 s39, s38, 4096
    s_waitcnt lgkmcnt(3)
    v_mfma_f32_16x16x32_bf16 v[76:79], v[112:115], v[80:83], v[76:79]
    s_lshl_b32 s59, s20, 11
    s_add_u32 s40, s58, s59
    s_waitcnt lgkmcnt(2)
    v_mfma_f32_16x16x32_bf16 v[64:67], v[128:131], v[84:87], v[64:67]
    ds_read_b128 v[112:115], v9 offset:11264
    s_add_u32 s40, s40, 8192
    s_add_u32 s41, s58, 16384
    v_mfma_f32_16x16x32_bf16 v[68:71], v[184:187], v[84:87], v[68:71]
    ds_read_b128 v[80:83], v4 offset:24576
    v_mfma_f32_16x16x32_bf16 v[72:75], v[240:243], v[84:87], v[72:75]
    s_waitcnt lgkmcnt(3)
    v_mfma_f32_16x16x32_bf16 v[76:79], v[108:111], v[84:87], v[76:79]
    s_waitcnt lgkmcnt(2)
    v_mfma_f32_16x16x32_bf16 v[64:67], v[132:135], v[88:91], v[64:67]
    ds_read_b128 v[108:111], v9 offset:12288
    v_mfma_f32_16x16x32_bf16 v[68:71], v[188:191], v[88:91], v[68:71]
    ds_read_b128 v[84:87], v5 offset:24576
    v_mfma_f32_16x16x32_bf16 v[72:75], v[244:247], v[88:91], v[72:75]
    s_waitcnt lgkmcnt(3)
    v_mfma_f32_16x16x32_bf16 v[76:79], v[112:115], v[88:91], v[76:79]
    s_waitcnt lgkmcnt(2)
    v_mfma_f32_16x16x32_bf16 v[64:67], v[136:139], v[80:83], v[64:67]
    ds_read_b128 v[112:115], v9 offset:13312
    v_mfma_f32_16x16x32_bf16 v[68:71], v[192:195], v[80:83], v[68:71]
    ds_read_b128 v[88:91], v4 offset:2048
    v_mfma_f32_16x16x32_bf16 v[72:75], v[248:251], v[80:83], v[72:75]
    s_waitcnt lgkmcnt(3)
    v_mfma_f32_16x16x32_bf16 v[76:79], v[108:111], v[80:83], v[76:79]
    s_waitcnt lgkmcnt(2)
    v_mfma_f32_16x16x32_bf16 v[64:67], v[140:143], v[84:87], v[64:67]
    ds_read_b128 v[108:111], v9 offset:0
    v_mfma_f32_16x16x32_bf16 v[68:71], v[196:199], v[84:87], v[68:71]
    ds_read_b128 v[80:83], v5 offset:2048
    v_mfma_f32_16x16x32_bf16 v[72:75], v[252:255], v[84:87], v[72:75]
    s_waitcnt lgkmcnt(3)
    v_mfma_f32_16x16x32_bf16 v[76:79], v[112:115], v[84:87], v[76:79]
    s_waitcnt lgkmcnt(2)
    v_mfma_f32_16x16x32_bf16 v[92:95], a[224:227], v[88:91], 0
    ds_read_b128 v[112:115], v9 offset:1024
    v_mfma_f32_16x16x32_bf16 v[96:99], v[144:147], v[88:91], 0
    ds_read_b128 v[84:87], v4 offset:6144
    v_cvt_pk_bf16_f32 v64, v64, v65
    v_cvt_pk_bf16_f32 v65, v66, v67
    v_mfma_f32_16x16x32_bf16 v[100:103], v[200:203], v[88:91], 0
    s_waitcnt lgkmcnt(3)
    v_cvt_pk_bf16_f32 v66, v68, v69
    v_cvt_pk_bf16_f32 v67, v70, v71
    v_mfma_f32_16x16x32_bf16 v[104:107], v[108:111], v[88:91], 0
    buffer_store_dwordx4 v[64:67], v1, s[8:11], s49 offen offset:0
    v_cvt_pk_bf16_f32 v72, v72, v73
    s_waitcnt lgkmcnt(2)
    v_mfma_f32_16x16x32_bf16 v[92:95], a[228:231], v[80:83], v[92:95]
    ds_read_b128 v[108:111], v9 offset:2048
    v_cvt_pk_bf16_f32 v73, v74, v75
    v_cvt_pk_bf16_f32 v74, v76, v77
    v_mfma_f32_16x16x32_bf16 v[96:99], v[148:151], v[80:83], v[96:99]
    ds_read_b128 v[88:91], v5 offset:6144
    v_cvt_pk_bf16_f32 v75, v78, v79
    buffer_store_dwordx4 v[72:75], v1, s[8:11], s49 offen offset:2048
    v_mfma_f32_16x16x32_bf16 v[100:103], v[204:207], v[80:83], v[100:103]
    s_waitcnt lgkmcnt(3)
    v_mfma_f32_16x16x32_bf16 v[104:107], v[112:115], v[80:83], v[104:107]
    s_waitcnt lgkmcnt(2)
    v_mfma_f32_16x16x32_bf16 v[92:95], a[232:235], v[84:87], v[92:95]
    ds_read_b128 v[112:115], v9 offset:3072
    v_mfma_f32_16x16x32_bf16 v[96:99], v[152:155], v[84:87], v[96:99]
    ds_read_b128 v[80:83], v4 offset:10240
    v_mfma_f32_16x16x32_bf16 v[100:103], v[208:211], v[84:87], v[100:103]
    s_waitcnt lgkmcnt(3)
    v_mfma_f32_16x16x32_bf16 v[104:107], v[108:111], v[84:87], v[104:107]
    s_waitcnt lgkmcnt(2)
    v_mfma_f32_16x16x32_bf16 v[92:95], a[236:239], v[88:91], v[92:95]
    ds_read_b128 v[108:111], v9 offset:4096
    v_mfma_f32_16x16x32_bf16 v[96:99], v[156:159], v[88:91], v[96:99]
    ds_read_b128 v[84:87], v5 offset:10240
    v_mfma_f32_16x16x32_bf16 v[100:103], v[212:215], v[88:91], v[100:103]
    s_waitcnt lgkmcnt(3)
    v_mfma_f32_16x16x32_bf16 v[104:107], v[112:115], v[88:91], v[104:107]
    s_waitcnt lgkmcnt(2)
    v_mfma_f32_16x16x32_bf16 v[92:95], a[240:243], v[80:83], v[92:95]
    ds_read_b128 v[112:115], v9 offset:5120
    v_mfma_f32_16x16x32_bf16 v[96:99], v[160:163], v[80:83], v[96:99]
    ds_read_b128 v[88:91], v4 offset:14336
    v_mfma_f32_16x16x32_bf16 v[100:103], v[216:219], v[80:83], v[100:103]
    s_waitcnt lgkmcnt(3)
    v_mfma_f32_16x16x32_bf16 v[104:107], v[108:111], v[80:83], v[104:107]
    s_waitcnt lgkmcnt(2)
    v_mfma_f32_16x16x32_bf16 v[92:95], a[244:247], v[84:87], v[92:95]
    ds_read_b128 v[108:111], v9 offset:6144
    v_mfma_f32_16x16x32_bf16 v[96:99], v[164:167], v[84:87], v[96:99]
    ds_read_b128 v[80:83], v5 offset:14336
    v_mfma_f32_16x16x32_bf16 v[100:103], v[220:223], v[84:87], v[100:103]
    s_waitcnt lgkmcnt(3)
    v_mfma_f32_16x16x32_bf16 v[104:107], v[112:115], v[84:87], v[104:107]
    s_waitcnt lgkmcnt(2)
    v_mfma_f32_16x16x32_bf16 v[92:95], a[248:251], v[88:91], v[92:95]
    ds_read_b128 v[112:115], v9 offset:7168
    s_lshl_b32 s58, s29, 1
    s_or_b32 s58, s58, 0
    v_mfma_f32_16x16x32_bf16 v[96:99], v[168:171], v[88:91], v[96:99]
    ds_read_b128 v[84:87], v4 offset:18432
    v_mov_b32 v26, s58
    v_mfma_f32_16x16x32_bf16 v[100:103], v[224:227], v[88:91], v[100:103]
    s_waitcnt vmcnt(0)
    s_mov_b64 exec, 1
    buffer_store_dword v26, off, s[8:11], s51
    s_mov_b64 exec, -1
    s_waitcnt lgkmcnt(3)
    v_mfma_f32_16x16x32_bf16 v[104:107], v[108:111], v[88:91], v[104:107]
    s_waitcnt lgkmcnt(2)
    v_mfma_f32_16x16x32_bf16 v[92:95], a[252:255], v[80:83], v[92:95]
    ds_read_b128 v[108:111], v9 offset:8192
    v_mfma_f32_16x16x32_bf16 v[96:99], v[172:175], v[80:83], v[96:99]
    ds_read_b128 v[88:91], v5 offset:18432
    v_mfma_f32_16x16x32_bf16 v[100:103], v[228:231], v[80:83], v[100:103]
    s_waitcnt lgkmcnt(3)
    v_mfma_f32_16x16x32_bf16 v[104:107], v[112:115], v[80:83], v[104:107]
    s_waitcnt lgkmcnt(2)
    v_mfma_f32_16x16x32_bf16 v[92:95], v[120:123], v[84:87], v[92:95]
    ds_read_b128 v[112:115], v9 offset:9216
    v_mfma_f32_16x16x32_bf16 v[96:99], v[176:179], v[84:87], v[96:99]
    ds_read_b128 v[80:83], v4 offset:22528
    v_mfma_f32_16x16x32_bf16 v[100:103], v[232:235], v[84:87], v[100:103]
    s_waitcnt lgkmcnt(3)
    v_mfma_f32_16x16x32_bf16 v[104:107], v[108:111], v[84:87], v[104:107]
    s_waitcnt lgkmcnt(2)
    v_mfma_f32_16x16x32_bf16 v[92:95], v[124:127], v[88:91], v[92:95]
    ds_read_b128 v[108:111], v9 offset:10240
    v_mfma_f32_16x16x32_bf16 v[96:99], v[180:183], v[88:91], v[96:99]
    ds_read_b128 v[84:87], v5 offset:22528
    v_mfma_f32_16x16x32_bf16 v[100:103], v[236:239], v[88:91], v[100:103]
    s_waitcnt lgkmcnt(3)
    v_mfma_f32_16x16x32_bf16 v[104:107], v[112:115], v[88:91], v[104:107]
    s_waitcnt lgkmcnt(2)
    v_mfma_f32_16x16x32_bf16 v[92:95], v[128:131], v[80:83], v[92:95]
    ds_read_b128 v[112:115], v9 offset:11264
    v_mfma_f32_16x16x32_bf16 v[96:99], v[184:187], v[80:83], v[96:99]
    ds_read_b128 v[88:91], v4 offset:26624
    v_mfma_f32_16x16x32_bf16 v[100:103], v[240:243], v[80:83], v[100:103]
    s_waitcnt lgkmcnt(3)
    v_mfma_f32_16x16x32_bf16 v[104:107], v[108:111], v[80:83], v[104:107]
    s_waitcnt lgkmcnt(2)
    v_mfma_f32_16x16x32_bf16 v[92:95], v[132:135], v[84:87], v[92:95]
    ds_read_b128 v[108:111], v9 offset:12288
    v_mfma_f32_16x16x32_bf16 v[96:99], v[188:191], v[84:87], v[96:99]
    ds_read_b128 v[80:83], v5 offset:26624
    v_mfma_f32_16x16x32_bf16 v[100:103], v[244:247], v[84:87], v[100:103]
    s_waitcnt lgkmcnt(3)
    v_mfma_f32_16x16x32_bf16 v[104:107], v[112:115], v[84:87], v[104:107]
    s_waitcnt lgkmcnt(2)
    v_mfma_f32_16x16x32_bf16 v[92:95], v[136:139], v[88:91], v[92:95]
    ds_read_b128 v[112:115], v9 offset:13312
    v_mfma_f32_16x16x32_bf16 v[96:99], v[192:195], v[88:91], v[96:99]
    v_mfma_f32_16x16x32_bf16 v[100:103], v[248:251], v[88:91], v[100:103]
    s_waitcnt lgkmcnt(2)
    v_mfma_f32_16x16x32_bf16 v[104:107], v[108:111], v[88:91], v[104:107]
    s_waitcnt lgkmcnt(1)
    v_mfma_f32_16x16x32_bf16 v[92:95], v[140:143], v[80:83], v[92:95]
    v_mfma_f32_16x16x32_bf16 v[96:99], v[196:199], v[80:83], v[96:99]
    v_mfma_f32_16x16x32_bf16 v[100:103], v[252:255], v[80:83], v[100:103]
    s_waitcnt lgkmcnt(0)
    v_mfma_f32_16x16x32_bf16 v[104:107], v[112:115], v[80:83], v[104:107]
    v_cvt_pk_bf16_f32 v92, v92, v93
    v_cvt_pk_bf16_f32 v93, v94, v95
    v_cvt_pk_bf16_f32 v94, v96, v97
    v_cvt_pk_bf16_f32 v95, v98, v99
    buffer_store_dwordx4 v[92:95], v1, s[8:11], s49 offen offset:1024
    v_cvt_pk_bf16_f32 v100, v100, v101
    v_cvt_pk_bf16_f32 v101, v102, v103
    s_nop 0
    v_cvt_pk_bf16_f32 v102, v104, v105
    v_cvt_pk_bf16_f32 v103, v106, v107
    buffer_store_dwordx4 v[100:103], v1, s[8:11], s49 offen offset:3072
    s_lshl_b32 s58, s29, 1
    s_or_b32 s58, s58, 1
    v_mov_b32 v26, s58
    s_waitcnt vmcnt(0)
    s_mov_b64 exec, 1
    buffer_store_dword v26, off, s[8:11], s51
    s_mov_b64 exec, -1
    s_xor_b32 s19, s19, 98304
    s_add_u32 s91, s32, 86016
    s_cmp_lt_u32 s28, 61
    s_cselect_b32 s91, s91, 1073741824
    s_add_u32 m0, s19, 0
    s_nop 0
    buffer_load_dwordx4 v2, s[8:11], s91 offen offset:0 sc1 lds
    s_add_u32 m0, s19, 3968
    s_nop 0
    buffer_load_dwordx4 v2, s[8:11], s91 offen offset:128 sc1 lds
    s_add_u32 m0, s19, 7936
    s_nop 0
    buffer_load_dwordx4 v2, s[8:11], s91 offen offset:256 sc1 lds
    s_add_u32 m0, s19, 11904
    s_nop 0
    buffer_load_dwordx4 v2, s[8:11], s91 offen offset:384 sc1 lds
    s_add_u32 m0, s19, 15872
    s_nop 0
    buffer_load_dwordx4 v2, s[8:11], s91 offen offset:512 sc1 lds
    s_add_u32 m0, s19, 19840
    s_nop 0
    buffer_load_dwordx4 v2, s[8:11], s91 offen offset:640 sc1 lds
    s_add_u32 m0, s19, 23808
    s_nop 0
    buffer_load_dwordx4 v2, s[8:11], s91 offen offset:768 sc1 lds
    s_and_b32 s59, s25, 3
    s_lshl_b32 s59, s59, 2
    s_add_u32 s59, s59, s20
    s_mul_i32 s59, s59, 1792
    s_mul_i32 s58, s28, 28672
    s_add_u32 s58, s58, s59
    v_min_u32 v16, 52, v13
    v_lshlrev_b32 v16, 5, v16
    buffer_load_dword v15, v16, s[12:15], s58 offen sc1
    s_add_u32 s58, s28, 4
    s_cmp_ge_u32 s58, 64
    s_cbranch_scc1 LB_noclr
    s_and_b32 s59, s25, 3
    s_lshl_b32 s59, s59, 2
    s_add_u32 s59, s59, s20
    s_lshl_b32 s18, s58, 14
    s_add_u32 s18, s18, s3
    s_lshl_b32 s63, s59, 10
    s_add_u32 s18, s18, s63
    s_cmp_lt_u32 s59, 8
    s_cselect_b32 s18, s18, 1073741824
    v_mov_b32 v64, -1
    v_mov_b32 v65, -1
    v_mov_b32 v66, -1
    v_mov_b32 v67, -1
    buffer_store_dwordx4 v[64:67], v1, s[8:11], s18 offen sc1
    s_mul_i32 s58, s58, 28672
    s_lshl_b32 s63, s59, 11
    s_add_u32 s58, s58, s63
    s_cmp_lt_u32 s59, 14
    s_cbranch_scc0 LB_noclr
    s_mul_i32 s18, s23, 1835008
    s_add_u32 s18, s18, s58
    s_add_u32 s18, s18, 4210688
    buffer_store_dwordx4 v[64:67], v1, s[8:11], s18 offen sc1
    buffer_store_dwordx4 v[64:67], v1, s[8:11], s18 offen offset:1024 sc1
    s_cmp_eq_u32 s23, 0
    s_cbranch_scc0 LB_noclr
    s_add_u32 s18, s58, 7880704
    buffer_store_dwordx4 v[64:67], v1, s[8:11], s18 offen sc1
    buffer_store_dwordx4 v[64:67], v1, s[8:11], s18 offen offset:1024 sc1
    s_add_u32 s18, s58, 9715712
    buffer_store_dwordx4 v[64:67], v1, s[8:11], s18 offen sc1
    buffer_store_dwordx4 v[64:67], v1, s[8:11], s18 offen offset:1024 sc1
LB_noclr:
    buffer_load_dword v0, off, s[8:11], s53 sc1
    s_cmp_eq_u32 s23, 0
    s_cbranch_scc1 Lnoprobe_81
    v_xor_b32 v26, 98304, v3
    s_waitcnt vmcnt(2)
    ds_read_b128 v[80:83], v26 offset:0
    ds_read_b128 v[84:87], v26 offset:4096
    ds_read_b128 v[88:91], v26 offset:8192
    ds_read_b128 v[92:95], v26 offset:12288
    ds_read_b128 v[96:99], v26 offset:16384
    ds_read_b128 v[100:103], v26 offset:20480
    ds_read_b128 v[104:107], v26 offset:24576
    s_waitcnt lgkmcnt(6)
    v_max3_u32 v16, v80, v81, v82
    s_waitcnt lgkmcnt(5)
    v_max3_u32 v16, v16, v83, v84
    v_max3_u32 v16, v16, v85, v86
    s_waitcnt lgkmcnt(4)
    v_max3_u32 v16, v16, v87, v88
    v_max3_u32 v16, v16, v89, v90
    s_waitcnt lgkmcnt(3)
    v_max3_u32 v16, v16, v91, v92
    v_max3_u32 v16, v16, v93, v94
    s_waitcnt lgkmcnt(2)
    v_max3_u32 v16, v16, v95, v96
    v_max3_u32 v16, v16, v97, v98
    s_waitcnt lgkmcnt(1)
    v_max3_u32 v16, v16, v99, v100
    v_max3_u32 v16, v16, v101, v102
    s_waitcnt lgkmcnt(0)
    v_max3_u32 v16, v16, v103, v104
    v_max3_u32 v16, v16, v105, v106
    v_max_u32 v16, v16, v107
    v_cmp_eq_u32 vcc, -1, v16
    s_mov_b64 s[66:67], vcc
Lnoprobe_81:
    s_branch LA_chain
LB_after:
    buffer_store_dwordx4 v[116:119], v1, s[8:11], s50 offen
    s_add_u32 s28, s28, 3
    s_add_u32 s32, s32, 86016
    v_xor_b32 v3, 98304, v3
    s_cmp_ge_u32 s28, 64
    s_cbranch_scc1 Lend
    v_mov_b32 v16, -1
    buffer_store_dword v16, v24, s[8:11], s37 offen
    v_xor_b32 v4, 98304, v4
    v_xor_b32 v5, 98304, v5
    s_add_u32 s29, s29, 1
    s_waitcnt vmcnt(0)
    s_cmp_eq_u32 s23, 0
    s_cbranch_scc1 LB_job
    s_branch LB_load
Lxsretry_78:
    s_mul_i32 s58, s25, 37
    s_lshr_b32 s58, s58, 8
    s_mul_i32 s58, s58, 7
    s_sub_u32 s58, s25, s58
    s_lshl_b32 s58, s58, 7
    s_add_u32 s58, s58, s32
    s_mov_b32 s70, 0
Lpoll_82:
    buffer_load_dwordx4 v[80:83], v2, s[8:11], s58 offen sc1
    s_add_u32 s70, s70, 1
    s_cmp_gt_u32 s70, 131072
    s_cbranch_scc1 Lfail
    s_waitcnt vmcnt(0)
    v_max3_u32 v16, v80, v81, v82
    v_max_u32 v16, v16, v83
    v_cmp_eq_u32 vcc, -1, v16
    s_cbranch_vccnz Lpoll_82
    s_mov_b32 s70, 0
Lpoll_83:
    buffer_load_dwordx4 v[80:83], v2, s[8:11], s32 offen offset:0 sc1
    buffer_load_dwordx4 v[84:87], v2, s[8:11], s32 offen offset:128 sc1
    buffer_load_dwordx4 v[88:91], v2, s[8:11], s32 offen offset:256 sc1
    buffer_load_dwordx4 v[92:95], v2, s[8:11], s32 offen offset:384 sc1
    buffer_load_dwordx4 v[96:99], v2, s[8:11], s32 offen offset:512 sc1
    buffer_load_dwordx4 v[100:103], v2, s[8:11], s32 offen offset:640 sc1
    buffer_load_dwordx4 v[104:107], v2, s[8:11], s32 offen offset:768 sc1
    s_add_u32 s70, s70, 1
    s_cmp_gt_u32 s70, 131072
    s_cbranch_scc1 Lfail
    s_waitcnt vmcnt(6)
    v_max3_u32 v16, v80, v81, v82
    s_waitcnt vmcnt(5)
    v_max3_u32 v16, v16, v83, v84
    v_max3_u32 v16, v16, v85, v86
    s_waitcnt vmcnt(4)
    v_max3_u32 v16, v16, v87, v88
    v_max3_u32 v16, v16, v89, v90
    s_waitcnt vmcnt(3)
    v_max3_u32 v16, v16, v91, v92
    v_max3_u32 v16, v16, v93, v94
    s_waitcnt vmcnt(2)
    v_max3_u32 v16, v16, v95, v96
    v_max3_u32 v16, v16, v97, v98
    s_waitcnt vmcnt(1)
    v_max3_u32 v16, v16, v99, v100
    v_max3_u32 v16, v16, v101, v102
    s_waitcnt vmcnt(0)
    v_max3_u32 v16, v16, v103, v104
    v_max3_u32 v16, v16, v105, v106
    v_max_u32 v16, v16, v107
    v_cmp_eq_u32 vcc, -1, v16
    s_cbranch_vccnz Lpoll_83
    ds_write_b128 v3, v[80:83] offset:0
    ds_write_b128 v3, v[84:87] offset:4096
    ds_write_b128 v3, v[88:91] offset:8192
    ds_write_b128 v3, v[92:95] offset:12288
    ds_write_b128 v3, v[96:99] offset:16384
    ds_write_b128 v3, v[100:103] offset:20480
    ds_write_b128 v3, v[104:107] offset:24576
    s_branch Lxsok_77
LX:
    s_lshl_b32 s58, s22, 2
    s_add_u32 s58, s58, s20
    s_mul_i32 s58, s58, 3072
    s_add_u32 s58, s58, s30
    v_min_u32 v16, 92, v13
    v_lshlrev_b32 v16, 5, v16
    buffer_load_dword v15, v16, s[8:11], s58 offen sc1
    s_lshl_b32 s58, s22, 2
    s_add_u32 s58, s58, s20
    s_lshl_b32 s59, s58, 13
    s_add_u32 s59, s59, s31
    v_lshlrev_b32 v16, 3, v1
    buffer_load_dword v15, v16, s[8:11], s59 offen sc1
    s_getpc_b64 s[64:65]
Lpc_84:
    s_sub_u32 s64, s64, Lpc_84-Lstart
    s_subb_u32 s65, s65, 0
    s_mov_b32 s66, Lend-Lstart
    s_mov_b32 s67, 0x20000
    s_and_b32 s58, s58, 15
    s_lshl_b32 s58, s58, 13
    buffer_load_dword v15, v16, s[64:67], s58 offen
    v_lshrrev_b32 v51, 1, v49
    v_and_b32 v52, 1, v49
    v_lshl_add_u32 v51, v52, 1, v51
    v_lshrrev_b32 v52, 2, v48
    v_lshl_add_u32 v52, v52, 3, v51
    v_lshlrev_b32 v52, 5, v52
    v_and_b32 v53, 3, v0
    v_lshl_add_u32 v52, v53, 2, v52
    s_lshr_b32 s58, s25, 2
    s_lshl_b32 s58, s58, 11
    s_and_b32 s59, s25, 1
    s_lshl_b32 s59, s59, 10
    s_add_u32 s58, s58, s59
    s_and_b32 s59, s25, 2
    s_lshl_b32 s59, s59, 6
    s_add_u32 s58, s58, s59
    s_add_u32 s58, s58, 8192
    v_add_u32 v21, s58, v52
    s_lshl_b32 s58, s25, 6
    s_add_u32 s58, s58, 16384
    v_lshlrev_b32 v51, 4, v51
    v_add_u32 v51, s58, v51
    v_cmp_eq_u32 vcc, 0, v48
    s_nop 1
    v_cndmask_b32 v22, v54, v51, vcc
    s_lshr_b32 s58, s25, 2
    s_lshl_b32 s58, s58, 12
    s_and_b32 s59, s25, 3
    v_lshrrev_b32 v51, 1, v49
    v_and_b32 v52, 1, v49
    v_lshlrev_b32 v53, 4, v48
    v_add_u32 v53, s58, v53
    v_lshl_add_u32 v55, v51, 10, v53
    v_lshl_add_u32 v55, v52, 3, v55
    s_lshl_b32 s58, s59, 8
    v_add_u32 v23, s58, v55
    v_lshl_add_u32 v55, v51, 8, v53
    s_lshl_b32 s58, s59, 2
    s_add_u32 s58, s58, 2048
    v_add_u32 v55, s58, v55
    v_cmp_eq_u32 vcc, 0, v52
    s_nop 1
    v_cndmask_b32 v20, v54, v55, vcc
    v_lshlrev_b32 v51, 2, v49
    v_add_u32 v52, 0, v51
    v_cmp_le_u32 s[60:61], v52, v48
    v_add_u32 v52, 1, v51
    v_cmp_le_u32 s[62:63], v52, v48
    v_add_u32 v52, 2, v51
    v_cmp_le_u32 s[64:65], v52, v48
    v_add_u32 v52, 3, v51
    v_cmp_le_u32 s[66:67], v52, v48
    v_min_u32 v26, 24, v13
    v_mov_b32 v48, 0
    v_mov_b32 v49, 0
    v_mov_b32 v50, 0
    v_mov_b32 v51, 0
    ds_write_b128 v18, v[48:51]
    v_mov_b32 v232, -1
    v_mov_b32 v233, -1
    v_mov_b32 v234, -1
    v_mov_b32 v235, -1
    s_waitcnt vmcnt(0) lgkmcnt(0)
    s_cmp_eq_u32 s23, 0
    s_cbranch_scc1 LX_first
    s_barrier
    s_branch LX_first
LX_job:
    ds_read_b128 v[80:83], v4 offset:0
    ds_read_b128 v[84:87], v5 offset:0
    s_waitcnt lgkmcnt(1)
    v_mfma_f32_16x16x32_bf16 v[92:95], v[80:83], a[0:3], 0
    s_and_b32 s58, s29, 1
    buffer_load_dwordx4 v[48:51], v1, s[8:11], s54 offen offset:0 sc1
    s_mov_b32 s57, s35
    v_mfma_f32_16x16x32_bf16 v[96:99], v[80:83], a[56:59], 0
    ds_read_b128 v[88:91], v4 offset:4096
    s_mul_i32 s49, s58, 458752
    v_mfma_f32_16x16x32_bf16 v[100:103], v[80:83], a[112:115], 0
    s_mul_i32 s59, s25, 28672
    buffer_load_dwordx4 v[52:55], v1, s[8:11], s54 offen offset:1024 sc1
    v_mfma_f32_16x16x32_bf16 v[104:107], v[80:83], a[168:171], 0
    s_add_u32 s49, s49, s59
    s_waitcnt lgkmcnt(1)
    v_mfma_f32_16x16x32_bf16 v[92:95], v[84:87], a[4:7], v[92:95]
    s_add_u32 s49, s49, s31
    buffer_load_dwordx4 v[56:59], v1, s[8:11], s54 offen offset:2048 sc1
    v_mfma_f32_16x16x32_bf16 v[96:99], v[84:87], a[60:63], v[96:99]
    ds_read_b128 v[80:83], v5 offset:4096
    v_mfma_f32_16x16x32_bf16 v[100:103], v[84:87], a[116:119], v[100:103]
    buffer_load_dwordx4 v[60:63], v1, s[8:11], s54 offen offset:3072 sc1
    v_mfma_f32_16x16x32_bf16 v[104:107], v[84:87], a[172:175], v[104:107]
    s_waitcnt lgkmcnt(1)
    v_mfma_f32_16x16x32_bf16 v[92:95], v[88:91], a[8:11], v[92:95]
    buffer_load_dwordx4 v[64:67], v1, s[8:11], s55 offen offset:0 sc1
    v_mfma_f32_16x16x32_bf16 v[96:99], v[88:91], a[64:67], v[96:99]
    ds_read_b128 v[84:87], v4 offset:8192
    v_mfma_f32_16x16x32_bf16 v[100:103], v[88:91], a[120:123], v[100:103]
    v_mfma_f32_16x16x32_bf16 v[104:107], v[88:91], a[176:179], v[104:107]
    buffer_load_dwordx4 v[68:71], v1, s[8:11], s55 offen offset:1024 sc1
    s_waitcnt lgkmcnt(1)
    v_mfma_f32_16x16x32_bf16 v[92:95], v[80:83], a[12:15], v[92:95]
    v_mfma_f32_16x16x32_bf16 v[96:99], v[80:83], a[68:71], v[96:99]
    ds_read_b128 v[88:91], v5 offset:8192
    v_mfma_f32_16x16x32_bf16 v[100:103], v[80:83], a[124:127], v[100:103]
    buffer_load_dwordx4 v[72:75], v1, s[8:11], s55 offen offset:2048 sc1
    v_mfma_f32_16x16x32_bf16 v[104:107], v[80:83], a[180:183], v[104:107]
    s_waitcnt lgkmcnt(1)
    v_mfma_f32_16x16x32_bf16 v[92:95], v[84:87], a[16:19], v[92:95]
    v_mfma_f32_16x16x32_bf16 v[96:99], v[84:87], a[72:75], v[96:99]
    ds_read_b128 v[80:83], v4 offset:12288
    buffer_load_dwordx4 v[76:79], v1, s[8:11], s55 offen offset:3072 sc1
    v_mfma_f32_16x16x32_bf16 v[100:103], v[84:87], a[128:131], v[100:103]
    v_mfma_f32_16x16x32_bf16 v[104:107], v[84:87], a[184:187], v[104:107]
    s_waitcnt lgkmcnt(1)
    v_mfma_f32_16x16x32_bf16 v[92:95], v[88:91], a[20:23], v[92:95]
    s_waitcnt vmcnt(7)
    v_mfma_f32_16x16x32_bf16 v[48:51], v[32:35], v[48:51], 0
    s_waitcnt vmcnt(6)
    v_mfma_f32_16x16x32_bf16 v[52:55], v[32:35], v[52:55], 0
    s_waitcnt vmcnt(5)
    v_mfma_f32_16x16x32_bf16 v[56:59], v[36:39], v[56:59], 0
    s_waitcnt vmcnt(4)
    v_mfma_f32_16x16x32_bf16 v[60:63], v[36:39], v[60:63], 0
    v_mfma_f32_16x16x32_bf16 v[96:99], v[88:91], a[76:79], v[96:99]
    ds_read_b128 v[84:87], v5 offset:12288
    buffer_load_dwordx4 v[32:35], v25, s[8:11], s56 offen offset:2048 sc1
    v_mfma_f32_16x16x32_bf16 v[100:103], v[88:91], a[132:135], v[100:103]
    v_mfma_f32_16x16x32_bf16 v[104:107], v[88:91], a[188:191], v[104:107]
    s_waitcnt lgkmcnt(1)
    v_mfma_f32_16x16x32_bf16 v[92:95], v[80:83], a[24:27], v[92:95]
    buffer_load_dwordx4 v[36:39], v25, s[8:11], s56 offen offset:2304 sc1
    v_mfma_f32_16x16x32_bf16 v[96:99], v[80:83], a[80:83], v[96:99]
    ds_read_b128 v[88:91], v4 offset:16384
    v_mfma_f32_16x16x32_bf16 v[100:103], v[80:83], a[136:139], v[100:103]
    v_mfma_f32_16x16x32_bf16 v[104:107], v[80:83], a[192:195], v[104:107]
    s_waitcnt lgkmcnt(1)
    v_mfma_f32_16x16x32_bf16 v[92:95], v[84:87], a[28:31], v[92:95]
    v_mfma_f32_16x16x32_bf16 v[96:99], v[84:87], a[84:87], v[96:99]
    ds_read_b128 v[80:83], v5 offset:16384
    v_mfma_f32_16x16x32_bf16 v[100:103], v[84:87], a[140:143], v[100:103]
    v_mfma_f32_16x16x32_bf16 v[104:107], v[84:87], a[196:199], v[104:107]
    s_waitcnt lgkmcnt(1)
    v_mfma_f32_16x16x32_bf16 v[92:95], v[88:91], a[32:35], v[92:95]
    s_waitcnt vmcnt(5)
    v_mfma_f32_16x16x32_bf16 v[64:67], v[40:43], v[64:67], 0
    s_waitcnt vmcnt(4)
    v_mfma_f32_16x16x32_bf16 v[68:71], v[40:43], v[68:71], 0
    s_waitcnt vmcnt(3)
    v_mfma_f32_16x16x32_bf16 v[72:75], v[44:47], v[72:75], 0
    s_waitcnt vmcnt(2)
    v_mfma_f32_16x16x32_bf16 v[76:79], v[44:47], v[76:79], 0
    v_mfma_f32_16x16x32_bf16 v[96:99], v[88:91], a[88:91], v[96:99]
    ds_read_b128 v[84:87], v4 offset:20480
    buffer_load_dwordx4 v[40:43], v1, s[8:11], s56 offen offset:0 sc1
    v_mfma_f32_16x16x32_bf16 v[100:103], v[88:91], a[144:147], v[100:103]
    v_mfma_f32_16x16x32_bf16 v[104:107], v[88:91], a[200:203], v[104:107]
    buffer_load_dwordx4 v[44:47], v1, s[8:11], s56 offen offset:1024 sc1
    s_waitcnt lgkmcnt(1)
    v_mfma_f32_16x16x32_bf16 v[92:95], v[80:83], a[36:39], v[92:95]
    buffer_store_dword v232, v24, s[8:11], s37 offen
    v_mfma_f32_16x16x32_bf16 v[96:99], v[80:83], a[92:95], v[96:99]
    ds_read_b128 v[88:91], v5 offset:20480
    v_mfma_f32_16x16x32_bf16 v[100:103], v[80:83], a[148:151], v[100:103]
    buffer_store_dword v232, v21, s[8:11], s43 offen offset:0
    v_mfma_f32_16x16x32_bf16 v[104:107], v[80:83], a[204:207], v[104:107]
    s_waitcnt lgkmcnt(1)
    v_mfma_f32_16x16x32_bf16 v[92:95], v[84:87], a[40:43], v[92:95]
    buffer_store_dword v232, v21, s[8:11], s43 offen offset:16
    v_mfma_f32_16x16x32_bf16 v[96:99], v[84:87], a[96:99], v[96:99]
    ds_read_b128 v[80:83], v4 offset:24576
    v_mfma_f32_16x16x32_bf16 v[100:103], v[84:87], a[152:155], v[100:103]
    s_waitcnt vmcnt(6)
    v_max3_u32 v16, v32, v33, v34
    s_waitcnt vmcnt(5)
    v_max3_u32 v16, v16, v35, v36
    buffer_store_dwordx4 v[232:235], v22, s[8:11], s43 offen
    v_mfma_f32_16x16x32_bf16 v[104:107], v[84:87], a[208:211], v[104:107]
    s_waitcnt lgkmcnt(1)
    v_max3_u32 v16, v16, v37, v38
    v_max3_u32 v16, v16, v39, v15
    v_mfma_f32_16x16x32_bf16 v[92:95], v[88:91], a[44:47], v[92:95]
    v_cmp_eq_u32 vcc, -1, v16
    s_cbranch_vccnz Lalretry_86
Lalok_85:
    buffer_store_dwordx4 v[232:235], v1, s[8:11], s50 offen offset:0
    v_mfma_f32_16x16x32_bf16 v[96:99], v[88:91], a[100:103], v[96:99]
    ds_read_b128 v[84:87], v5 offset:24576
    v_mul_f32 v48, v48, v32
    v_mul_f32 v49, v49, v32
    v_mfma_f32_16x16x32_bf16 v[100:103], v[88:91], a[156:159], v[100:103]
    v_mul_f32 v50, v50, v32
    v_mul_f32 v51, v51, v32
    buffer_store_dwordx4 v[232:235], v1, s[8:11], s50 offen offset:1024
    v_mfma_f32_16x16x32_bf16 v[104:107], v[88:91], a[212:215], v[104:107]
    s_waitcnt lgkmcnt(1)
    v_mul_f32 v52, v52, v36
    v_mul_f32 v53, v53, v36
    v_mfma_f32_16x16x32_bf16 v[92:95], v[80:83], a[48:51], v[92:95]
    v_mul_f32 v54, v54, v36
    v_mul_f32 v55, v55, v36
    buffer_store_dwordx4 v[232:235], v1, s[8:11], s50 offen offset:2048
    v_mfma_f32_16x16x32_bf16 v[96:99], v[80:83], a[104:107], v[96:99]
    ds_read_b128 v[88:91], v4 offset:2048
    v_fmac_f32 v48, v64, v34
    v_fmac_f32 v49, v65, v34
    v_mfma_f32_16x16x32_bf16 v[100:103], v[80:83], a[160:163], v[100:103]
    v_fmac_f32 v50, v66, v34
    v_fmac_f32 v51, v67, v34
    buffer_store_dwordx4 v[232:235], v1, s[8:11], s50 offen offset:3072
    v_mfma_f32_16x16x32_bf16 v[104:107], v[80:83], a[216:219], v[104:107]
    s_waitcnt lgkmcnt(1)
    v_fmac_f32 v52, v68, v38
    v_fmac_f32 v53, v69, v38
    v_mfma_f32_16x16x32_bf16 v[92:95], v[84:87], a[52:55], v[92:95]
    v_fmac_f32 v54, v70, v38
    v_fmac_f32 v55, v71, v38
    v_mfma_f32_16x16x32_bf16 v[96:99], v[84:87], a[108:111], v[96:99]
    ds_read_b128 v[80:83], v5 offset:2048
    v_fmac_f32 v48, v72, v35
    v_fmac_f32 v49, v73, v35
    v_mfma_f32_16x16x32_bf16 v[100:103], v[84:87], a[164:167], v[100:103]
    v_fmac_f32 v50, v74, v35
    v_fmac_f32 v51, v75, v35
    v_mfma_f32_16x16x32_bf16 v[104:107], v[84:87], a[220:223], v[104:107]
    s_waitcnt lgkmcnt(1)
    v_fmac_f32 v52, v76, v39
    v_fmac_f32 v53, v77, v39
    v_mfma_f32_16x16x32_bf16 v[120:123], v[88:91], a[0:3], 0
    v_fmac_f32 v54, v78, v39
    v_fmac_f32 v55, v79, v39
    v_mfma_f32_16x16x32_bf16 v[124:127], v[88:91], a[56:59], 0
    ds_read_b128 v[84:87], v4 offset:6144
    v_fmac_f32 v48, v56, v33
    v_fmac_f32 v49, v57, v33
    buffer_load_dword v142, v26, s[8:11], s51 offen sc1
    v_mfma_f32_16x16x32_bf16 v[128:131], v[88:91], a[112:115], 0
    v_fmac_f32 v50, v58, v33
    v_fmac_f32 v51, v59, v33
    v_mfma_f32_16x16x32_bf16 v[132:135], v[88:91], a[168:171], 0
    s_waitcnt lgkmcnt(1)
    v_fmac_f32 v52, v60, v37
    v_fmac_f32 v53, v61, v37
    v_mfma_f32_16x16x32_bf16 v[120:123], v[80:83], a[4:7], v[120:123]
    v_fmac_f32 v54, v62, v37
    v_fmac_f32 v55, v63, v37
    v_mfma_f32_16x16x32_bf16 v[124:127], v[80:83], a[60:63], v[124:127]
    ds_read_b128 v[88:91], v5 offset:6144
    s_waitcnt vmcnt(10)
    v_max3_u32 v16, v40, v41, v42
    s_waitcnt vmcnt(9)
    v_max3_u32 v16, v16, v43, v44
    v_mfma_f32_16x16x32_bf16 v[128:131], v[80:83], a[116:119], v[128:131]
    v_max3_u32 v16, v16, v45, v46
    v_max_u32 v16, v16, v47
    v_mfma_f32_16x16x32_bf16 v[132:135], v[80:83], a[172:175], v[132:135]
    v_cmp_eq_u32 vcc, -1, v16
    s_cbranch_vccnz Lpretry_88
Lpok_87:
    v_mfma_f32_16x16x32_bf16 v[48:51], v[116:119], v[40:43], v[48:51]
    v_mfma_f32_16x16x32_bf16 v[52:55], v[116:119], v[44:47], v[52:55]
    s_waitcnt lgkmcnt(1)
    v_mfma_f32_16x16x32_bf16 v[120:123], v[84:87], a[8:11], v[120:123]
    ds_write_b128 v11, v[48:51] offset:12288
    v_mfma_f32_16x16x32_bf16 v[124:127], v[84:87], a[64:67], v[124:127]
    ds_read_b128 v[80:83], v4 offset:10240
    ds_write_b128 v11, v[52:55] offset:13312
    v_mfma_f32_16x16x32_bf16 v[128:131], v[84:87], a[120:123], v[128:131]
    v_lshlrev_b32 v32, 16, v15
    v_and_b32 v33, 0xffff0000, v15
    v_mfma_f32_16x16x32_bf16 v[132:135], v[84:87], a[176:179], v[132:135]
    s_waitcnt lgkmcnt(3)
    v_mfma_f32_16x16x32_bf16 v[120:123], v[88:91], a[12:15], v[120:123]
    v_mfma_f32_16x16x32_bf16 v[124:127], v[88:91], a[68:71], v[124:127]
    ds_read_b128 v[84:87], v5 offset:10240
    v_mfma_f32_16x16x32_bf16 v[128:131], v[88:91], a[124:127], v[128:131]
    v_mfma_f32_16x16x32_bf16 v[132:135], v[88:91], a[180:183], v[132:135]
    s_waitcnt lgkmcnt(0)
    s_barrier
    ds_read_b64 v[56:57], v12 offset:12288
    ds_read_b64 v[58:59], v12 offset:14336
    v_mfma_f32_16x16x32_bf16 v[120:123], v[80:83], a[16:19], v[120:123]
    ds_read_b64 v[60:61], v12 offset:16384
    ds_read_b64 v[62:63], v12 offset:18432
    s_lshl_b32 s58, s29, 1
    s_or_b32 s58, s58, 0
    s_waitcnt vmcnt(0)
    v_cmp_gt_i32 vcc, s58, v142
    s_cbranch_vccnz Lkxpoll_90
Lkxok_89:
    s_mov_b32 s59, s49
    v_mfma_f32_16x16x32_bf16 v[124:127], v[80:83], a[72:75], v[124:127]
    ds_read_b128 v[88:91], v4 offset:14336
    buffer_load_dwordx4 v[144:147], v1, s[8:11], s59 offen offset:0 sc1
    v_mfma_f32_16x16x32_bf16 v[128:131], v[80:83], a[128:131], v[128:131]
    buffer_load_dwordx4 v[148:151], v1, s[8:11], s59 offen offset:2048 sc1
    s_add_u32 s59, s59, 4096
    v_mfma_f32_16x16x32_bf16 v[132:135], v[80:83], a[184:187], v[132:135]
    buffer_load_dwordx4 v[152:155], v1, s[8:11], s59 offen offset:0 sc1
    v_mfma_f32_16x16x32_bf16 v[120:123], v[84:87], a[20:23], v[120:123]
    s_waitcnt lgkmcnt(4)
    v_add_f32 v32, v32, v56
    v_add_f32 v33, v33, v57
    buffer_load_dwordx4 v[156:159], v1, s[8:11], s59 offen offset:2048 sc1
    s_add_u32 s59, s59, 4096
    v_mfma_f32_16x16x32_bf16 v[124:127], v[84:87], a[76:79], v[124:127]
    ds_read_b128 v[80:83], v5 offset:14336
    s_waitcnt lgkmcnt(4)
    v_add_f32 v32, v32, v58
    v_add_f32 v33, v33, v59
    buffer_load_dwordx4 v[160:163], v1, s[8:11], s59 offen offset:0 sc1
    v_mfma_f32_16x16x32_bf16 v[128:131], v[84:87], a[132:135], v[128:131]
    s_waitcnt lgkmcnt(3)
    v_add_f32 v32, v32, v60
    v_add_f32 v33, v33, v61
    buffer_load_dwordx4 v[164:167], v1, s[8:11], s59 offen offset:2048 sc1
    s_add_u32 s59, s59, 4096
    v_mfma_f32_16x16x32_bf16 v[132:135], v[84:87], a[188:191], v[132:135]
    s_waitcnt lgkmcnt(2)
    v_add_f32 v32, v32, v62
    v_add_f32 v33, v33, v63
    buffer_load_dwordx4 v[168:171], v1, s[8:11], s59 offen offset:0 sc1
    s_waitcnt lgkmcnt(1)
    v_mfma_f32_16x16x32_bf16 v[120:123], v[88:91], a[24:27], v[120:123]
    v_cvt_pk_bf16_f32 v32, v32, v33
    buffer_store_dword v32, v13, s[8:11], s57 offen sc1
    buffer_load_dwordx4 v[172:175], v1, s[8:11], s59 offen offset:2048 sc1
    s_add_u32 s59, s59, 4096
    v_mfma_f32_16x16x32_bf16 v[124:127], v[88:91], a[80:83], v[124:127]
    ds_read_b128 v[84:87], v4 offset:18432
    buffer_load_dwordx4 v[176:179], v1, s[8:11], s59 offen offset:0 sc1
    v_mfma_f32_16x16x32_bf16 v[128:131], v[88:91], a[136:139], v[128:131]
    buffer_load_dwordx4 v[180:183], v1, s[8:11], s59 offen offset:2048 sc1
    s_add_u32 s59, s59, 4096
    v_mfma_f32_16x16x32_bf16 v[132:135], v[88:91], a[192:195], v[132:135]
    buffer_load_dwordx4 v[184:187], v1, s[8:11], s59 offen offset:0 sc1
    s_waitcnt lgkmcnt(1)
    v_mfma_f32_16x16x32_bf16 v[120:123], v[80:83], a[28:31], v[120:123]
    buffer_load_dwordx4 v[188:191], v1, s[8:11], s59 offen offset:2048 sc1
    s_add_u32 s59, s59, 4096
    v_mfma_f32_16x16x32_bf16 v[124:127], v[80:83], a[84:87], v[124:127]
    ds_read_b128 v[88:91], v5 offset:18432
    buffer_load_dwordx4 v[192:195], v1, s[8:11], s59 offen offset:0 sc1
    v_mfma_f32_16x16x32_bf16 v[128:131], v[80:83], a[140:143], v[128:131]
    buffer_load_dwordx4 v[196:199], v1, s[8:11], s59 offen offset:2048 sc1
    v_mfma_f32_16x16x32_bf16 v[132:135], v[80:83], a[196:199], v[132:135]
    s_mul_i32 s58, s28, 28672
    s_lshl_b32 s59, s27, 5
    s_add_u32 s48, s58, s59
    s_waitcnt lgkmcnt(1)
    v_mfma_f32_16x16x32_bf16 v[120:123], v[84:87], a[32:35], v[120:123]
    s_mul_i32 s35, s23, 1835008
    s_add_u32 s35, s35, s58
    s_lshl_b32 s59, s27, 10
    v_mfma_f32_16x16x32_bf16 v[124:127], v[84:87], a[88:91], v[124:127]
    ds_read_b128 v[80:83], v4 offset:22528
    s_add_u32 s35, s35, s59
    s_lshl_b32 s59, s20, 8
    s_add_u32 s35, s35, s59
    v_mfma_f32_16x16x32_bf16 v[128:131], v[84:87], a[144:147], v[128:131]
    s_add_u32 s35, s35, 4210688
    s_lshl_b32 s33, s28, 14
    s_add_u32 s33, s33, s3
    v_mfma_f32_16x16x32_bf16 v[132:135], v[84:87], a[200:203], v[132:135]
    s_lshl_b32 s59, s27, 8
    s_add_u32 s34, s33, s59
    s_add_u32 s34, s34, 16384
    s_waitcnt lgkmcnt(1)
    v_mfma_f32_16x16x32_bf16 v[120:123], v[88:91], a[36:39], v[120:123]
    s_add_u32 s53, s33, 7168
    s_and_b32 s58, s29, 1
    s_mul_i32 s50, s58, 114688
    v_mfma_f32_16x16x32_bf16 v[124:127], v[88:91], a[92:95], v[124:127]
    ds_read_b128 v[84:87], v5 offset:22528
    s_mul_i32 s59, s25, 7168
    s_add_u32 s50, s50, s59
    s_add_u32 s50, s50, s30
    v_mfma_f32_16x16x32_bf16 v[128:131], v[88:91], a[148:151], v[128:131]
    s_lshl_b32 s18, s58, 15
    s_add_u32 s18, s18, s31
    s_add_u32 s18, s18, 917504
    v_mfma_f32_16x16x32_bf16 v[132:135], v[88:91], a[204:207], v[132:135]
    s_lshl_b32 s59, s20, 13
    s_add_u32 s54, s18, s59
    s_add_u32 s55, s54, 4096
    s_waitcnt lgkmcnt(1)
    v_mfma_f32_16x16x32_bf16 v[120:123], v[80:83], a[40:43], v[120:123]
    s_mul_i32 s58, s58, 16384
    s_add_u32 s58, s58, s30
    s_add_u32 s58, s58, 229376
    v_mfma_f32_16x16x32_bf16 v[124:127], v[80:83], a[96:99], v[124:127]
    ds_read_b128 v[88:91], v4 offset:26624
    s_lshl_b32 s59, s20, 12
    s_add_u32 s56, s58, s59
    s_lshl_b32 s59, s25, 11
    v_mfma_f32_16x16x32_bf16 v[128:131], v[80:83], a[152:155], v[128:131]
    s_add_u32 s52, s18, s59
    s_mov_b32 s16, s58
    s_mov_b32 s59, 16384
    v_mfma_f32_16x16x32_bf16 v[132:135], v[80:83], a[208:211], v[132:135]
    s_bitcmp1_b32 s29, 0
    s_cselect_b32 s59, 4294950912, s59
    s_add_u32 s17, s16, s59
    s_waitcnt lgkmcnt(1)
    v_mfma_f32_16x16x32_bf16 v[120:123], v[84:87], a[44:47], v[120:123]
    s_and_b32 s58, s29, 3
    s_mul_i32 s58, s58, 17408
    s_add_u32 s58, s58, s30
    v_mfma_f32_16x16x32_bf16 v[124:127], v[84:87], a[100:103], v[124:127]
    ds_read_b128 v[80:83], v5 offset:26624
    s_add_u32 s58, s58, 264192
    s_add_u32 s18, s29, 3
    s_and_b32 s18, s18, 3
    v_mfma_f32_16x16x32_bf16 v[128:131], v[84:87], a[156:159], v[128:131]
    s_mul_i32 s18, s18, 17408
    s_add_u32 s18, s18, s30
    s_add_u32 s18, s18, 264192
    v_mfma_f32_16x16x32_bf16 v[132:135], v[84:87], a[212:215], v[132:135]
    s_lshl_b32 s59, s26, 4
    s_add_u32 s59, s59, s25
    s_lshl_b32 s59, s59, 8
    s_waitcnt lgkmcnt(1)
    v_mfma_f32_16x16x32_bf16 v[120:123], v[88:91], a[48:51], v[120:123]
    s_add_u32 s36, s58, s59
    s_add_u32 s37, s18, s59
    s_lshl_b32 s59, s20, 10
    v_mfma_f32_16x16x32_bf16 v[124:127], v[88:91], a[104:107], v[124:127]
    s_add_u32 s38, s58, s59
    s_add_u32 s39, s38, 4096
    s_lshl_b32 s59, s20, 11
    v_mfma_f32_16x16x32_bf16 v[128:131], v[88:91], a[160:163], v[128:131]
    s_add_u32 s40, s58, s59
    s_add_u32 s40, s40, 8192
    s_add_u32 s41, s58, 16384
    v_mfma_f32_16x16x32_bf16 v[132:135], v[88:91], a[216:219], v[132:135]
    s_mov_b32 s42, s58
    s_mov_b32 s43, s18
    s_waitcnt lgkmcnt(0)
    v_mfma_f32_16x16x32_bf16 v[120:123], v[80:83], a[52:55], v[120:123]
    v_mfma_f32_16x16x32_bf16 v[124:127], v[80:83], a[108:111], v[124:127]
    v_mfma_f32_16x16x32_bf16 v[128:131], v[80:83], a[164:167], v[128:131]
    v_mfma_f32_16x16x32_bf16 v[132:135], v[80:83], a[220:223], v[132:135]
LX_p1:
    buffer_load_dword v142, v26, s[8:11], s51 offen sc1
    ds_read_b128 v[48:51], v4 offset:0
    ds_read_b128 v[52:55], v4 offset:2048
    ds_read_b128 v[56:59], v5 offset:0
    ds_read_b128 v[60:63], v5 offset:2048
    v_cvt_pk_bf16_f32 v32, v92, v120
    v_cvt_pk_bf16_f32 v33, v93, v121
    v_cvt_pk_bf16_f32 v34, v94, v122
    v_cvt_pk_bf16_f32 v35, v95, v123
    v_cvt_pk_bf16_f32 v36, v96, v124
    v_cvt_pk_bf16_f32 v37, v97, v125
    v_cvt_pk_bf16_f32 v38, v98, v126
    v_cvt_pk_bf16_f32 v39, v99, v127
    v_cvt_pk_bf16_f32 v40, v100, v128
    v_cvt_pk_bf16_f32 v41, v101, v129
    v_cvt_pk_bf16_f32 v42, v102, v130
    v_cvt_pk_bf16_f32 v43, v103, v131
    v_cvt_pk_bf16_f32 v44, v104, v132
    v_cvt_pk_bf16_f32 v45, v105, v133
    v_cvt_pk_bf16_f32 v46, v106, v134
    v_cvt_pk_bf16_f32 v47, v107, v135
    s_waitcnt vmcnt(15) lgkmcnt(3)
    v_mfma_f32_16x16x32_bf16 v[120:123], v[144:147], v[48:51], 0
    ds_read_b128 v[64:67], v4 offset:4096
    s_waitcnt lgkmcnt(3)
    v_mfma_f32_16x16x32_bf16 v[124:127], v[144:147], v[52:55], 0
    ds_read_b128 v[68:71], v4 offset:6144
    s_waitcnt vmcnt(14) lgkmcnt(3)
    v_mfma_f32_16x16x32_bf16 v[120:123], v[148:151], v[56:59], v[120:123]
    ds_read_b128 v[48:51], v5 offset:4096
    s_waitcnt lgkmcnt(3)
    v_mfma_f32_16x16x32_bf16 v[124:127], v[148:151], v[60:63], v[124:127]
    ds_read_b128 v[52:55], v5 offset:6144
    s_waitcnt vmcnt(13) lgkmcnt(3)
    v_mfma_f32_16x16x32_bf16 v[120:123], v[152:155], v[64:67], v[120:123]
    ds_read_b128 v[56:59], v4 offset:8192
    s_waitcnt lgkmcnt(3)
    v_mfma_f32_16x16x32_bf16 v[124:127], v[152:155], v[68:71], v[124:127]
    ds_read_b128 v[60:63], v4 offset:10240
    s_waitcnt vmcnt(12) lgkmcnt(3)
    v_mfma_f32_16x16x32_bf16 v[120:123], v[156:159], v[48:51], v[120:123]
    ds_read_b128 v[64:67], v5 offset:8192
    s_waitcnt lgkmcnt(3)
    v_mfma_f32_16x16x32_bf16 v[124:127], v[156:159], v[52:55], v[124:127]
    ds_read_b128 v[68:71], v5 offset:10240
    s_waitcnt vmcnt(11) lgkmcnt(3)
    v_mfma_f32_16x16x32_bf16 v[120:123], v[160:163], v[56:59], v[120:123]
    ds_read_b128 v[48:51], v4 offset:12288
    s_waitcnt lgkmcnt(3)
    v_mfma_f32_16x16x32_bf16 v[124:127], v[160:163], v[60:63], v[124:127]
    ds_read_b128 v[52:55], v4 offset:14336
    s_waitcnt vmcnt(10) lgkmcnt(3)
    v_mfma_f32_16x16x32_bf16 v[120:123], v[164:167], v[64:67], v[120:123]
    ds_read_b128 v[56:59], v5 offset:12288
    s_lshl_b32 s58, s29, 1
    s_or_b32 s58, s58, 1
    s_waitcnt vmcnt(0)
    v_cmp_gt_i32 vcc, s58, v142
    s_cbranch_vccnz Lkxpoll_92
Lkxok_91:
    s_mov_b32 s59, s49
    s_waitcnt lgkmcnt(3)
    v_mfma_f32_16x16x32_bf16 v[124:127], v[164:167], v[68:71], v[124:127]
    ds_read_b128 v[60:63], v5 offset:14336
    buffer_load_dwordx4 v[200:203], v1, s[8:11], s59 offen offset:1024 sc1
    s_waitcnt lgkmcnt(3)
    v_mfma_f32_16x16x32_bf16 v[120:123], v[168:171], v[48:51], v[120:123]
    ds_read_b128 v[64:67], v4 offset:16384
    buffer_load_dwordx4 v[204:207], v1, s[8:11], s59 offen offset:3072 sc1
    s_add_u32 s59, s59, 4096
    s_waitcnt lgkmcnt(3)
    v_mfma_f32_16x16x32_bf16 v[124:127], v[168:171], v[52:55], v[124:127]
    ds_read_b128 v[68:71], v4 offset:18432
    buffer_load_dwordx4 v[208:211], v1, s[8:11], s59 offen offset:1024 sc1
    s_waitcnt lgkmcnt(3)
    v_mfma_f32_16x16x32_bf16 v[120:123], v[172:175], v[56:59], v[120:123]
    ds_read_b128 v[48:51], v5 offset:16384
    buffer_load_dwordx4 v[212:215], v1, s[8:11], s59 offen offset:3072 sc1
    s_add_u32 s59, s59, 4096
    s_waitcnt lgkmcnt(3)
    v_mfma_f32_16x16x32_bf16 v[124:127], v[172:175], v[60:63], v[124:127]
    ds_read_b128 v[52:55], v5 offset:18432
    buffer_load_dwordx4 v[216:219], v1, s[8:11], s59 offen offset:1024 sc1
    s_waitcnt lgkmcnt(3)
    v_mfma_f32_16x16x32_bf16 v[120:123], v[176:179], v[64:67], v[120:123]
    ds_read_b128 v[56:59], v4 offset:20480
    buffer_load_dwordx4 v[220:223], v1, s[8:11], s59 offen offset:3072 sc1
    s_add_u32 s59, s59, 4096
    s_waitcnt lgkmcnt(3)
    v_mfma_f32_16x16x32_bf16 v[124:127], v[176:179], v[68:71], v[124:127]
    ds_read_b128 v[60:63], v4 offset:22528
    buffer_load_dwordx4 v[224:227], v1, s[8:11], s59 offen offset:1024 sc1
    s_waitcnt lgkmcnt(3)
    v_mfma_f32_16x16x32_bf16 v[120:123], v[180:183], v[48:51], v[120:123]
    ds_read_b128 v[64:67], v5 offset:20480
    buffer_load_dwordx4 v[228:231], v1, s[8:11], s59 offen offset:3072 sc1
    s_add_u32 s59, s59, 4096
    s_waitcnt lgkmcnt(3)
    v_mfma_f32_16x16x32_bf16 v[124:127], v[180:183], v[52:55], v[124:127]
    ds_read_b128 v[68:71], v5 offset:22528
    buffer_load_dwordx4 v[232:235], v1, s[8:11], s59 offen offset:1024 sc1
    s_waitcnt lgkmcnt(3)
    v_mfma_f32_16x16x32_bf16 v[120:123], v[184:187], v[56:59], v[120:123]
    ds_read_b128 v[48:51], v4 offset:24576
    buffer_load_dwordx4 v[236:239], v1, s[8:11], s59 offen offset:3072 sc1
    s_add_u32 s59, s59, 4096
    s_waitcnt lgkmcnt(3)
    v_mfma_f32_16x16x32_bf16 v[124:127], v[184:187], v[60:63], v[124:127]
    ds_read_b128 v[52:55], v4 offset:26624
    buffer_load_dwordx4 v[240:243], v1, s[8:11], s59 offen offset:1024 sc1
    s_waitcnt lgkmcnt(3)
    v_mfma_f32_16x16x32_bf16 v[120:123], v[188:191], v[64:67], v[120:123]
    ds_read_b128 v[56:59], v5 offset:24576
    buffer_load_dwordx4 v[244:247], v1, s[8:11], s59 offen offset:3072 sc1
    s_add_u32 s59, s59, 4096
    s_waitcnt lgkmcnt(3)
    v_mfma_f32_16x16x32_bf16 v[124:127], v[188:191], v[68:71], v[124:127]
    ds_read_b128 v[60:63], v5 offset:26624
    buffer_load_dwordx4 v[248:251], v1, s[8:11], s59 offen offset:1024 sc1
    s_waitcnt lgkmcnt(3)
    v_mfma_f32_16x16x32_bf16 v[120:123], v[192:195], v[48:51], v[120:123]
    buffer_load_dwordx4 v[252:255], v1, s[8:11], s59 offen offset:3072 sc1
    s_waitcnt lgkmcnt(2)
    v_mfma_f32_16x16x32_bf16 v[124:127], v[192:195], v[52:55], v[124:127]
    s_waitcnt lgkmcnt(1)
    v_mfma_f32_16x16x32_bf16 v[120:123], v[196:199], v[56:59], v[120:123]
    s_waitcnt lgkmcnt(0)
    v_mfma_f32_16x16x32_bf16 v[124:127], v[196:199], v[60:63], v[124:127]
    ds_read_b128 v[72:75], v4 offset:2048
    ds_read_b128 v[76:79], v5 offset:2048
    ds_read_b128 v[80:83], v4 offset:6144
    ds_read_b128 v[84:87], v5 offset:6144
    ds_read_b128 v[88:91], v4 offset:10240
    s_waitcnt vmcnt(13) lgkmcnt(4)
    v_mfma_f32_16x16x32_bf16 v[128:131], v[200:203], v[72:75], 0
    ds_read_b128 v[92:95], v5 offset:10240
    s_waitcnt vmcnt(12) lgkmcnt(4)
    v_mfma_f32_16x16x32_bf16 v[128:131], v[204:207], v[76:79], v[128:131]
    ds_read_b128 v[72:75], v4 offset:14336
    s_waitcnt vmcnt(11) lgkmcnt(4)
    v_mfma_f32_16x16x32_bf16 v[128:131], v[208:211], v[80:83], v[128:131]
    ds_read_b128 v[76:79], v5 offset:14336
    s_waitcnt vmcnt(10) lgkmcnt(4)
    v_mfma_f32_16x16x32_bf16 v[128:131], v[212:215], v[84:87], v[128:131]
    ds_read_b128 v[80:83], v4 offset:18432
    s_waitcnt vmcnt(9) lgkmcnt(4)
    v_mfma_f32_16x16x32_bf16 v[128:131], v[216:219], v[88:91], v[128:131]
    ds_read_b128 v[84:87], v5 offset:18432
    s_waitcnt vmcnt(8) lgkmcnt(4)
    v_mfma_f32_16x16x32_bf16 v[128:131], v[220:223], v[92:95], v[128:131]
    ds_read_b128 v[88:91], v4 offset:22528
    s_waitcnt vmcnt(7) lgkmcnt(4)
    v_mfma_f32_16x16x32_bf16 v[128:131], v[224:227], v[72:75], v[128:131]
    ds_read_b128 v[92:95], v5 offset:22528
    s_waitcnt vmcnt(6) lgkmcnt(4)
    v_mfma_f32_16x16x32_bf16 v[128:131], v[228:231], v[76:79], v[128:131]
    ds_read_b128 v[72:75], v4 offset:26624
    s_waitcnt vmcnt(5) lgkmcnt(4)
    v_mfma_f32_16x16x32_bf16 v[128:131], v[232:235], v[80:83], v[128:131]
    ds_read_b128 v[76:79], v5 offset:26624
    s_waitcnt vmcnt(4) lgkmcnt(4)
    v_mfma_f32_16x16x32_bf16 v[128:131], v[236:239], v[84:87], v[128:131]
    s_waitcnt vmcnt(3) lgkmcnt(3)
    v_mfma_f32_16x16x32_bf16 v[128:131], v[240:243], v[88:91], v[128:131]
    s_waitcnt vmcnt(2) lgkmcnt(2)
    v_mfma_f32_16x16x32_bf16 v[128:131], v[244:247], v[92:95], v[128:131]
    s_waitcnt vmcnt(1) lgkmcnt(1)
    v_mfma_f32_16x16x32_bf16 v[128:131], v[248:251], v[72:75], v[128:131]
    s_waitcnt vmcnt(0) lgkmcnt(0)
    v_mfma_f32_16x16x32_bf16 v[128:131], v[252:255], v[76:79], v[128:131]
    v_mov_b32 v16, 0xff800000
    v_cndmask_b32 v120, v16, v120, s[60:61]
    v_cndmask_b32 v121, v16, v121, s[62:63]
    v_cndmask_b32 v122, v16, v122, s[64:65]
    v_cndmask_b32 v123, v16, v123, s[66:67]
    s_nop 2
    v_cndmask_b32 v128, v16, v128, s[60:61]
    v_cndmask_b32 v129, v16, v129, s[62:63]
    v_cndmask_b32 v130, v16, v130, s[64:65]
    v_cndmask_b32 v131, v16, v131, s[66:67]
    v_max3_f32 v132, v120, v121, v122
    v_max3_f32 v134, v124, v125, v126
    v_max_f32 v132, v132, v123
    v_max3_f32 v134, v134, v127, v128
    v_max3_f32 v134, v134, v129, v130
    v_max_f32 v134, v134, v131
    s_nop 1
    v_permlane32_swap_b32 v132, v134
    v_max_f32 v140, v132, v134
    v_mov_b32 v132, v140
    s_nop 1
    v_permlane16_swap_b32 v140, v132
    v_max_f32 v140, v140, v132
    v_mov_b32 v132, v140
    v_mov_b32 v134, v140
    s_nop 1
    v_permlane32_swap_b32 v132, v134
    v_pk_add_f32 v[120:121], v[120:121], v[132:133] op_sel_hi:[1,0] neg_lo:[0,1] neg_hi:[0,1]
    v_pk_add_f32 v[122:123], v[122:123], v[132:133] op_sel_hi:[1,0] neg_lo:[0,1] neg_hi:[0,1]
    v_pk_add_f32 v[124:125], v[124:125], v[134:135] op_sel_hi:[1,0] neg_lo:[0,1] neg_hi:[0,1]
    v_pk_add_f32 v[126:127], v[126:127], v[134:135] op_sel_hi:[1,0] neg_lo:[0,1] neg_hi:[0,1]
    v_pk_add_f32 v[128:129], v[128:129], v[134:135] op_sel_hi:[1,0] neg_lo:[0,1] neg_hi:[0,1]
    v_pk_add_f32 v[130:131], v[130:131], v[134:135] op_sel_hi:[1,0] neg_lo:[0,1] neg_hi:[0,1]
    v_exp_f32 v120, v120
    v_exp_f32 v121, v121
    v_exp_f32 v122, v122
    v_exp_f32 v123, v123
    v_exp_f32 v124, v124
    v_exp_f32 v125, v125
    v_exp_f32 v126, v126
    v_exp_f32 v127, v127
    v_exp_f32 v128, v128
    v_exp_f32 v129, v129
    v_exp_f32 v130, v130
    v_exp_f32 v131, v131
    v_cvt_pk_bf16_f32 v48, v120, 0
    v_cvt_pk_bf16_f32 v49, v121, 0
    v_cvt_pk_bf16_f32 v50, v122, 0
    v_cvt_pk_bf16_f32 v51, v123, 0
    v_cvt_pk_bf16_f32 v52, v124, v128
    v_cvt_pk_bf16_f32 v53, v125, v129
    v_cvt_pk_bf16_f32 v54, v126, v130
    v_cvt_pk_bf16_f32 v55, v127, v131
    buffer_store_dwordx4 v[48:51], v1, s[8:11], s52 offen
    buffer_store_dwordx4 v[52:55], v1, s[8:11], s52 offen offset:1024
    buffer_load_dword v0, off, s[8:11], s53 sc1
    v_pk_add_f32 v[132:133], v[120:121], v[122:123]
    v_pk_add_f32 v[134:135], v[124:125], v[126:127]
    v_pk_add_f32 v[134:135], v[134:135], v[128:129]
    v_pk_add_f32 v[134:135], v[134:135], v[130:131]
    v_add_f32 v132, v132, v133
    v_add_f32 v134, v134, v135
    s_nop 1
    v_permlane32_swap_b32 v132, v134
    v_add_f32 v141, v132, v134
    v_mov_b32 v48, 0
    v_mov_b32 v49, 0
    v_mov_b32 v50, 0
    v_mov_b32 v51, 0
    v_mov_b32 v52, 0
    v_mov_b32 v53, 0
    v_mov_b32 v54, 0
    v_mov_b32 v55, 0
    v_mov_b32 v64, 0
    v_mov_b32 v65, 0
    v_mov_b32 v66, 0
    v_mov_b32 v67, 0
    v_mov_b32 v68, 0
    v_mov_b32 v69, 0
    v_mov_b32 v70, 0
    v_mov_b32 v71, 0
    v_mov_b32 v72, 0
    v_mov_b32 v73, 0
    v_mov_b32 v74, 0
    v_mov_b32 v75, 0
    v_mov_b32 v76, 0
    v_mov_b32 v77, 0
    v_mov_b32 v78, 0
    v_mov_b32 v79, 0
    s_waitcnt vmcnt(0) lgkmcnt(0)
    v_cmp_eq_u32 vcc, -1, v0
    s_mov_b32 s70, 0
    s_cbranch_vccz Lmpoll_93
    s_mov_b32 s70, 0
Lpoll_95:
    buffer_load_dword v0, off, s[8:11], s53 sc1
    s_add_u32 s70, s70, 1
    s_cmp_gt_u32 s70, 131072
    s_cbranch_scc1 Lfail
    s_waitcnt vmcnt(0)
    v_cmp_eq_u32 vcc, -1, v0
    s_cbranch_vccnz Lpoll_95
Lmpoll_93:
    buffer_load_dwordx4 v[92:95], v7, s[8:11], s33 offen sc1
    buffer_load_dwordx4 v[80:83], v8, s[8:11], s33 offen sc1
    s_add_u32 s70, s70, 1
    s_cmp_gt_u32 s70, 262144
    s_cbranch_scc1 Lfail
    s_waitcnt vmcnt(1)
    ds_write_b128 v7, v[92:95] offset:0
    v_max3_u32 v16, v92, v93, v94
    s_waitcnt vmcnt(0)
    v_max3_u32 v16, v16, v95, v80
    v_max3_u32 v16, v16, v81, v82
    v_max_u32 v16, v16, v83
    v_cmp_eq_u32 vcc, -1, v16
    ds_write_b128 v8, v[80:83] offset:0
    s_cbranch_vccnz Lmpoll_93
    v_smfmac_f32_16x16x64_bf16 v[48:51], v[92:95], v[168:175], v6
    v_smfmac_f32_16x16x64_bf16 v[48:51], v[80:83], v[144:151], v6
    v_smfmac_f32_16x16x64_bf16 v[52:55], v[92:95], v[224:231], v6
    v_smfmac_f32_16x16x64_bf16 v[52:55], v[80:83], v[200:207], v6
    v_smfmac_f32_16x16x64_bf16 v[64:67], v[92:95], a[24:31], v6
    s_waitcnt lgkmcnt(0)
    s_barrier
    ds_read_b128 v[84:87], v1 offset:1024
    ds_read_b128 v[88:91], v1 offset:2048
    v_smfmac_f32_16x16x64_bf16 v[68:71], v[92:95], a[136:143], v6
    ds_read_b128 v[96:99], v1 offset:4096
    v_smfmac_f32_16x16x64_bf16 v[64:67], v[80:83], a[0:7], v6
    v_smfmac_f32_16x16x64_bf16 v[68:71], v[80:83], a[112:119], v6
    ds_read_b128 v[100:103], v1 offset:5120
    ds_read_b128 v[104:107], v1 offset:6144
    s_waitcnt lgkmcnt(4)
    v_smfmac_f32_16x16x64_bf16 v[48:51], v[84:87], v[152:159], v6
    v_smfmac_f32_16x16x64_bf16 v[52:55], v[84:87], v[208:215], v6
    s_waitcnt lgkmcnt(3)
    v_smfmac_f32_16x16x64_bf16 v[48:51], v[88:91], v[160:167], v6
    v_smfmac_f32_16x16x64_bf16 v[52:55], v[88:91], v[216:223], v6
    s_waitcnt lgkmcnt(2)
    v_smfmac_f32_16x16x64_bf16 v[48:51], v[96:99], v[176:183], v6
    v_smfmac_f32_16x16x64_bf16 v[52:55], v[96:99], v[232:239], v6
    s_waitcnt lgkmcnt(1)
    v_smfmac_f32_16x16x64_bf16 v[48:51], v[100:103], v[184:191], v6
    v_smfmac_f32_16x16x64_bf16 v[52:55], v[100:103], v[240:247], v6
    s_waitcnt lgkmcnt(0)
    v_smfmac_f32_16x16x64_bf16 v[48:51], v[104:107], v[192:199], v6
    v_smfmac_f32_16x16x64_bf16 v[52:55], v[104:107], v[248:255], v6
    v_smfmac_f32_16x16x64_bf16 v[64:67], v[84:87], a[8:15], v6
    v_permlane32_swap_b32 v48, v50
    v_permlane32_swap_b32 v49, v51
    s_nop 1
    v_permlane32_swap_b32 v52, v54
    v_permlane32_swap_b32 v53, v55
    v_add_f32 v48, v48, v50
    v_add_f32 v52, v52, v54
    v_add_f32 v49, v49, v51
    v_add_f32 v53, v53, v55
    v_max_f32 v56, v48, v52
    v_max_f32 v57, v49, v53
    s_nop 0
    v_max_f32_dpp v56, v56, v56 row_ror:8 row_mask:0xf bank_mask:0xf
    v_max_f32_dpp v57, v57, v57 row_ror:8 row_mask:0xf bank_mask:0xf
    s_nop 0
    v_max_f32_dpp v56, v56, v56 row_ror:4 row_mask:0xf bank_mask:0xf
    v_max_f32_dpp v57, v57, v57 row_ror:4 row_mask:0xf bank_mask:0xf
    s_nop 0
    v_max_f32_dpp v56, v56, v56 row_ror:2 row_mask:0xf bank_mask:0xf
    v_max_f32_dpp v57, v57, v57 row_ror:2 row_mask:0xf bank_mask:0xf
    s_nop 0
    v_max_f32_dpp v56, v56, v56 row_ror:1 row_mask:0xf bank_mask:0xf
    v_max_f32_dpp v57, v57, v57 row_ror:1 row_mask:0xf bank_mask:0xf
    v_sub_f32 v48, v48, v56
    v_sub_f32 v52, v52, v56
    v_sub_f32 v49, v49, v57
    v_sub_f32 v53, v53, v57
    v_exp_f32 v48, v48
    v_exp_f32 v52, v52
    v_exp_f32 v49, v49
    v_exp_f32 v53, v53
    v_cvt_pk_bf16_f32 v50, v48, v52
    v_cvt_pk_bf16_f32 v51, v49, v53
    buffer_store_dword v50, v21, s[8:11], s42 offen
    buffer_store_dword v51, v21, s[8:11], s42 offen offset:16
    v_add_f32 v48, v48, v52
    v_add_f32 v49, v49, v53
    v_mov_b32 v60, v56
    v_mov_b32 v62, v57
    v_add_f32_dpp v48, v48, v48 row_ror:8 row_mask:0xf bank_mask:0xf
    v_add_f32_dpp v49, v49, v49 row_ror:8 row_mask:0xf bank_mask:0xf
    s_nop 0
    v_add_f32_dpp v48, v48, v48 row_ror:4 row_mask:0xf bank_mask:0xf
    v_add_f32_dpp v49, v49, v49 row_ror:4 row_mask:0xf bank_mask:0xf
    s_nop 0
    v_add_f32_dpp v48, v48, v48 row_ror:2 row_mask:0xf bank_mask:0xf
    v_add_f32_dpp v49, v49, v49 row_ror:2 row_mask:0xf bank_mask:0xf
    s_nop 0
    v_add_f32_dpp v48, v48, v48 row_ror:1 row_mask:0xf bank_mask:0xf
    v_add_f32_dpp v49, v49, v49 row_ror:1 row_mask:0xf bank_mask:0xf
    v_mul_f32 v61, 0.5, v48
    v_mul_f32 v63, 0.5, v49
    buffer_store_dwordx4 v[60:63], v22, s[8:11], s42 offen
    v_smfmac_f32_16x16x64_bf16 v[68:71], v[84:87], a[120:127], v6
    v_smfmac_f32_16x16x64_bf16 v[64:67], v[88:91], a[16:23], v6
    v_smfmac_f32_16x16x64_bf16 v[68:71], v[88:91], a[128:135], v6
    v_smfmac_f32_16x16x64_bf16 v[64:67], v[96:99], a[32:39], v6
    v_smfmac_f32_16x16x64_bf16 v[68:71], v[96:99], a[144:151], v6
    v_smfmac_f32_16x16x64_bf16 v[64:67], v[100:103], a[40:47], v6
    v_smfmac_f32_16x16x64_bf16 v[68:71], v[100:103], a[152:159], v6
    v_smfmac_f32_16x16x64_bf16 v[64:67], v[104:107], a[48:55], v6
    v_smfmac_f32_16x16x64_bf16 v[68:71], v[104:107], a[160:167], v6
    s_waitcnt lgkmcnt(0)
    s_barrier
    ds_read2_b32 v[30:31], v19 offset0:0 offset1:160
    v_smfmac_f32_16x16x64_bf16 v[72:75], v[80:83], a[56:63], v6
    buffer_load_dwordx4 v[108:111], v1, s[8:11], s40 offen offset:0 sc1
    v_smfmac_f32_16x16x64_bf16 v[76:79], v[80:83], a[168:175], v6
    buffer_load_dwordx4 v[112:115], v1, s[8:11], s40 offen offset:1024 sc1
    v_smfmac_f32_16x16x64_bf16 v[72:75], v[84:87], a[64:71], v6
    s_waitcnt lgkmcnt(0)
    v_add_f32 v30, v30, v31
    v_smfmac_f32_16x16x64_bf16 v[76:79], v[84:87], a[176:183], v6
    s_nop 0
    v_add_f32_dpp v30, v30, v30 quad_perm:[1,0,3,2] row_mask:0xf bank_mask:0xf
    v_smfmac_f32_16x16x64_bf16 v[72:75], v[88:91], a[72:79], v6
    s_nop 0
    v_add_f32_dpp v30, v30, v30 quad_perm:[2,3,0,1] row_mask:0xf bank_mask:0xf
    buffer_store_dword v30, v24, s[8:11], s36 offen
    v_smfmac_f32_16x16x64_bf16 v[76:79], v[88:91], a[184:191], v6
    v_permlane32_swap_b32 v64, v68
    v_smfmac_f32_16x16x64_bf16 v[72:75], v[92:95], a[80:87], v6
    v_permlane32_swap_b32 v65, v69
    v_smfmac_f32_16x16x64_bf16 v[76:79], v[92:95], a[192:199], v6
    v_permlane32_swap_b32 v66, v70
    v_smfmac_f32_16x16x64_bf16 v[72:75], v[96:99], a[88:95], v6
    v_permlane32_swap_b32 v67, v71
    v_smfmac_f32_16x16x64_bf16 v[76:79], v[96:99], a[200:207], v6
    v_add_f32 v64, v64, v68
    v_smfmac_f32_16x16x64_bf16 v[72:75], v[100:103], a[96:103], v6
    v_add_f32 v65, v65, v69
    v_smfmac_f32_16x16x64_bf16 v[76:79], v[100:103], a[208:215], v6
    v_add_f32 v66, v66, v70
    v_smfmac_f32_16x16x64_bf16 v[72:75], v[104:107], a[104:111], v6
    v_add_f32 v67, v67, v71
    v_smfmac_f32_16x16x64_bf16 v[76:79], v[104:107], a[216:223], v6
    v_cvt_pk_bf16_f32 v64, v64, v65
    buffer_load_dword v30, v27, s[8:11], s41 offen offset:0 sc1
    buffer_load_dword v31, v27, s[8:11], s41 offen offset:4 sc1
    buffer_load_dwordx4 v[80:83], v1, s[8:11], s38 offen sc1
    buffer_load_dwordx4 v[84:87], v1, s[8:11], s39 offen sc1
    v_cvt_pk_bf16_f32 v65, v66, v67
    s_waitcnt vmcnt(5)
Leok_96:
    v_mfma_f32_16x16x32_bf16 v[48:51], v[108:111], v[32:35], 0
    v_max3_u32 v16, v108, v109, v110
    v_max3_u32 v16, v16, v111, v112
    v_mfma_f32_16x16x32_bf16 v[52:55], v[112:115], v[36:39], 0
    v_max3_u32 v16, v16, v113, v114
    v_max_u32 v16, v16, v115
    v_mfma_f32_16x16x32_bf16 v[56:59], v[108:111], v[40:43], 0
    v_cmp_eq_u32 vcc, -1, v16
    v_mfma_f32_16x16x32_bf16 v[60:63], v[112:115], v[44:47], 0
    s_cbranch_vccnz Leretry_97
    v_cvt_pk_bf16_f32 v88, v48, v49
    v_cvt_pk_bf16_f32 v89, v50, v51
    v_cvt_pk_bf16_f32 v90, v52, v53
    v_cvt_pk_bf16_f32 v91, v54, v55
    v_cvt_pk_bf16_f32 v108, v56, v57
    v_cvt_pk_bf16_f32 v109, v58, v59
    s_nop 0
    v_cvt_pk_bf16_f32 v110, v60, v61
    v_cvt_pk_bf16_f32 v111, v62, v63
    v_cndmask_b32 v88, v108, v88, s[100:101]
    v_cndmask_b32 v90, v110, v90, s[100:101]
    v_cndmask_b32 v89, v109, v89, s[100:101]
    v_cndmask_b32 v91, v111, v91, s[100:101]
    v_permlane16_swap_b32 v88, v90
    buffer_load_dwordx4 v[68:71], v1, s[8:11], s38 offen sc1
    buffer_load_dwordx4 v[112:115], v1, s[8:11], s39 offen sc1
    v_permlane32_swap_b32 v72, v76
    v_permlane16_swap_b32 v89, v91
    v_permlane32_swap_b32 v73, v77
    v_permlane32_swap_b32 v74, v78
    v_permlane32_swap_b32 v75, v79
    v_add_f32 v72, v72, v76
    v_add_f32 v73, v73, v77
    v_add_f32 v74, v74, v78
    v_add_f32 v75, v75, v79
    v_cvt_pk_bf16_f32 v66, v72, v73
    v_cvt_pk_bf16_f32 v67, v74, v75
    s_nop 0
    v_permlane16_swap_b32 v64, v66
    v_permlane16_swap_b32 v65, v67
    s_waitcnt vmcnt(2)
    v_pk_add_f32 v[96:97], v[80:81], v[84:85]
    v_pk_add_f32 v[98:99], v[82:83], v[86:87]
    v_max3_f32 v100, v96, v97, v98
    v_max3_f32 v100, v100, v99, v30
    v_pk_fma_f32 v[104:105], v[96:97], v[30:31], v[98:99]
    v_cmp_u_f32 vcc, v104, v105
    v_max_f32_dpp v100, v100, v100 row_ror:8 row_mask:0xf bank_mask:0xf
    v_sub_f32 v102, v30, v100
    v_pk_add_f32 v[96:97], v[96:97], v[100:101] op_sel_hi:[1,0] neg_lo:[0,1] neg_hi:[0,1]
    v_pk_add_f32 v[98:99], v[98:99], v[100:101] op_sel_hi:[1,0] neg_lo:[0,1] neg_hi:[0,1]
    s_cbranch_vccnz Lsretry_100
Lsok_99:
    v_exp_f32 v96, v96
    v_exp_f32 v97, v97
    v_exp_f32 v98, v98
    v_exp_f32 v99, v99
    v_exp_f32 v102, v102
    v_pk_add_f32 v[104:105], v[96:97], v[98:99]
    v_add_f32 v104, v104, v105
    v_fmac_f32 v104, v102, v31
    v_pk_mul_f32 v[102:103], v[102:103], v[28:29] op_sel_hi:[0,1]
    s_nop 0
    v_add_f32_dpp v104, v104, v104 row_ror:8 row_mask:0xf bank_mask:0xf
    v_rcp_f32 v104, v104
    s_nop 0
    v_pk_mul_f32 v[96:97], v[96:97], v[104:105] op_sel_hi:[1,0]
    v_pk_mul_f32 v[98:99], v[98:99], v[104:105] op_sel_hi:[1,0]
    v_pk_mul_f32 v[102:103], v[102:103], v[104:105] op_sel_hi:[1,0]
    v_cvt_pk_bf16_f32 v48, v96, v97
    v_cvt_pk_bf16_f32 v49, v98, v99
    v_cvt_pk_bf16_f32 v102, v102, v103
    v_mov_b32_dpp v50, v48 row_ror:8 row_mask:0xf bank_mask:0xf
    v_mov_b32_dpp v51, v49 row_ror:8 row_mask:0xf bank_mask:0xf
    v_cndmask_b32 v92, 0, v102, s[92:93]
    v_cndmask_b32 v93, 0, v102, s[94:95]
    v_mfma_f32_16x16x32_bf16 v[60:63], v[64:67], v[48:51], 0
    v_cndmask_b32 v94, 0, v102, s[96:97]
    v_cndmask_b32 v95, 0, v102, s[98:99]
    s_nop 1
    v_mfma_f32_16x16x32_bf16 v[60:63], v[88:91], v[92:95], v[60:63]
    s_nop 7
    ds_write_b128 v7, v[60:63] offset:8192
    v_mov_b32 v116, v64
    v_mov_b32 v117, v65
    v_mov_b32 v118, v66
    v_mov_b32 v119, v67
    s_waitcnt lgkmcnt(0)
    s_barrier
    buffer_load_dwordx4 v[144:147], v1, s[8:11], s50 offen offset:0 sc1
    buffer_load_dwordx4 v[148:151], v1, s[8:11], s50 offen offset:1024 sc1
    buffer_load_dwordx4 v[152:155], v1, s[8:11], s50 offen offset:2048 sc1
    buffer_load_dwordx4 v[156:159], v1, s[8:11], s50 offen offset:3072 sc1
    s_mov_b32 s70, 0
    v_mov_b32 v232, -1
    v_mov_b32 v233, -1
    v_mov_b32 v234, -1
    v_mov_b32 v235, -1
    ds_read_b128 v[160:163], v1 offset:25600
    ds_read_b128 v[164:167], v1 offset:26624
    ds_read_b128 v[168:171], v1 offset:27648
    s_barrier
    buffer_store_dwordx2 v[232:233], v23, s[8:11], s17 offen
    buffer_store_dword v232, v20, s[8:11], s17 offen
    s_add_u32 s28, s28, 3
    s_cmp_eq_u32 s23, 0
    s_cselect_b32 s58, 64, s28
    s_cmp_ge_u32 s58, 64
    s_cbranch_scc1 LX_km
    s_barrier
LX_km:
    ds_read_b128 v[200:203], v4 offset:16384
    ds_read_b128 v[204:207], v4 offset:18432
    ds_read_b128 v[208:211], v5 offset:16384
    ds_read_b128 v[212:215], v5 offset:18432
    s_waitcnt lgkmcnt(3)
    v_mfma_f32_16x16x32_bf16 v[172:175], v[160:163], v[200:203], 0
    ds_read_b128 v[216:219], v4 offset:20480
    s_waitcnt lgkmcnt(3)
    v_mfma_f32_16x16x32_bf16 v[176:179], v[160:163], v[204:207], 0
    ds_read_b128 v[220:223], v4 offset:22528
    s_waitcnt lgkmcnt(3)
    v_mfma_f32_16x16x32_bf16 v[180:183], v[160:163], v[208:211], 0
    ds_read_b128 v[200:203], v5 offset:20480
    s_waitcnt lgkmcnt(3)
    v_mfma_f32_16x16x32_bf16 v[184:187], v[160:163], v[212:215], 0
    ds_read_b128 v[204:207], v5 offset:22528
    s_waitcnt lgkmcnt(3)
    v_mfma_f32_16x16x32_bf16 v[172:175], v[164:167], v[216:219], v[172:175]
    ds_read_b128 v[208:211], v4 offset:24576
    s_waitcnt lgkmcnt(3)
    v_mfma_f32_16x16x32_bf16 v[176:179], v[164:167], v[220:223], v[176:179]
    ds_read_b128 v[212:215], v4 offset:26624
    s_waitcnt lgkmcnt(3)
    v_mfma_f32_16x16x32_bf16 v[180:183], v[164:167], v[200:203], v[180:183]
    ds_read_b128 v[216:219], v5 offset:24576
    s_waitcnt lgkmcnt(3)
    v_mfma_f32_16x16x32_bf16 v[184:187], v[164:167], v[204:207], v[184:187]
    ds_read_b128 v[220:223], v5 offset:26624
    s_waitcnt lgkmcnt(3)
    v_mfma_f32_16x16x32_bf16 v[172:175], v[168:171], v[208:211], v[172:175]
    ds_read_b128 v[200:203], v4 offset:0
    s_waitcnt lgkmcnt(3)
    v_mfma_f32_16x16x32_bf16 v[176:179], v[168:171], v[212:215], v[176:179]
    ds_read_b128 v[204:207], v4 offset:2048
    s_waitcnt lgkmcnt(3)
    v_mfma_f32_16x16x32_bf16 v[180:183], v[168:171], v[216:219], v[180:183]
    ds_read_b128 v[208:211], v5 offset:0
    s_waitcnt lgkmcnt(3)
    v_mfma_f32_16x16x32_bf16 v[184:187], v[168:171], v[220:223], v[184:187]
    ds_read_b128 v[212:215], v5 offset:2048
    s_waitcnt vmcnt(5) lgkmcnt(3)
    v_mfma_f32_16x16x32_bf16 v[172:175], v[144:147], v[200:203], v[172:175]
    ds_read_b128 v[216:219], v4 offset:4096
    s_waitcnt lgkmcnt(3)
    v_mfma_f32_16x16x32_bf16 v[176:179], v[144:147], v[204:207], v[176:179]
    ds_read_b128 v[220:223], v4 offset:6144
    s_waitcnt lgkmcnt(3)
    v_mfma_f32_16x16x32_bf16 v[180:183], v[144:147], v[208:211], v[180:183]
    ds_read_b128 v[200:203], v5 offset:4096
    s_waitcnt lgkmcnt(3)
    v_mfma_f32_16x16x32_bf16 v[184:187], v[144:147], v[212:215], v[184:187]
    ds_read_b128 v[204:207], v5 offset:6144
    s_waitcnt vmcnt(4) lgkmcnt(3)
    v_mfma_f32_16x16x32_bf16 v[172:175], v[148:151], v[216:219], v[172:175]
    ds_read_b128 v[208:211], v4 offset:8192
    s_waitcnt lgkmcnt(3)
    v_mfma_f32_16x16x32_bf16 v[176:179], v[148:151], v[220:223], v[176:179]
    ds_read_b128 v[212:215], v4 offset:10240
    s_waitcnt lgkmcnt(3)
    v_mfma_f32_16x16x32_bf16 v[180:183], v[148:151], v[200:203], v[180:183]
    ds_read_b128 v[216:219], v5 offset:8192
    s_waitcnt lgkmcnt(3)
    v_mfma_f32_16x16x32_bf16 v[184:187], v[148:151], v[204:207], v[184:187]
    ds_read_b128 v[220:223], v5 offset:10240
    s_waitcnt vmcnt(3) lgkmcnt(3)
    v_mfma_f32_16x16x32_bf16 v[172:175], v[152:155], v[208:211], v[172:175]
    ds_read_b128 v[200:203], v4 offset:12288
    s_waitcnt lgkmcnt(3)
    v_mfma_f32_16x16x32_bf16 v[176:179], v[152:155], v[212:215], v[176:179]
    ds_read_b128 v[204:207], v4 offset:14336
    s_waitcnt lgkmcnt(3)
    v_mfma_f32_16x16x32_bf16 v[180:183], v[152:155], v[216:219], v[180:183]
    ds_read_b128 v[208:211], v5 offset:12288
    s_waitcnt lgkmcnt(3)
    v_mfma_f32_16x16x32_bf16 v[184:187], v[152:155], v[220:223], v[184:187]
    ds_read_b128 v[212:215], v5 offset:14336
    s_waitcnt vmcnt(2) lgkmcnt(3)
    v_mfma_f32_16x16x32_bf16 v[172:175], v[156:159], v[200:203], v[172:175]
    s_waitcnt lgkmcnt(2)
    v_mfma_f32_16x16x32_bf16 v[176:179], v[156:159], v[204:207], v[176:179]
    s_waitcnt lgkmcnt(1)
    v_mfma_f32_16x16x32_bf16 v[180:183], v[156:159], v[208:211], v[180:183]
    s_waitcnt lgkmcnt(0)
    v_mfma_f32_16x16x32_bf16 v[184:187], v[156:159], v[212:215], v[184:187]
    s_nop 3
    v_permlane32_swap_b32 v180, v176
    v_permlane32_swap_b32 v181, v177
    v_permlane32_swap_b32 v182, v178
    v_permlane32_swap_b32 v183, v179
    v_add_f32 v172, v172, v176
    v_add_f32 v173, v173, v177
    v_add_f32 v174, v174, v178
    v_add_f32 v175, v175, v179
    v_add_f32 v184, v184, v180
    v_add_f32 v185, v185, v181
    v_add_f32 v186, v186, v182
    v_add_f32 v187, v187, v183
    v_cndmask_b32 v172, v184, v172, s[100:101]
    v_cndmask_b32 v173, v185, v173, s[100:101]
    v_cndmask_b32 v174, v186, v174, s[100:101]
    v_cndmask_b32 v175, v187, v175, s[100:101]
    v_max3_f32 v188, v172, v173, v174
    v_max3_f32 v188, v188, v175, v140
    v_mov_b32 v190, v188
    v_pk_add_f32 v[192:193], v[172:173], v[174:175]
    v_cmp_u_f32 vcc, v192, v193
    s_cbranch_vccnz LX_kmchk
LX_kmok:
    v_permlane16_swap_b32 v188, v190
    v_max_f32 v188, v188, v190
    v_sub_f32 v190, v140, v188
    v_pk_add_f32 v[172:173], v[172:173], v[188:189] op_sel_hi:[1,0] neg_lo:[0,1] neg_hi:[0,1]
    v_pk_add_f32 v[174:175], v[174:175], v[188:189] op_sel_hi:[1,0] neg_lo:[0,1] neg_hi:[0,1]
    v_exp_f32 v172, v172
    v_exp_f32 v173, v173
    v_exp_f32 v174, v174
    v_exp_f32 v175, v175
    v_exp_f32 v190, v190
    v_pk_add_f32 v[192:193], v[172:173], v[174:175]
    v_add_f32 v192, v192, v193
    v_fmac_f32 v192, v190, v141
    v_mov_b32 v193, v192
    s_nop 1
    v_permlane16_swap_b32 v192, v193
    v_add_f32 v192, v192, v193
    v_rcp_f32 v192, v192
    s_nop 0
    v_pk_mul_f32 v[172:173], v[172:173], v[192:193] op_sel_hi:[1,0]
    v_pk_mul_f32 v[174:175], v[174:175], v[192:193] op_sel_hi:[1,0]
    v_mul_f32 v190, v190, v192
    v_cvt_pk_bf16_f32 v188, v172, v173
    v_cvt_pk_bf16_f32 v189, v174, v175
    s_waitcnt vmcnt(0)
    buffer_store_dwordx2 v[188:189], v23, s[8:11], s16 offen
    buffer_store_dword v190, v20, s[8:11], s16 offen
    s_cmp_ge_u32 s28, 64
    s_cbranch_scc1 LX_last
    buffer_load_dword v15, v14, s[12:15], s48 offen sc1
    v_xor_b32 v4, 98304, v4
    v_xor_b32 v5, 98304, v5
    s_add_u32 s29, s29, 1
    s_branch LX_job
LX_first:
    ds_read_b128 v[80:83], v4 offset:0
    ds_read_b128 v[84:87], v5 offset:0
    s_waitcnt lgkmcnt(1)
    v_mfma_f32_16x16x32_bf16 v[92:95], v[80:83], a[0:3], 0
    s_and_b32 s58, s29, 1
    v_mfma_f32_16x16x32_bf16 v[96:99], v[80:83], a[56:59], 0
    ds_read_b128 v[88:91], v4 offset:4096
    s_mul_i32 s49, s58, 458752
    v_mfma_f32_16x16x32_bf16 v[100:103], v[80:83], a[112:115], 0
    s_mul_i32 s59, s25, 28672
    v_mfma_f32_16x16x32_bf16 v[104:107], v[80:83], a[168:171], 0
    s_add_u32 s49, s49, s59
    s_waitcnt lgkmcnt(1)
    v_mfma_f32_16x16x32_bf16 v[92:95], v[84:87], a[4:7], v[92:95]
    s_add_u32 s49, s49, s31
    v_mfma_f32_16x16x32_bf16 v[96:99], v[84:87], a[60:63], v[96:99]
    ds_read_b128 v[80:83], v5 offset:4096
    s_mul_i32 s58, s28, 28672
    s_lshl_b32 s59, s27, 5
    v_mfma_f32_16x16x32_bf16 v[100:103], v[84:87], a[116:119], v[100:103]
    s_add_u32 s48, s58, s59
    s_mul_i32 s35, s23, 1835008
    v_mfma_f32_16x16x32_bf16 v[104:107], v[84:87], a[172:175], v[104:107]
    s_add_u32 s35, s35, s58
    s_lshl_b32 s59, s27, 10
    s_waitcnt lgkmcnt(1)
    v_mfma_f32_16x16x32_bf16 v[92:95], v[88:91], a[8:11], v[92:95]
    s_add_u32 s35, s35, s59
    s_lshl_b32 s59, s20, 8
    v_mfma_f32_16x16x32_bf16 v[96:99], v[88:91], a[64:67], v[96:99]
    ds_read_b128 v[84:87], v4 offset:8192
    s_add_u32 s35, s35, s59
    s_add_u32 s35, s35, 4210688
    v_mfma_f32_16x16x32_bf16 v[100:103], v[88:91], a[120:123], v[100:103]
    s_lshl_b32 s33, s28, 14
    s_add_u32 s33, s33, s3
    v_mfma_f32_16x16x32_bf16 v[104:107], v[88:91], a[176:179], v[104:107]
    s_lshl_b32 s59, s27, 8
    s_add_u32 s34, s33, s59
    s_waitcnt lgkmcnt(1)
    v_mfma_f32_16x16x32_bf16 v[92:95], v[80:83], a[12:15], v[92:95]
    s_add_u32 s34, s34, 16384
    s_add_u32 s53, s33, 7168
    v_mfma_f32_16x16x32_bf16 v[96:99], v[80:83], a[68:71], v[96:99]
    ds_read_b128 v[88:91], v5 offset:8192
    s_and_b32 s58, s29, 1
    s_mul_i32 s50, s58, 114688
    v_mfma_f32_16x16x32_bf16 v[100:103], v[80:83], a[124:127], v[100:103]
    s_mul_i32 s59, s25, 7168
    s_add_u32 s50, s50, s59
    v_mfma_f32_16x16x32_bf16 v[104:107], v[80:83], a[180:183], v[104:107]
    s_add_u32 s50, s50, s30
    s_lshl_b32 s18, s58, 15
    s_waitcnt lgkmcnt(1)
    v_mfma_f32_16x16x32_bf16 v[92:95], v[84:87], a[16:19], v[92:95]
    s_add_u32 s18, s18, s31
    s_add_u32 s18, s18, 917504
    v_mfma_f32_16x16x32_bf16 v[96:99], v[84:87], a[72:75], v[96:99]
    ds_read_b128 v[80:83], v4 offset:12288
    s_lshl_b32 s59, s20, 13
    s_add_u32 s54, s18, s59
    v_mfma_f32_16x16x32_bf16 v[100:103], v[84:87], a[128:131], v[100:103]
    s_add_u32 s55, s54, 4096
    s_mul_i32 s58, s58, 16384
    v_mfma_f32_16x16x32_bf16 v[104:107], v[84:87], a[184:187], v[104:107]
    s_add_u32 s58, s58, s30
    s_add_u32 s58, s58, 229376
    s_waitcnt lgkmcnt(1)
    v_mfma_f32_16x16x32_bf16 v[92:95], v[88:91], a[20:23], v[92:95]
    s_lshl_b32 s59, s20, 12
    s_add_u32 s56, s58, s59
    v_mfma_f32_16x16x32_bf16 v[96:99], v[88:91], a[76:79], v[96:99]
    ds_read_b128 v[84:87], v5 offset:12288
    s_lshl_b32 s59, s25, 11
    s_add_u32 s52, s18, s59
    v_mfma_f32_16x16x32_bf16 v[100:103], v[88:91], a[132:135], v[100:103]
    s_mov_b32 s16, s58
    s_mov_b32 s59, 16384
    v_mfma_f32_16x16x32_bf16 v[104:107], v[88:91], a[188:191], v[104:107]
    s_bitcmp1_b32 s29, 0
    s_cselect_b32 s59, 4294950912, s59
    s_waitcnt lgkmcnt(1)
    v_mfma_f32_16x16x32_bf16 v[92:95], v[80:83], a[24:27], v[92:95]
    s_add_u32 s17, s16, s59
    s_and_b32 s58, s29, 3
    v_mfma_f32_16x16x32_bf16 v[96:99], v[80:83], a[80:83], v[96:99]
    ds_read_b128 v[88:91], v4 offset:16384
    s_mul_i32 s58, s58, 17408
    s_add_u32 s58, s58, s30
    v_mfma_f32_16x16x32_bf16 v[100:103], v[80:83], a[136:139], v[100:103]
    s_add_u32 s58, s58, 264192
    s_add_u32 s18, s29, 3
    v_mfma_f32_16x16x32_bf16 v[104:107], v[80:83], a[192:195], v[104:107]
    s_and_b32 s18, s18, 3
    s_mul_i32 s18, s18, 17408
    s_waitcnt lgkmcnt(1)
    v_mfma_f32_16x16x32_bf16 v[92:95], v[84:87], a[28:31], v[92:95]
    s_add_u32 s18, s18, s30
    s_add_u32 s18, s18, 264192
    v_mfma_f32_16x16x32_bf16 v[96:99], v[84:87], a[84:87], v[96:99]
    ds_read_b128 v[80:83], v5 offset:16384
    s_lshl_b32 s59, s26, 4
    s_add_u32 s59, s59, s25
    v_mfma_f32_16x16x32_bf16 v[100:103], v[84:87], a[140:143], v[100:103]
    s_lshl_b32 s59, s59, 8
    s_add_u32 s36, s58, s59
    v_mfma_f32_16x16x32_bf16 v[104:107], v[84:87], a[196:199], v[104:107]
    s_add_u32 s37, s18, s59
    s_lshl_b32 s59, s20, 10
    s_waitcnt lgkmcnt(1)
    v_mfma_f32_16x16x32_bf16 v[92:95], v[88:91], a[32:35], v[92:95]
    s_add_u32 s38, s58, s59
    s_add_u32 s39, s38, 4096
    v_mfma_f32_16x16x32_bf16 v[96:99], v[88:91], a[88:91], v[96:99]
    ds_read_b128 v[84:87], v4 offset:20480
    s_lshl_b32 s59, s20, 11
    s_add_u32 s40, s58, s59
    v_mfma_f32_16x16x32_bf16 v[100:103], v[88:91], a[144:147], v[100:103]
    s_add_u32 s40, s40, 8192
    s_add_u32 s41, s58, 16384
    v_mfma_f32_16x16x32_bf16 v[104:107], v[88:91], a[200:203], v[104:107]
    s_mov_b32 s42, s58
    s_mov_b32 s43, s18
    s_waitcnt lgkmcnt(1)
    v_mfma_f32_16x16x32_bf16 v[92:95], v[80:83], a[36:39], v[92:95]
    v_mfma_f32_16x16x32_bf16 v[96:99], v[80:83], a[92:95], v[96:99]
    ds_read_b128 v[88:91], v5 offset:20480
    v_mfma_f32_16x16x32_bf16 v[100:103], v[80:83], a[148:151], v[100:103]
    v_mfma_f32_16x16x32_bf16 v[104:107], v[80:83], a[204:207], v[104:107]
    s_waitcnt lgkmcnt(1)
    v_mfma_f32_16x16x32_bf16 v[92:95], v[84:87], a[40:43], v[92:95]
    v_mfma_f32_16x16x32_bf16 v[96:99], v[84:87], a[96:99], v[96:99]
    ds_read_b128 v[80:83], v4 offset:24576
    v_mfma_f32_16x16x32_bf16 v[100:103], v[84:87], a[152:155], v[100:103]
    v_mfma_f32_16x16x32_bf16 v[104:107], v[84:87], a[208:211], v[104:107]
    s_waitcnt lgkmcnt(1)
    v_mfma_f32_16x16x32_bf16 v[92:95], v[88:91], a[44:47], v[92:95]
    v_mfma_f32_16x16x32_bf16 v[96:99], v[88:91], a[100:103], v[96:99]
    ds_read_b128 v[84:87], v5 offset:24576
    v_mfma_f32_16x16x32_bf16 v[100:103], v[88:91], a[156:159], v[100:103]
    v_mfma_f32_16x16x32_bf16 v[104:107], v[88:91], a[212:215], v[104:107]
    s_waitcnt lgkmcnt(1)
    v_mfma_f32_16x16x32_bf16 v[92:95], v[80:83], a[48:51], v[92:95]
    v_mfma_f32_16x16x32_bf16 v[96:99], v[80:83], a[104:107], v[96:99]
    ds_read_b128 v[88:91], v4 offset:2048
    v_mfma_f32_16x16x32_bf16 v[100:103], v[80:83], a[160:163], v[100:103]
    v_mfma_f32_16x16x32_bf16 v[104:107], v[80:83], a[216:219], v[104:107]
    s_waitcnt lgkmcnt(1)
    v_mfma_f32_16x16x32_bf16 v[92:95], v[84:87], a[52:55], v[92:95]
    v_mfma_f32_16x16x32_bf16 v[96:99], v[84:87], a[108:111], v[96:99]
    ds_read_b128 v[80:83], v5 offset:2048
    v_mfma_f32_16x16x32_bf16 v[100:103], v[84:87], a[164:167], v[100:103]
    v_mfma_f32_16x16x32_bf16 v[104:107], v[84:87], a[220:223], v[104:107]
    s_waitcnt lgkmcnt(1)
    v_mfma_f32_16x16x32_bf16 v[120:123], v[88:91], a[0:3], 0
    v_mfma_f32_16x16x32_bf16 v[124:127], v[88:91], a[56:59], 0
    ds_read_b128 v[84:87], v4 offset:6144
    v_mfma_f32_16x16x32_bf16 v[128:131], v[88:91], a[112:115], 0
    v_mfma_f32_16x16x32_bf16 v[132:135], v[88:91], a[168:171], 0
    s_waitcnt lgkmcnt(1)
    v_mfma_f32_16x16x32_bf16 v[120:123], v[80:83], a[4:7], v[120:123]
    v_mfma_f32_16x16x32_bf16 v[124:127], v[80:83], a[60:63], v[124:127]
    ds_read_b128 v[88:91], v5 offset:6144
    v_mfma_f32_16x16x32_bf16 v[128:131], v[80:83], a[116:119], v[128:131]
    v_mfma_f32_16x16x32_bf16 v[132:135], v[80:83], a[172:175], v[132:135]
    s_waitcnt lgkmcnt(1)
    v_mfma_f32_16x16x32_bf16 v[120:123], v[84:87], a[8:11], v[120:123]
    v_mfma_f32_16x16x32_bf16 v[124:127], v[84:87], a[64:67], v[124:127]
    ds_read_b128 v[80:83], v4 offset:10240
    v_mfma_f32_16x16x32_bf16 v[128:131], v[84:87], a[120:123], v[128:131]
    v_mfma_f32_16x16x32_bf16 v[132:135], v[84:87], a[176:179], v[132:135]
    s_waitcnt lgkmcnt(1)
    v_mfma_f32_16x16x32_bf16 v[120:123], v[88:91], a[12:15], v[120:123]
    v_mfma_f32_16x16x32_bf16 v[124:127], v[88:91], a[68:71], v[124:127]
    ds_read_b128 v[84:87], v5 offset:10240
    v_mfma_f32_16x16x32_bf16 v[128:131], v[88:91], a[124:127], v[128:131]
    v_mfma_f32_16x16x32_bf16 v[132:135], v[88:91], a[180:183], v[132:135]
    s_waitcnt lgkmcnt(1)
    v_mfma_f32_16x16x32_bf16 v[120:123], v[80:83], a[16:19], v[120:123]
    v_mfma_f32_16x16x32_bf16 v[124:127], v[80:83], a[72:75], v[124:127]
    ds_read_b128 v[88:91], v4 offset:14336
    v_mfma_f32_16x16x32_bf16 v[128:131], v[80:83], a[128:131], v[128:131]
    v_mfma_f32_16x16x32_bf16 v[132:135], v[80:83], a[184:187], v[132:135]
    s_waitcnt lgkmcnt(1)
    v_mfma_f32_16x16x32_bf16 v[120:123], v[84:87], a[20:23], v[120:123]
    v_mfma_f32_16x16x32_bf16 v[124:127], v[84:87], a[76:79], v[124:127]
    ds_read_b128 v[80:83], v5 offset:14336
    v_mfma_f32_16x16x32_bf16 v[128:131], v[84:87], a[132:135], v[128:131]
    v_mfma_f32_16x16x32_bf16 v[132:135], v[84:87], a[188:191], v[132:135]
    s_waitcnt lgkmcnt(1)
    v_mfma_f32_16x16x32_bf16 v[120:123], v[88:91], a[24:27], v[120:123]
    v_mfma_f32_16x16x32_bf16 v[124:127], v[88:91], a[80:83], v[124:127]
    ds_read_b128 v[84:87], v4 offset:18432
    v_mfma_f32_16x16x32_bf16 v[128:131], v[88:91], a[136:139], v[128:131]
    v_mfma_f32_16x16x32_bf16 v[132:135], v[88:91], a[192:195], v[132:135]
    s_waitcnt lgkmcnt(1)
    v_mfma_f32_16x16x32_bf16 v[120:123], v[80:83], a[28:31], v[120:123]
    v_mfma_f32_16x16x32_bf16 v[124:127], v[80:83], a[84:87], v[124:127]
    ds_read_b128 v[88:91], v5 offset:18432
    v_mfma_f32_16x16x32_bf16 v[128:131], v[80:83], a[140:143], v[128:131]
    v_mfma_f32_16x16x32_bf16 v[132:135], v[80:83], a[196:199], v[132:135]
    s_waitcnt lgkmcnt(1)
    v_mfma_f32_16x16x32_bf16 v[120:123], v[84:87], a[32:35], v[120:123]
    v_mfma_f32_16x16x32_bf16 v[124:127], v[84:87], a[88:91], v[124:127]
    ds_read_b128 v[80:83], v4 offset:22528
    v_mfma_f32_16x16x32_bf16 v[128:131], v[84:87], a[144:147], v[128:131]
    v_mfma_f32_16x16x32_bf16 v[132:135], v[84:87], a[200:203], v[132:135]
    s_waitcnt lgkmcnt(1)
    v_mfma_f32_16x16x32_bf16 v[120:123], v[88:91], a[36:39], v[120:123]
    v_mfma_f32_16x16x32_bf16 v[124:127], v[88:91], a[92:95], v[124:127]
    ds_read_b128 v[84:87], v5 offset:22528
    v_mfma_f32_16x16x32_bf16 v[128:131], v[88:91], a[148:151], v[128:131]
    v_mfma_f32_16x16x32_bf16 v[132:135], v[88:91], a[204:207], v[132:135]
    s_waitcnt lgkmcnt(1)
    v_mfma_f32_16x16x32_bf16 v[120:123], v[80:83], a[40:43], v[120:123]
    v_mfma_f32_16x16x32_bf16 v[124:127], v[80:83], a[96:99], v[124:127]
    ds_read_b128 v[88:91], v4 offset:26624
    v_mfma_f32_16x16x32_bf16 v[128:131], v[80:83], a[152:155], v[128:131]
    v_mfma_f32_16x16x32_bf16 v[132:135], v[80:83], a[208:211], v[132:135]
    s_waitcnt lgkmcnt(1)
    v_mfma_f32_16x16x32_bf16 v[120:123], v[84:87], a[44:47], v[120:123]
    v_mfma_f32_16x16x32_bf16 v[124:127], v[84:87], a[100:103], v[124:127]
    ds_read_b128 v[80:83], v5 offset:26624
    v_mfma_f32_16x16x32_bf16 v[128:131], v[84:87], a[156:159], v[128:131]
    v_mfma_f32_16x16x32_bf16 v[132:135], v[84:87], a[212:215], v[132:135]
    s_waitcnt lgkmcnt(1)
    v_mfma_f32_16x16x32_bf16 v[120:123], v[88:91], a[48:51], v[120:123]
    v_mfma_f32_16x16x32_bf16 v[124:127], v[88:91], a[104:107], v[124:127]
    v_mfma_f32_16x16x32_bf16 v[128:131], v[88:91], a[160:163], v[128:131]
    v_mfma_f32_16x16x32_bf16 v[132:135], v[88:91], a[216:219], v[132:135]
    s_waitcnt lgkmcnt(0)
    v_mfma_f32_16x16x32_bf16 v[120:123], v[80:83], a[52:55], v[120:123]
    v_mfma_f32_16x16x32_bf16 v[124:127], v[80:83], a[108:111], v[124:127]
    v_mfma_f32_16x16x32_bf16 v[128:131], v[80:83], a[164:167], v[128:131]
    v_mfma_f32_16x16x32_bf16 v[132:135], v[80:83], a[220:223], v[132:135]
    buffer_load_dword v142, v26, s[8:11], s51 offen sc1
    s_lshl_b32 s58, s29, 1
    s_or_b32 s58, s58, 0
    s_waitcnt vmcnt(0)
    v_cmp_gt_i32 vcc, s58, v142
    s_cbranch_vccnz Lkxpoll_102
Lkxok_101:
    s_mov_b32 s59, s49
    buffer_load_dwordx4 v[144:147], v1, s[8:11], s59 offen offset:0 sc1
    buffer_load_dwordx4 v[148:151], v1, s[8:11], s59 offen offset:2048 sc1
    s_add_u32 s59, s59, 4096
    buffer_load_dwordx4 v[152:155], v1, s[8:11], s59 offen offset:0 sc1
    buffer_load_dwordx4 v[156:159], v1, s[8:11], s59 offen offset:2048 sc1
    s_add_u32 s59, s59, 4096
    buffer_load_dwordx4 v[160:163], v1, s[8:11], s59 offen offset:0 sc1
    buffer_load_dwordx4 v[164:167], v1, s[8:11], s59 offen offset:2048 sc1
    s_add_u32 s59, s59, 4096
    buffer_load_dwordx4 v[168:171], v1, s[8:11], s59 offen offset:0 sc1
    buffer_load_dwordx4 v[172:175], v1, s[8:11], s59 offen offset:2048 sc1
    s_add_u32 s59, s59, 4096
    buffer_load_dwordx4 v[176:179], v1, s[8:11], s59 offen offset:0 sc1
    buffer_load_dwordx4 v[180:183], v1, s[8:11], s59 offen offset:2048 sc1
    s_add_u32 s59, s59, 4096
    buffer_load_dwordx4 v[184:187], v1, s[8:11], s59 offen offset:0 sc1
    buffer_load_dwordx4 v[188:191], v1, s[8:11], s59 offen offset:2048 sc1
    s_add_u32 s59, s59, 4096
    buffer_load_dwordx4 v[192:195], v1, s[8:11], s59 offen offset:0 sc1
    buffer_load_dwordx4 v[196:199], v1, s[8:11], s59 offen offset:2048 sc1
    s_waitcnt vmcnt(0) lgkmcnt(0)
    s_nop 7
    s_branch LX_p1
Lalretry_86:
    s_mov_b32 s70, 0
Lpoll_103:
    buffer_load_dword v15, v14, s[12:15], s48 offen sc1
    buffer_load_dwordx4 v[32:35], v25, s[8:11], s56 offen offset:2048 sc1
    buffer_load_dwordx4 v[36:39], v25, s[8:11], s56 offen offset:2304 sc1
    s_add_u32 s70, s70, 1
    s_cmp_gt_u32 s70, 131072
    s_cbranch_scc1 Lfail
    s_waitcnt vmcnt(1)
    v_max3_u32 v16, v32, v33, v34
    s_waitcnt vmcnt(0)
    v_max3_u32 v16, v16, v35, v36
    v_max3_u32 v16, v16, v37, v38
    v_max3_u32 v16, v16, v39, v15
    v_cmp_eq_u32 vcc, -1, v16
    s_cbranch_vccnz Lpoll_103
    buffer_load_dwordx4 v[40:43], v1, s[8:11], s56 offen offset:0 sc1
    buffer_load_dwordx4 v[44:47], v1, s[8:11], s56 offen offset:1024 sc1
    s_waitcnt vmcnt(0)
    s_branch Lalok_85
Lpretry_88:
    s_mov_b32 s70, 0
Lpoll_104:
    buffer_load_dwordx4 v[40:43], v1, s[8:11], s56 offen offset:0 sc1
    buffer_load_dwordx4 v[44:47], v1, s[8:11], s56 offen offset:1024 sc1
    s_add_u32 s70, s70, 1
    s_cmp_gt_u32 s70, 131072
    s_cbranch_scc1 Lfail
    s_waitcnt vmcnt(1)
    v_max3_u32 v16, v40, v41, v42
    s_waitcnt vmcnt(0)
    v_max3_u32 v16, v16, v43, v44
    v_max3_u32 v16, v16, v45, v46
    v_max_u32 v16, v16, v47
    v_cmp_eq_u32 vcc, -1, v16
    s_cbranch_vccnz Lpoll_104
    s_branch Lpok_87
Lkxpoll_90:
    s_mov_b32 s70, 0
Lpoll_105:
    buffer_load_dword v142, v26, s[8:11], s51 offen sc1
    s_add_u32 s70, s70, 1
    s_cmp_gt_u32 s70, 131072
    s_cbranch_scc1 Lfail
    s_waitcnt vmcnt(0)
    v_cmp_gt_i32 vcc, s58, v142
    s_cbranch_vccnz Lpoll_105
    s_branch Lkxok_89
LX_last:
    buffer_load_dword v15, v14, s[12:15], s48 offen sc1
    buffer_load_dwordx4 v[48:51], v1, s[8:11], s54 offen offset:0 sc1
    buffer_load_dwordx4 v[52:55], v1, s[8:11], s54 offen offset:1024 sc1
    buffer_load_dwordx4 v[56:59], v1, s[8:11], s54 offen offset:2048 sc1
    buffer_load_dwordx4 v[60:63], v1, s[8:11], s54 offen offset:3072 sc1
    buffer_load_dwordx4 v[64:67], v1, s[8:11], s55 offen offset:0 sc1
    buffer_load_dwordx4 v[68:71], v1, s[8:11], s55 offen offset:1024 sc1
    buffer_load_dwordx4 v[72:75], v1, s[8:11], s55 offen offset:2048 sc1
    buffer_load_dwordx4 v[76:79], v1, s[8:11], s55 offen offset:3072 sc1
    s_waitcnt vmcnt(7)
    v_mfma_f32_16x16x32_bf16 v[48:51], v[32:35], v[48:51], 0
    s_waitcnt vmcnt(6)
    v_mfma_f32_16x16x32_bf16 v[52:55], v[32:35], v[52:55], 0
    s_waitcnt vmcnt(5)
    v_mfma_f32_16x16x32_bf16 v[56:59], v[36:39], v[56:59], 0
    s_waitcnt vmcnt(4)
    v_mfma_f32_16x16x32_bf16 v[60:63], v[36:39], v[60:63], 0
    s_waitcnt vmcnt(3)
    v_mfma_f32_16x16x32_bf16 v[64:67], v[40:43], v[64:67], 0
    s_waitcnt vmcnt(2)
    v_mfma_f32_16x16x32_bf16 v[68:71], v[40:43], v[68:71], 0
    s_waitcnt vmcnt(1)
    v_mfma_f32_16x16x32_bf16 v[72:75], v[44:47], v[72:75], 0
    s_waitcnt vmcnt(0)
    v_mfma_f32_16x16x32_bf16 v[76:79], v[44:47], v[76:79], 0
    buffer_load_dwordx4 v[32:35], v25, s[8:11], s56 offen offset:2048 sc1
    buffer_load_dwordx4 v[36:39], v25, s[8:11], s56 offen offset:2304 sc1
    buffer_load_dwordx4 v[40:43], v1, s[8:11], s56 offen offset:0 sc1
    buffer_load_dwordx4 v[44:47], v1, s[8:11], s56 offen offset:1024 sc1
    s_waitcnt vmcnt(3)
    v_max3_u32 v16, v32, v33, v34
    s_waitcnt vmcnt(2)
    v_max3_u32 v16, v16, v35, v36
    v_max3_u32 v16, v16, v37, v38
    s_waitcnt vmcnt(1)
    v_max3_u32 v16, v16, v39, v40
    v_max3_u32 v16, v16, v41, v42
    s_waitcnt vmcnt(0)
    v_max3_u32 v16, v16, v43, v44
    v_max3_u32 v16, v16, v45, v46
    v_max3_u32 v16, v16, v47, v15
    v_cmp_eq_u32 vcc, -1, v16
    s_cbranch_vccnz Llateretry_107
Llateok_106:
    v_pk_mul_f32 v[48:49], v[48:49], v[32:33] op_sel:[0,0] op_sel_hi:[1,0]
    v_pk_mul_f32 v[50:51], v[50:51], v[32:33] op_sel:[0,0] op_sel_hi:[1,0]
    v_pk_mul_f32 v[52:53], v[52:53], v[36:37] op_sel:[0,0] op_sel_hi:[1,0]
    v_pk_mul_f32 v[54:55], v[54:55], v[36:37] op_sel:[0,0] op_sel_hi:[1,0]
    v_pk_fma_f32 v[48:49], v[56:57], v[32:33], v[48:49] op_sel:[0,1,0] op_sel_hi:[1,1,1]
    v_pk_fma_f32 v[50:51], v[58:59], v[32:33], v[50:51] op_sel:[0,1,0] op_sel_hi:[1,1,1]
    v_pk_fma_f32 v[52:53], v[60:61], v[36:37], v[52:53] op_sel:[0,1,0] op_sel_hi:[1,1,1]
    v_pk_fma_f32 v[54:55], v[62:63], v[36:37], v[54:55] op_sel:[0,1,0] op_sel_hi:[1,1,1]
    v_pk_fma_f32 v[48:49], v[64:65], v[34:35], v[48:49] op_sel:[0,0,0] op_sel_hi:[1,0,1]
    v_pk_fma_f32 v[50:51], v[66:67], v[34:35], v[50:51] op_sel:[0,0,0] op_sel_hi:[1,0,1]
    v_pk_fma_f32 v[52:53], v[68:69], v[38:39], v[52:53] op_sel:[0,0,0] op_sel_hi:[1,0,1]
    v_pk_fma_f32 v[54:55], v[70:71], v[38:39], v[54:55] op_sel:[0,0,0] op_sel_hi:[1,0,1]
    v_pk_fma_f32 v[48:49], v[72:73], v[34:35], v[48:49] op_sel:[0,1,0] op_sel_hi:[1,1,1]
    v_pk_fma_f32 v[50:51], v[74:75], v[34:35], v[50:51] op_sel:[0,1,0] op_sel_hi:[1,1,1]
    v_pk_fma_f32 v[52:53], v[76:77], v[38:39], v[52:53] op_sel:[0,1,0] op_sel_hi:[1,1,1]
    v_pk_fma_f32 v[54:55], v[78:79], v[38:39], v[54:55] op_sel:[0,1,0] op_sel_hi:[1,1,1]
    v_lshlrev_b32 v32, 16, v15
    v_and_b32 v33, 0xffff0000, v15
    v_mfma_f32_16x16x32_bf16 v[48:51], v[116:119], v[40:43], v[48:51]
    v_mfma_f32_16x16x32_bf16 v[52:55], v[116:119], v[44:47], v[52:55]
    s_nop 3
    ds_write_b128 v11, v[48:51] offset:12288
    s_nop 2
    ds_write_b128 v11, v[52:55] offset:13312
    s_waitcnt lgkmcnt(0)
    s_barrier
    ds_read_b64 v[56:57], v12 offset:12288
    ds_read_b64 v[58:59], v12 offset:14336
    ds_read_b64 v[60:61], v12 offset:16384
    ds_read_b64 v[62:63], v12 offset:18432
    s_waitcnt lgkmcnt(3)
    v_add_f32 v32, v32, v56
    v_add_f32 v33, v33, v57
    s_waitcnt lgkmcnt(2)
    v_add_f32 v32, v32, v58
    v_add_f32 v33, v33, v59
    s_waitcnt lgkmcnt(1)
    v_add_f32 v32, v32, v60
    v_add_f32 v33, v33, v61
    s_waitcnt lgkmcnt(0)
    v_add_f32 v32, v32, v62
    v_add_f32 v33, v33, v63
    v_cvt_pk_bf16_f32 v32, v32, v33
    buffer_store_dword v32, v13, s[8:11], s35 offen sc1
    s_branch Ldone
Llateretry_107:
    s_mov_b32 s70, 0
Lpoll_108:
    buffer_load_dword v15, v14, s[12:15], s48 offen sc1
    buffer_load_dwordx4 v[32:35], v25, s[8:11], s56 offen offset:2048 sc1
    buffer_load_dwordx4 v[36:39], v25, s[8:11], s56 offen offset:2304 sc1
    buffer_load_dwordx4 v[40:43], v1, s[8:11], s56 offen offset:0 sc1
    buffer_load_dwordx4 v[44:47], v1, s[8:11], s56 offen offset:1024 sc1
    s_add_u32 s70, s70, 1
    s_cmp_gt_u32 s70, 131072
    s_cbranch_scc1 Lfail
    s_waitcnt vmcnt(3)
    v_max3_u32 v16, v32, v33, v34
    s_waitcnt vmcnt(2)
    v_max3_u32 v16, v16, v35, v36
    v_max3_u32 v16, v16, v37, v38
    s_waitcnt vmcnt(1)
    v_max3_u32 v16, v16, v39, v40
    v_max3_u32 v16, v16, v41, v42
    s_waitcnt vmcnt(0)
    v_max3_u32 v16, v16, v43, v44
    v_max3_u32 v16, v16, v45, v46
    v_max3_u32 v16, v16, v47, v15
    v_cmp_eq_u32 vcc, -1, v16
    s_cbranch_vccnz Lpoll_108
    s_branch Llateok_106
Lkxpoll_92:
    s_mov_b32 s70, 0
Lpoll_109:
    buffer_load_dword v142, v26, s[8:11], s51 offen sc1
    s_add_u32 s70, s70, 1
    s_cmp_gt_u32 s70, 131072
    s_cbranch_scc1 Lfail
    s_waitcnt vmcnt(0)
    v_cmp_gt_i32 vcc, s58, v142
    s_cbranch_vccnz Lpoll_109
    s_branch Lkxok_91
Leretry_97:
    s_mov_b32 s70, 0
Lpoll_110:
    buffer_load_dwordx4 v[108:111], v1, s[8:11], s40 offen offset:0 sc1
    buffer_load_dwordx4 v[112:115], v1, s[8:11], s40 offen offset:1024 sc1
    s_add_u32 s70, s70, 1
    s_cmp_gt_u32 s70, 131072
    s_cbranch_scc1 Lfail
    s_waitcnt vmcnt(1)
    v_max3_u32 v16, v108, v109, v110
    s_waitcnt vmcnt(0)
    v_max3_u32 v16, v16, v111, v112
    v_max3_u32 v16, v16, v113, v114
    v_max_u32 v16, v16, v115
    v_cmp_eq_u32 vcc, -1, v16
    s_cbranch_vccnz Lpoll_110
    s_branch Leok_96
Lsretry_100:
    buffer_load_dwordx4 v[80:83], v1, s[8:11], s38 offen sc1
    buffer_load_dwordx4 v[84:87], v1, s[8:11], s39 offen sc1
    s_waitcnt vmcnt(2)
    v_pk_add_f32 v[96:97], v[68:69], v[112:113]
    v_pk_add_f32 v[98:99], v[70:71], v[114:115]
    v_max3_f32 v100, v96, v97, v98
    v_max3_f32 v100, v100, v99, v30
    v_pk_fma_f32 v[104:105], v[96:97], v[30:31], v[98:99]
    v_cmp_u_f32 vcc, v104, v105
    v_max_f32_dpp v100, v100, v100 row_ror:8 row_mask:0xf bank_mask:0xf
    v_sub_f32 v102, v30, v100
    v_pk_add_f32 v[96:97], v[96:97], v[100:101] op_sel_hi:[1,0] neg_lo:[0,1] neg_hi:[0,1]
    v_pk_add_f32 v[98:99], v[98:99], v[100:101] op_sel_hi:[1,0] neg_lo:[0,1] neg_hi:[0,1]
    s_cbranch_vccz Lsok_99
    buffer_load_dwordx4 v[68:71], v1, s[8:11], s38 offen sc1
    buffer_load_dwordx4 v[112:115], v1, s[8:11], s39 offen sc1
    s_waitcnt vmcnt(2)
    v_pk_add_f32 v[96:97], v[80:81], v[84:85]
    v_pk_add_f32 v[98:99], v[82:83], v[86:87]
    v_max3_f32 v100, v96, v97, v98
    v_max3_f32 v100, v100, v99, v30
    v_pk_fma_f32 v[104:105], v[96:97], v[30:31], v[98:99]
    v_cmp_u_f32 vcc, v104, v105
    v_max_f32_dpp v100, v100, v100 row_ror:8 row_mask:0xf bank_mask:0xf
    v_sub_f32 v102, v30, v100
    v_pk_add_f32 v[96:97], v[96:97], v[100:101] op_sel_hi:[1,0] neg_lo:[0,1] neg_hi:[0,1]
    v_pk_add_f32 v[98:99], v[98:99], v[100:101] op_sel_hi:[1,0] neg_lo:[0,1] neg_hi:[0,1]
    s_cbranch_vccz Lsok_99
    buffer_load_dwordx4 v[80:83], v1, s[8:11], s38 offen sc1
    buffer_load_dwordx4 v[84:87], v1, s[8:11], s39 offen sc1
    s_waitcnt vmcnt(2)
    v_pk_add_f32 v[96:97], v[68:69], v[112:113]
    v_pk_add_f32 v[98:99], v[70:71], v[114:115]
    v_max3_f32 v100, v96, v97, v98
    v_max3_f32 v100, v100, v99, v30
    v_pk_fma_f32 v[104:105], v[96:97], v[30:31], v[98:99]
    v_cmp_u_f32 vcc, v104, v105
    v_max_f32_dpp v100, v100, v100 row_ror:8 row_mask:0xf bank_mask:0xf
    v_sub_f32 v102, v30, v100
    v_pk_add_f32 v[96:97], v[96:97], v[100:101] op_sel_hi:[1,0] neg_lo:[0,1] neg_hi:[0,1]
    v_pk_add_f32 v[98:99], v[98:99], v[100:101] op_sel_hi:[1,0] neg_lo:[0,1] neg_hi:[0,1]
    s_cbranch_vccz Lsok_99
    buffer_load_dwordx4 v[68:71], v1, s[8:11], s38 offen sc1
    buffer_load_dwordx4 v[112:115], v1, s[8:11], s39 offen sc1
    s_waitcnt vmcnt(2)
    v_pk_add_f32 v[96:97], v[80:81], v[84:85]
    v_pk_add_f32 v[98:99], v[82:83], v[86:87]
    v_max3_f32 v100, v96, v97, v98
    v_max3_f32 v100, v100, v99, v30
    v_pk_fma_f32 v[104:105], v[96:97], v[30:31], v[98:99]
    v_cmp_u_f32 vcc, v104, v105
    v_max_f32_dpp v100, v100, v100 row_ror:8 row_mask:0xf bank_mask:0xf
    v_sub_f32 v102, v30, v100
    v_pk_add_f32 v[96:97], v[96:97], v[100:101] op_sel_hi:[1,0] neg_lo:[0,1] neg_hi:[0,1]
    v_pk_add_f32 v[98:99], v[98:99], v[100:101] op_sel_hi:[1,0] neg_lo:[0,1] neg_hi:[0,1]
    s_cbranch_vccz Lsok_99
    s_mov_b32 s70, 0
Lpoll_111:
    buffer_load_dword v30, v27, s[8:11], s41 offen offset:0 sc1
    buffer_load_dword v31, v27, s[8:11], s41 offen offset:4 sc1
    buffer_load_dwordx4 v[80:83], v1, s[8:11], s38 offen sc1
    buffer_load_dwordx4 v[84:87], v1, s[8:11], s39 offen sc1
    s_add_u32 s70, s70, 1
    s_cmp_gt_u32 s70, 131072
    s_cbranch_scc1 Lfail
    s_waitcnt vmcnt(1)
    v_max3_u32 v16, v30, v31, v80
    v_max3_u32 v16, v16, v81, v82
    s_waitcnt vmcnt(0)
    v_max3_u32 v16, v16, v83, v84
    v_max3_u32 v16, v16, v85, v86
    v_max_u32 v16, v16, v87
    v_cmp_eq_u32 vcc, -1, v16
    s_cbranch_vccnz Lpoll_111
    s_waitcnt vmcnt(0)
    v_pk_add_f32 v[96:97], v[80:81], v[84:85]
    v_pk_add_f32 v[98:99], v[82:83], v[86:87]
    v_max3_f32 v100, v96, v97, v98
    v_max3_f32 v100, v100, v99, v30
    v_pk_fma_f32 v[104:105], v[96:97], v[30:31], v[98:99]
    v_cmp_u_f32 vcc, v104, v105
    v_max_f32_dpp v100, v100, v100 row_ror:8 row_mask:0xf bank_mask:0xf
    v_sub_f32 v102, v30, v100
    v_pk_add_f32 v[96:97], v[96:97], v[100:101] op_sel_hi:[1,0] neg_lo:[0,1] neg_hi:[0,1]
    v_pk_add_f32 v[98:99], v[98:99], v[100:101] op_sel_hi:[1,0] neg_lo:[0,1] neg_hi:[0,1]
    s_branch Lsok_99
Lkxpoll_102:
    s_mov_b32 s70, 0
Lpoll_112:
    buffer_load_dword v142, v26, s[8:11], s51 offen sc1
    s_add_u32 s70, s70, 1
    s_cmp_gt_u32 s70, 131072
    s_cbranch_scc1 Lfail
    s_waitcnt vmcnt(0)
    v_cmp_gt_i32 vcc, s58, v142
    s_cbranch_vccnz Lpoll_112
    s_branch Lkxok_101
LX_kmchk:
    v_max3_u32 v16, v144, v145, v146
    v_max3_u32 v16, v16, v147, v148
    v_max3_u32 v16, v16, v149, v150
    v_max3_u32 v16, v16, v151, v152
    v_max3_u32 v16, v16, v153, v154
    v_max3_u32 v16, v16, v155, v156
    v_max3_u32 v16, v16, v157, v158
    v_max_u32 v16, v16, v159
    v_cmp_eq_u32 vcc, -1, v16
    s_cbranch_vccz LX_kmok
    buffer_load_dwordx4 v[144:147], v1, s[8:11], s50 offen offset:0 sc1
    buffer_load_dwordx4 v[148:151], v1, s[8:11], s50 offen offset:1024 sc1
    buffer_load_dwordx4 v[152:155], v1, s[8:11], s50 offen offset:2048 sc1
    buffer_load_dwordx4 v[156:159], v1, s[8:11], s50 offen offset:3072 sc1
    s_add_u32 s70, s70, 1
    s_cmp_gt_u32 s70, 131072
    s_cbranch_scc1 Lfail
    s_waitcnt vmcnt(0)
    s_branch LX_km
Lmlp:
    s_mov_b32 s3, s35
    s_lshr_b32 s25, s22, 4
    s_and_b32 s26, s22, 15
    s_mov_b32 s28, s25
    s_mov_b32 s29, 0
    s_mov_b32 s68, -1
    s_mov_b32 s69, 0x00ffffff
    s_lshl_b32 s35, s25, 8
    s_add_u32 s35, s35, s30
    s_add_u32 s35, s35, 262144
    s_lshl_b32 s58, s26, 2
    s_add_u32 s58, s58, s20
    s_lshl_b32 s58, s58, 2
    s_add_u32 s34, s35, s58
    s_mul_i32 s58, s25, 917504
    s_add_u32 s31, s31, s58
    s_add_u32 s58, s6, 9715712
    s_addc_u32 s59, s7, 0
    s_cmp_eq_u32 s23, 0
    s_cselect_b32 s12, s58, s44
    s_cselect_b32 s13, s59, s45
    s_mov_b32 s14, 1835008
    s_mov_b32 s15, 0x20000
    v_and_b32 v48, 15, v0
    v_lshrrev_b32 v49, 4, v0
    s_lshl_b32 s58, s20, 10
    v_add_u32 v2, s58, v1
    v_lshrrev_b32 v50, 1, v49
    v_lshlrev_b32 v50, 10, v50
    v_and_b32 v51, 1, v49
    v_lshl_add_u32 v50, v51, 8, v50
    v_lshl_add_u32 v3, v48, 4, v50
    s_lshl_b32 s58, s20, 11
    v_add_u32 v4, s58, v1
    v_lshrrev_b32 v50, 5, v0
    v_lshlrev_b32 v50, 9, v50
    v_lshl_add_u32 v6, v48, 4, v50
    s_lshl_b32 s58, s20, 2
    v_add_u32 v5, s58, v1
    v_lshlrev_b32 v50, 12, v49
    v_lshl_add_u32 v50, v48, 4, v50
    s_lshl_b32 s58, s20, 8
    v_add_u32 v7, s58, v50
    v_lshlrev_b32 v8, 2, v0
    s_and_b32 s58, s20, 1
    s_cmp_ge_u32 s26, 14
    s_cselect_b32 s71, 2, s58
    s_lshl_b32 s60, s58, 4
    s_add_u32 s60, s60, s26
    s_mul_i32 s66, s26, 37
    s_lshr_b32 s66, s66, 8
    s_mul_i32 s66, s66, 7
    s_sub_u32 s66, s26, s66
    s_lshr_b32 s64, s20, 1
    s_mul_i32 s65, s60, 896
    s_lshl_b32 s48, s60, 10
    s_mul_i32 s59, s64, 229376
    s_add_u32 s48, s48, s59
    s_mul_i32 s58, s58, 1792
    s_add_u32 s58, s58, 37888
    v_lshlrev_b32 v50, 5, v0
    v_add_u32 v12, s58, v50
    v_mul_u32_u24 v50, 112, v49
    v_add_lshl_u32 v50, v50, v48, 2
    s_mul_i32 s58, s20, 1792
    s_add_u32 s58, s58, 37888
    v_add_u32 v11, s58, v50
    v_lshrrev_b32 v51, 1, v0
    v_lshlrev_b32 v51, 10, v51
    v_and_b32 v52, 1, v0
    v_lshl_add_u32 v51, v52, 8, v51
    s_lshr_b32 s59, s60, 4
    s_lshl_b32 s59, s59, 9
    s_and_b32 s62, s60, 15
    s_lshl_b32 s62, s62, 4
    s_add_u32 s59, s59, s62
    v_add_u32 v51, s59, v51
    v_mov_b32 v52, 0x40000000
    v_cndmask_b32 v9, v52, v51, s[68:69]
    v_lshrrev_b32 v51, 2, v0
    v_min_u32 v51, 6, v51
    v_lshlrev_b32 v51, 15, v51
    v_and_b32 v52, 3, v0
    v_lshl_add_u32 v51, v52, 8, v51
    v_add_u32 v173, 252, v51
    v_mov_b32 v13, 0x3f803f80
    v_mov_b32 v14, 0x3f80
    v_mov_b32 v15, 0x3f800000
    s_mov_b32 s16, s42
    s_mov_b32 s17, s43
    s_mov_b32 s18, 896
    s_mov_b32 s19, 0x20000
    buffer_load_dwordx4 v[40:43], v1, s[16:19], 0 offen
    s_waitcnt vmcnt(0)
    v_lshlrev_b32 v32, 16, v40
    v_and_b32 v33, 0xffff0000, v40
    v_lshlrev_b32 v34, 16, v41
    v_and_b32 v35, 0xffff0000, v41
    v_lshlrev_b32 v36, 16, v42
    v_and_b32 v37, 0xffff0000, v42
    v_lshlrev_b32 v38, 16, v43
    v_and_b32 v39, 0xffff0000, v43
    s_mul_i32 s58, s28, 28672
    s_mul_i32 s32, s23, 1835008
    s_add_u32 s32, s32, s58
    s_add_u32 s32, s32, 4210688
    s_mov_b32 s60, 0x3b124925
    s_mov_b32 s61, 0x3727c5ac
    s_mov_b32 s62, 0xbdd2d3e8
    s_mov_b32 s63, 0xc0135761
    s_cmp_ge_u32 s26, 14
    s_cbranch_scc1 LM_go
    s_mov_b32 s16, s36
    s_mov_b32 s17, s37
    s_mov_b32 s18, 1605632
    s_mov_b32 s19, 0x20000
    v_mul_u32_u24 v50, 3584, v49
    v_lshl_add_u32 v50, v48, 4, v50
    s_mul_i32 s62, s20, 401408
    s_lshl_b32 s58, s26, 8
    s_add_u32 s62, s62, s58
    s_mul_i32 s63, s20, 28672
    s_mov_b32 m0, s63
    s_nop 0
    buffer_load_dwordx4 v50, s[16:19], s62 offen lds
    s_add_u32 s62, s62, 14336
    s_add_u32 m0, m0, 1024
    s_nop 0
    buffer_load_dwordx4 v50, s[16:19], s62 offen lds
    s_add_u32 s62, s62, 14336
    s_add_u32 m0, m0, 1024
    s_nop 0
    buffer_load_dwordx4 v50, s[16:19], s62 offen lds
    s_add_u32 s62, s62, 14336
    s_add_u32 m0, m0, 1024
    s_nop 0
    buffer_load_dwordx4 v50, s[16:19], s62 offen lds
    s_add_u32 s62, s62, 14336
    s_add_u32 m0, m0, 1024
    s_nop 0
    buffer_load_dwordx4 v50, s[16:19], s62 offen lds
    s_add_u32 s62, s62, 14336
    s_add_u32 m0, m0, 1024
    s_nop 0
    buffer_load_dwordx4 v50, s[16:19], s62 offen lds
    s_add_u32 s62, s62, 14336
    s_add_u32 m0, m0, 1024
    s_nop 0
    buffer_load_dwordx4 v50, s[16:19], s62 offen lds
    s_add_u32 s62, s62, 14336
    s_add_u32 m0, m0, 1024
    s_nop 0
    buffer_load_dwordx4 v50, s[16:19], s62 offen lds
    s_add_u32 s62, s62, 14336
    s_add_u32 m0, m0, 1024
    s_nop 0
    buffer_load_dwordx4 v50, s[16:19], s62 offen lds
    s_add_u32 s62, s62, 14336
    s_add_u32 m0, m0, 1024
    s_nop 0
    buffer_load_dwordx4 v50, s[16:19], s62 offen lds
    s_add_u32 s62, s62, 14336
    s_add_u32 m0, m0, 1024
    s_nop 0
    buffer_load_dwordx4 v50, s[16:19], s62 offen lds
    s_add_u32 s62, s62, 14336
    s_add_u32 m0, m0, 1024
    s_nop 0
    buffer_load_dwordx4 v50, s[16:19], s62 offen lds
    s_add_u32 s62, s62, 14336
    s_add_u32 m0, m0, 1024
    s_nop 0
    buffer_load_dwordx4 v50, s[16:19], s62 offen lds
    s_add_u32 s62, s62, 14336
    s_add_u32 m0, m0, 1024
    s_nop 0
    buffer_load_dwordx4 v50, s[16:19], s62 offen lds
    s_add_u32 s62, s62, 14336
    s_add_u32 m0, m0, 1024
    s_nop 0
    buffer_load_dwordx4 v50, s[16:19], s62 offen lds
    s_add_u32 s62, s62, 14336
    s_add_u32 m0, m0, 1024
    s_nop 0
    buffer_load_dwordx4 v50, s[16:19], s62 offen lds
    s_add_u32 s62, s62, 14336
    s_add_u32 m0, m0, 1024
    s_nop 0
    buffer_load_dwordx4 v50, s[16:19], s62 offen lds
    s_add_u32 s62, s62, 14336
    s_add_u32 m0, m0, 1024
    s_nop 0
    buffer_load_dwordx4 v50, s[16:19], s62 offen lds
    s_add_u32 s62, s62, 14336
    s_add_u32 m0, m0, 1024
    s_nop 0
    buffer_load_dwordx4 v50, s[16:19], s62 offen lds
    s_add_u32 s62, s62, 14336
    s_add_u32 m0, m0, 1024
    s_nop 0
    buffer_load_dwordx4 v50, s[16:19], s62 offen lds
    s_add_u32 s62, s62, 14336
    s_add_u32 m0, m0, 1024
    s_nop 0
    buffer_load_dwordx4 v50, s[16:19], s62 offen lds
    s_add_u32 s62, s62, 14336
    s_add_u32 m0, m0, 1024
    s_nop 0
    buffer_load_dwordx4 v50, s[16:19], s62 offen lds
    s_add_u32 s62, s62, 14336
    s_add_u32 m0, m0, 1024
    s_nop 0
    buffer_load_dwordx4 v50, s[16:19], s62 offen lds
    s_add_u32 s62, s62, 14336
    s_add_u32 m0, m0, 1024
    s_nop 0
    buffer_load_dwordx4 v50, s[16:19], s62 offen lds
    s_add_u32 s62, s62, 14336
    s_add_u32 m0, m0, 1024
    s_nop 0
    buffer_load_dwordx4 v50, s[16:19], s62 offen lds
    s_add_u32 s62, s62, 14336
    s_add_u32 m0, m0, 1024
    s_nop 0
    buffer_load_dwordx4 v50, s[16:19], s62 offen lds
    s_add_u32 s62, s62, 14336
    s_add_u32 m0, m0, 1024
    s_nop 0
    buffer_load_dwordx4 v50, s[16:19], s62 offen lds
    s_add_u32 s62, s62, 14336
    s_add_u32 m0, m0, 1024
    s_nop 0
    buffer_load_dwordx4 v50, s[16:19], s62 offen lds
    s_mov_b32 s16, s40
    s_mov_b32 s17, s41
    s_mov_b32 s18, 1605632
    s_mov_b32 s19, 0x20000
    s_mul_i32 s62, s26, 114688
    s_add_u32 s62, s62, s63
    buffer_load_dwordx4 v[60:63], v1, s[16:19], s62 offen offset:0
    buffer_load_dwordx4 v[64:67], v1, s[16:19], s62 offen offset:1024
    buffer_load_dwordx4 v[68:71], v1, s[16:19], s62 offen offset:2048
    buffer_load_dwordx4 v[72:75], v1, s[16:19], s62 offen offset:3072
    s_add_u32 s62, s62, 4096
    buffer_load_dwordx4 v[76:79], v1, s[16:19], s62 offen offset:0
    buffer_load_dwordx4 v[80:83], v1, s[16:19], s62 offen offset:1024
    buffer_load_dwordx4 v[84:87], v1, s[16:19], s62 offen offset:2048
    buffer_load_dwordx4 v[88:91], v1, s[16:19], s62 offen offset:3072
    s_add_u32 s62, s62, 4096
    buffer_load_dwordx4 v[92:95], v1, s[16:19], s62 offen offset:0
    buffer_load_dwordx4 v[96:99], v1, s[16:19], s62 offen offset:1024
    buffer_load_dwordx4 v[100:103], v1, s[16:19], s62 offen offset:2048
    buffer_load_dwordx4 v[104:107], v1, s[16:19], s62 offen offset:3072
    s_add_u32 s62, s62, 4096
    buffer_load_dwordx4 v[108:111], v1, s[16:19], s62 offen offset:0
    buffer_load_dwordx4 v[112:115], v1, s[16:19], s62 offen offset:1024
    buffer_load_dwordx4 v[116:119], v1, s[16:19], s62 offen offset:2048
    buffer_load_dwordx4 v[120:123], v1, s[16:19], s62 offen offset:3072
    s_add_u32 s62, s62, 4096
    buffer_load_dwordx4 v[124:127], v1, s[16:19], s62 offen offset:0
    buffer_load_dwordx4 v[128:131], v1, s[16:19], s62 offen offset:1024
    buffer_load_dwordx4 v[132:135], v1, s[16:19], s62 offen offset:2048
    buffer_load_dwordx4 v[136:139], v1, s[16:19], s62 offen offset:3072
    s_add_u32 s62, s62, 4096
    buffer_load_dwordx4 v[140:143], v1, s[16:19], s62 offen offset:0
    buffer_load_dwordx4 v[144:147], v1, s[16:19], s62 offen offset:1024
    buffer_load_dwordx4 v[148:151], v1, s[16:19], s62 offen offset:2048
    buffer_load_dwordx4 v[152:155], v1, s[16:19], s62 offen offset:3072
    s_add_u32 s62, s62, 4096
    buffer_load_dwordx4 v[156:159], v1, s[16:19], s62 offen offset:0
    buffer_load_dwordx4 v[160:163], v1, s[16:19], s62 offen offset:1024
    buffer_load_dwordx4 v[164:167], v1, s[16:19], s62 offen offset:2048
    buffer_load_dwordx4 v[168:171], v1, s[16:19], s62 offen offset:3072
    s_add_u32 s62, s62, 4096
    s_mov_b32 s16, s38
    s_mov_b32 s17, s39
    s_mov_b32 s18, 3584
    s_mov_b32 s19, 0x20000
    s_lshl_b32 s59, s20, 6
    s_add_u32 s58, s58, s59
    v_lshlrev_b32 v50, 4, v49
    buffer_load_dwordx4 v[40:43], v50, s[16:19], s58 offen
    v_bfe_u32 v51, v0, 2, 2
    v_lshl_add_u32 v51, v49, 3, v51
    v_and_b32 v52, 3, v0
    v_lshlrev_b32 v53, 8, v51
    v_lshl_add_u32 v53, v52, 4, v53
    v_add_u32 v53, s59, v53
    v_add_u32 v54, 0xe000, v53
    v_add_u32 v55, s63, v1
    s_waitcnt vmcnt(29)
    s_barrier
    ds_read_b64_tr_b16 a[0:1], v53 offset:0
    ds_read_b64_tr_b16 a[2:3], v53 offset:1024
    ds_read_b64_tr_b16 a[56:57], v53 offset:8
    ds_read_b64_tr_b16 a[58:59], v53 offset:1032
    ds_read_b64_tr_b16 a[4:5], v53 offset:8192
    ds_read_b64_tr_b16 a[6:7], v53 offset:9216
    ds_read_b64_tr_b16 a[60:61], v53 offset:8200
    ds_read_b64_tr_b16 a[62:63], v53 offset:9224
    ds_read_b64_tr_b16 a[8:9], v53 offset:16384
    ds_read_b64_tr_b16 a[10:11], v53 offset:17408
    ds_read_b64_tr_b16 a[64:65], v53 offset:16392
    ds_read_b64_tr_b16 a[66:67], v53 offset:17416
    ds_read_b64_tr_b16 a[12:13], v53 offset:24576
    ds_read_b64_tr_b16 a[14:15], v53 offset:25600
    ds_read_b64_tr_b16 a[68:69], v53 offset:24584
    ds_read_b64_tr_b16 a[70:71], v53 offset:25608
    ds_read_b64_tr_b16 a[16:17], v53 offset:32768
    ds_read_b64_tr_b16 a[18:19], v53 offset:33792
    ds_read_b64_tr_b16 a[72:73], v53 offset:32776
    ds_read_b64_tr_b16 a[74:75], v53 offset:33800
    ds_read_b64_tr_b16 a[20:21], v53 offset:40960
    ds_read_b64_tr_b16 a[22:23], v53 offset:41984
    ds_read_b64_tr_b16 a[76:77], v53 offset:40968
    ds_read_b64_tr_b16 a[78:79], v53 offset:41992
    ds_read_b64_tr_b16 a[24:25], v53 offset:49152
    ds_read_b64_tr_b16 a[26:27], v53 offset:50176
    ds_read_b64_tr_b16 a[80:81], v53 offset:49160
    ds_read_b64_tr_b16 a[82:83], v53 offset:50184
    ds_read_b64_tr_b16 a[28:29], v54 offset:0
    ds_read_b64_tr_b16 a[30:31], v54 offset:1024
    ds_read_b64_tr_b16 a[84:85], v54 offset:8
    ds_read_b64_tr_b16 a[86:87], v54 offset:1032
    ds_read_b64_tr_b16 a[32:33], v54 offset:8192
    ds_read_b64_tr_b16 a[34:35], v54 offset:9216
    ds_read_b64_tr_b16 a[88:89], v54 offset:8200
    ds_read_b64_tr_b16 a[90:91], v54 offset:9224
    ds_read_b64_tr_b16 a[36:37], v54 offset:16384
    ds_read_b64_tr_b16 a[38:39], v54 offset:17408
    ds_read_b64_tr_b16 a[92:93], v54 offset:16392
    ds_read_b64_tr_b16 a[94:95], v54 offset:17416
    ds_read_b64_tr_b16 a[40:41], v54 offset:24576
    ds_read_b64_tr_b16 a[42:43], v54 offset:25600
    ds_read_b64_tr_b16 a[96:97], v54 offset:24584
    ds_read_b64_tr_b16 a[98:99], v54 offset:25608
    ds_read_b64_tr_b16 a[44:45], v54 offset:32768
    ds_read_b64_tr_b16 a[46:47], v54 offset:33792
    ds_read_b64_tr_b16 a[100:101], v54 offset:32776
    ds_read_b64_tr_b16 a[102:103], v54 offset:33800
    ds_read_b64_tr_b16 a[48:49], v54 offset:40960
    ds_read_b64_tr_b16 a[50:51], v54 offset:41984
    ds_read_b64_tr_b16 a[104:105], v54 offset:40968
    ds_read_b64_tr_b16 a[106:107], v54 offset:41992
    ds_read_b64_tr_b16 a[52:53], v54 offset:49152
    ds_read_b64_tr_b16 a[54:55], v54 offset:50176
    ds_read_b64_tr_b16 a[108:109], v54 offset:49160
    ds_read_b64_tr_b16 a[110:111], v54 offset:50184
    s_waitcnt lgkmcnt(0)
    s_barrier
    s_waitcnt vmcnt(28)
    ds_write_b128 v55, v[60:63] offset:0
    s_waitcnt vmcnt(27)
    ds_write_b128 v55, v[64:67] offset:1024
    s_waitcnt vmcnt(26)
    ds_write_b128 v55, v[68:71] offset:2048
    s_waitcnt vmcnt(25)
    ds_write_b128 v55, v[72:75] offset:3072
    s_waitcnt vmcnt(24)
    ds_write_b128 v55, v[76:79] offset:4096
    s_waitcnt vmcnt(23)
    ds_write_b128 v55, v[80:83] offset:5120
    s_waitcnt vmcnt(22)
    ds_write_b128 v55, v[84:87] offset:6144
    s_waitcnt vmcnt(21)
    ds_write_b128 v55, v[88:91] offset:7168
    s_waitcnt vmcnt(20)
    ds_write_b128 v55, v[92:95] offset:8192
    s_waitcnt vmcnt(19)
    ds_write_b128 v55, v[96:99] offset:9216
    s_waitcnt vmcnt(18)
    ds_write_b128 v55, v[100:103] offset:10240
    s_waitcnt vmcnt(17)
    ds_write_b128 v55, v[104:107] offset:11264
    s_waitcnt vmcnt(16)
    ds_write_b128 v55, v[108:111] offset:12288
    s_waitcnt vmcnt(15)
    ds_write_b128 v55, v[112:115] offset:13312
    s_waitcnt vmcnt(14)
    ds_write_b128 v55, v[116:119] offset:14336
    s_waitcnt vmcnt(13)
    ds_write_b128 v55, v[120:123] offset:15360
    s_waitcnt vmcnt(12)
    ds_write_b128 v55, v[124:127] offset:16384
    s_waitcnt vmcnt(11)
    ds_write_b128 v55, v[128:131] offset:17408
    s_waitcnt vmcnt(10)
    ds_write_b128 v55, v[132:135] offset:18432
    s_waitcnt vmcnt(9)
    ds_write_b128 v55, v[136:139] offset:19456
    s_waitcnt vmcnt(8)
    ds_write_b128 v55, v[140:143] offset:20480
    s_waitcnt vmcnt(7)
    ds_write_b128 v55, v[144:147] offset:21504
    s_waitcnt vmcnt(6)
    ds_write_b128 v55, v[148:151] offset:22528
    s_waitcnt vmcnt(5)
    ds_write_b128 v55, v[152:155] offset:23552
    s_waitcnt vmcnt(4)
    ds_write_b128 v55, v[156:159] offset:24576
    s_waitcnt vmcnt(3)
    ds_write_b128 v55, v[160:163] offset:25600
    s_waitcnt vmcnt(2)
    ds_write_b128 v55, v[164:167] offset:26624
    s_waitcnt vmcnt(1)
    ds_write_b128 v55, v[168:171] offset:27648
    s_waitcnt vmcnt(0)
    v_lshlrev_b32 v16, 16, v40
    v_and_b32 v17, 0xffff0000, v40
    v_lshlrev_b32 v18, 16, v41
    v_and_b32 v19, 0xffff0000, v41
    v_lshlrev_b32 v20, 16, v42
    v_and_b32 v21, 0xffff0000, v42
    v_lshlrev_b32 v22, 16, v43
    v_and_b32 v23, 0xffff0000, v43
    v_mov_b32 v40, v13
    v_mov_b32 v41, v13
    v_mov_b32 v42, v13
    v_mov_b32 v43, v13
    s_nop 1
    v_mfma_f32_16x16x32_bf16 v[24:27], a[0:3], v[40:43], 0
    v_mfma_f32_16x16x32_bf16 v[28:31], a[56:59], v[40:43], 0
    v_mfma_f32_16x16x32_bf16 v[24:27], a[4:7], v[40:43], v[24:27]
    v_mfma_f32_16x16x32_bf16 v[28:31], a[60:63], v[40:43], v[28:31]
    v_mfma_f32_16x16x32_bf16 v[24:27], a[8:11], v[40:43], v[24:27]
    v_mfma_f32_16x16x32_bf16 v[28:31], a[64:67], v[40:43], v[28:31]
    v_mfma_f32_16x16x32_bf16 v[24:27], a[12:15], v[40:43], v[24:27]
    v_mfma_f32_16x16x32_bf16 v[28:31], a[68:71], v[40:43], v[28:31]
    v_mfma_f32_16x16x32_bf16 v[24:27], a[16:19], v[40:43], v[24:27]
    v_mfma_f32_16x16x32_bf16 v[28:31], a[72:75], v[40:43], v[28:31]
    v_mfma_f32_16x16x32_bf16 v[24:27], a[20:23], v[40:43], v[24:27]
    v_mfma_f32_16x16x32_bf16 v[28:31], a[76:79], v[40:43], v[28:31]
    v_mfma_f32_16x16x32_bf16 v[24:27], a[24:27], v[40:43], v[24:27]
    v_mfma_f32_16x16x32_bf16 v[28:31], a[80:83], v[40:43], v[28:31]
    v_mfma_f32_16x16x32_bf16 v[24:27], a[28:31], v[40:43], v[24:27]
    v_mfma_f32_16x16x32_bf16 v[28:31], a[84:87], v[40:43], v[28:31]
    v_mfma_f32_16x16x32_bf16 v[24:27], a[32:35], v[40:43], v[24:27]
    v_mfma_f32_16x16x32_bf16 v[28:31], a[88:91], v[40:43], v[28:31]
    v_mfma_f32_16x16x32_bf16 v[24:27], a[36:39], v[40:43], v[24:27]
    v_mfma_f32_16x16x32_bf16 v[28:31], a[92:95], v[40:43], v[28:31]
    v_mfma_f32_16x16x32_bf16 v[24:27], a[40:43], v[40:43], v[24:27]
    v_mfma_f32_16x16x32_bf16 v[28:31], a[96:99], v[40:43], v[28:31]
    v_mfma_f32_16x16x32_bf16 v[24:27], a[44:47], v[40:43], v[24:27]
    v_mfma_f32_16x16x32_bf16 v[28:31], a[100:103], v[40:43], v[28:31]
    v_mfma_f32_16x16x32_bf16 v[24:27], a[48:51], v[40:43], v[24:27]
    v_mfma_f32_16x16x32_bf16 v[28:31], a[104:107], v[40:43], v[28:31]
    v_mfma_f32_16x16x32_bf16 v[24:27], a[52:55], v[40:43], v[24:27]
    v_mfma_f32_16x16x32_bf16 v[28:31], a[108:111], v[40:43], v[28:31]
    v_mul_u32_u24 v53, 896, v51
    s_mul_i32 s58, s20, 224
    v_add_u32 v53, s58, v53
    v_lshl_add_u32 v53, v52, 3, v53
    v_add_u32 v54, 57344, v53
    s_waitcnt lgkmcnt(0)
    s_barrier
    ds_read_b64_tr_b16 a[112:113], v53 offset:0
    ds_read_b64_tr_b16 a[114:115], v53 offset:3584
    ds_read_b64_tr_b16 a[128:129], v53 offset:32
    ds_read_b64_tr_b16 a[130:131], v53 offset:3616
    ds_read_b64_tr_b16 a[144:145], v53 offset:64
    ds_read_b64_tr_b16 a[146:147], v53 offset:3648
    ds_read_b64_tr_b16 a[160:161], v53 offset:96
    ds_read_b64_tr_b16 a[162:163], v53 offset:3680
    ds_read_b64_tr_b16 a[176:177], v53 offset:128
    ds_read_b64_tr_b16 a[178:179], v53 offset:3712
    ds_read_b64_tr_b16 a[192:193], v53 offset:160
    ds_read_b64_tr_b16 a[194:195], v53 offset:3744
    ds_read_b64_tr_b16 a[208:209], v53 offset:192
    ds_read_b64_tr_b16 a[210:211], v53 offset:3776
    ds_read_b64_tr_b16 a[116:117], v53 offset:28672
    ds_read_b64_tr_b16 a[118:119], v53 offset:32256
    ds_read_b64_tr_b16 a[132:133], v53 offset:28704
    ds_read_b64_tr_b16 a[134:135], v53 offset:32288
    ds_read_b64_tr_b16 a[148:149], v53 offset:28736
    ds_read_b64_tr_b16 a[150:151], v53 offset:32320
    ds_read_b64_tr_b16 a[164:165], v53 offset:28768
    ds_read_b64_tr_b16 a[166:167], v53 offset:32352
    ds_read_b64_tr_b16 a[180:181], v53 offset:28800
    ds_read_b64_tr_b16 a[182:183], v53 offset:32384
    ds_read_b64_tr_b16 a[196:197], v53 offset:28832
    ds_read_b64_tr_b16 a[198:199], v53 offset:32416
    ds_read_b64_tr_b16 a[212:213], v53 offset:28864
    ds_read_b64_tr_b16 a[214:215], v53 offset:32448
    ds_read_b64_tr_b16 a[120:121], v54 offset:0
    ds_read_b64_tr_b16 a[122:123], v54 offset:3584
    ds_read_b64_tr_b16 a[136:137], v54 offset:32
    ds_read_b64_tr_b16 a[138:139], v54 offset:3616
    ds_read_b64_tr_b16 a[152:153], v54 offset:64
    ds_read_b64_tr_b16 a[154:155], v54 offset:3648
    ds_read_b64_tr_b16 a[168:169], v54 offset:96
    ds_read_b64_tr_b16 a[170:171], v54 offset:3680
    ds_read_b64_tr_b16 a[184:185], v54 offset:128
    ds_read_b64_tr_b16 a[186:187], v54 offset:3712
    ds_read_b64_tr_b16 a[200:201], v54 offset:160
    ds_read_b64_tr_b16 a[202:203], v54 offset:3744
    ds_read_b64_tr_b16 a[216:217], v54 offset:192
    ds_read_b64_tr_b16 a[218:219], v54 offset:3776
    ds_read_b64_tr_b16 a[124:125], v54 offset:28672
    ds_read_b64_tr_b16 a[126:127], v54 offset:32256
    ds_read_b64_tr_b16 a[140:141], v54 offset:28704
    ds_read_b64_tr_b16 a[142:143], v54 offset:32288
    ds_read_b64_tr_b16 a[156:157], v54 offset:28736
    ds_read_b64_tr_b16 a[158:159], v54 offset:32320
    ds_read_b64_tr_b16 a[172:173], v54 offset:28768
    ds_read_b64_tr_b16 a[174:175], v54 offset:32352
    ds_read_b64_tr_b16 a[188:189], v54 offset:28800
    ds_read_b64_tr_b16 a[190:191], v54 offset:32384
    ds_read_b64_tr_b16 a[204:205], v54 offset:28832
    ds_read_b64_tr_b16 a[206:207], v54 offset:32416
    ds_read_b64_tr_b16 a[220:221], v54 offset:28864
    ds_read_b64_tr_b16 a[222:223], v54 offset:32448
    s_waitcnt lgkmcnt(0)
    s_barrier
    s_mov_b32 s60, 0x3b124925
    s_mov_b32 s61, 0x3727c5ac
    s_mov_b32 s62, 0xbdd2d3e8
    s_mov_b32 s63, 0xc0135761
LM_go:
    v_mov_b32 v220, 0
    v_mov_b32 v221, 0
    v_mov_b32 v222, 0
    v_mov_b32 v223, 0
    s_add_u32 s58, s31, s48
    buffer_store_dwordx4 v[220:223], v1, s[8:11], s58 offen
    s_add_u32 s58, s58, 32768
    buffer_store_dwordx4 v[220:223], v1, s[8:11], s58 offen
    s_add_u32 s58, s58, 32768
    buffer_store_dwordx4 v[220:223], v1, s[8:11], s58 offen
    s_add_u32 s58, s58, 32768
    buffer_store_dwordx4 v[220:223], v1, s[8:11], s58 offen
    s_add_u32 s58, s58, 32768
    buffer_store_dwordx4 v[220:223], v1, s[8:11], s58 offen
    s_add_u32 s58, s58, 32768
    buffer_store_dwordx4 v[220:223], v1, s[8:11], s58 offen
    s_add_u32 s58, s58, 32768
    buffer_store_dwordx4 v[220:223], v1, s[8:11], s58 offen
    s_add_u32 s58, s58, 262144
    buffer_store_dwordx4 v[220:223], v1, s[8:11], s58 offen
    s_add_u32 s58, s58, 32768
    buffer_store_dwordx4 v[220:223], v1, s[8:11], s58 offen
    s_add_u32 s58, s58, 32768
    buffer_store_dwordx4 v[220:223], v1, s[8:11], s58 offen
    s_add_u32 s58, s58, 32768
    buffer_store_dwordx4 v[220:223], v1, s[8:11], s58 offen
    s_add_u32 s58, s58, 32768
    buffer_store_dwordx4 v[220:223], v1, s[8:11], s58 offen
    s_add_u32 s58, s58, 32768
    buffer_store_dwordx4 v[220:223], v1, s[8:11], s58 offen
    s_add_u32 s58, s58, 32768
    buffer_store_dwordx4 v[220:223], v1, s[8:11], s58 offen
    s_add_u32 s58, s58, 32768
    v_mov_b32 v56, 132
    global_load_dword v56, v56, s[46:47] sc1
    s_lshl_b32 s58, s22, 2
    s_add_u32 s58, s58, s20
    s_lshl_b32 s58, s58, 2
    s_add_u32 s58, s58, s3
    s_waitcnt vmcnt(0)
    v_cmp_eq_u32 vcc, 0, v56
    s_cbranch_vccnz Lvwait_114
Lvok_113:
    v_mov_b32 v56, 0
    s_mov_b64 exec, 1
    buffer_store_dword v56, off, s[8:11], s58
    s_mov_b64 exec, -1
    s_mov_b32 s59, 34491904
    v_lshrrev_b32 v56, 1, v1
    buffer_load_dwordx2 v[56:57], v56, s[8:11], s59 offen sc1
    s_waitcnt vmcnt(0)
    v_max_u32 v58, v56, v57
    v_cmp_eq_u32 vcc, -1, v58
    s_cbranch_vccnz Lvwait_116
Lvok_115:
    v_lshrrev_b32 v56, 1, v1
    buffer_load_dwordx2 v[56:57], v56, s[8:11], s3 offen sc1
    s_waitcnt vmcnt(0)
    v_max_u32 v58, v56, v57
    v_cmp_eq_u32 vcc, -1, v58
    s_cbranch_vccnz Lvwait_118
Lvok_117:
    v_mov_b32 v10, 1
    s_mov_b64 exec, 1
    buffer_store_dword v10, off, s[8:11], s34
    s_mov_b64 exec, -1
    s_mov_b32 s70, 0
    s_cmp_lt_u32 s26, 14
    s_cbranch_scc1 LM_xgap
LM_job:
    s_cmp_lt_u32 s26, 14
    s_cbranch_scc1 LM_gemm
    s_mul_i32 s58, s28, 28672
    s_add_u32 s49, s58, s65
    s_add_u32 s50, s49, 7880704
    s_and_b32 s58, s29, 1
    s_mul_i32 s33, s58, 458752
    s_add_u32 s33, s33, s31
    s_lshl_b32 s58, s26, 15
    s_add_u32 s98, s33, s58
    s_add_u32 s99, s98, 16384
    s_add_u32 s27, s29, 128
    s_lshl_b32 s27, s27, 16
    s_add_u32 s51, s33, s48
    s_add_u32 s52, s51, 32768
    s_add_u32 s53, s51, 65536
    s_add_u32 s54, s51, 98304
    s_add_u32 s55, s51, 131072
    s_add_u32 s56, s51, 163840
    s_add_u32 s57, s51, 196608
    s_mov_b32 s70, 0
Lpoll_119:
    s_sleep 4
    buffer_load_dwordx4 v[168:171], v9, s[8:11], s32 offen sc1
    s_add_u32 s70, s70, 1
    s_cmp_gt_u32 s70, 131072
    s_cbranch_scc1 Lfail
    s_waitcnt vmcnt(0)
    v_max3_u32 v10, v168, v169, v170
    v_max_u32 v10, v10, v171
    v_cmp_eq_u32 vcc, -1, v10
    s_cbranch_vccnz Lpoll_119
    s_add_u32 s58, s29, 1
    v_mov_b32 v10, s58
    s_mov_b64 exec, 1
    buffer_store_dword v10, off, s[8:11], s34
    s_mov_b64 exec, -1
    s_barrier
    s_branch LM_red
LM_xgap0:
    s_waitcnt lgkmcnt(0)
    s_branch LM_xgap
LM_xchk:
    v_max3_u32 v10, v228, v229, v230
    v_max3_u32 v10, v10, v231, v232
    v_max3_u32 v10, v10, v233, v234
    v_max3_u32 v10, v10, v235, v236
    v_max3_u32 v10, v10, v237, v238
    v_max3_u32 v10, v10, v239, v240
    v_max3_u32 v10, v10, v241, v242
    v_max3_u32 v10, v10, v243, v244
    v_max3_u32 v10, v10, v245, v246
    v_max3_u32 v10, v10, v247, v248
    v_max3_u32 v10, v10, v249, v250
    v_max3_u32 v10, v10, v251, v252
    v_max3_u32 v10, v10, v253, v254
    v_max_u32 v10, v10, v255
    v_cmp_eq_u32 vcc, -1, v10
    s_cbranch_vccz LM_xok
LM_xgap:
    s_lshl_b32 s67, s66, 12
    s_add_u32 s67, s67, s32
    s_add_u32 s91, s32, 0
    s_add_u32 s92, s32, 4096
    s_add_u32 s93, s32, 8192
    s_add_u32 s94, s32, 12288
    s_add_u32 s95, s32, 16384
    s_add_u32 s96, s32, 20480
    s_add_u32 s97, s32, 24576
LM_xlight:
    buffer_load_dwordx4 v[228:231], v2, s[8:11], s67 offen sc1
    s_add_u32 s70, s70, 1
    s_cmp_gt_u32 s70, 131072
    s_cbranch_scc1 Lfail
    s_waitcnt vmcnt(0)
    v_max3_u32 v10, v228, v229, v230
    v_max_u32 v10, v10, v231
    v_cmp_eq_u32 vcc, -1, v10
    s_cbranch_vccnz LM_xlight
    buffer_load_dwordx4 v[228:231], v2, s[8:11], s91 offen sc1
    buffer_load_dwordx4 v[232:235], v2, s[8:11], s92 offen sc1
    buffer_load_dwordx4 v[236:239], v2, s[8:11], s93 offen sc1
    buffer_load_dwordx4 v[240:243], v2, s[8:11], s94 offen sc1
    buffer_load_dwordx4 v[244:247], v2, s[8:11], s95 offen sc1
    buffer_load_dwordx4 v[248:251], v2, s[8:11], s96 offen sc1
    buffer_load_dwordx4 v[252:255], v2, s[8:11], s97 offen sc1
    s_waitcnt vmcnt(6)
    ds_write_b128 v2, v[228:231] offset:0
    v_dot2_f32_bf16 v40, v228, v13, 0
    v_dot2_f32_bf16 v41, v228, v228, 0
    v_dot2_f32_bf16 v40, v229, v13, v40
    v_dot2_f32_bf16 v41, v229, v229, v41
    v_dot2_f32_bf16 v40, v230, v13, v40
    v_dot2_f32_bf16 v41, v230, v230, v41
    v_dot2_f32_bf16 v40, v231, v13, v40
    v_dot2_f32_bf16 v41, v231, v231, v41
    s_waitcnt vmcnt(5)
    ds_write_b128 v2, v[232:235] offset:4096
    v_dot2_f32_bf16 v40, v232, v13, v40
    v_dot2_f32_bf16 v41, v232, v232, v41
    v_dot2_f32_bf16 v40, v233, v13, v40
    v_dot2_f32_bf16 v41, v233, v233, v41
    v_dot2_f32_bf16 v40, v234, v13, v40
    v_dot2_f32_bf16 v41, v234, v234, v41
    v_dot2_f32_bf16 v40, v235, v13, v40
    v_dot2_f32_bf16 v41, v235, v235, v41
    s_waitcnt vmcnt(4)
    ds_write_b128 v2, v[236:239] offset:8192
    v_dot2_f32_bf16 v40, v236, v13, v40
    v_dot2_f32_bf16 v41, v236, v236, v41
    v_dot2_f32_bf16 v40, v237, v13, v40
    v_dot2_f32_bf16 v41, v237, v237, v41
    v_dot2_f32_bf16 v40, v238, v13, v40
    v_dot2_f32_bf16 v41, v238, v238, v41
    v_dot2_f32_bf16 v40, v239, v13, v40
    v_dot2_f32_bf16 v41, v239, v239, v41
    s_waitcnt vmcnt(3)
    ds_write_b128 v2, v[240:243] offset:12288
    v_dot2_f32_bf16 v40, v240, v13, v40
    v_dot2_f32_bf16 v41, v240, v240, v41
    v_dot2_f32_bf16 v40, v241, v13, v40
    v_dot2_f32_bf16 v41, v241, v241, v41
    v_dot2_f32_bf16 v40, v242, v13, v40
    v_dot2_f32_bf16 v41, v242, v242, v41
    v_dot2_f32_bf16 v40, v243, v13, v40
    v_dot2_f32_bf16 v41, v243, v243, v41
    s_waitcnt vmcnt(2)
    ds_write_b128 v2, v[244:247] offset:16384
    v_dot2_f32_bf16 v40, v244, v13, v40
    v_dot2_f32_bf16 v41, v244, v244, v41
    v_dot2_f32_bf16 v40, v245, v13, v40
    v_dot2_f32_bf16 v41, v245, v245, v41
    v_dot2_f32_bf16 v40, v246, v13, v40
    v_dot2_f32_bf16 v41, v246, v246, v41
    v_dot2_f32_bf16 v40, v247, v13, v40
    v_dot2_f32_bf16 v41, v247, v247, v41
    s_waitcnt vmcnt(1)
    ds_write_b128 v2, v[248:251] offset:20480
    v_dot2_f32_bf16 v40, v248, v13, v40
    v_dot2_f32_bf16 v41, v248, v248, v41
    v_dot2_f32_bf16 v40, v249, v13, v40
    v_dot2_f32_bf16 v41, v249, v249, v41
    v_dot2_f32_bf16 v40, v250, v13, v40
    v_dot2_f32_bf16 v41, v250, v250, v41
    v_dot2_f32_bf16 v40, v251, v13, v40
    v_dot2_f32_bf16 v41, v251, v251, v41
    s_waitcnt vmcnt(0)
    ds_write_b128 v2, v[252:255] offset:24576
    v_dot2_f32_bf16 v40, v252, v13, v40
    v_dot2_f32_bf16 v41, v252, v252, v41
    v_dot2_f32_bf16 v40, v253, v13, v40
    v_dot2_f32_bf16 v41, v253, v253, v41
    v_dot2_f32_bf16 v40, v254, v13, v40
    v_dot2_f32_bf16 v41, v254, v254, v41
    v_dot2_f32_bf16 v40, v255, v13, v40
    v_dot2_f32_bf16 v41, v255, v255, v41
    s_nop 2
    v_cmp_u_f32 vcc, v40, v41
    s_cbranch_vccnz LM_xchk
    s_branch LM_xok
LM_gemm:
    s_mov_b32 s70, 0
    s_waitcnt vmcnt(1)
    s_barrier
    ds_read_b128 v[228:231], v2 offset:0
    ds_read_b128 v[232:235], v2 offset:4096
    ds_read_b128 v[236:239], v2 offset:8192
    ds_read_b128 v[240:243], v2 offset:12288
    ds_read_b128 v[244:247], v2 offset:16384
    ds_read_b128 v[248:251], v2 offset:20480
    ds_read_b128 v[252:255], v2 offset:24576
    s_waitcnt lgkmcnt(6)
    v_cmp_eq_u32 vcc, -1, v228
    s_cbranch_vccnz LM_xgap0
    v_dot2_f32_bf16 v40, v228, v13, 0
    v_dot2_f32_bf16 v41, v228, v228, 0
    v_dot2_f32_bf16 v40, v229, v13, v40
    v_dot2_f32_bf16 v41, v229, v229, v41
    v_dot2_f32_bf16 v40, v230, v13, v40
    v_dot2_f32_bf16 v41, v230, v230, v41
    v_dot2_f32_bf16 v40, v231, v13, v40
    v_dot2_f32_bf16 v41, v231, v231, v41
    s_waitcnt lgkmcnt(5)
    v_dot2_f32_bf16 v40, v232, v13, v40
    v_dot2_f32_bf16 v41, v232, v232, v41
    v_dot2_f32_bf16 v40, v233, v13, v40
    v_dot2_f32_bf16 v41, v233, v233, v41
    v_dot2_f32_bf16 v40, v234, v13, v40
    v_dot2_f32_bf16 v41, v234, v234, v41
    v_dot2_f32_bf16 v40, v235, v13, v40
    v_dot2_f32_bf16 v41, v235, v235, v41
    s_waitcnt lgkmcnt(4)
    v_dot2_f32_bf16 v40, v236, v13, v40
    v_dot2_f32_bf16 v41, v236, v236, v41
    v_dot2_f32_bf16 v40, v237, v13, v40
    v_dot2_f32_bf16 v41, v237, v237, v41
    v_dot2_f32_bf16 v40, v238, v13, v40
    v_dot2_f32_bf16 v41, v238, v238, v41
    v_dot2_f32_bf16 v40, v239, v13, v40
    v_dot2_f32_bf16 v41, v239, v239, v41
    s_waitcnt lgkmcnt(3)
    v_dot2_f32_bf16 v40, v240, v13, v40
    v_dot2_f32_bf16 v41, v240, v240, v41
    v_dot2_f32_bf16 v40, v241, v13, v40
    v_dot2_f32_bf16 v41, v241, v241, v41
    v_dot2_f32_bf16 v40, v242, v13, v40
    v_dot2_f32_bf16 v41, v242, v242, v41
    v_dot2_f32_bf16 v40, v243, v13, v40
    v_dot2_f32_bf16 v41, v243, v243, v41
    s_waitcnt lgkmcnt(2)
    v_dot2_f32_bf16 v40, v244, v13, v40
    v_dot2_f32_bf16 v41, v244, v244, v41
    v_dot2_f32_bf16 v40, v245, v13, v40
    v_dot2_f32_bf16 v41, v245, v245, v41
    v_dot2_f32_bf16 v40, v246, v13, v40
    v_dot2_f32_bf16 v41, v246, v246, v41
    v_dot2_f32_bf16 v40, v247, v13, v40
    v_dot2_f32_bf16 v41, v247, v247, v41
    s_waitcnt lgkmcnt(1)
    v_dot2_f32_bf16 v40, v248, v13, v40
    v_dot2_f32_bf16 v41, v248, v248, v41
    v_dot2_f32_bf16 v40, v249, v13, v40
    v_dot2_f32_bf16 v41, v249, v249, v41
    v_dot2_f32_bf16 v40, v250, v13, v40
    v_dot2_f32_bf16 v41, v250, v250, v41
    v_dot2_f32_bf16 v40, v251, v13, v40
    v_dot2_f32_bf16 v41, v251, v251, v41
    s_waitcnt lgkmcnt(0)
    v_dot2_f32_bf16 v40, v252, v13, v40
    v_dot2_f32_bf16 v41, v252, v252, v41
    v_dot2_f32_bf16 v40, v253, v13, v40
    v_dot2_f32_bf16 v41, v253, v253, v41
    v_dot2_f32_bf16 v40, v254, v13, v40
    v_dot2_f32_bf16 v41, v254, v254, v41
    v_dot2_f32_bf16 v40, v255, v13, v40
    v_dot2_f32_bf16 v41, v255, v255, v41
    s_nop 2
    v_cmp_u_f32 vcc, v40, v41
    s_cbranch_vccnz LM_xchk
LM_xok:
    s_nop 1
    v_permlane16_swap_b32 v40, v41
    v_add_f32 v40, v40, v41
    ds_write_b32 v5, v40 offset:36864
    s_waitcnt lgkmcnt(0)
    s_barrier
    ds_read_b128 v[144:147], v3 offset:0
    ds_read_b128 v[148:151], v3 offset:2048
    ds_read_b128 v[64:67], v6 offset:36864
    ds_read_b128 v[68:71], v6 offset:37120
    ds_read_b128 v[152:155], v3 offset:4096
    ds_read_b128 v[156:159], v3 offset:6144
    buffer_load_dwordx4 v[168:171], v9, s[8:11], s32 offen sc1
    s_waitcnt lgkmcnt(5)
    v_mfma_f32_16x16x32_bf16 v[48:51], a[0:3], v[144:147], 0
    ds_read_b128 v[160:163], v3 offset:8192
    s_mul_i32 s58, s28, 28672
    s_add_u32 s49, s58, s65
    v_mfma_f32_16x16x32_bf16 v[52:55], a[56:59], v[144:147], 0
    s_add_u32 s50, s49, 7880704
    s_and_b32 s58, s29, 1
    s_waitcnt lgkmcnt(5)
    v_mfma_f32_16x16x32_bf16 v[48:51], a[4:7], v[148:151], v[48:51]
    ds_read_b128 v[144:147], v3 offset:10240
    s_mul_i32 s33, s58, 458752
    s_add_u32 s33, s33, s31
    v_mfma_f32_16x16x32_bf16 v[52:55], a[60:63], v[148:151], v[52:55]
    s_lshl_b32 s58, s26, 15
    s_add_u32 s98, s33, s58
    s_waitcnt lgkmcnt(3)
    v_mfma_f32_16x16x32_bf16 v[48:51], a[8:11], v[152:155], v[48:51]
    ds_read_b128 v[148:151], v3 offset:12288
    v_add_f32 v64, v64, v65
    v_add_f32 v68, v68, v69
    v_mfma_f32_16x16x32_bf16 v[52:55], a[64:67], v[152:155], v[52:55]
    s_waitcnt lgkmcnt(3)
    v_add_f32 v66, v66, v67
    v_add_f32 v70, v70, v71
    v_mfma_f32_16x16x32_bf16 v[48:51], a[12:15], v[156:159], v[48:51]
    ds_read_b128 v[152:155], v3 offset:14336
    v_add_f32 v64, v64, v66
    v_add_f32 v68, v68, v70
    v_mfma_f32_16x16x32_bf16 v[52:55], a[68:71], v[156:159], v[52:55]
    s_waitcnt lgkmcnt(3)
    v_mul_f32 v64, s60, v64
    v_mul_f32 v68, s60, v68
    v_mfma_f32_16x16x32_bf16 v[48:51], a[16:19], v[160:163], v[48:51]
    ds_read_b128 v[156:159], v3 offset:16384
    v_fma_f32 v68, -v64, v64, v68
    v_max_f32 v68, 0, v68
    v_mfma_f32_16x16x32_bf16 v[52:55], a[72:75], v[160:163], v[52:55]
    s_waitcnt lgkmcnt(3)
    v_add_f32 v44, s61, v68
    v_rsq_f32 v44, v44
    v_mfma_f32_16x16x32_bf16 v[48:51], a[20:23], v[144:147], v[48:51]
    ds_read_b128 v[160:163], v3 offset:18432
    v_mul_f32 v68, v68, v44
    v_fma_f32 v68, v68, v44, s61
    v_mfma_f32_16x16x32_bf16 v[52:55], a[76:79], v[144:147], v[52:55]
    s_waitcnt lgkmcnt(3)
    v_rsq_f32 v68, v68
    v_mov_b32 v42, s63
    v_mfma_f32_16x16x32_bf16 v[48:51], a[24:27], v[148:151], v[48:51]
    ds_read_b128 v[144:147], v3 offset:20480
    v_mov_b32 v43, s62
    v_mul_f32 v44, v44, v68
    v_mfma_f32_16x16x32_bf16 v[52:55], a[80:83], v[148:151], v[52:55]
    s_waitcnt lgkmcnt(3)
    v_mul_f32 v45, -v64, v44
    v_mov_b32 v46, v44
    v_mfma_f32_16x16x32_bf16 v[48:51], a[28:31], v[152:155], v[48:51]
    ds_read_b128 v[148:151], v3 offset:22528
    v_mov_b32 v47, v45
    buffer_load_dword v172, v8, s[8:11], s35 offen sc1
    v_mfma_f32_16x16x32_bf16 v[52:55], a[84:87], v[152:155], v[52:55]
    s_waitcnt lgkmcnt(3)
    v_permlane32_swap_b32 v44, v46
    v_permlane32_swap_b32 v45, v47
    v_mfma_f32_16x16x32_bf16 v[48:51], a[32:35], v[156:159], v[48:51]
    ds_read_b128 v[152:155], v3 offset:24576
    v_fma_f32 v80, v45, v24, v16
    v_fma_f32 v81, v45, v25, v17
    v_mfma_f32_16x16x32_bf16 v[52:55], a[88:91], v[156:159], v[52:55]
    s_waitcnt lgkmcnt(3)
    v_fma_f32 v82, v45, v26, v18
    v_fma_f32 v83, v45, v27, v19
    v_mfma_f32_16x16x32_bf16 v[48:51], a[36:39], v[160:163], v[48:51]
    ds_read_b128 v[156:159], v3 offset:26624
    v_fma_f32 v84, v45, v28, v20
    v_fma_f32 v85, v45, v29, v21
    v_mfma_f32_16x16x32_bf16 v[52:55], a[92:95], v[160:163], v[52:55]
    s_waitcnt lgkmcnt(3)
    v_fma_f32 v86, v45, v30, v22
    v_fma_f32 v87, v45, v31, v23
    v_mfma_f32_16x16x32_bf16 v[48:51], a[40:43], v[144:147], v[48:51]
    ds_read_b128 v[160:163], v3 offset:512
    v_fma_f32 v88, v47, v24, v16
    v_fma_f32 v89, v47, v25, v17
    v_mfma_f32_16x16x32_bf16 v[52:55], a[96:99], v[144:147], v[52:55]
    s_waitcnt lgkmcnt(3)
    v_fma_f32 v90, v47, v26, v18
    v_fma_f32 v91, v47, v27, v19
    v_mfma_f32_16x16x32_bf16 v[48:51], a[44:47], v[148:151], v[48:51]
    ds_read_b128 v[144:147], v3 offset:2560
    v_fma_f32 v92, v47, v28, v20
    v_fma_f32 v93, v47, v29, v21
    v_mfma_f32_16x16x32_bf16 v[52:55], a[100:103], v[148:151], v[52:55]
    s_waitcnt lgkmcnt(3)
    v_fma_f32 v94, v47, v30, v22
    v_fma_f32 v95, v47, v31, v23
    v_mfma_f32_16x16x32_bf16 v[48:51], a[48:51], v[152:155], v[48:51]
    ds_read_b128 v[148:151], v3 offset:4608
    v_mfma_f32_16x16x32_bf16 v[52:55], a[104:107], v[152:155], v[52:55]
    s_waitcnt lgkmcnt(3)
    v_mfma_f32_16x16x32_bf16 v[48:51], a[52:55], v[156:159], v[48:51]
    ds_read_b128 v[152:155], v3 offset:6656
    v_mfma_f32_16x16x32_bf16 v[52:55], a[108:111], v[156:159], v[52:55]
    s_waitcnt lgkmcnt(3)
    v_mfma_f32_16x16x32_bf16 v[56:59], a[0:3], v[160:163], 0
    ds_read_b128 v[156:159], v3 offset:8704
    s_add_u32 s99, s98, 16384
    s_add_u32 s27, s29, 128
    s_lshl_b32 s27, s27, 16
    s_add_u32 s51, s33, s48
    s_add_u32 s52, s51, 32768
    v_mfma_f32_16x16x32_bf16 v[60:63], a[56:59], v[160:163], 0
    s_add_u32 s53, s51, 65536
    s_add_u32 s54, s51, 98304
    s_add_u32 s55, s51, 131072
    s_add_u32 s56, s51, 163840
    s_add_u32 s57, s51, 196608
    s_waitcnt lgkmcnt(3)
    v_mfma_f32_16x16x32_bf16 v[56:59], a[4:7], v[144:147], v[56:59]
    ds_read_b128 v[160:163], v3 offset:10752
    v_fma_f32 v48, v48, v44, v80
    v_fma_f32 v49, v49, v44, v81
    v_mfma_f32_16x16x32_bf16 v[60:63], a[60:63], v[144:147], v[60:63]
    s_waitcnt lgkmcnt(3)
    v_fma_f32 v50, v50, v44, v82
    v_fma_f32 v51, v51, v44, v83
    v_fma_f32 v52, v52, v44, v84
    v_mfma_f32_16x16x32_bf16 v[56:59], a[8:11], v[148:151], v[56:59]
    ds_read_b128 v[144:147], v3 offset:12800
    v_fma_f32 v53, v53, v44, v85
    v_fma_f32 v54, v54, v44, v86
    v_mfma_f32_16x16x32_bf16 v[60:63], a[64:67], v[148:151], v[60:63]
    s_waitcnt lgkmcnt(3)
    v_fma_f32 v55, v55, v44, v87
    v_mul_f32 v80, v48, v48
    v_mul_f32 v81, v49, v49
    v_mfma_f32_16x16x32_bf16 v[56:59], a[12:15], v[152:155], v[56:59]
    ds_read_b128 v[148:151], v3 offset:14848
    v_mul_f32 v82, v50, v50
    v_mul_f32 v83, v51, v51
    v_mul_f32 v84, v52, v52
    v_mfma_f32_16x16x32_bf16 v[60:63], a[68:71], v[152:155], v[60:63]
    s_waitcnt lgkmcnt(3)
    v_mul_f32 v85, v53, v53
    v_mul_f32 v86, v54, v54
    v_mfma_f32_16x16x32_bf16 v[56:59], a[16:19], v[156:159], v[56:59]
    ds_read_b128 v[152:155], v3 offset:16896
    v_mul_f32 v87, v55, v55
    v_fma_f32 v80, v80, s62, v42
    v_fma_f32 v81, v81, s62, v42
    v_mfma_f32_16x16x32_bf16 v[60:63], a[72:75], v[156:159], v[60:63]
    s_waitcnt lgkmcnt(3)
    v_fma_f32 v82, v82, s62, v42
    v_fma_f32 v83, v83, s62, v42
    v_mfma_f32_16x16x32_bf16 v[56:59], a[20:23], v[160:163], v[56:59]
    ds_read_b128 v[156:159], v3 offset:18944
    v_fma_f32 v84, v84, s62, v42
    v_fma_f32 v85, v85, s62, v42
    v_fma_f32 v86, v86, s62, v42
    v_mfma_f32_16x16x32_bf16 v[60:63], a[76:79], v[160:163], v[60:63]
    s_waitcnt lgkmcnt(3)
    v_fma_f32 v87, v87, s62, v42
    v_mul_f32 v80, v80, v48
    v_mul_f32 v81, v81, v49
    v_mfma_f32_16x16x32_bf16 v[56:59], a[24:27], v[144:147], v[56:59]
    ds_read_b128 v[160:163], v3 offset:20992
    v_mul_f32 v82, v82, v50
    v_mul_f32 v83, v83, v51
    v_mfma_f32_16x16x32_bf16 v[60:63], a[80:83], v[144:147], v[60:63]
    s_waitcnt lgkmcnt(3)
    v_mul_f32 v84, v84, v52
    v_mul_f32 v85, v85, v53
    v_mul_f32 v86, v86, v54
    v_mfma_f32_16x16x32_bf16 v[56:59], a[28:31], v[148:151], v[56:59]
    ds_read_b128 v[144:147], v3 offset:23040
    v_mul_f32 v87, v87, v55
    v_exp_f32 v80, v80
    v_mfma_f32_16x16x32_bf16 v[60:63], a[84:87], v[148:151], v[60:63]
    s_waitcnt lgkmcnt(3)
    v_exp_f32 v81, v81
    v_add_f32 v80, 1.0, v80
    v_exp_f32 v82, v82
    v_mfma_f32_16x16x32_bf16 v[56:59], a[32:35], v[152:155], v[56:59]
    ds_read_b128 v[148:151], v3 offset:25088
    v_add_f32 v81, 1.0, v81
    v_exp_f32 v83, v83
    v_add_f32 v82, 1.0, v82
    v_mfma_f32_16x16x32_bf16 v[60:63], a[88:91], v[152:155], v[60:63]
    s_waitcnt lgkmcnt(3)
    v_exp_f32 v84, v84
    v_add_f32 v83, 1.0, v83
    v_mfma_f32_16x16x32_bf16 v[56:59], a[36:39], v[156:159], v[56:59]
    ds_read_b128 v[152:155], v3 offset:27136
    v_exp_f32 v85, v85
    v_add_f32 v84, 1.0, v84
    v_exp_f32 v86, v86
    v_mfma_f32_16x16x32_bf16 v[60:63], a[92:95], v[156:159], v[60:63]
    s_waitcnt lgkmcnt(3)
    v_add_f32 v85, 1.0, v85
    v_exp_f32 v87, v87
    v_mfma_f32_16x16x32_bf16 v[56:59], a[40:43], v[160:163], v[56:59]
    v_add_f32 v86, 1.0, v86
    v_rcp_f32 v80, v80
    v_add_f32 v87, 1.0, v87
    v_mfma_f32_16x16x32_bf16 v[60:63], a[96:99], v[160:163], v[60:63]
    s_waitcnt lgkmcnt(2)
    v_rcp_f32 v81, v81
    v_mul_f32 v48, v48, v80
    v_rcp_f32 v82, v82
    v_mfma_f32_16x16x32_bf16 v[56:59], a[44:47], v[144:147], v[56:59]
    v_mul_f32 v49, v49, v81
    v_rcp_f32 v83, v83
    v_mfma_f32_16x16x32_bf16 v[60:63], a[100:103], v[144:147], v[60:63]
    s_waitcnt lgkmcnt(1)
    v_mul_f32 v50, v50, v82
    v_rcp_f32 v84, v84
    v_mul_f32 v51, v51, v83
    v_mfma_f32_16x16x32_bf16 v[56:59], a[48:51], v[148:151], v[56:59]
    v_rcp_f32 v85, v85
    v_mul_f32 v52, v52, v84
    v_mfma_f32_16x16x32_bf16 v[60:63], a[104:107], v[148:151], v[60:63]
    s_waitcnt lgkmcnt(0)
    v_rcp_f32 v86, v86
    v_mul_f32 v53, v53, v85
    v_rcp_f32 v87, v87
    v_mfma_f32_16x16x32_bf16 v[56:59], a[52:55], v[152:155], v[56:59]
    v_mul_f32 v54, v54, v86
    v_cvt_pk_bf16_f32 v108, v48, v49
    v_mul_f32 v55, v55, v87
    v_mfma_f32_16x16x32_bf16 v[60:63], a[108:111], v[152:155], v[60:63]
    v_cvt_pk_bf16_f32 v109, v50, v51
    v_cvt_pk_bf16_f32 v110, v52, v53
    v_cvt_pk_bf16_f32 v111, v54, v55
    ds_write_b128 v4, v[108:111] offset:28672
    v_pk_fma_f32 v[56:57], v[56:57], v[46:47], v[88:89] op_sel_hi:[1,0,1]
    v_pk_fma_f32 v[58:59], v[58:59], v[46:47], v[90:91] op_sel_hi:[1,0,1]
    s_nop 1
    v_pk_fma_f32 v[60:61], v[60:61], v[46:47], v[92:93] op_sel_hi:[1,0,1]
    v_pk_fma_f32 v[62:63], v[62:63], v[46:47], v[94:95] op_sel_hi:[1,0,1]
    v_pk_mul_f32 v[88:89], v[56:57], v[56:57]
    v_pk_mul_f32 v[90:91], v[58:59], v[58:59]
    v_pk_mul_f32 v[92:93], v[60:61], v[60:61]
    v_pk_mul_f32 v[94:95], v[62:63], v[62:63]
    v_pk_fma_f32 v[88:89], v[88:89], v[42:43], v[42:43] op_sel:[0,1,0] op_sel_hi:[1,1,0]
    v_pk_fma_f32 v[90:91], v[90:91], v[42:43], v[42:43] op_sel:[0,1,0] op_sel_hi:[1,1,0]
    v_pk_fma_f32 v[92:93], v[92:93], v[42:43], v[42:43] op_sel:[0,1,0] op_sel_hi:[1,1,0]
    v_pk_fma_f32 v[94:95], v[94:95], v[42:43], v[42:43] op_sel:[0,1,0] op_sel_hi:[1,1,0]
    v_pk_mul_f32 v[88:89], v[88:89], v[56:57]
    v_pk_mul_f32 v[90:91], v[90:91], v[58:59]
    v_pk_mul_f32 v[92:93], v[92:93], v[60:61]
    v_pk_mul_f32 v[94:95], v[94:95], v[62:63]
    v_exp_f32 v88, v88
    v_exp_f32 v89, v89
    s_waitcnt vmcnt(0)
    v_cmp_gt_i32 vcc, s29, v172
    s_cbranch_vccnz LM_flw
LM_flok:
    s_waitcnt lgkmcnt(0)
    s_barrier
    ds_read_b128 v[64:67], v1 offset:28672
    ds_read_b128 v[68:71], v1 offset:30720
    ds_read_b128 v[72:75], v1 offset:32768
    ds_read_b128 v[76:79], v1 offset:34816
    v_add_f32 v88, 1.0, v88
    v_exp_f32 v90, v90
    v_add_f32 v89, 1.0, v89
    v_exp_f32 v91, v91
    v_add_f32 v90, 1.0, v90
    v_exp_f32 v92, v92
    v_add_f32 v91, 1.0, v91
    v_exp_f32 v93, v93
    s_waitcnt lgkmcnt(3)
    v_mfma_f32_16x16x32_bf16 v[116:119], v[64:67], a[112:115], 0
    v_add_f32 v92, 1.0, v92
    v_mfma_f32_16x16x32_bf16 v[120:123], v[64:67], a[128:131], 0
    v_exp_f32 v94, v94
    v_add_f32 v93, 1.0, v93
    v_mfma_f32_16x16x32_bf16 v[124:127], v[64:67], a[144:147], 0
    v_exp_f32 v95, v95
    v_mfma_f32_16x16x32_bf16 v[128:131], v[64:67], a[160:163], 0
    v_add_f32 v94, 1.0, v94
    v_rcp_f32 v88, v88
    v_mfma_f32_16x16x32_bf16 v[132:135], v[64:67], a[176:179], 0
    v_add_f32 v95, 1.0, v95
    v_rcp_f32 v89, v89
    v_mfma_f32_16x16x32_bf16 v[136:139], v[64:67], a[192:195], 0
    v_mul_f32 v56, v56, v88
    v_mfma_f32_16x16x32_bf16 v[140:143], v[64:67], a[208:211], 0
    s_waitcnt lgkmcnt(2)
    v_rcp_f32 v90, v90
    v_mul_f32 v57, v57, v89
    v_mfma_f32_16x16x32_bf16 v[116:119], v[68:71], a[116:119], v[116:119]
    v_rcp_f32 v91, v91
    v_mfma_f32_16x16x32_bf16 v[120:123], v[68:71], a[132:135], v[120:123]
    v_mul_f32 v58, v58, v90
    v_rcp_f32 v92, v92
    v_mfma_f32_16x16x32_bf16 v[124:127], v[68:71], a[148:151], v[124:127]
    v_mul_f32 v59, v59, v91
    v_rcp_f32 v93, v93
    v_mfma_f32_16x16x32_bf16 v[128:131], v[68:71], a[164:167], v[128:131]
    v_mul_f32 v60, v60, v92
    v_mfma_f32_16x16x32_bf16 v[132:135], v[68:71], a[180:183], v[132:135]
    v_rcp_f32 v94, v94
    v_mul_f32 v61, v61, v93
    v_mfma_f32_16x16x32_bf16 v[136:139], v[68:71], a[196:199], v[136:139]
    v_rcp_f32 v95, v95
    v_mfma_f32_16x16x32_bf16 v[140:143], v[68:71], a[212:215], v[140:143]
    s_waitcnt lgkmcnt(1)
    v_mul_f32 v62, v62, v94
    v_cvt_pk_bf16_f32 v112, v56, v57
    v_mfma_f32_16x16x32_bf16 v[116:119], v[72:75], a[120:123], v[116:119]
    v_mul_f32 v63, v63, v95
    v_cvt_pk_bf16_f32 v113, v58, v59
    v_mfma_f32_16x16x32_bf16 v[120:123], v[72:75], a[136:139], v[120:123]
    v_cvt_pk_bf16_f32 v114, v60, v61
    v_mfma_f32_16x16x32_bf16 v[124:127], v[72:75], a[152:155], v[124:127]
    v_cvt_pk_bf16_f32 v115, v62, v63
    ds_write_b128 v4, v[112:115] offset:29696
    v_mfma_f32_16x16x32_bf16 v[128:131], v[72:75], a[168:171], v[128:131]
    v_mfma_f32_16x16x32_bf16 v[132:135], v[72:75], a[184:187], v[132:135]
    s_add_u32 s58, s29, 1
    v_mov_b32 v10, s58
    s_mov_b64 exec, 1
    buffer_store_dword v10, off, s[8:11], s34
    s_mov_b64 exec, -1
    v_mfma_f32_16x16x32_bf16 v[136:139], v[72:75], a[200:203], v[136:139]
    v_mfma_f32_16x16x32_bf16 v[140:143], v[72:75], a[216:219], v[140:143]
    s_waitcnt lgkmcnt(1)
    v_mfma_f32_16x16x32_bf16 v[116:119], v[76:79], a[124:127], v[116:119]
    v_mfma_f32_16x16x32_bf16 v[120:123], v[76:79], a[140:143], v[120:123]
    s_waitcnt lgkmcnt(0)
    s_barrier
    v_mfma_f32_16x16x32_bf16 v[124:127], v[76:79], a[156:159], v[124:127]
    ds_read_b128 v[176:179], v1 offset:29696
    v_mfma_f32_16x16x32_bf16 v[128:131], v[76:79], a[172:175], v[128:131]
    ds_read_b128 v[180:183], v1 offset:31744
    v_mfma_f32_16x16x32_bf16 v[132:135], v[76:79], a[188:191], v[132:135]
    ds_read_b128 v[184:187], v1 offset:33792
    v_mfma_f32_16x16x32_bf16 v[136:139], v[76:79], a[204:207], v[136:139]
    ds_read_b128 v[188:191], v1 offset:35840
    v_mfma_f32_16x16x32_bf16 v[140:143], v[76:79], a[220:223], v[140:143]
    s_waitcnt lgkmcnt(3)
    v_mfma_f32_16x16x32_bf16 v[192:195], v[176:179], a[112:115], 0
    v_mfma_f32_16x16x32_bf16 v[196:199], v[176:179], a[128:131], 0
    v_cvt_pk_bf16_f32 v144, v116, v120
    v_mfma_f32_16x16x32_bf16 v[200:203], v[176:179], a[144:147], 0
    v_cvt_pk_bf16_f32 v145, v124, v128
    v_mfma_f32_16x16x32_bf16 v[204:207], v[176:179], a[160:163], 0
    v_cvt_pk_bf16_f32 v146, v132, v136
    v_mfma_f32_16x16x32_bf16 v[208:211], v[176:179], a[176:179], 0
    v_cvt_pk_bf16_f32 v147, v140, s27
    v_mfma_f32_16x16x32_bf16 v[212:215], v[176:179], a[192:195], 0
    buffer_store_dwordx4 v[144:147], v7, s[8:11], s98 offen offset:0
    v_mfma_f32_16x16x32_bf16 v[216:219], v[176:179], a[208:211], 0
    s_waitcnt lgkmcnt(2)
    v_cvt_pk_bf16_f32 v148, v117, v121
    v_mfma_f32_16x16x32_bf16 v[192:195], v[180:183], a[116:119], v[192:195]
    v_cvt_pk_bf16_f32 v149, v125, v129
    v_mfma_f32_16x16x32_bf16 v[196:199], v[180:183], a[132:135], v[196:199]
    v_cvt_pk_bf16_f32 v150, v133, v137
    v_mfma_f32_16x16x32_bf16 v[200:203], v[180:183], a[148:151], v[200:203]
    v_cvt_pk_bf16_f32 v151, v141, s27
    v_mfma_f32_16x16x32_bf16 v[204:207], v[180:183], a[164:167], v[204:207]
    buffer_store_dwordx4 v[148:151], v7, s[8:11], s98 offen offset:1024
    v_mfma_f32_16x16x32_bf16 v[208:211], v[180:183], a[180:183], v[208:211]
    v_cvt_pk_bf16_f32 v152, v118, v122
    v_mfma_f32_16x16x32_bf16 v[212:215], v[180:183], a[196:199], v[212:215]
    v_cvt_pk_bf16_f32 v153, v126, v130
    v_mfma_f32_16x16x32_bf16 v[216:219], v[180:183], a[212:215], v[216:219]
    s_waitcnt lgkmcnt(1)
    v_cvt_pk_bf16_f32 v154, v134, v138
    v_mfma_f32_16x16x32_bf16 v[192:195], v[184:187], a[120:123], v[192:195]
    v_cvt_pk_bf16_f32 v155, v142, s27
    v_mfma_f32_16x16x32_bf16 v[196:199], v[184:187], a[136:139], v[196:199]
    buffer_store_dwordx4 v[152:155], v7, s[8:11], s98 offen offset:2048
    v_mfma_f32_16x16x32_bf16 v[200:203], v[184:187], a[152:155], v[200:203]
    v_cvt_pk_bf16_f32 v156, v119, v123
    v_mfma_f32_16x16x32_bf16 v[204:207], v[184:187], a[168:171], v[204:207]
    v_cvt_pk_bf16_f32 v157, v127, v131
    v_mfma_f32_16x16x32_bf16 v[208:211], v[184:187], a[184:187], v[208:211]
    v_cvt_pk_bf16_f32 v158, v135, v139
    v_mfma_f32_16x16x32_bf16 v[212:215], v[184:187], a[200:203], v[212:215]
    v_cvt_pk_bf16_f32 v159, v143, s27
    v_mfma_f32_16x16x32_bf16 v[216:219], v[184:187], a[216:219], v[216:219]
    buffer_store_dwordx4 v[156:159], v7, s[8:11], s98 offen offset:3072
    s_waitcnt lgkmcnt(0)
    v_mfma_f32_16x16x32_bf16 v[192:195], v[188:191], a[124:127], v[192:195]
    v_mfma_f32_16x16x32_bf16 v[196:199], v[188:191], a[140:143], v[196:199]
    v_mfma_f32_16x16x32_bf16 v[200:203], v[188:191], a[156:159], v[200:203]
    v_mfma_f32_16x16x32_bf16 v[204:207], v[188:191], a[172:175], v[204:207]
    v_mfma_f32_16x16x32_bf16 v[208:211], v[188:191], a[188:191], v[208:211]
    v_mfma_f32_16x16x32_bf16 v[212:215], v[188:191], a[204:207], v[212:215]
    v_mfma_f32_16x16x32_bf16 v[216:219], v[188:191], a[220:223], v[216:219]
    v_cvt_pk_bf16_f32 v144, v192, v196
    v_cvt_pk_bf16_f32 v145, v200, v204
    s_nop 1
    v_cvt_pk_bf16_f32 v146, v208, v212
    s_nop 2
    v_cvt_pk_bf16_f32 v147, v216, s27
    buffer_store_dwordx4 v[144:147], v7, s[8:11], s99 offen offset:0
    v_cvt_pk_bf16_f32 v148, v193, v197
    v_cvt_pk_bf16_f32 v149, v201, v205
    v_cvt_pk_bf16_f32 v150, v209, v213
    v_cvt_pk_bf16_f32 v151, v217, s27
    buffer_store_dwordx4 v[148:151], v7, s[8:11], s99 offen offset:1024
    v_cvt_pk_bf16_f32 v152, v194, v198
    v_cvt_pk_bf16_f32 v153, v202, v206
    v_cvt_pk_bf16_f32 v154, v210, v214
    v_cvt_pk_bf16_f32 v155, v218, s27
    buffer_store_dwordx4 v[152:155], v7, s[8:11], s99 offen offset:2048
    v_cvt_pk_bf16_f32 v156, v195, v199
    v_cvt_pk_bf16_f32 v157, v203, v207
    v_cvt_pk_bf16_f32 v158, v211, v215
    v_cvt_pk_bf16_f32 v159, v219, s27
    buffer_store_dwordx4 v[156:159], v7, s[8:11], s99 offen offset:3072
LM_red:
    v_lshlrev_b32 v96, 16, v168
    v_and_b32 v97, 0xffff0000, v168
    v_lshlrev_b32 v98, 16, v169
    v_and_b32 v99, 0xffff0000, v169
    v_lshlrev_b32 v100, 16, v170
    v_and_b32 v101, 0xffff0000, v170
    v_lshlrev_b32 v102, 16, v171
    v_and_b32 v103, 0xffff0000, v171
    v_pk_add_f32 v[96:97], v[96:97], v[32:33]
    v_pk_add_f32 v[98:99], v[98:99], v[34:35]
    v_pk_add_f32 v[100:101], v[100:101], v[36:37]
    v_pk_add_f32 v[102:103], v[102:103], v[38:39]
    v_mov_b32 v40, 0
    v_mov_b32 v41, 0
    s_mov_b32 s70, 0
    s_cmp_eq_u32 s71, 0
    s_cbranch_scc1 LM_pfull
    s_waitcnt vmcnt(0)
    s_cmp_eq_u32 s71, 1
    s_cbranch_scc1 LM_pfull
LM_plight:
    buffer_load_dword v64, v173, s[8:11], s51 offen sc1
    s_add_u32 s70, s70, 1
    s_cmp_gt_u32 s70, 131072
    s_cbranch_scc1 Lfail
    s_waitcnt vmcnt(0)
    v_cmp_gt_u32 vcc, s27, v64
    s_cbranch_vccnz LM_plight
LM_pfull:
    buffer_load_dwordx4 v[64:67], v1, s[8:11], s51 offen sc1
    buffer_load_dwordx4 v[68:71], v1, s[8:11], s52 offen sc1
    buffer_load_dwordx4 v[72:75], v1, s[8:11], s53 offen sc1
    buffer_load_dwordx4 v[76:79], v1, s[8:11], s54 offen sc1
    buffer_load_dwordx4 v[80:83], v1, s[8:11], s55 offen sc1
    buffer_load_dwordx4 v[84:87], v1, s[8:11], s56 offen sc1
    buffer_load_dwordx4 v[88:91], v1, s[8:11], s57 offen sc1
    s_waitcnt vmcnt(6)
    v_cmp_gt_u32 vcc, s27, v67
    s_cbranch_vccnz LM_pr0
LM_pk0:
    s_waitcnt vmcnt(5)
    v_cmp_gt_u32 vcc, s27, v71
    v_dot2_f32_bf16 v48, v64, v14, 0
    v_dot2_f32_bf16 v49, v64, v15, 0
    v_dot2_f32_bf16 v50, v65, v14, 0
    v_dot2_f32_bf16 v51, v65, v15, 0
    v_dot2_f32_bf16 v52, v66, v14, 0
    v_dot2_f32_bf16 v53, v66, v15, 0
    v_dot2_f32_bf16 v54, v67, v14, 0
    s_cbranch_vccnz LM_pr1
LM_pk1:
    s_waitcnt vmcnt(4)
    v_cmp_gt_u32 vcc, s27, v75
    v_dot2_f32_bf16 v48, v68, v14, v48
    v_dot2_f32_bf16 v49, v68, v15, v49
    v_dot2_f32_bf16 v50, v69, v14, v50
    v_dot2_f32_bf16 v51, v69, v15, v51
    v_dot2_f32_bf16 v52, v70, v14, v52
    v_dot2_f32_bf16 v53, v70, v15, v53
    v_dot2_f32_bf16 v54, v71, v14, v54
    s_cbranch_vccnz LM_pr2
LM_pk2:
    s_waitcnt vmcnt(3)
    v_cmp_gt_u32 vcc, s27, v79
    v_dot2_f32_bf16 v48, v72, v14, v48
    v_dot2_f32_bf16 v49, v72, v15, v49
    v_dot2_f32_bf16 v50, v73, v14, v50
    v_dot2_f32_bf16 v51, v73, v15, v51
    v_dot2_f32_bf16 v52, v74, v14, v52
    v_dot2_f32_bf16 v53, v74, v15, v53
    v_dot2_f32_bf16 v54, v75, v14, v54
    s_cbranch_vccnz LM_pr3
LM_pk3:
    s_waitcnt vmcnt(2)
    v_cmp_gt_u32 vcc, s27, v83
    v_dot2_f32_bf16 v48, v76, v14, v48
    v_dot2_f32_bf16 v49, v76, v15, v49
    v_dot2_f32_bf16 v50, v77, v14, v50
    v_dot2_f32_bf16 v51, v77, v15, v51
    v_dot2_f32_bf16 v52, v78, v14, v52
    v_dot2_f32_bf16 v53, v78, v15, v53
    v_dot2_f32_bf16 v54, v79, v14, v54
    s_cbranch_vccnz LM_pr4
LM_pk4:
    s_waitcnt vmcnt(1)
    v_cmp_gt_u32 vcc, s27, v87
    v_dot2_f32_bf16 v48, v80, v14, v48
    v_dot2_f32_bf16 v49, v80, v15, v49
    v_dot2_f32_bf16 v50, v81, v14, v50
    v_dot2_f32_bf16 v51, v81, v15, v51
    v_dot2_f32_bf16 v52, v82, v14, v52
    v_dot2_f32_bf16 v53, v82, v15, v53
    v_dot2_f32_bf16 v54, v83, v14, v54
    s_cbranch_vccnz LM_pr5
LM_pk5:
    s_waitcnt vmcnt(0)
    v_cmp_gt_u32 vcc, s27, v91
    v_dot2_f32_bf16 v48, v84, v14, v48
    v_dot2_f32_bf16 v49, v84, v15, v49
    v_dot2_f32_bf16 v50, v85, v14, v50
    v_dot2_f32_bf16 v51, v85, v15, v51
    v_dot2_f32_bf16 v52, v86, v14, v52
    v_dot2_f32_bf16 v53, v86, v15, v53
    v_dot2_f32_bf16 v54, v87, v14, v54
    s_cbranch_vccnz LM_pr6
LM_pk6:
    v_dot2_f32_bf16 v48, v88, v14, v48
    v_dot2_f32_bf16 v49, v88, v15, v49
    v_dot2_f32_bf16 v50, v89, v14, v50
    v_dot2_f32_bf16 v51, v89, v15, v51
    v_dot2_f32_bf16 v52, v90, v14, v52
    v_dot2_f32_bf16 v53, v90, v15, v53
    v_dot2_f32_bf16 v54, v91, v14, v54
    ds_write2_b32 v11, v48, v49 offset0:0 offset1:16
    ds_write2_b32 v11, v50, v51 offset0:32 offset1:48
    ds_write2_b32 v11, v52, v53 offset0:64 offset1:80
    ds_write_b32 v11, v54 offset:384
    s_cmp_lg_u32 s71, 0
    s_cbranch_scc1 LM_nodma
    s_mul_i32 s58, s64, 14336
    s_add_u32 m0, s58, 0
    s_add_u32 s58, s58, s32
    s_add_u32 s58, s58, 57344
    buffer_load_dwordx4 v1, s[8:11], s58 offen offset:0 sc1 lds
    buffer_load_dwordx4 v1, s[8:11], s58 offen offset:1024 sc1 lds
    buffer_load_dwordx4 v1, s[8:11], s58 offen offset:2048 sc1 lds
    buffer_load_dwordx4 v1, s[8:11], s58 offen offset:3072 sc1 lds
    s_add_u32 m0, m0, 4096
    s_add_u32 s58, s58, 4096
    buffer_load_dwordx4 v1, s[8:11], s58 offen offset:0 sc1 lds
    buffer_load_dwordx4 v1, s[8:11], s58 offen offset:1024 sc1 lds
    buffer_load_dwordx4 v1, s[8:11], s58 offen offset:2048 sc1 lds
    buffer_load_dwordx4 v1, s[8:11], s58 offen offset:3072 sc1 lds
    s_add_u32 m0, m0, 4096
    s_add_u32 s58, s58, 4096
    buffer_load_dwordx4 v1, s[8:11], s58 offen offset:0 sc1 lds
    buffer_load_dwordx4 v1, s[8:11], s58 offen offset:1024 sc1 lds
    buffer_load_dwordx4 v1, s[8:11], s58 offen offset:2048 sc1 lds
    buffer_load_dwordx4 v1, s[8:11], s58 offen offset:3072 sc1 lds
    s_add_u32 m0, m0, 4096
    s_add_u32 s58, s58, 4096
    buffer_load_dwordx4 v1, s[8:11], s58 offen offset:0 sc1 lds
    buffer_load_dwordx4 v1, s[8:11], s58 offen offset:1024 sc1 lds
LM_nodma:
    s_waitcnt lgkmcnt(0)
    s_barrier
    s_mov_b64 exec, s[68:69]
    ds_read_b128 v[104:107], v12 offset:0
    ds_read_b128 v[108:111], v12 offset:16
    ds_read_b128 v[112:115], v12 offset:3584
    ds_read_b128 v[116:119], v12 offset:3600
    s_waitcnt lgkmcnt(3)
    v_pk_add_f32 v[96:97], v[96:97], v[104:105]
    v_pk_add_f32 v[98:99], v[98:99], v[106:107]
    s_waitcnt lgkmcnt(2)
    v_pk_add_f32 v[100:101], v[100:101], v[108:109]
    v_pk_add_f32 v[102:103], v[102:103], v[110:111]
    s_waitcnt lgkmcnt(1)
    v_pk_add_f32 v[96:97], v[96:97], v[112:113]
    v_pk_add_f32 v[98:99], v[98:99], v[114:115]
    s_waitcnt lgkmcnt(0)
    v_pk_add_f32 v[100:101], v[100:101], v[116:117]
    v_pk_add_f32 v[102:103], v[102:103], v[118:119]
    s_cmp_eq_u32 s64, 0
    s_cbranch_scc0 LM_ln
    v_cvt_pk_bf16_f32 v104, v96, v97
    v_cvt_pk_bf16_f32 v105, v98, v99
    v_cvt_pk_bf16_f32 v106, v100, v101
    v_cvt_pk_bf16_f32 v107, v102, v103
    s_cmp_eq_u32 s23, 0
    s_cbranch_scc1 LM_xb
    buffer_store_dwordx4 v[104:107], v1, s[12:15], s49 offen
    s_branch LM_next
LM_idle:
    s_waitcnt vmcnt(0)
    s_branch LM_next
LM_xb:
    buffer_store_dwordx4 v[104:107], v1, s[12:15], s49 offen sc1
    s_branch LM_next
LM_ln:
    s_cmp_eq_u32 s23, 0
    s_cbranch_scc0 LM_idle
    v_pk_add_f32 v[104:105], v[96:97], v[98:99]
    v_pk_mul_f32 v[106:107], v[96:97], v[96:97]
    v_pk_add_f32 v[104:105], v[104:105], v[100:101]
    v_pk_fma_f32 v[106:107], v[98:99], v[98:99], v[106:107]
    v_pk_add_f32 v[104:105], v[104:105], v[102:103]
    v_pk_fma_f32 v[106:107], v[100:101], v[100:101], v[106:107]
    v_add_f32 v40, v104, v105
    v_pk_fma_f32 v[106:107], v[102:103], v[102:103], v[106:107]
    v_add_f32 v41, v106, v107
    s_mov_b64 exec, -1
    s_nop 0
    v_permlane16_swap_b32 v40, v41
    v_add_f32 v40, v40, v41
    v_mov_b32 v41, v40
    s_nop 1
    v_permlane32_swap_b32 v40, v41
    v_add_f32 v40, v40, v41
    s_nop 1
    v_add_f32_dpp v40, v40, v40 row_ror:8 row_mask:0xf bank_mask:0xf
    s_nop 1
    v_add_f32_dpp v40, v40, v40 row_ror:4 row_mask:0xf bank_mask:0xf
    s_nop 1
    v_add_f32_dpp v40, v40, v40 row_ror:2 row_mask:0xf bank_mask:0xf
    s_nop 1
    v_add_f32_dpp v40, v40, v40 row_ror:1 row_mask:0xf bank_mask:0xf
    v_mul_f32 v40, s60, v40
    s_nop 0
    v_readlane_b32 s58, v40, 0
    v_readlane_b32 s59, v40, 16
    s_nop 0
    v_mov_b32 v42, s58
    v_fma_f32 v40, -v42, v42, s59
    v_max_f32 v40, 0, v40
    v_add_f32 v40, s61, v40
    v_rsq_f32 v40, v40
    v_pk_add_f32 v[96:97], v[96:97], v[42:43] op_sel_hi:[1,0] neg_lo:[0,1] neg_hi:[0,1]
    v_pk_add_f32 v[98:99], v[98:99], v[42:43] op_sel_hi:[1,0] neg_lo:[0,1] neg_hi:[0,1]
    v_pk_add_f32 v[100:101], v[100:101], v[42:43] op_sel_hi:[1,0] neg_lo:[0,1] neg_hi:[0,1]
    v_pk_add_f32 v[102:103], v[102:103], v[42:43] op_sel_hi:[1,0] neg_lo:[0,1] neg_hi:[0,1]
    v_pk_mul_f32 v[96:97], v[96:97], v[40:41] op_sel_hi:[1,0]
    v_pk_mul_f32 v[98:99], v[98:99], v[40:41] op_sel_hi:[1,0]
    v_pk_mul_f32 v[100:101], v[100:101], v[40:41] op_sel_hi:[1,0]
    v_pk_mul_f32 v[102:103], v[102:103], v[40:41] op_sel_hi:[1,0]
    v_cvt_pk_bf16_f32 v104, v96, v97
    v_cvt_pk_bf16_f32 v105, v98, v99
    v_cvt_pk_bf16_f32 v106, v100, v101
    v_cvt_pk_bf16_f32 v107, v102, v103
    s_mov_b64 exec, s[68:69]
    buffer_store_dwordx4 v[104:107], v1, s[8:11], s50 offen sc1
LM_next:
    s_mov_b64 exec, -1
    s_add_u32 s28, s28, 2
    s_add_u32 s29, s29, 1
    s_add_u32 s32, s32, 57344
    s_cmp_lt_u32 s28, 64
    s_cbranch_scc1 LM_job
    s_branch Ldone
LM_flw:
    s_mov_b32 s70, 0
Lpoll_120:
    buffer_load_dword v172, v8, s[8:11], s35 offen sc1
    s_add_u32 s70, s70, 1
    s_cmp_gt_u32 s70, 131072
    s_cbranch_scc1 Lfail
    s_waitcnt vmcnt(0)
    v_cmp_gt_i32 vcc, s29, v172
    s_cbranch_vccnz Lpoll_120
    s_branch LM_flok
LM_pr0:
    buffer_load_dwordx4 v[64:67], v1, s[8:11], s51 offen sc1
    buffer_load_dwordx4 v[68:71], v1, s[8:11], s52 offen sc1
    buffer_load_dwordx4 v[72:75], v1, s[8:11], s53 offen sc1
    buffer_load_dwordx4 v[76:79], v1, s[8:11], s54 offen sc1
    buffer_load_dwordx4 v[80:83], v1, s[8:11], s55 offen sc1
    buffer_load_dwordx4 v[84:87], v1, s[8:11], s56 offen sc1
    buffer_load_dwordx4 v[88:91], v1, s[8:11], s57 offen sc1
    s_add_u32 s70, s70, 1
    s_cmp_gt_u32 s70, 131072
    s_cbranch_scc1 Lfail
    s_waitcnt vmcnt(6)
    v_cmp_gt_u32 vcc, s27, v67
    s_cbranch_vccnz LM_pr0
    s_branch LM_pk0
LM_pr1:
    buffer_load_dwordx4 v[68:71], v1, s[8:11], s52 offen sc1
    buffer_load_dwordx4 v[72:75], v1, s[8:11], s53 offen sc1
    buffer_load_dwordx4 v[76:79], v1, s[8:11], s54 offen sc1
    buffer_load_dwordx4 v[80:83], v1, s[8:11], s55 offen sc1
    buffer_load_dwordx4 v[84:87], v1, s[8:11], s56 offen sc1
    buffer_load_dwordx4 v[88:91], v1, s[8:11], s57 offen sc1
    s_add_u32 s70, s70, 1
    s_cmp_gt_u32 s70, 131072
    s_cbranch_scc1 Lfail
    s_waitcnt vmcnt(5)
    v_cmp_gt_u32 vcc, s27, v71
    s_cbranch_vccnz LM_pr1
    s_branch LM_pk1
LM_pr2:
    buffer_load_dwordx4 v[72:75], v1, s[8:11], s53 offen sc1
    buffer_load_dwordx4 v[76:79], v1, s[8:11], s54 offen sc1
    buffer_load_dwordx4 v[80:83], v1, s[8:11], s55 offen sc1
    buffer_load_dwordx4 v[84:87], v1, s[8:11], s56 offen sc1
    buffer_load_dwordx4 v[88:91], v1, s[8:11], s57 offen sc1
    s_add_u32 s70, s70, 1
    s_cmp_gt_u32 s70, 131072
    s_cbranch_scc1 Lfail
    s_waitcnt vmcnt(4)
    v_cmp_gt_u32 vcc, s27, v75
    s_cbranch_vccnz LM_pr2
    s_branch LM_pk2
LM_pr3:
    buffer_load_dwordx4 v[76:79], v1, s[8:11], s54 offen sc1
    buffer_load_dwordx4 v[80:83], v1, s[8:11], s55 offen sc1
    buffer_load_dwordx4 v[84:87], v1, s[8:11], s56 offen sc1
    buffer_load_dwordx4 v[88:91], v1, s[8:11], s57 offen sc1
    s_add_u32 s70, s70, 1
    s_cmp_gt_u32 s70, 131072
    s_cbranch_scc1 Lfail
    s_waitcnt vmcnt(3)
    v_cmp_gt_u32 vcc, s27, v79
    s_cbranch_vccnz LM_pr3
    s_branch LM_pk3
LM_pr4:
    buffer_load_dwordx4 v[80:83], v1, s[8:11], s55 offen sc1
    buffer_load_dwordx4 v[84:87], v1, s[8:11], s56 offen sc1
    buffer_load_dwordx4 v[88:91], v1, s[8:11], s57 offen sc1
    s_add_u32 s70, s70, 1
    s_cmp_gt_u32 s70, 131072
    s_cbranch_scc1 Lfail
    s_waitcnt vmcnt(2)
    v_cmp_gt_u32 vcc, s27, v83
    s_cbranch_vccnz LM_pr4
    s_branch LM_pk4
LM_pr5:
    buffer_load_dwordx4 v[84:87], v1, s[8:11], s56 offen sc1
    buffer_load_dwordx4 v[88:91], v1, s[8:11], s57 offen sc1
    s_add_u32 s70, s70, 1
    s_cmp_gt_u32 s70, 131072
    s_cbranch_scc1 Lfail
    s_waitcnt vmcnt(1)
    v_cmp_gt_u32 vcc, s27, v87
    s_cbranch_vccnz LM_pr5
    s_branch LM_pk5
LM_pr6:
    buffer_load_dwordx4 v[88:91], v1, s[8:11], s57 offen sc1
    s_add_u32 s70, s70, 1
    s_cmp_gt_u32 s70, 131072
    s_cbranch_scc1 Lfail
    s_waitcnt vmcnt(0)
    v_cmp_gt_u32 vcc, s27, v91
    s_cbranch_vccnz LM_pr6
    s_branch LM_pk6
Lvwait_2:
    s_mov_b32 s70, 0
Lpoll_121:
    s_sleep 2
    v_mov_b32 v28, 132
    global_load_dword v28, v28, s[46:47] sc1
    s_add_u32 s70, s70, 1
    s_cmp_gt_u32 s70, 131072
    s_cbranch_scc1 Lfail
    s_waitcnt vmcnt(0)
    v_cmp_eq_u32 vcc, 0, v28
    s_cbranch_vccnz Lpoll_121
    s_branch Lvok_1
Lvwait_10:
    s_mov_b32 s70, 0
Lpoll_122:
    s_sleep 2
    v_mov_b32 v13, 132
    global_load_dword v13, v13, s[46:47] sc1
    s_add_u32 s70, s70, 1
    s_cmp_gt_u32 s70, 131072
    s_cbranch_scc1 Lfail
    s_waitcnt vmcnt(0)
    v_cmp_eq_u32 vcc, 0, v13
    s_cbranch_vccnz Lpoll_122
    s_branch Lvok_9
Lvwait_12:
    s_mov_b32 s70, 0
Lpoll_123:
    s_sleep 2
    v_mov_b32 v114, 132
    global_load_dword v114, v114, s[46:47] sc1
    s_add_u32 s70, s70, 1
    s_cmp_gt_u32 s70, 131072
    s_cbranch_scc1 Lfail
    s_waitcnt vmcnt(0)
    v_cmp_eq_u32 vcc, 0, v114
    s_cbranch_vccnz Lpoll_123
    s_branch Lvok_11
Lvwait_14:
    s_mov_b32 s70, 0
Lpoll_124:
    s_sleep 2
    v_bfe_u32 v115, v1, 2, 6
    buffer_load_dword v115, v115, s[8:11], s43 offen sc1
    s_add_u32 s70, s70, 1
    s_cmp_gt_u32 s70, 131072
    s_cbranch_scc1 Lfail
    s_waitcnt vmcnt(0)
    v_cmp_eq_u32 vcc, -1, v115
    s_cbranch_vccnz Lpoll_124
    s_branch Lvok_13
Lvwait_16:
    s_mov_b32 s70, 0
Lpoll_125:
    s_sleep 2
    v_lshrrev_b32 v112, 1, v1
    buffer_load_dwordx2 v[112:113], v112, s[8:11], s39 offen sc1
    s_add_u32 s70, s70, 1
    s_cmp_gt_u32 s70, 131072
    s_cbranch_scc1 Lfail
    s_waitcnt vmcnt(0)
    v_max_u32 v114, v112, v113
    v_cmp_eq_u32 vcc, -1, v114
    s_cbranch_vccnz Lpoll_125
    s_branch Lvok_15
Lvwait_18:
    s_mov_b32 s70, 0
Lpoll_126:
    s_sleep 2
    v_lshrrev_b32 v112, 1, v1
    buffer_load_dwordx2 v[112:113], v112, s[8:11], s35 offen sc1
    s_add_u32 s70, s70, 1
    s_cmp_gt_u32 s70, 131072
    s_cbranch_scc1 Lfail
    s_waitcnt vmcnt(0)
    v_max_u32 v114, v112, v113
    v_cmp_eq_u32 vcc, -1, v114
    s_cbranch_vccnz Lpoll_126
    s_branch Lvok_17
Lvwait_20:
    s_mov_b32 s70, 0
Lpoll_127:
    s_sleep 2
    v_mov_b32 v114, 132
    global_load_dword v114, v114, s[46:47] sc1
    s_add_u32 s70, s70, 1
    s_cmp_gt_u32 s70, 131072
    s_cbranch_scc1 Lfail
    s_waitcnt vmcnt(0)
    v_cmp_eq_u32 vcc, 0, v114
    s_cbranch_vccnz Lpoll_127
    s_branch Lvok_19
Lvwait_22:
    s_mov_b32 s70, 0
Lpoll_128:
    s_sleep 2
    v_bfe_u32 v115, v1, 2, 6
    buffer_load_dword v115, v115, s[8:11], s43 offen sc1
    s_add_u32 s70, s70, 1
    s_cmp_gt_u32 s70, 131072
    s_cbranch_scc1 Lfail
    s_waitcnt vmcnt(0)
    v_cmp_eq_u32 vcc, -1, v115
    s_cbranch_vccnz Lpoll_128
    s_branch Lvok_21
Lvwait_24:
    s_mov_b32 s70, 0
Lpoll_129:
    s_sleep 2
    v_lshrrev_b32 v112, 1, v1
    buffer_load_dwordx2 v[112:113], v112, s[8:11], s39 offen sc1
    s_add_u32 s70, s70, 1
    s_cmp_gt_u32 s70, 131072
    s_cbranch_scc1 Lfail
    s_waitcnt vmcnt(0)
    v_max_u32 v114, v112, v113
    v_cmp_eq_u32 vcc, -1, v114
    s_cbranch_vccnz Lpoll_129
    s_branch Lvok_23
Lvwait_26:
    s_mov_b32 s70, 0
Lpoll_130:
    s_sleep 2
    v_lshrrev_b32 v112, 1, v1
    buffer_load_dwordx2 v[112:113], v112, s[8:11], s35 offen sc1
    s_add_u32 s70, s70, 1
    s_cmp_gt_u32 s70, 131072
    s_cbranch_scc1 Lfail
    s_waitcnt vmcnt(0)
    v_max_u32 v114, v112, v113
    v_cmp_eq_u32 vcc, -1, v114
    s_cbranch_vccnz Lpoll_130
    s_branch Lvok_25
Lvwait_114:
    s_mov_b32 s70, 0
Lpoll_131:
    s_sleep 2
    v_mov_b32 v56, 132
    global_load_dword v56, v56, s[46:47] sc1
    s_add_u32 s70, s70, 1
    s_cmp_gt_u32 s70, 131072
    s_cbranch_scc1 Lfail
    s_waitcnt vmcnt(0)
    v_cmp_eq_u32 vcc, 0, v56
    s_cbranch_vccnz Lpoll_131
    s_branch Lvok_113
Lvwait_116:
    s_mov_b32 s70, 0
Lpoll_132:
    s_sleep 2
    v_lshrrev_b32 v56, 1, v1
    buffer_load_dwordx2 v[56:57], v56, s[8:11], s59 offen sc1
    s_add_u32 s70, s70, 1
    s_cmp_gt_u32 s70, 131072
    s_cbranch_scc1 Lfail
    s_waitcnt vmcnt(0)
    v_max_u32 v58, v56, v57
    v_cmp_eq_u32 vcc, -1, v58
    s_cbranch_vccnz Lpoll_132
    s_branch Lvok_115
Lvwait_118:
    s_mov_b32 s70, 0
Lpoll_133:
    s_sleep 2
    v_lshrrev_b32 v56, 1, v1
    buffer_load_dwordx2 v[56:57], v56, s[8:11], s3 offen sc1
    s_add_u32 s70, s70, 1
    s_cmp_gt_u32 s70, 131072
    s_cbranch_scc1 Lfail
    s_waitcnt vmcnt(0)
    v_max_u32 v58, v56, v57
    v_cmp_eq_u32 vcc, -1, v58
    s_cbranch_vccnz Lpoll_133
    s_branch Lvok_117
Lfail:
    s_mov_b64 exec, 1
    v_mov_b32 v2, 20
    v_mov_b32 v3, 1
    global_atomic_add v2, v3, s[46:47]
    s_endpgm
Ldone:
Lend:
    s_endpgm

.section .rodata,"a"
.p2align 6
.amdhsa_kernel interleave_layers__memory_aug_recurrent_mem_tr__mixer_channel_mlp__prompt_kernel
  .amdhsa_next_free_vgpr 512
  .amdhsa_next_free_sgpr 102
  .amdhsa_accum_offset 256
  .amdhsa_group_segment_fixed_size 0
  .amdhsa_kernarg_size 120
  .amdhsa_user_sgpr_count 2
  .amdhsa_user_sgpr_kernarg_segment_ptr 1
  .amdhsa_system_sgpr_workgroup_id_x 1
  .amdhsa_float_denorm_mode_32 3
.end_amdhsa_kernel
```
